```python
import torch

def _softmax(x, axis=-1):
    return torch.softmax(x, dim=axis)
def _gelu(x):
    return torch.nn.functional.gelu(x, approximate="tanh")
def _silu(x):
    return torch.nn.functional.silu(x)
def _sigmoid(x):
    return torch.sigmoid(x)
def _layernorm(x, axis=-1, eps=1e-5):
    m = x.mean(dim=axis, keepdim=True)
    v = x.var(dim=axis, keepdim=True, unbiased=False)
    return (x - m) / torch.sqrt(v + eps)
def _scatter_add(tgt, idx, src, axis=0):
    return tgt.clone().index_add_(axis, idx, src)
def _segment_sum(src, seg, n):
    out = torch.zeros((n,) + src.shape[1:], dtype=src.dtype)
    return out.index_add_(0, seg, src)
def _pad(x, pw):
    flat = tuple(v for pair in reversed(pw) for v in pair)
    return torch.nn.functional.pad(x, flat)

kernel_name = 'interleave_layers__linear_attn_block__dense_activation_silu__prompt'

def setup_inputs():

    _w = (lambda a: (lambda t: t.to(torch.bfloat16) if t.is_floating_point() else t)(torch.as_tensor(a)))
    def _A_setup():
        B, S, D = 1, 2048, 448
        return {
            "x": _w((lambda *s: torch.randn(*s, dtype=torch.bfloat16) * 0.05)(B, S, D)),
            "wqkv": _w((lambda *s: torch.randn(*s, dtype=torch.bfloat16) * 0.1)(D, 3 * D)),
            "wo": _w((lambda *s: torch.randn(*s, dtype=torch.bfloat16) * 0.05)(D, D)),
        }
    _A_in = _A_setup()

    def _B_setup():
        B, S, D, F = 1, 2048, 448, 1792
        return {
            "x": _w((lambda *s: torch.randn(*s, dtype=torch.bfloat16) * 0.05)(B, S, D)),
            "w1": _w((lambda *s: torch.randn(*s, dtype=torch.bfloat16) * 3.2)(D, F) * (D ** -0.5)),
            "w2": _w((lambda *s: torch.randn(*s, dtype=torch.bfloat16) * 0.8)(F, D) * (F ** -0.5)),
        }
    _B_in = _B_setup()

    return {
        "A_x": _A_in["x"],
        "A_wqkv": _A_in["wqkv"],
        "A_wo": _A_in["wo"],
        "B_x": _B_in["x"],
        "B_w1": _B_in["w1"],
        "B_w2": _B_in["w2"],
    }

def reference(A_x, A_wqkv, A_wo, B_x, B_w1, B_w2):
    def _A_ref(x, wqkv, wo):
        B, S, D = x.shape
        H = 16; Dh = D // H
        qkv = (lambda x, *d: x.permute(*d))((x @ wqkv).reshape(B, S, 3, H, Dh), 2, 0, 3, 1, 4)
        q, k, v = qkv[0], qkv[1], qkv[2]
        phi = lambda t: torch.where(t > 0, t + 1, torch.exp(t)) + 1e-6
        pq, pk = phi(q), phi(k)
        kv = torch.einsum("bhsd,bhse->bhde", pk, v)
        z = torch.einsum("bhsd->bhd", pk)
        num = torch.einsum("bhqd,bhde->bhqe", pq, kv)
        den = torch.einsum("bhqd,bhd->bhq", pq, z)[..., None] + 1e-6
        o = num / den
        return (lambda x, *d: x.permute(*d))(o, 0, 2, 1, 3).reshape(B, S, D) @ wo

    def _B_ref(x, w1, w2):
        h = torch.einsum("bsd,df->bsf", x, w1)
        h = _silu(h)
        out = torch.einsum("bsf,fd->bsd", h, w2)
        return out

    x = A_x
    x = x + _A_ref(_layernorm(x, axis=-1), A_wqkv, A_wo)
    x = x + _B_ref(_layernorm(x, axis=-1), B_w1, B_w2)
    x = x + _A_ref(_layernorm(x, axis=-1), A_wqkv, A_wo)
    x = x + _B_ref(_layernorm(x, axis=-1), B_w1, B_w2)
    return x
```

```asm
; @launch grid=(256,1,1) block=(256,1,1) lds=163840
.amdgcn_target "amdgcn-amd-amdhsa--gfx950"
.text
.globl interleave_layers__linear_attn_block__dense_activation_silu__prompt_kernel
.p2align 12
.p2align 8
.type interleave_layers__linear_attn_block__dense_activation_silu__prompt_kernel,@function
interleave_layers__linear_attn_block__dense_activation_silu__prompt_kernel:
s_cmp_ge_u32 s2, 256
s_cbranch_scc1 L_end
s_load_dwordx2 s[24:25], s[0:1], 0
s_load_dwordx2 s[8:9], s[0:1], 8
s_load_dwordx2 s[4:5], s[0:1], 64
s_load_dwordx2 s[12:13], s[0:1], 16
s_load_dwordx2 s[16:17], s[0:1], 32
s_load_dwordx2 s[20:21], s[0:1], 40
s_load_dwordx2 s[28:29], s[0:1], 48
s_lshr_b32 s62, s2, 3
s_lshl_b32 s62, s62, 4
v_add_lshl_u32 v28, s62, v0, 7
v_cmp_gt_u32 vcc, 16, v0
s_getpc_b64 s[62:63]
s_and_saveexec_b64 s[64:65], vcc
s_cbranch_execz LP_skip
global_load_dword v32, v28, s[62:63]
LP_skip:
s_mov_b64 exec, -1
v_lshrrev_b32 v1, 6, v0
v_and_b32 v0, 63, v0
v_readfirstlane_b32 s32, v1
s_and_b32 s60, s2, 7
s_lshr_b32 s61, s2, 7
s_lshl1_add_u32 s34, s60, s61
s_bfe_u32 s33, s2, 0x40003
s_mov_b32 s26, 1835008
s_mov_b32 s27, 0x20000
s_mov_b32 s10, 1204224
s_mov_b32 s11, 0x20000
s_lshr_b32 s62, s2, 3
s_lshl2_add_u32 s62, s62, s32
s_mul_i32 s64, s60, 229376
s_mul_i32 s63, s62, 1792
s_add_u32 s64, s64, s63
v_lshlrev_b32 v26, 7, v0
s_mul_i32 s63, s62, 49
v_add_u32 v27, s63, v0
s_mov_b32 s63, 37450
v_mul_u32_u24 v28, s63, v27
v_lshrrev_b32 v28, 19, v28
v_mul_u32_u24 v28, 7, v28
v_add_lshl_u32 v27, v27, v28, 7
v_lshrrev_b32 v28, 3, v0
v_lshrrev_b32 v29, 4, v0
v_xor_b32 v29, v29, v0
v_and_b32 v29, 7, v29
v_mul_u32_u24 v30, 896, v28
v_lshl_add_u32 v30, v29, 4, v30
v_xor_b32 v31, 64, v30
s_lshl2_add_u32 s65, s34, s32
s_mul_i32 s65, s65, 28672
s_mul_i32 s66, s32, 28672
s_add_u32 s66, s66, 28672
s_waitcnt lgkmcnt(0)
s_load_dword s35, s[4:5], 0
s_mov_b64 exec, 0x3fff
buffer_load_dword v32, v26, s[24:27], s64 offen
s_mov_b64 exec, -1
s_mov_b32 exec_hi, 0x1ffff
buffer_load_dword v32, v27, s[8:11], 0 offen offset:896
s_mov_b64 exec, -1
s_add_u32 m0, s66, 0
s_add_u32 s63, s65, 0
buffer_load_dwordx4 v30, s[24:27], s63 offen offset:0 lds
s_add_u32 s63, s65, 6144
buffer_load_dwordx4 v30, s[24:27], s63 offen offset:1024 lds
s_add_u32 s63, s65, 12288
buffer_load_dwordx4 v31, s[24:27], s63 offen offset:2048 lds
s_add_u32 s63, s65, 18432
buffer_load_dwordx4 v31, s[24:27], s63 offen offset:3072 lds
s_getreg_b32 s36, hwreg(HW_REG_XCC_ID, 0, 4)
s_mov_b32 s6, 268435456
s_mov_b32 s7, 0x20000
s_mov_b32 s14, 401408
s_mov_b32 s15, 0x20000
s_mov_b32 s18, 1605632
s_mov_b32 s19, 0x20000
s_mov_b32 s22, 1605632
s_mov_b32 s23, 0x20000
s_mov_b32 s30, 1835008
s_mov_b32 s31, 0x20000
s_min_u32 s69, s33, 13
s_cmp_ge_u32 s69, 7
s_cselect_b32 s39, 1, 0
s_mul_i32 s60, s39, 7
s_sub_u32 s38, s69, s60
s_lshr_b32 s60, s32, 1
s_lshl1_add_u32 s58, s39, s60
s_and_b32 s60, s32, 1
s_lshl1_add_u32 s59, s38, s60
s_lshl_b32 s59, s59, 1
s_lshl2_add_u32 s62, s34, s58
s_mul_i32 s62, s62, 28672
s_lshl_b32 s63, s59, 5
s_add_u32 s76, s62, s63
s_mul_i32 s78, s32, 7168
v_lshrrev_b32 v36, 2, v0
v_mul_u32_u24 v138, 2688, v36
v_and_b32 v36, 3, v0
v_lshl_add_u32 v138, v36, 4, v138
v_cmp_eq_u32 vcc, 3, v36
v_subrev_u32 v37, 8, v138
s_lshl_b32 s90, s38, 12
v_cndmask_b32 v138, v138, v37, vcc
s_add_u32 s91, s90, 4096
s_cmp_eq_u32 s91, 28672
s_cselect_b32 s91, 0, s91
s_add_u32 s92, s91, 4096
s_cmp_eq_u32 s92, 28672
s_cselect_b32 s92, 0, s92
s_add_u32 s93, s92, 4096
s_cmp_eq_u32 s93, 28672
s_cselect_b32 s93, 0, s93
s_add_u32 s94, s93, 4096
s_cmp_eq_u32 s94, 28672
s_cselect_b32 s94, 0, s94
s_add_u32 s95, s94, 4096
s_cmp_eq_u32 s95, 28672
s_cselect_b32 s95, 0, s95
s_add_u32 s96, s95, 4096
s_cmp_eq_u32 s96, 28672
s_cselect_b32 s96, 0, s96
s_mul_i32 s40, s34, 589824
s_add_u32 s40, s40, 1048576
s_mov_b32 s62, 0x75634120
s_mov_b32 s63, 0xfecdab89
s_lshl_b32 s60, s33, 2
s_lshr_b64 s[62:63], s[62:63], s60
s_and_b32 s101, s62, 15
s_lshl2_add_u32 s60, s33, s32
s_lshl2_add_u32 s41, s60, s40
s_lshl_b32 s42, s60, 13
s_lshl_b32 s61, s34, 9
s_add_u32 s42, s42, s61
s_add_u32 s42, s42, 12582912
s_lshl2_add_u32 s60, s101, s32
s_lshl_b32 s43, s60, 13
s_add_u32 s43, s43, 12582912
s_add_u32 s64, s40, 16384
s_mul_i32 s61, s58, 28
s_add_u32 s61, s61, s59
s_lshl_b32 s61, s61, 10
s_add_u32 s44, s61, s64
s_mul_i32 s61, s32, 28672
s_add_u32 s70, s61, s64
s_mov_b32 s77, s64
s_add_u32 s64, s40, 1024
s_mul_i32 s61, s58, 7
s_add_u32 s61, s61, s38
s_lshl_b32 s61, s61, 9
s_and_b32 s62, s32, 1
s_lshl3_add_u32 s61, s62, s61
s_add_u32 s45, s61, s64
s_mul_i32 s61, s32, 3584
s_add_u32 s71, s61, s64
s_add_u32 s64, s40, 131072
s_mul_i32 s61, s32, 114688
s_lshl_b32 s62, s101, 11
s_add_u32 s61, s61, s62
s_add_u32 s72, s61, s64
s_mul_i32 s61, s58, 114688
s_and_b32 s62, s32, 1
s_lshl_b32 s62, s62, 14
s_add_u32 s61, s61, s62
s_add_u32 s73, s61, s64
s_lshl2_add_u32 s61, s69, s32
s_lshl_b32 s61, s61, 11
s_add_u32 s74, s61, s64
s_mul_i32 s61, s39, 229376
s_mul_i32 s62, s32, 28672
s_add_u32 s61, s61, s62
s_add_u32 s75, s61, s64
s_mul_i32 s61, s32, 100352
s_lshl_b32 s62, s38, 7
s_add_u32 s79, s61, s62
s_lshl1_add_u32 s80, s78, 86016
s_cmp_eq_u32 s32, 3
s_cselect_b32 s81, 0, -2
s_mov_b32 s88, 0x3f803f80
s_lshl_b32 s89, s32, 12
s_mov_b32 s37, 2097152
s_mov_b32 s82, 0x3fb8aa3b
s_mov_b32 s83, s82
s_mov_b32 s84, 0x3f800008
s_mov_b32 s85, s84
s_mov_b32 s86, 0x358637bd
s_mov_b32 s87, s86
s_and_b32 s60, s32, 1
s_lshr_b32 s61, s32, 1
s_mul_i32 s61, s61, 28
s_lshl1_add_u32 s61, s60, s61
s_mov_b32 s46, 0x3333333
s_mov_b32 s47, 0
s_lshl_b64 s[46:47], s[46:47], s61
s_mov_b32 s48, -1
s_mov_b32 s49, 0xffffff
s_lshl_b32 s60, s60, 5
s_add_u32 s60, s60, s58
s_mov_b32 s50, 0x11111111
s_mov_b32 s51, 0
s_lshl_b64 s[50:51], s[50:51], s60
s_mul_i32 s60, s32, 14
s_mov_b32 s52, 0x3fff
s_mov_b32 s53, 0
s_lshl_b64 s[52:53], s[52:53], s60
s_mov_b32 s54, 0xefffffff
s_mov_b32 s55, 0xefffffff
s_mov_b32 s56, 0
s_mov_b32 s57, -1
v_lshlrev_b32 v1, 4, v0
v_lshlrev_b32 v4, 2, v0
v_bfe_u32 v36, v0, 2, 2
v_lshrrev_b32 v37, 5, v0
v_lshl_add_u32 v37, v37, 3, v36
v_and_b32 v38, 1, v0
v_bfe_u32 v39, v0, 1, 1
v_lshl_add_u32 v38, v38, 1, v39
v_bfe_u32 v39, v0, 4, 1
v_lshl_add_u32 v38, v39, 2, v38
v_cmp_le_u32 vcc, 6, v38
v_xor_b32 v39, 1, v38
v_lshlrev_b32 v2, 6, v37
v_cndmask_b32 v39, v38, v39, vcc
v_lshl_add_u32 v2, v39, 3, v2
v_add_u32 v3, 57344, v2
v_lshlrev_b32 v5, 7, v37
v_lshrrev_b32 v36, 1, v36
v_lshl_add_u32 v5, v36, 6, v5
v_lshl_add_u32 v5, v38, 3, v5
v_lshrrev_b32 v36, 3, v0
v_bfe_u32 v37, v0, 4, 1
v_lshlrev_b32 v37, 2, v37
v_and_b32 v38, 7, v0
v_xor_b32 v37, v37, v38
v_mul_u32_u24 v6, 896, v36
v_lshl_add_u32 v6, v37, 4, v6
v_mov_b32 v8, 0
v_mov_b32 v9, 0
v_mov_b32 v10, 0
v_mov_b32 v11, 0
v_mov_b32 v12, 0
v_mov_b32 v13, 0
v_mov_b32 v14, 0
v_mov_b32 v15, 0
v_mov_b32 v16, 0
v_mov_b32 v17, 0
s_add_u32 s3, s75, 114688
v_and_b32 v36, 31, v0
v_lshrrev_b32 v37, 3, v36
v_and_b32 v38, 7, v36
v_lshlrev_b32 v37, 10, v37
v_lshl_add_u32 v37, v38, 7, v37
v_bfe_u32 v38, v36, 1, 2
v_lshrrev_b32 v36, 4, v36
v_lshl_add_u32 v38, v36, 2, v38
v_lshrrev_b32 v36, 5, v0
v_xor_b32 v38, v38, v36
v_lshl_add_u32 v37, v38, 4, v37
s_mul_i32 s60, s32, 28672
s_add_u32 s60, s60, 28672
s_mul_i32 s61, s58, 28672
s_lshl_b32 s62, s38, 12
s_add_u32 s61, s61, s62
s_add_u32 s61, s61, 28672
s_and_b32 s62, s32, 1
s_lshl_b32 s62, s62, 6
s_add_u32 s64, s32, 0
s_and_b32 s64, s64, 3
s_lshl_b32 s63, s64, 5
v_xor_b32 v36, s63, v37
v_add_u32 v130, s60, v36
s_lshl_b32 s63, s64, 10
v_add_u32 v114, s63, v2
s_add_u32 s64, s32, 1
s_and_b32 s64, s64, 3
s_lshl_b32 s63, s64, 5
v_xor_b32 v36, s63, v37
v_add_u32 v131, s60, v36
s_lshl_b32 s63, s64, 10
v_add_u32 v115, s63, v2
s_add_u32 s64, s32, 2
s_and_b32 s64, s64, 3
s_lshl_b32 s63, s64, 5
v_xor_b32 v36, s63, v37
v_add_u32 v132, s60, v36
s_lshl_b32 s63, s64, 10
v_add_u32 v116, s63, v2
s_add_u32 s64, s32, 3
s_and_b32 s64, s64, 3
s_lshl_b32 s63, s64, 5
v_xor_b32 v36, s63, v37
v_add_u32 v133, s60, v36
s_lshl_b32 s63, s64, 10
v_add_u32 v117, s63, v2
v_xor_b32 v36, s62, v37
v_add_u32 v134, s61, v36
v_xor_b32 v36, 32, v36
v_add_u32 v135, s61, v36
s_add_u32 m0, s66, 4096
s_add_u32 s63, s65, 128
buffer_load_dwordx4 v30, s[24:27], s63 offen offset:0 lds
s_add_u32 s63, s65, 6272
buffer_load_dwordx4 v30, s[24:27], s63 offen offset:1024 lds
s_add_u32 s63, s65, 12416
buffer_load_dwordx4 v31, s[24:27], s63 offen offset:2048 lds
s_add_u32 s63, s65, 18560
buffer_load_dwordx4 v31, s[24:27], s63 offen offset:3072 lds
s_add_u32 m0, s66, 8192
s_add_u32 s63, s65, 256
buffer_load_dwordx4 v30, s[24:27], s63 offen offset:0 lds
s_add_u32 s63, s65, 6400
buffer_load_dwordx4 v30, s[24:27], s63 offen offset:1024 lds
s_mov_b64 exec, 0
s_cmp_eq_u32 s32, 1
s_cbranch_scc1 L_hop1
s_cmp_eq_u32 s32, 2
s_cbranch_scc1 L_hop2
s_cmp_eq_u32 s32, 3
s_cbranch_scc1 L_hop3
s_branch L_hop0
.p2align 12
L_main:
L_hopret:
s_mov_b64 exec, -1
v_mov_b32 v162, 0x3f803f80
s_add_u32 s63, s65, 12544
buffer_load_dwordx4 v31, s[24:27], s63 offen offset:2048 lds
s_add_u32 s63, s65, 18688
buffer_load_dwordx4 v31, s[24:27], s63 offen offset:3072 lds
s_add_u32 m0, s66, 12288
s_add_u32 s63, s65, 384
buffer_load_dwordx4 v30, s[24:27], s63 offen offset:0 lds
s_add_u32 s63, s65, 6528
buffer_load_dwordx4 v30, s[24:27], s63 offen offset:1024 lds
s_waitcnt vmcnt(10)
ds_read_b128 v[94:97], v130 offset:0
ds_read_b128 v[98:101], v131 offset:0
ds_read_b128 v[102:105], v132 offset:0
ds_read_b128 v[106:109], v133 offset:0
ds_read_b128 a[0:3], v130 offset:0
ds_read_b128 a[4:7], v131 offset:0
ds_read_b128 a[8:11], v132 offset:0
ds_read_b128 a[12:15], v133 offset:0
s_waitcnt lgkmcnt(7)
v_dot2_f32_bf16 v158, v162, v94, 0
v_dot2_f32_bf16 v159, v94, v94, 0
v_dot2_f32_bf16 v160, v162, v95, 0
v_dot2_f32_bf16 v161, v95, v95, 0
v_dot2_f32_bf16 v158, v162, v96, v158
v_dot2_f32_bf16 v159, v96, v96, v159
v_dot2_f32_bf16 v160, v162, v97, v160
v_dot2_f32_bf16 v161, v97, v97, v161
s_waitcnt lgkmcnt(6)
v_dot2_f32_bf16 v158, v162, v98, v158
v_dot2_f32_bf16 v159, v98, v98, v159
v_dot2_f32_bf16 v160, v162, v99, v160
v_dot2_f32_bf16 v161, v99, v99, v161
v_dot2_f32_bf16 v158, v162, v100, v158
v_dot2_f32_bf16 v159, v100, v100, v159
v_dot2_f32_bf16 v160, v162, v101, v160
v_dot2_f32_bf16 v161, v101, v101, v161
s_waitcnt lgkmcnt(5)
v_dot2_f32_bf16 v158, v162, v102, v158
v_dot2_f32_bf16 v159, v102, v102, v159
v_dot2_f32_bf16 v160, v162, v103, v160
v_dot2_f32_bf16 v161, v103, v103, v161
v_dot2_f32_bf16 v158, v162, v104, v158
v_dot2_f32_bf16 v159, v104, v104, v159
v_dot2_f32_bf16 v160, v162, v105, v160
v_dot2_f32_bf16 v161, v105, v105, v161
s_waitcnt lgkmcnt(4)
v_dot2_f32_bf16 v158, v162, v106, v158
v_dot2_f32_bf16 v159, v106, v106, v159
v_dot2_f32_bf16 v160, v162, v107, v160
v_dot2_f32_bf16 v161, v107, v107, v161
v_dot2_f32_bf16 v158, v162, v108, v158
v_dot2_f32_bf16 v159, v108, v108, v159
v_dot2_f32_bf16 v160, v162, v109, v160
v_dot2_f32_bf16 v161, v109, v109, v161
s_add_u32 s63, s65, 12672
buffer_load_dwordx4 v31, s[24:27], s63 offen offset:2048 lds
s_add_u32 s63, s65, 18816
buffer_load_dwordx4 v31, s[24:27], s63 offen offset:3072 lds
s_add_u32 m0, s66, 16384
s_add_u32 s63, s65, 512
buffer_load_dwordx4 v30, s[24:27], s63 offen offset:0 lds
s_add_u32 s63, s65, 6656
buffer_load_dwordx4 v30, s[24:27], s63 offen offset:1024 lds
s_waitcnt vmcnt(10)
ds_read_b128 v[94:97], v130 offset:4096
ds_read_b128 v[98:101], v131 offset:4096
ds_read_b128 v[102:105], v132 offset:4096
ds_read_b128 v[106:109], v133 offset:4096
ds_read_b128 a[16:19], v130 offset:4096
ds_read_b128 a[20:23], v131 offset:4096
ds_read_b128 a[24:27], v132 offset:4096
ds_read_b128 a[28:31], v133 offset:4096
s_waitcnt lgkmcnt(7)
v_dot2_f32_bf16 v158, v162, v94, v158
v_dot2_f32_bf16 v159, v94, v94, v159
v_dot2_f32_bf16 v160, v162, v95, v160
v_dot2_f32_bf16 v161, v95, v95, v161
v_dot2_f32_bf16 v158, v162, v96, v158
v_dot2_f32_bf16 v159, v96, v96, v159
v_dot2_f32_bf16 v160, v162, v97, v160
v_dot2_f32_bf16 v161, v97, v97, v161
s_waitcnt lgkmcnt(6)
v_dot2_f32_bf16 v158, v162, v98, v158
v_dot2_f32_bf16 v159, v98, v98, v159
v_dot2_f32_bf16 v160, v162, v99, v160
v_dot2_f32_bf16 v161, v99, v99, v161
v_dot2_f32_bf16 v158, v162, v100, v158
v_dot2_f32_bf16 v159, v100, v100, v159
v_dot2_f32_bf16 v160, v162, v101, v160
v_dot2_f32_bf16 v161, v101, v101, v161
s_waitcnt lgkmcnt(5)
v_dot2_f32_bf16 v158, v162, v102, v158
v_dot2_f32_bf16 v159, v102, v102, v159
v_dot2_f32_bf16 v160, v162, v103, v160
v_dot2_f32_bf16 v161, v103, v103, v161
v_dot2_f32_bf16 v158, v162, v104, v158
v_dot2_f32_bf16 v159, v104, v104, v159
v_dot2_f32_bf16 v160, v162, v105, v160
v_dot2_f32_bf16 v161, v105, v105, v161
s_waitcnt lgkmcnt(4)
v_dot2_f32_bf16 v158, v162, v106, v158
v_dot2_f32_bf16 v159, v106, v106, v159
v_dot2_f32_bf16 v160, v162, v107, v160
v_dot2_f32_bf16 v161, v107, v107, v161
v_dot2_f32_bf16 v158, v162, v108, v158
v_dot2_f32_bf16 v159, v108, v108, v159
v_dot2_f32_bf16 v160, v162, v109, v160
v_dot2_f32_bf16 v161, v109, v109, v161
s_add_u32 s63, s65, 12800
buffer_load_dwordx4 v31, s[24:27], s63 offen offset:2048 lds
s_add_u32 s63, s65, 18944
buffer_load_dwordx4 v31, s[24:27], s63 offen offset:3072 lds
s_add_u32 m0, s66, 20480
s_add_u32 s63, s65, 640
buffer_load_dwordx4 v30, s[24:27], s63 offen offset:0 lds
s_add_u32 s63, s65, 6784
buffer_load_dwordx4 v30, s[24:27], s63 offen offset:1024 lds
s_waitcnt vmcnt(10)
ds_read_b128 v[94:97], v130 offset:8192
ds_read_b128 v[98:101], v131 offset:8192
ds_read_b128 v[102:105], v132 offset:8192
ds_read_b128 v[106:109], v133 offset:8192
ds_read_b128 a[32:35], v130 offset:8192
ds_read_b128 a[36:39], v131 offset:8192
ds_read_b128 a[40:43], v132 offset:8192
ds_read_b128 a[44:47], v133 offset:8192
s_waitcnt lgkmcnt(7)
v_dot2_f32_bf16 v158, v162, v94, v158
v_dot2_f32_bf16 v159, v94, v94, v159
v_dot2_f32_bf16 v160, v162, v95, v160
v_dot2_f32_bf16 v161, v95, v95, v161
v_dot2_f32_bf16 v158, v162, v96, v158
v_dot2_f32_bf16 v159, v96, v96, v159
v_dot2_f32_bf16 v160, v162, v97, v160
v_dot2_f32_bf16 v161, v97, v97, v161
s_waitcnt lgkmcnt(6)
v_dot2_f32_bf16 v158, v162, v98, v158
v_dot2_f32_bf16 v159, v98, v98, v159
v_dot2_f32_bf16 v160, v162, v99, v160
v_dot2_f32_bf16 v161, v99, v99, v161
v_dot2_f32_bf16 v158, v162, v100, v158
v_dot2_f32_bf16 v159, v100, v100, v159
v_dot2_f32_bf16 v160, v162, v101, v160
v_dot2_f32_bf16 v161, v101, v101, v161
s_waitcnt lgkmcnt(5)
v_dot2_f32_bf16 v158, v162, v102, v158
v_dot2_f32_bf16 v159, v102, v102, v159
v_dot2_f32_bf16 v160, v162, v103, v160
v_dot2_f32_bf16 v161, v103, v103, v161
v_dot2_f32_bf16 v158, v162, v104, v158
v_dot2_f32_bf16 v159, v104, v104, v159
v_dot2_f32_bf16 v160, v162, v105, v160
v_dot2_f32_bf16 v161, v105, v105, v161
s_waitcnt lgkmcnt(4)
v_dot2_f32_bf16 v158, v162, v106, v158
v_dot2_f32_bf16 v159, v106, v106, v159
v_dot2_f32_bf16 v160, v162, v107, v160
v_dot2_f32_bf16 v161, v107, v107, v161
v_dot2_f32_bf16 v158, v162, v108, v158
v_dot2_f32_bf16 v159, v108, v108, v159
v_dot2_f32_bf16 v160, v162, v109, v160
v_dot2_f32_bf16 v161, v109, v109, v161
s_add_u32 s63, s65, 12928
buffer_load_dwordx4 v31, s[24:27], s63 offen offset:2048 lds
s_add_u32 s63, s65, 19072
buffer_load_dwordx4 v31, s[24:27], s63 offen offset:3072 lds
s_add_u32 m0, s66, 24576
s_add_u32 s63, s65, 768
buffer_load_dwordx4 v30, s[24:27], s63 offen offset:0 lds
s_add_u32 s63, s65, 6912
buffer_load_dwordx4 v30, s[24:27], s63 offen offset:1024 lds
s_waitcnt vmcnt(10)
ds_read_b128 v[94:97], v130 offset:12288
ds_read_b128 v[98:101], v131 offset:12288
ds_read_b128 v[102:105], v132 offset:12288
ds_read_b128 v[106:109], v133 offset:12288
ds_read_b128 a[48:51], v130 offset:12288
ds_read_b128 a[52:55], v131 offset:12288
ds_read_b128 a[56:59], v132 offset:12288
ds_read_b128 a[60:63], v133 offset:12288
s_waitcnt lgkmcnt(7)
v_dot2_f32_bf16 v158, v162, v94, v158
v_dot2_f32_bf16 v159, v94, v94, v159
v_dot2_f32_bf16 v160, v162, v95, v160
v_dot2_f32_bf16 v161, v95, v95, v161
v_dot2_f32_bf16 v158, v162, v96, v158
v_dot2_f32_bf16 v159, v96, v96, v159
v_dot2_f32_bf16 v160, v162, v97, v160
v_dot2_f32_bf16 v161, v97, v97, v161
s_waitcnt lgkmcnt(6)
v_dot2_f32_bf16 v158, v162, v98, v158
v_dot2_f32_bf16 v159, v98, v98, v159
v_dot2_f32_bf16 v160, v162, v99, v160
v_dot2_f32_bf16 v161, v99, v99, v161
v_dot2_f32_bf16 v158, v162, v100, v158
v_dot2_f32_bf16 v159, v100, v100, v159
v_dot2_f32_bf16 v160, v162, v101, v160
v_dot2_f32_bf16 v161, v101, v101, v161
s_waitcnt lgkmcnt(5)
v_dot2_f32_bf16 v158, v162, v102, v158
v_dot2_f32_bf16 v159, v102, v102, v159
v_dot2_f32_bf16 v160, v162, v103, v160
v_dot2_f32_bf16 v161, v103, v103, v161
v_dot2_f32_bf16 v158, v162, v104, v158
v_dot2_f32_bf16 v159, v104, v104, v159
v_dot2_f32_bf16 v160, v162, v105, v160
v_dot2_f32_bf16 v161, v105, v105, v161
s_waitcnt lgkmcnt(4)
v_dot2_f32_bf16 v158, v162, v106, v158
v_dot2_f32_bf16 v159, v106, v106, v159
v_dot2_f32_bf16 v160, v162, v107, v160
v_dot2_f32_bf16 v161, v107, v107, v161
v_dot2_f32_bf16 v158, v162, v108, v158
v_dot2_f32_bf16 v159, v108, v108, v159
v_dot2_f32_bf16 v160, v162, v109, v160
v_dot2_f32_bf16 v161, v109, v109, v161
s_add_u32 s63, s65, 13056
buffer_load_dwordx4 v31, s[24:27], s63 offen offset:2048 lds
s_add_u32 s63, s65, 19200
buffer_load_dwordx4 v31, s[24:27], s63 offen offset:3072 lds
s_mul_i32 s67, s32, 43008
s_mul_i32 s64, s33, 56
s_add_u32 s67, s67, s64
s_lshl_b32 s64, s32, 10
s_add_u32 m0, s64, 0
s_add_u32 s63, s67, 896
buffer_load_dwordx4 v138, s[8:11], s63 offen lds
s_add_u32 m0, s64, 4096
s_add_u32 s63, s67, 172928
buffer_load_dwordx4 v138, s[8:11], s63 offen lds
s_waitcnt vmcnt(10)
ds_read_b128 v[94:97], v130 offset:16384
ds_read_b128 v[98:101], v131 offset:16384
ds_read_b128 v[102:105], v132 offset:16384
ds_read_b128 v[106:109], v133 offset:16384
ds_read_b128 a[64:67], v130 offset:16384
ds_read_b128 a[68:71], v131 offset:16384
ds_read_b128 a[72:75], v132 offset:16384
ds_read_b128 a[76:79], v133 offset:16384
s_waitcnt lgkmcnt(7)
v_dot2_f32_bf16 v158, v162, v94, v158
v_dot2_f32_bf16 v159, v94, v94, v159
v_dot2_f32_bf16 v160, v162, v95, v160
v_dot2_f32_bf16 v161, v95, v95, v161
v_dot2_f32_bf16 v158, v162, v96, v158
v_dot2_f32_bf16 v159, v96, v96, v159
v_dot2_f32_bf16 v160, v162, v97, v160
v_dot2_f32_bf16 v161, v97, v97, v161
s_waitcnt lgkmcnt(6)
v_dot2_f32_bf16 v158, v162, v98, v158
v_dot2_f32_bf16 v159, v98, v98, v159
v_dot2_f32_bf16 v160, v162, v99, v160
v_dot2_f32_bf16 v161, v99, v99, v161
v_dot2_f32_bf16 v158, v162, v100, v158
v_dot2_f32_bf16 v159, v100, v100, v159
v_dot2_f32_bf16 v160, v162, v101, v160
v_dot2_f32_bf16 v161, v101, v101, v161
s_waitcnt lgkmcnt(5)
v_dot2_f32_bf16 v158, v162, v102, v158
v_dot2_f32_bf16 v159, v102, v102, v159
v_dot2_f32_bf16 v160, v162, v103, v160
v_dot2_f32_bf16 v161, v103, v103, v161
v_dot2_f32_bf16 v158, v162, v104, v158
v_dot2_f32_bf16 v159, v104, v104, v159
v_dot2_f32_bf16 v160, v162, v105, v160
v_dot2_f32_bf16 v161, v105, v105, v161
s_waitcnt lgkmcnt(4)
v_dot2_f32_bf16 v158, v162, v106, v158
v_dot2_f32_bf16 v159, v106, v106, v159
v_dot2_f32_bf16 v160, v162, v107, v160
v_dot2_f32_bf16 v161, v107, v107, v161
v_dot2_f32_bf16 v158, v162, v108, v158
v_dot2_f32_bf16 v159, v108, v108, v159
v_dot2_f32_bf16 v160, v162, v109, v160
v_dot2_f32_bf16 v161, v109, v109, v161
s_add_u32 m0, s64, 8192
s_add_u32 s63, s67, 344960
buffer_load_dwordx4 v138, s[8:11], s63 offen lds
s_add_u32 m0, s64, 12288
s_add_u32 s63, s67, 516992
buffer_load_dwordx4 v138, s[8:11], s63 offen lds
s_add_u32 m0, s64, 16384
s_add_u32 s63, s67, 689024
buffer_load_dwordx4 v138, s[8:11], s63 offen lds
s_add_u32 m0, s64, 20480
s_add_u32 s63, s67, 861056
buffer_load_dwordx4 v138, s[8:11], s63 offen lds
s_waitcnt vmcnt(10)
ds_read_b128 v[94:97], v130 offset:20480
ds_read_b128 v[98:101], v131 offset:20480
ds_read_b128 v[102:105], v132 offset:20480
ds_read_b128 v[106:109], v133 offset:20480
ds_read_b128 a[80:83], v130 offset:20480
ds_read_b128 a[84:87], v131 offset:20480
ds_read_b128 a[88:91], v132 offset:20480
ds_read_b128 a[92:95], v133 offset:20480
s_waitcnt lgkmcnt(7)
v_dot2_f32_bf16 v158, v162, v94, v158
v_dot2_f32_bf16 v159, v94, v94, v159
v_dot2_f32_bf16 v160, v162, v95, v160
v_dot2_f32_bf16 v161, v95, v95, v161
v_dot2_f32_bf16 v158, v162, v96, v158
v_dot2_f32_bf16 v159, v96, v96, v159
v_dot2_f32_bf16 v160, v162, v97, v160
v_dot2_f32_bf16 v161, v97, v97, v161
s_waitcnt lgkmcnt(6)
v_dot2_f32_bf16 v158, v162, v98, v158
v_dot2_f32_bf16 v159, v98, v98, v159
v_dot2_f32_bf16 v160, v162, v99, v160
v_dot2_f32_bf16 v161, v99, v99, v161
v_dot2_f32_bf16 v158, v162, v100, v158
v_dot2_f32_bf16 v159, v100, v100, v159
v_dot2_f32_bf16 v160, v162, v101, v160
v_dot2_f32_bf16 v161, v101, v101, v161
s_waitcnt lgkmcnt(5)
v_dot2_f32_bf16 v158, v162, v102, v158
v_dot2_f32_bf16 v159, v102, v102, v159
v_dot2_f32_bf16 v160, v162, v103, v160
v_dot2_f32_bf16 v161, v103, v103, v161
v_dot2_f32_bf16 v158, v162, v104, v158
v_dot2_f32_bf16 v159, v104, v104, v159
v_dot2_f32_bf16 v160, v162, v105, v160
v_dot2_f32_bf16 v161, v105, v105, v161
s_waitcnt lgkmcnt(4)
v_dot2_f32_bf16 v158, v162, v106, v158
v_dot2_f32_bf16 v159, v106, v106, v159
v_dot2_f32_bf16 v160, v162, v107, v160
v_dot2_f32_bf16 v161, v107, v107, v161
v_dot2_f32_bf16 v158, v162, v108, v158
v_dot2_f32_bf16 v159, v108, v108, v159
v_dot2_f32_bf16 v160, v162, v109, v160
v_dot2_f32_bf16 v161, v109, v109, v161
s_add_u32 m0, s64, 24576
s_add_u32 s63, s67, 1033088
buffer_load_dwordx4 v138, s[8:11], s63 offen lds
s_waitcnt vmcnt(7)
ds_read_b128 v[94:97], v130 offset:24576
ds_read_b128 v[98:101], v131 offset:24576
ds_read_b128 v[102:105], v132 offset:24576
ds_read_b128 v[106:109], v133 offset:24576
ds_read_b128 a[96:99], v130 offset:24576
ds_read_b128 a[100:103], v131 offset:24576
ds_read_b128 a[104:107], v132 offset:24576
ds_read_b128 a[108:111], v133 offset:24576
s_waitcnt lgkmcnt(7)
v_dot2_f32_bf16 v158, v162, v94, v158
v_dot2_f32_bf16 v159, v94, v94, v159
v_dot2_f32_bf16 v160, v162, v95, v160
v_dot2_f32_bf16 v161, v95, v95, v161
v_dot2_f32_bf16 v158, v162, v96, v158
v_dot2_f32_bf16 v159, v96, v96, v159
v_dot2_f32_bf16 v160, v162, v97, v160
v_dot2_f32_bf16 v161, v97, v97, v161
s_waitcnt lgkmcnt(6)
v_dot2_f32_bf16 v158, v162, v98, v158
v_dot2_f32_bf16 v159, v98, v98, v159
v_dot2_f32_bf16 v160, v162, v99, v160
v_dot2_f32_bf16 v161, v99, v99, v161
v_dot2_f32_bf16 v158, v162, v100, v158
v_dot2_f32_bf16 v159, v100, v100, v159
v_dot2_f32_bf16 v160, v162, v101, v160
v_dot2_f32_bf16 v161, v101, v101, v161
s_waitcnt lgkmcnt(5)
v_dot2_f32_bf16 v158, v162, v102, v158
v_dot2_f32_bf16 v159, v102, v102, v159
v_dot2_f32_bf16 v160, v162, v103, v160
v_dot2_f32_bf16 v161, v103, v103, v161
v_dot2_f32_bf16 v158, v162, v104, v158
v_dot2_f32_bf16 v159, v104, v104, v159
v_dot2_f32_bf16 v160, v162, v105, v160
v_dot2_f32_bf16 v161, v105, v105, v161
s_waitcnt lgkmcnt(4)
v_dot2_f32_bf16 v158, v162, v106, v158
v_dot2_f32_bf16 v159, v106, v106, v159
v_dot2_f32_bf16 v160, v162, v107, v160
v_dot2_f32_bf16 v161, v107, v107, v161
v_dot2_f32_bf16 v158, v162, v108, v158
v_dot2_f32_bf16 v159, v108, v108, v159
v_dot2_f32_bf16 v160, v162, v109, v160
v_dot2_f32_bf16 v161, v109, v109, v161
v_mov_b32 v36, -1
v_mov_b32 v37, -1
v_lshlrev_b32 v38, 3, v0
s_add_u32 s61, s42, 1048576
buffer_store_dwordx2 v[36:37], v38, s[4:7], s42 offen sc1
buffer_store_dwordx2 v[36:37], v38, s[4:7], s61 offen sc1
s_waitcnt lgkmcnt(0)
s_add_u32 s35, s35, 65
s_barrier
ds_read_b128 v[18:21], v134
ds_read_b128 v[22:25], v135
s_waitcnt lgkmcnt(0)
s_barrier
v_lshrrev_b32 v126, 2, v0
v_lshrrev_b32 v127, 4, v0
v_xor_b32 v126, v126, v127
v_and_b32 v126, 1, v126
v_cmp_eq_u32 vcc, 0, v126
v_mov_b32 v127, 0x3f803f80
s_nop 0
v_cndmask_b32 v126, 0, v127, vcc
v_mov_b32 v127, v126
v_mov_b32 v128, v126
v_mov_b32 v129, v126
v_add_u32 v110, 159744, v4
s_lshl_b32 s61, s32, 8
v_add_u32 v111, s61, v110
s_waitcnt vmcnt(7)
s_barrier
ds_read_b64_tr_b16 v[74:75], v114 offset:0
ds_read_b64_tr_b16 v[76:77], v114 offset:256
ds_read_b64_tr_b16 v[78:79], v115 offset:0
ds_read_b64_tr_b16 v[80:81], v115 offset:256
ds_read_b64_tr_b16 v[82:83], v116 offset:0
ds_read_b64_tr_b16 v[84:85], v116 offset:256
ds_read_b64_tr_b16 v[86:87], v117 offset:0
ds_read_b64_tr_b16 v[88:89], v117 offset:256
s_waitcnt lgkmcnt(6)
v_mfma_f32_32x32x16_bf16 v[26:41], a[0:3], v[74:77], 0
s_mul_i32 s65, s32, 43008
s_mul_i32 s66, s33, 56
s_add_u32 s65, s65, s66
s_lshl_b32 s66, s32, 10
ds_read_b64_tr_b16 v[90:91], v114 offset:4096
ds_read_b64_tr_b16 v[92:93], v114 offset:4352
v_add_f32 v158, v158, v160
v_add_f32 v159, v159, v161
v_mov_b32 v160, v158
v_mfma_f32_16x16x32_bf16 v[130:133], v[126:129], v[74:77], 0
v_mov_b32 v161, v159
v_mov_b32 v174, 0
v_mov_b32 v175, 0
s_waitcnt lgkmcnt(6)
v_mfma_f32_32x32x16_bf16 v[26:41], a[4:7], v[78:81], v[26:41]
ds_read_b64_tr_b16 v[74:75], v115 offset:4096
ds_read_b64_tr_b16 v[76:77], v115 offset:4352
v_permlane32_swap_b32 v158, v160
v_permlane32_swap_b32 v159, v161
v_add_f32 v158, v158, v160
s_waitcnt lgkmcnt(6)
v_mfma_f32_32x32x16_bf16 v[26:41], a[8:11], v[82:85], v[26:41]
s_add_u32 m0, s66, 28672
s_add_u32 s63, s65, 1792
buffer_load_dwordx4 v138, s[8:11], s63 offen lds
ds_read_b64_tr_b16 v[78:79], v116 offset:4096
ds_read_b64_tr_b16 v[80:81], v116 offset:4352
v_add_f32 v159, v159, v161
v_mul_f32 v160, 0x3b124925, v158
s_waitcnt lgkmcnt(6)
v_mfma_f32_32x32x16_bf16 v[26:41], a[12:15], v[86:89], v[26:41]
s_waitcnt vmcnt(6)
s_barrier
ds_read_b64_tr_b16 v[82:83], v117 offset:4096
ds_read_b64_tr_b16 v[84:85], v117 offset:4352
v_mul_f32 v159, 0x3b124925, v159
v_fmamk_f32 v158, v160, 0xc3e00000, v158
s_waitcnt lgkmcnt(6)
v_mfma_f32_32x32x16_bf16 v[26:41], a[16:19], v[90:93], v[26:41]
ds_read_b64_tr_b16 v[86:87], v114 offset:8192
ds_read_b64_tr_b16 v[88:89], v114 offset:8448
v_fmamk_f32 v158, v158, 0x3b124925, v160
v_fma_f32 v159, -v158, v158, v159
v_max_f32 v159, 0, v159
v_cvt_pk_bf16_f32 v160, -v158, v159
v_mfma_f32_16x16x32_bf16 v[130:133], v[126:129], v[90:93], v[130:133]
s_add_u32 m0, s66, 32768
s_add_u32 s63, s65, 173824
buffer_load_dwordx4 v138, s[8:11], s63 offen lds
v_and_b32 v159, 0xffff0000, v160
v_and_b32 v160, 0xffff, v160
s_waitcnt lgkmcnt(6)
v_mfma_f32_32x32x16_bf16 v[26:41], a[20:23], v[74:77], v[26:41]
ds_read_b64_tr_b16 v[90:91], v115 offset:8192
ds_read_b64_tr_b16 v[92:93], v115 offset:8448
v_add_f32 v159, 0x3727c5ac, v159
v_cndmask_b32 v173, v160, 0, s[56:57]
v_cvt_pk_bf16_f32 v159, v159, v159
s_waitcnt lgkmcnt(6)
v_mfma_f32_32x32x16_bf16 v[26:41], a[24:27], v[78:81], v[26:41]
ds_read_b64_tr_b16 v[74:75], v116 offset:8192
ds_read_b64_tr_b16 v[76:77], v116 offset:8448
v_lshl_or_b32 v172, v173, 16, v173
v_and_b32 v159, 0xffff0000, v159
v_sqrt_f32 v159, v159
s_waitcnt lgkmcnt(6)
v_mfma_f32_32x32x16_bf16 v[26:41], a[28:31], v[82:85], v[26:41]
s_add_u32 m0, s66, 36864
s_add_u32 s63, s65, 345856
buffer_load_dwordx4 v138, s[8:11], s63 offen lds
ds_read_b64_tr_b16 v[78:79], v117 offset:8192
ds_read_b64_tr_b16 v[80:81], v117 offset:8448
v_cvt_pk_bf16_f32 v159, v159, v159
v_and_b32 v159, 0xffff0000, v159
s_waitcnt lgkmcnt(6)
v_mfma_f32_32x32x16_bf16 v[26:41], a[32:35], v[86:89], v[26:41]
ds_read_b64_tr_b16 v[82:83], v114 offset:12288
ds_read_b64_tr_b16 v[84:85], v114 offset:12544
v_rcp_f32 v158, v159
s_nop 0
v_mul_f32 v159, 0x3fb8aa3b, v158
s_lshl_b32 s64, s32, 7
v_mfma_f32_16x16x32_bf16 v[130:133], v[126:129], v[86:89], v[130:133]
s_add_u32 s64, s64, 161792
v_and_b32 v168, 31, v0
s_waitcnt lgkmcnt(6)
v_mfma_f32_32x32x16_bf16 v[26:41], a[36:39], v[90:93], v[26:41]
s_add_u32 m0, s66, 40960
s_add_u32 s63, s65, 517888
buffer_load_dwordx4 v138, s[8:11], s63 offen lds
ds_read_b64_tr_b16 v[86:87], v115 offset:12288
ds_read_b64_tr_b16 v[88:89], v115 offset:12544
v_lshl_add_u32 v168, v168, 2, s64
v_lshrrev_b32 v169, 5, v0
s_waitcnt lgkmcnt(6)
v_mfma_f32_32x32x16_bf16 v[26:41], a[40:43], v[74:77], v[26:41]
ds_read_b64_tr_b16 v[90:91], v116 offset:12288
ds_read_b64_tr_b16 v[92:93], v116 offset:12544
v_lshl_add_u32 v169, v169, 4, s64
ds_write_b32 v168, v158
ds_read_b128 v[142:145], v169 offset:0
s_waitcnt lgkmcnt(8)
v_mfma_f32_32x32x16_bf16 v[26:41], a[44:47], v[78:81], v[26:41]
s_waitcnt vmcnt(6)
s_barrier
ds_read_b64_tr_b16 v[74:75], v117 offset:12288
ds_read_b64_tr_b16 v[76:77], v117 offset:12544
ds_read_b128 v[146:149], v169 offset:32
ds_read_b128 v[150:153], v169 offset:64
s_waitcnt lgkmcnt(10)
v_mfma_f32_32x32x16_bf16 v[26:41], a[48:51], v[82:85], v[26:41]
s_add_u32 m0, s66, 45056
s_add_u32 s63, s65, 689920
buffer_load_dwordx4 v138, s[8:11], s63 offen lds
ds_read_b64_tr_b16 v[78:79], v114 offset:16384
ds_read_b64_tr_b16 v[80:81], v114 offset:16640
ds_read_b128 v[154:157], v169 offset:96
v_mfma_f32_16x16x32_bf16 v[130:133], v[126:129], v[82:85], v[130:133]
v_mov_b32 v160, 0x3f803f80
s_waitcnt lgkmcnt(11)
v_mfma_f32_32x32x16_bf16 v[26:41], a[52:55], v[86:89], v[26:41]
ds_read_b64_tr_b16 v[82:83], v115 offset:16384
ds_read_b64_tr_b16 v[84:85], v115 offset:16640
v_mov_b32 v161, 0x3f803f80
v_mov_b32 v162, 0x3f803f80
v_mov_b32 v163, 0x3f803f80
s_waitcnt lgkmcnt(11)
v_mfma_f32_32x32x16_bf16 v[26:41], a[56:59], v[90:93], v[26:41]
s_add_u32 m0, s66, 49152
s_add_u32 s63, s65, 861952
buffer_load_dwordx4 v138, s[8:11], s63 offen lds
ds_read_b64_tr_b16 v[86:87], v116 offset:16384
ds_read_b64_tr_b16 v[88:89], v116 offset:16640
v_mov_b32 v164, 0x3f803f80
s_waitcnt lgkmcnt(9)
v_mfma_f32_32x32x16_bf16 v[26:41], a[60:63], v[74:77], v[26:41]
ds_read_b64_tr_b16 v[90:91], v117 offset:16384
ds_read_b64_tr_b16 v[92:93], v117 offset:16640
v_mov_b32 v165, 0x3f803f80
v_mov_b32 v166, 0x3f803f80
v_mov_b32 v167, 0x3f803f80
s_waitcnt lgkmcnt(7)
L_hop0:
s_cbranch_execz L_hop4
v_mfma_f32_32x32x16_bf16 v[26:41], a[64:67], v[78:81], v[26:41]
ds_read_b64_tr_b16 v[74:75], v114 offset:20480
ds_read_b64_tr_b16 v[76:77], v114 offset:20736
v_mfma_f32_16x16x32_bf16 v[130:133], v[126:129], v[78:81], v[130:133]
s_add_u32 m0, s66, 53248
s_add_u32 s63, s65, 1033984
buffer_load_dwordx4 v138, s[8:11], s63 offen lds
s_waitcnt lgkmcnt(6)
v_mfma_f32_32x32x16_bf16 v[26:41], a[68:71], v[82:85], v[26:41]
ds_read_b64_tr_b16 v[78:79], v115 offset:20480
ds_read_b64_tr_b16 v[80:81], v115 offset:20736
s_waitcnt lgkmcnt(6)
v_mfma_f32_32x32x16_bf16 v[26:41], a[72:75], v[86:89], v[26:41]
ds_read_b64_tr_b16 v[82:83], v116 offset:20480
ds_read_b64_tr_b16 v[84:85], v116 offset:20736
s_waitcnt lgkmcnt(6)
v_mfma_f32_32x32x16_bf16 v[26:41], a[76:79], v[90:93], v[26:41]
ds_read_b64_tr_b16 v[86:87], v117 offset:20480
ds_read_b64_tr_b16 v[88:89], v117 offset:20736
s_waitcnt lgkmcnt(6)
v_mfma_f32_32x32x16_bf16 v[26:41], a[80:83], v[74:77], v[26:41]
ds_read_b64_tr_b16 v[90:91], v114 offset:24576
ds_read_b64_tr_b16 v[92:93], v114 offset:24832
v_mfma_f32_16x16x32_bf16 v[130:133], v[126:129], v[74:77], v[130:133]
s_lshl_b32 s60, 1, s33
s_sub_u32 s62, s60, 1
s_and_b32 s62, s62, 54699
s_bcnt1_i32_b32 s62, s62
s_mul_i32 s61, s34, 10
s_add_u32 s62, s62, s61
s_lshl2_add_u32 s62, s62, s32
s_and_b32 s60, s60, 54699
s_cselect_b32 s62, s62, 0x10000
s_mul_i32 s60, s62, 20
v_add_lshl_u32 v139, s60, v0, 7
s_mul_i32 s60, s62, 5
v_add_lshl_u32 v140, s60, v0, 7
s_mov_b64 exec, 0xfffff
buffer_load_dword v141, v139, s[16:19], 0 offen
buffer_load_dword v141, v139, s[20:23], 0 offen
s_mov_b64 exec, 31
buffer_load_dword v141, v140, s[12:15], 0 offen
s_mov_b64 exec, -1
s_waitcnt lgkmcnt(6)
v_mfma_f32_32x32x16_bf16 v[26:41], a[84:87], v[78:81], v[26:41]
ds_read_b64_tr_b16 v[74:75], v115 offset:24576
ds_read_b64_tr_b16 v[76:77], v115 offset:24832
s_waitcnt lgkmcnt(6)
v_mfma_f32_32x32x16_bf16 v[26:41], a[88:91], v[82:85], v[26:41]
ds_read_b64_tr_b16 v[78:79], v116 offset:24576
ds_read_b64_tr_b16 v[80:81], v116 offset:24832
s_waitcnt lgkmcnt(6)
v_mfma_f32_32x32x16_bf16 v[26:41], a[92:95], v[86:89], v[26:41]
ds_read_b64_tr_b16 v[82:83], v117 offset:24576
ds_read_b64_tr_b16 v[84:85], v117 offset:24832
s_waitcnt lgkmcnt(6)
v_mfma_f32_32x32x16_bf16 v[26:41], a[96:99], v[90:93], v[26:41]
v_mfma_f32_16x16x32_bf16 v[130:133], v[126:129], v[90:93], v[130:133]
s_waitcnt lgkmcnt(4)
v_mfma_f32_32x32x16_bf16 v[26:41], a[100:103], v[74:77], v[26:41]
s_waitcnt lgkmcnt(2)
v_mfma_f32_32x32x16_bf16 v[26:41], a[104:107], v[78:81], v[26:41]
s_waitcnt lgkmcnt(0)
v_mfma_f32_32x32x16_bf16 v[26:41], a[108:111], v[82:85], v[26:41]
s_nop 1
ds_write_b32 v111, v130 offset:0
s_waitcnt vmcnt(8) lgkmcnt(0)
s_barrier
ds_read_b32 v106, v110 offset:0
ds_read_b32 v107, v110 offset:256
ds_read_b32 v108, v110 offset:512
ds_read_b32 v109, v110 offset:768
s_add_u32 s61, s35, s36
v_mov_b32 v58, s61
s_lshl4_add_u32 s61, s34, s33
s_lshl_b32 s61, s61, 7
s_add_u32 s61, s61, 4096
s_cmp_eq_u32 s32, 0
s_cselect_b64 exec, 1, 0
s_cbranch_execz LM_skip
buffer_store_dword v58, off, s[4:7], s61 sc1
LM_skip:
s_mov_b64 exec, -1
ds_read_b64_tr_b16 v[74:75], v114 offset:28672
ds_read_b64_tr_b16 v[76:77], v114 offset:28928
ds_read_b64_tr_b16 v[78:79], v115 offset:28672
ds_read_b64_tr_b16 v[80:81], v115 offset:28928
ds_read_b64_tr_b16 v[82:83], v116 offset:28672
ds_read_b64_tr_b16 v[84:85], v116 offset:28928
ds_read_b64_tr_b16 v[86:87], v117 offset:28672
ds_read_b64_tr_b16 v[88:89], v117 offset:28928
s_waitcnt lgkmcnt(6)
v_mfma_f32_32x32x16_bf16 v[42:57], a[0:3], v[74:77], 0
ds_read_b64_tr_b16 v[90:91], v114 offset:32768
ds_read_b64_tr_b16 v[92:93], v114 offset:33024
s_waitcnt lgkmcnt(10)
v_add_f32 v106, v106, v107
v_add_f32 v108, v108, v109
v_add_f32 v106, v106, v108
v_mfma_f32_16x16x32_bf16 v[130:133], v[126:129], v[74:77], 0
v_cvt_pk_bf16_f32 v107, v106, v106
s_waitcnt lgkmcnt(6)
v_mfma_f32_32x32x16_bf16 v[42:57], a[4:7], v[78:81], v[42:57]
ds_read_b64_tr_b16 v[74:75], v115 offset:32768
ds_read_b64_tr_b16 v[76:77], v115 offset:33024
v_and_b32 v108, 0xffff0000, v107
v_sub_f32 v108, v106, v108
v_cvt_pk_bf16_f32 v8, v106, v108
s_waitcnt lgkmcnt(6)
v_mfma_f32_32x32x16_bf16 v[42:57], a[8:11], v[82:85], v[42:57]
ds_read_b64_tr_b16 v[78:79], v116 offset:32768
ds_read_b64_tr_b16 v[80:81], v116 offset:33024
v_and_b32 v107, 0xffff0000, v8
v_sub_f32 v108, v108, v107
v_cvt_pk_bf16_f32 v9, v108, 0
s_waitcnt lgkmcnt(6)
v_mfma_f32_32x32x16_bf16 v[42:57], a[12:15], v[86:89], v[42:57]
s_waitcnt vmcnt(6)
s_barrier
ds_read_b64_tr_b16 v[82:83], v117 offset:32768
ds_read_b64_tr_b16 v[84:85], v117 offset:33024
v_mfma_f32_32x32x16_bf16 v[26:41], v[172:175], v[8:11], v[26:41]
s_waitcnt lgkmcnt(6)
v_mfma_f32_32x32x16_bf16 v[42:57], a[16:19], v[90:93], v[42:57]
ds_read_b64_tr_b16 v[86:87], v114 offset:36864
ds_read_b64_tr_b16 v[88:89], v114 offset:37120
v_mfma_f32_16x16x32_bf16 v[130:133], v[126:129], v[90:93], v[130:133]
s_waitcnt lgkmcnt(6)
v_mfma_f32_32x32x16_bf16 v[42:57], a[20:23], v[74:77], v[42:57]
ds_read_b64_tr_b16 v[90:91], v115 offset:36864
ds_read_b64_tr_b16 v[92:93], v115 offset:37120
s_nop 2
v_mul_f32 v26, v26, v142
v_mul_f32 v27, v27, v143
v_mul_f32 v168, s82, v26
s_waitcnt lgkmcnt(6)
v_mfma_f32_32x32x16_bf16 v[42:57], a[24:27], v[78:81], v[42:57]
ds_read_b64_tr_b16 v[74:75], v116 offset:36864
ds_read_b64_tr_b16 v[76:77], v116 offset:37120
v_mul_f32 v169, s82, v27
v_exp_f32 v168, v168 clamp
s_waitcnt lgkmcnt(6)
v_mfma_f32_32x32x16_bf16 v[42:57], a[28:31], v[82:85], v[42:57]
ds_read_b64_tr_b16 v[78:79], v117 offset:36864
ds_read_b64_tr_b16 v[80:81], v117 offset:37120
v_exp_f32 v169, v169 clamp
v_add_f32 v26, s84, v26
s_waitcnt lgkmcnt(6)
v_mfma_f32_32x32x16_bf16 v[42:57], a[32:35], v[86:89], v[42:57]
ds_read_b64_tr_b16 v[82:83], v114 offset:40960
ds_read_b64_tr_b16 v[84:85], v114 offset:41216
v_add_f32 v27, s84, v27
v_add_f32 v168, s86, v168
v_add_f32 v169, s86, v169
v_max_f32 v168, v168, v26
v_mfma_f32_16x16x32_bf16 v[130:133], v[126:129], v[86:89], v[130:133]
v_max_f32 v169, v169, v27
v_cvt_pk_bf16_f32 v26, v168, v169
v_mul_f32 v28, v28, v144
s_waitcnt lgkmcnt(6)
v_mfma_f32_32x32x16_bf16 v[42:57], a[36:39], v[90:93], v[42:57]
ds_read_b64_tr_b16 v[86:87], v115 offset:40960
ds_read_b64_tr_b16 v[88:89], v115 offset:41216
v_mul_f32 v29, v29, v145
v_mul_f32 v170, s82, v28
v_mul_f32 v171, s82, v29
s_waitcnt lgkmcnt(6)
v_mfma_f32_32x32x16_bf16 v[42:57], a[40:43], v[74:77], v[42:57]
ds_read_b64_tr_b16 v[90:91], v116 offset:40960
ds_read_b64_tr_b16 v[92:93], v116 offset:41216
v_exp_f32 v170, v170 clamp
v_exp_f32 v171, v171 clamp
s_waitcnt lgkmcnt(6)
v_mfma_f32_32x32x16_bf16 v[42:57], a[44:47], v[78:81], v[42:57]
s_waitcnt vmcnt(3)
s_barrier
ds_read_b64_tr_b16 v[74:75], v117 offset:40960
ds_read_b64_tr_b16 v[76:77], v117 offset:41216
v_add_f32 v28, s84, v28
v_add_f32 v29, s84, v29
s_waitcnt lgkmcnt(6)
v_mfma_f32_32x32x16_bf16 v[42:57], a[48:51], v[82:85], v[42:57]
ds_read_b64_tr_b16 v[78:79], v114 offset:45056
ds_read_b64_tr_b16 v[80:81], v114 offset:45312
v_add_f32 v170, s86, v170
v_add_f32 v171, s86, v171
v_max_f32 v170, v170, v28
v_max_f32 v171, v171, v29
v_mfma_f32_16x16x32_bf16 v[130:133], v[126:129], v[82:85], v[130:133]
s_mul_i32 s65, s32, 43008
s_mul_i32 s66, s101, 56
s_add_u32 s65, s65, s66
s_lshl_b32 s66, s32, 10
v_cvt_pk_bf16_f32 v27, v170, v171
v_mul_f32 v30, v30, v146
s_waitcnt lgkmcnt(6)
v_mfma_f32_32x32x16_bf16 v[42:57], a[52:55], v[86:89], v[42:57]
ds_read_b64_tr_b16 v[82:83], v115 offset:45056
ds_read_b64_tr_b16 v[84:85], v115 offset:45312
v_mul_f32 v31, v31, v147
v_mul_f32 v168, s82, v30
v_mul_f32 v169, s82, v31
s_waitcnt lgkmcnt(6)
v_mfma_f32_32x32x16_bf16 v[42:57], a[56:59], v[90:93], v[42:57]
s_add_u32 m0, s66, 57344
s_add_u32 s63, s65, 0
buffer_load_dwordx4 v138, s[8:11], s63 offen lds
ds_read_b64_tr_b16 v[86:87], v116 offset:45056
ds_read_b64_tr_b16 v[88:89], v116 offset:45312
v_exp_f32 v168, v168 clamp
s_waitcnt lgkmcnt(6)
v_mfma_f32_32x32x16_bf16 v[42:57], a[60:63], v[74:77], v[42:57]
ds_read_b64_tr_b16 v[90:91], v117 offset:45056
ds_read_b64_tr_b16 v[92:93], v117 offset:45312
v_exp_f32 v169, v169 clamp
v_add_f32 v30, s84, v30
s_waitcnt lgkmcnt(6)
v_mfma_f32_32x32x16_bf16 v[42:57], a[64:67], v[78:81], v[42:57]
s_add_u32 m0, s66, 61440
s_add_u32 s63, s65, 172032
buffer_load_dwordx4 v138, s[8:11], s63 offen lds
ds_read_b64_tr_b16 v[74:75], v114 offset:49152
ds_read_b64_tr_b16 v[76:77], v114 offset:49408
v_add_f32 v31, s84, v31
v_add_f32 v168, s86, v168
v_mfma_f32_16x16x32_bf16 v[130:133], v[126:129], v[78:81], v[130:133]
v_add_f32 v169, s86, v169
v_max_f32 v168, v168, v30
s_waitcnt lgkmcnt(6)
v_mfma_f32_32x32x16_bf16 v[42:57], a[68:71], v[82:85], v[42:57]
s_add_u32 m0, s66, 65536
s_add_u32 s63, s65, 344064
buffer_load_dwordx4 v138, s[8:11], s63 offen lds
ds_read_b64_tr_b16 v[78:79], v115 offset:49152
ds_read_b64_tr_b16 v[80:81], v115 offset:49408
v_max_f32 v169, v169, v31
v_cvt_pk_bf16_f32 v28, v168, v169
s_waitcnt lgkmcnt(6)
v_mfma_f32_32x32x16_bf16 v[42:57], a[72:75], v[86:89], v[42:57]
ds_read_b64_tr_b16 v[82:83], v116 offset:49152
ds_read_b64_tr_b16 v[84:85], v116 offset:49408
v_mul_f32 v32, v32, v148
v_mul_f32 v33, v33, v149
v_mul_f32 v170, s82, v32
s_waitcnt lgkmcnt(6)
v_mfma_f32_32x32x16_bf16 v[42:57], a[76:79], v[90:93], v[42:57]
s_add_u32 m0, s66, 69632
s_add_u32 s63, s65, 516096
buffer_load_dwordx4 v138, s[8:11], s63 offen lds
ds_read_b64_tr_b16 v[86:87], v117 offset:49152
ds_read_b64_tr_b16 v[88:89], v117 offset:49408
v_mul_f32 v171, s82, v33
v_exp_f32 v170, v170 clamp
s_waitcnt lgkmcnt(6)
v_mfma_f32_32x32x16_bf16 v[42:57], a[80:83], v[74:77], v[42:57]
ds_read_b64_tr_b16 v[90:91], v114 offset:53248
ds_read_b64_tr_b16 v[92:93], v114 offset:53504
v_exp_f32 v171, v171 clamp
v_add_f32 v32, s84, v32
v_add_f32 v33, s84, v33
v_mfma_f32_16x16x32_bf16 v[130:133], v[126:129], v[74:77], v[130:133]
s_add_u32 m0, s66, 73728
s_add_u32 s63, s65, 688128
buffer_load_dwordx4 v138, s[8:11], s63 offen lds
v_add_f32 v170, s86, v170
s_waitcnt lgkmcnt(6)
v_mfma_f32_32x32x16_bf16 v[42:57], a[84:87], v[78:81], v[42:57]
ds_read_b64_tr_b16 v[74:75], v115 offset:53248
ds_read_b64_tr_b16 v[76:77], v115 offset:53504
v_add_f32 v171, s86, v171
v_max_f32 v170, v170, v32
v_max_f32 v171, v171, v33
s_waitcnt lgkmcnt(6)
v_mfma_f32_32x32x16_bf16 v[42:57], a[88:91], v[82:85], v[42:57]
s_add_u32 m0, s66, 77824
s_add_u32 s63, s65, 860160
buffer_load_dwordx4 v138, s[8:11], s63 offen lds
ds_read_b64_tr_b16 v[78:79], v116 offset:53248
ds_read_b64_tr_b16 v[80:81], v116 offset:53504
v_cvt_pk_bf16_f32 v29, v170, v171
s_waitcnt lgkmcnt(6)
v_mfma_f32_32x32x16_bf16 v[42:57], a[92:95], v[86:89], v[42:57]
ds_read_b64_tr_b16 v[82:83], v117 offset:53248
ds_read_b64_tr_b16 v[84:85], v117 offset:53504
s_waitcnt lgkmcnt(6)
v_mfma_f32_32x32x16_bf16 v[42:57], a[96:99], v[90:93], v[42:57]
s_add_u32 m0, s66, 81920
s_add_u32 s63, s65, 1032192
buffer_load_dwordx4 v138, s[8:11], s63 offen lds
v_mfma_f32_16x16x32_bf16 v[130:133], v[126:129], v[90:93], v[130:133]
s_waitcnt lgkmcnt(4)
v_mfma_f32_32x32x16_bf16 v[42:57], a[100:103], v[74:77], v[42:57]
s_waitcnt lgkmcnt(2)
v_mfma_f32_32x32x16_bf16 v[42:57], a[104:107], v[78:81], v[42:57]
s_waitcnt lgkmcnt(0)
v_mfma_f32_32x32x16_bf16 v[42:57], a[108:111], v[82:85], v[42:57]
s_nop 1
ds_write_b32 v111, v130 offset:1024
s_waitcnt lgkmcnt(0)
s_barrier
ds_read_b32 v106, v110 offset:1024
ds_read_b32 v107, v110 offset:1280
ds_read_b32 v108, v110 offset:1536
ds_read_b32 v109, v110 offset:1792
v_pk_mul_f32 v[34:35], v[34:35], v[150:151]
v_pk_mul_f32 v[168:169], v[34:35], s[82:83]
v_exp_f32 v168, v168 clamp
v_exp_f32 v169, v169 clamp
v_pk_add_f32 v[34:35], v[34:35], s[84:85]
v_pk_add_f32 v[168:169], v[168:169], s[86:87]
v_max_f32 v168, v168, v34
v_max_f32 v169, v169, v35
v_cvt_pk_bf16_f32 v30, v168, v169
v_pk_mul_f32 v[36:37], v[36:37], v[152:153]
v_pk_mul_f32 v[170:171], v[36:37], s[82:83]
v_exp_f32 v170, v170 clamp
v_exp_f32 v171, v171 clamp
v_pk_add_f32 v[36:37], v[36:37], s[84:85]
v_pk_add_f32 v[170:171], v[170:171], s[86:87]
v_max_f32 v170, v170, v36
v_max_f32 v171, v171, v37
v_cvt_pk_bf16_f32 v31, v170, v171
v_pk_mul_f32 v[38:39], v[38:39], v[154:155]
v_pk_mul_f32 v[168:169], v[38:39], s[82:83]
v_exp_f32 v168, v168 clamp
v_exp_f32 v169, v169 clamp
v_pk_add_f32 v[38:39], v[38:39], s[84:85]
v_pk_add_f32 v[168:169], v[168:169], s[86:87]
v_max_f32 v168, v168, v38
v_max_f32 v169, v169, v39
v_cvt_pk_bf16_f32 v32, v168, v169
v_pk_mul_f32 v[40:41], v[40:41], v[156:157]
v_pk_mul_f32 v[170:171], v[40:41], s[82:83]
v_exp_f32 v170, v170 clamp
v_exp_f32 v171, v171 clamp
v_pk_add_f32 v[40:41], v[40:41], s[84:85]
v_pk_add_f32 v[170:171], v[170:171], s[86:87]
v_max_f32 v170, v170, v40
v_max_f32 v171, v171, v41
v_cvt_pk_bf16_f32 v33, v170, v171
s_waitcnt lgkmcnt(0)
v_add_f32 v106, v106, v107
v_add_f32 v108, v108, v109
v_add_f32 v106, v106, v108
v_cvt_pk_bf16_f32 v107, v106, v106
v_and_b32 v108, 0xffff0000, v107
v_sub_f32 v108, v106, v108
v_cvt_pk_bf16_f32 v10, v106, v108
v_and_b32 v107, 0xffff0000, v10
v_sub_f32 v108, v108, v107
v_cvt_pk_bf16_f32 v11, v108, 0
s_nop 1
v_mfma_f32_32x32x16_bf16 v[42:57], v[172:175], v[10:13], v[42:57]
s_nop 11
v_pk_mul_f32 v[42:43], v[42:43], v[142:143]
v_pk_mul_f32 v[44:45], v[44:45], v[144:145]
v_pk_mul_f32 v[46:47], v[46:47], v[146:147]
v_pk_mul_f32 v[48:49], v[48:49], v[148:149]
v_pk_mul_f32 v[50:51], v[50:51], v[150:151]
v_pk_mul_f32 v[52:53], v[52:53], v[152:153]
v_pk_mul_f32 v[54:55], v[54:55], v[154:155]
v_pk_mul_f32 v[56:57], v[56:57], v[156:157]
s_mov_b64 exec, s[54:55]
v_cvt_pk_bf16_f32 v160, v42, v43
v_cvt_pk_bf16_f32 v161, v44, v45
v_cvt_pk_bf16_f32 v162, v46, v47
v_cvt_pk_bf16_f32 v163, v48, v49
v_cvt_pk_bf16_f32 v164, v50, v51
v_cvt_pk_bf16_f32 v165, v52, v53
v_cvt_pk_bf16_f32 v166, v54, v55
v_cvt_pk_bf16_f32 v167, v56, v57
s_mov_b64 exec, -1
s_add_u32 s61, s89, 143360
v_add_u32 v168, s61, v1
v_mfma_f32_32x32x16_bf16 v[42:57], v[26:29], v[160:163], 0
v_mfma_f32_32x32x16_bf16 v[42:57], v[30:33], v[164:167], v[42:57]
s_lshr_b32 s61, s89, 2
s_add_u32 s61, s61, 143360
v_add_u32 v169, s61, v1
s_nop 8
ds_write_b128 v168, v[42:45] offset:0
ds_write_b128 v168, v[46:49] offset:1024
ds_write_b128 v168, v[50:53] offset:2048
ds_write_b128 v168, v[54:57] offset:3072
s_waitcnt lgkmcnt(0)
s_barrier
ds_read_b128 v[26:29], v169 offset:0
ds_read_b128 v[30:33], v169 offset:4096
ds_read_b128 v[34:37], v169 offset:8192
ds_read_b128 v[38:41], v169 offset:12288
v_lshlrev_b32 v160, 3, v0
v_mov_b32 v161, s81
v_cndmask_b32 v161, -2, v161, s[56:57]
s_waitcnt lgkmcnt(2)
v_pk_add_f32 v[26:27], v[26:27], v[30:31]
v_pk_add_f32 v[28:29], v[28:29], v[32:33]
s_waitcnt lgkmcnt(0)
v_pk_add_f32 v[34:35], v[34:35], v[38:39]
v_pk_add_f32 v[36:37], v[36:37], v[40:41]
v_pk_add_f32 v[26:27], v[26:27], v[34:35]
v_pk_add_f32 v[28:29], v[28:29], v[36:37]
v_cvt_pk_bf16_f32 v26, v26, v27
v_cvt_pk_bf16_f32 v27, v28, v29
v_min_u32 v26, v161, v26
v_min_u32 v27, v161, v27
buffer_store_dwordx2 v[26:27], v160, s[4:7], s42 offen sc1
v_and_b32 v122, 15, v0
s_lshl_b32 s61, s34, 4
v_add_u32 v123, s61, v122
v_lshl_add_u32 v122, v122, 4, s101
v_cmp_gt_u32 vcc, 16, v0
s_movk_i32 s63, 4096
s_nop 0
v_cndmask_b32 v123, v122, v123, vcc
v_lshlrev_b32 v123, 7, v123
s_mov_b32 exec_hi, 0
buffer_load_dword v122, v123, s[4:7], s63 offen sc1
s_mov_b64 exec, -1
v_lshrrev_b32 v136, 3, v0
v_mul_u32_u24 v136, 2688, v136
v_add_u32 v136, v136, v6
s_and_b32 s67, s32, 1
s_lshl_b32 s62, s67, 6
v_xor_b32 v137, s62, v5
s_mul_i32 s67, s67, 200704
s_lshr_b32 s62, s32, 1
s_mul_i32 s61, s62, 14336
s_add_u32 s61, s61, 86016
v_add_u32 v137, s61, v137
s_lshl_b32 s62, s62, 7
s_add_u32 s67, s67, s62
s_lshl_b32 s62, s69, 8
s_add_u32 s67, s67, s62
s_add_u32 m0, s78, 86016
s_add_u32 s63, s67, 0
buffer_load_dwordx4 v136, s[16:19], s63 offen offset:0 lds
s_add_u32 s63, s67, 27648
buffer_load_dwordx4 v136, s[16:19], s63 offen offset:1024 lds
s_add_u32 s63, s67, 55296
buffer_load_dwordx4 v136, s[16:19], s63 offen offset:2048 lds
s_add_u32 s63, s67, 82944
buffer_load_dwordx4 v136, s[16:19], s63 offen offset:3072 lds
s_add_u32 m0, s78, 90112
s_add_u32 s63, s67, 114688
buffer_load_dwordx4 v136, s[16:19], s63 offen offset:0 lds
s_add_u32 s63, s67, 142336
buffer_load_dwordx4 v136, s[16:19], s63 offen offset:1024 lds
s_add_u32 s63, s67, 169984
buffer_load_dwordx4 v136, s[16:19], s63 offen offset:2048 lds
s_add_u32 m0, s78, 114688
s_add_u32 s63, s67, 401408
buffer_load_dwordx4 v136, s[16:19], s63 offen offset:0 lds
s_add_u32 s63, s67, 429056
buffer_load_dwordx4 v136, s[16:19], s63 offen offset:1024 lds
s_add_u32 s63, s67, 456704
buffer_load_dwordx4 v136, s[16:19], s63 offen offset:2048 lds
s_add_u32 s63, s67, 484352
buffer_load_dwordx4 v136, s[16:19], s63 offen offset:3072 lds
s_add_u32 m0, s78, 118784
s_add_u32 s63, s67, 516096
buffer_load_dwordx4 v136, s[16:19], s63 offen offset:0 lds
s_add_u32 s63, s67, 543744
buffer_load_dwordx4 v136, s[16:19], s63 offen offset:1024 lds
s_add_u32 s63, s67, 571392
buffer_load_dwordx4 v136, s[16:19], s63 offen offset:2048 lds
v_lshlrev_b32 v168, 7, v0
s_mov_b64 exec, 0xffff
buffer_load_dword v141, v168, s[4:7], s72 offen
s_mov_b64 exec, -1
v_add_u32 v114, 57344, v114
v_add_u32 v115, 57344, v115
v_add_u32 v116, 57344, v116
v_add_u32 v117, 57344, v117
s_waitcnt vmcnt(17)
s_barrier
ds_read_b64_tr_b16 v[74:75], v114 offset:0
ds_read_b64_tr_b16 v[76:77], v114 offset:256
ds_read_b64_tr_b16 v[78:79], v115 offset:0
ds_read_b64_tr_b16 v[80:81], v115 offset:256
ds_read_b64_tr_b16 v[82:83], v116 offset:0
ds_read_b64_tr_b16 v[84:85], v116 offset:256
ds_read_b64_tr_b16 v[86:87], v117 offset:0
ds_read_b64_tr_b16 v[88:89], v117 offset:256
s_waitcnt lgkmcnt(6)
v_mfma_f32_32x32x16_bf16 v[58:73], v[74:77], a[0:3], 0
ds_read_b64_tr_b16 v[90:91], v114 offset:4096
ds_read_b64_tr_b16 v[92:93], v114 offset:4352
v_mfma_f32_16x16x32_bf16 v[130:133], v[126:129], v[74:77], 0
s_waitcnt lgkmcnt(6)
v_mfma_f32_32x32x16_bf16 v[58:73], v[78:81], a[4:7], v[58:73]
s_mov_b32 exec_hi, 0
s_waitcnt vmcnt(15)
LM_check:
v_subrev_u32 v122, s35, v122
v_cmp_le_u32 vcc, 16, v122
s_cbranch_vccnz LM_again
LM_done:
v_cmp_ne_u32 vcc, s36, v122
s_and_b32 s36, vcc_lo, 0xffff
s_mov_b64 exec, -1
s_waitcnt vmcnt(8)
s_barrier
ds_read_b64_tr_b16 v[74:75], v115 offset:4096
ds_read_b64_tr_b16 v[76:77], v115 offset:4352
s_waitcnt lgkmcnt(6)
v_mfma_f32_32x32x16_bf16 v[58:73], v[82:85], a[8:11], v[58:73]
ds_read_b64_tr_b16 a[224:225], v137 offset:0
ds_read_b64_tr_b16 a[226:227], v137 offset:512
s_add_u32 s65, s43, 0
buffer_load_dwordx2 v[28:29], v160, s[4:7], s65 offen offset:0 sc1
ds_read_b64_tr_b16 v[78:79], v116 offset:4096
ds_read_b64_tr_b16 v[80:81], v116 offset:4352
s_waitcnt lgkmcnt(8)
v_mfma_f32_32x32x16_bf16 v[58:73], v[86:89], a[12:15], v[58:73]
ds_read_b64_tr_b16 a[228:229], v137 offset:2048
ds_read_b64_tr_b16 a[230:231], v137 offset:2560
buffer_load_dwordx2 v[30:31], v160, s[4:7], s65 offen offset:512 sc1
ds_read_b64_tr_b16 v[82:83], v117 offset:4096
ds_read_b64_tr_b16 v[84:85], v117 offset:4352
s_waitcnt lgkmcnt(10)
v_mfma_f32_32x32x16_bf16 v[58:73], v[90:93], a[16:19], v[58:73]
ds_read_b64_tr_b16 a[232:233], v137 offset:4096
ds_read_b64_tr_b16 a[234:235], v137 offset:4608
buffer_load_dwordx2 v[32:33], v160, s[4:7], s65 offen offset:1024 sc1
ds_read_b64_tr_b16 v[86:87], v114 offset:8192
ds_read_b64_tr_b16 v[88:89], v114 offset:8448
v_mfma_f32_16x16x32_bf16 v[130:133], v[126:129], v[90:93], v[130:133]
ds_read_b64_tr_b16 a[236:237], v137 offset:6144
ds_read_b64_tr_b16 a[238:239], v137 offset:6656
buffer_load_dwordx2 v[34:35], v160, s[4:7], s65 offen offset:1536 sc1
s_waitcnt lgkmcnt(14)
v_mfma_f32_32x32x16_bf16 v[58:73], v[74:77], a[20:23], v[58:73]
ds_read_b64_tr_b16 a[240:241], v137 offset:8192
ds_read_b64_tr_b16 a[242:243], v137 offset:8704
buffer_load_dwordx2 v[36:37], v160, s[4:7], s65 offen offset:2048 sc1
ds_read_b64_tr_b16 v[90:91], v115 offset:8192
ds_read_b64_tr_b16 v[92:93], v115 offset:8448
s_waitcnt lgkmcnt(14)
v_mfma_f32_32x32x16_bf16 v[58:73], v[78:81], a[24:27], v[58:73]
ds_read_b64_tr_b16 a[244:245], v137 offset:10240
ds_read_b64_tr_b16 a[246:247], v137 offset:10752
buffer_load_dwordx2 v[38:39], v160, s[4:7], s65 offen offset:2560 sc1
ds_read_b64_tr_b16 v[74:75], v116 offset:8192
ds_read_b64_tr_b16 v[76:77], v116 offset:8448
s_waitcnt lgkmcnt(14)
v_mfma_f32_32x32x16_bf16 v[58:73], v[82:85], a[28:31], v[58:73]
ds_read_b64_tr_b16 a[248:249], v137 offset:12288
ds_read_b64_tr_b16 a[250:251], v137 offset:12800
buffer_load_dwordx2 v[40:41], v160, s[4:7], s65 offen offset:3072 sc1
ds_read_b64_tr_b16 v[78:79], v117 offset:8192
ds_read_b64_tr_b16 v[80:81], v117 offset:8448
s_waitcnt lgkmcnt(14)
v_mfma_f32_32x32x16_bf16 v[58:73], v[86:89], a[32:35], v[58:73]
s_waitcnt lgkmcnt(0)
s_barrier
buffer_load_dwordx2 v[42:43], v160, s[4:7], s65 offen offset:3584 sc1
ds_read_b64_tr_b16 v[82:83], v114 offset:12288
ds_read_b64_tr_b16 v[84:85], v114 offset:12544
v_mfma_f32_16x16x32_bf16 v[130:133], v[126:129], v[86:89], v[130:133]
s_add_u32 s65, s43, 4096
buffer_load_dwordx2 v[44:45], v160, s[4:7], s65 offen offset:0 sc1
s_waitcnt lgkmcnt(10)
v_mfma_f32_32x32x16_bf16 v[58:73], v[90:93], a[36:39], v[58:73]
buffer_load_dwordx2 v[46:47], v160, s[4:7], s65 offen offset:512 sc1
ds_read_b64_tr_b16 v[86:87], v115 offset:12288
ds_read_b64_tr_b16 v[88:89], v115 offset:12544
s_waitcnt lgkmcnt(8)
v_mfma_f32_32x32x16_bf16 v[58:73], v[74:77], a[40:43], v[58:73]
buffer_load_dwordx2 v[48:49], v160, s[4:7], s65 offen offset:1024 sc1
ds_read_b64_tr_b16 v[90:91], v116 offset:12288
ds_read_b64_tr_b16 v[92:93], v116 offset:12544
s_waitcnt lgkmcnt(6)
v_mfma_f32_32x32x16_bf16 v[58:73], v[78:81], a[44:47], v[58:73]
buffer_load_dwordx2 v[50:51], v160, s[4:7], s65 offen offset:1536 sc1
ds_read_b64_tr_b16 v[74:75], v117 offset:12288
ds_read_b64_tr_b16 v[76:77], v117 offset:12544
s_waitcnt lgkmcnt(6)
v_mfma_f32_32x32x16_bf16 v[58:73], v[82:85], a[48:51], v[58:73]
buffer_load_dwordx2 v[52:53], v160, s[4:7], s65 offen offset:2048 sc1
ds_read_b64_tr_b16 v[78:79], v114 offset:16384
ds_read_b64_tr_b16 v[80:81], v114 offset:16640
v_mfma_f32_16x16x32_bf16 v[130:133], v[126:129], v[82:85], v[130:133]
buffer_load_dwordx2 v[54:55], v160, s[4:7], s65 offen offset:2560 sc1
s_waitcnt lgkmcnt(6)
v_mfma_f32_32x32x16_bf16 v[58:73], v[86:89], a[52:55], v[58:73]
buffer_load_dwordx2 v[56:57], v160, s[4:7], s65 offen offset:3072 sc1
ds_read_b64_tr_b16 v[82:83], v115 offset:16384
ds_read_b64_tr_b16 v[84:85], v115 offset:16640
s_waitcnt lgkmcnt(6)
v_mfma_f32_32x32x16_bf16 v[58:73], v[90:93], a[56:59], v[58:73]
buffer_load_dwordx2 v[26:27], v160, s[4:7], s65 offen offset:3584 sc1
s_lshr_b32 s66, s32, 1
s_mul_i32 s66, s66, 4
s_and_b32 s62, s32, 1
s_add_u32 s66, s66, s62
ds_read_b64_tr_b16 v[86:87], v116 offset:16384
ds_read_b64_tr_b16 v[88:89], v116 offset:16640
s_waitcnt lgkmcnt(6)
v_mfma_f32_32x32x16_bf16 v[58:73], v[74:77], a[60:63], v[58:73]
s_mul_i32 s66, s66, 50176
s_lshl_b32 s62, s38, 7
s_add_u32 s66, s66, s62
ds_read_b64_tr_b16 v[90:91], v117 offset:16384
ds_read_b64_tr_b16 v[92:93], v117 offset:16640
s_waitcnt lgkmcnt(6)
v_mfma_f32_32x32x16_bf16 v[58:73], v[78:81], a[64:67], v[58:73]
s_add_u32 m0, s78, 86016
s_add_u32 s63, s66, 0
buffer_load_dwordx4 v6, s[12:15], s63 offen offset:0 lds
ds_read_b64_tr_b16 v[74:75], v114 offset:20480
ds_read_b64_tr_b16 v[76:77], v114 offset:20736
v_mfma_f32_16x16x32_bf16 v[130:133], v[126:129], v[78:81], v[130:133]
s_add_u32 s63, s66, 6144
buffer_load_dwordx4 v6, s[12:15], s63 offen offset:1024 lds
s_waitcnt lgkmcnt(6)
v_mfma_f32_32x32x16_bf16 v[58:73], v[82:85], a[68:71], v[58:73]
s_add_u32 s63, s66, 12288
buffer_load_dwordx4 v6, s[12:15], s63 offen offset:2048 lds
ds_read_b64_tr_b16 v[78:79], v115 offset:20480
ds_read_b64_tr_b16 v[80:81], v115 offset:20736
L_hop1:
s_cbranch_execz L_hop5
s_waitcnt lgkmcnt(6)
v_mfma_f32_32x32x16_bf16 v[58:73], v[86:89], a[72:75], v[58:73]
s_add_u32 s63, s66, 18432
buffer_load_dwordx4 v6, s[12:15], s63 offen offset:3072 lds
ds_read_b64_tr_b16 v[82:83], v116 offset:20480
ds_read_b64_tr_b16 v[84:85], v116 offset:20736
s_waitcnt lgkmcnt(6)
v_mfma_f32_32x32x16_bf16 v[58:73], v[90:93], a[76:79], v[58:73]
s_add_u32 m0, s78, 90112
s_add_u32 s63, s66, 28672
buffer_load_dwordx4 v6, s[12:15], s63 offen offset:0 lds
ds_read_b64_tr_b16 v[86:87], v117 offset:20480
ds_read_b64_tr_b16 v[88:89], v117 offset:20736
s_waitcnt lgkmcnt(6)
v_mfma_f32_32x32x16_bf16 v[58:73], v[74:77], a[80:83], v[58:73]
s_add_u32 s63, s66, 34816
buffer_load_dwordx4 v6, s[12:15], s63 offen offset:1024 lds
ds_read_b64_tr_b16 v[90:91], v114 offset:24576
ds_read_b64_tr_b16 v[92:93], v114 offset:24832
v_mfma_f32_16x16x32_bf16 v[130:133], v[126:129], v[74:77], v[130:133]
s_add_u32 s63, s66, 40960
buffer_load_dwordx4 v6, s[12:15], s63 offen offset:2048 lds
s_waitcnt vmcnt(24)
s_barrier
s_waitcnt lgkmcnt(6)
v_mfma_f32_32x32x16_bf16 v[58:73], v[78:81], a[84:87], v[58:73]
ds_read_b64_tr_b16 a[252:253], v137 offset:28672
ds_read_b64_tr_b16 a[254:255], v137 offset:29184
ds_read_b64_tr_b16 v[74:75], v115 offset:24576
ds_read_b64_tr_b16 v[76:77], v115 offset:24832
s_waitcnt lgkmcnt(8)
v_mfma_f32_32x32x16_bf16 v[58:73], v[82:85], a[88:91], v[58:73]
ds_read_b64_tr_b16 v[176:177], v137 offset:30720
ds_read_b64_tr_b16 v[178:179], v137 offset:31232
ds_read_b64_tr_b16 v[78:79], v116 offset:24576
ds_read_b64_tr_b16 v[80:81], v116 offset:24832
s_waitcnt lgkmcnt(10)
v_mfma_f32_32x32x16_bf16 v[58:73], v[86:89], a[92:95], v[58:73]
ds_read_b64_tr_b16 v[180:181], v137 offset:32768
ds_read_b64_tr_b16 v[182:183], v137 offset:33280
ds_read_b64_tr_b16 v[82:83], v117 offset:24576
ds_read_b64_tr_b16 v[84:85], v117 offset:24832
s_waitcnt lgkmcnt(12)
v_mfma_f32_32x32x16_bf16 v[58:73], v[90:93], a[96:99], v[58:73]
ds_read_b64_tr_b16 v[184:185], v137 offset:34816
ds_read_b64_tr_b16 v[186:187], v137 offset:35328
v_mfma_f32_16x16x32_bf16 v[130:133], v[126:129], v[90:93], v[130:133]
ds_read_b64_tr_b16 v[188:189], v137 offset:36864
ds_read_b64_tr_b16 v[190:191], v137 offset:37376
s_waitcnt lgkmcnt(12)
v_mfma_f32_32x32x16_bf16 v[58:73], v[74:77], a[100:103], v[58:73]
ds_read_b64_tr_b16 v[192:193], v137 offset:38912
ds_read_b64_tr_b16 v[194:195], v137 offset:39424
s_waitcnt lgkmcnt(10)
v_mfma_f32_32x32x16_bf16 v[58:73], v[78:81], a[104:107], v[58:73]
ds_read_b64_tr_b16 v[196:197], v137 offset:40960
ds_read_b64_tr_b16 v[198:199], v137 offset:41472
s_waitcnt lgkmcnt(8)
v_mfma_f32_32x32x16_bf16 v[58:73], v[82:85], a[108:111], v[58:73]
ds_write_b32 v111, v130 offset:0
s_waitcnt lgkmcnt(0)
s_barrier
s_add_u32 m0, s78, 114688
s_add_u32 s63, s66, 100352
buffer_load_dwordx4 v6, s[12:15], s63 offen offset:0 lds
s_add_u32 s63, s66, 106496
buffer_load_dwordx4 v6, s[12:15], s63 offen offset:1024 lds
s_add_u32 s63, s66, 112640
buffer_load_dwordx4 v6, s[12:15], s63 offen offset:2048 lds
s_add_u32 s63, s66, 118784
buffer_load_dwordx4 v6, s[12:15], s63 offen offset:3072 lds
s_add_u32 m0, s78, 118784
s_add_u32 s63, s66, 129024
buffer_load_dwordx4 v6, s[12:15], s63 offen offset:0 lds
s_add_u32 s63, s66, 135168
buffer_load_dwordx4 v6, s[12:15], s63 offen offset:1024 lds
s_add_u32 s63, s66, 141312
buffer_load_dwordx4 v6, s[12:15], s63 offen offset:2048 lds
s_waitcnt lgkmcnt(0)
s_barrier
ds_read_b32 v106, v110 offset:0
ds_read_b32 v107, v110 offset:256
ds_read_b32 v108, v110 offset:512
ds_read_b32 v109, v110 offset:768
s_waitcnt lgkmcnt(0)
v_add_f32 v106, v106, v107
v_add_f32 v108, v108, v109
v_add_f32 v106, v106, v108
v_cvt_pk_bf16_f32 v107, v106, v106
v_and_b32 v108, 0xffff0000, v107
v_sub_f32 v108, v106, v108
v_cvt_pk_bf16_f32 v12, v106, v108
v_and_b32 v107, 0xffff0000, v12
v_sub_f32 v108, v108, v107
v_cvt_pk_bf16_f32 v13, v108, 0
s_nop 1
v_mfma_f32_32x32x16_bf16 v[58:73], v[12:15], v[172:175], v[58:73]
s_and_b32 s61, s32, 1
s_lshl_b32 s62, s61, 6
s_mul_i32 s61, s61, 14336
s_add_u32 s61, s61, 86016
v_xor_b32 v74, s62, v5
v_xor_b32 v75, 64, v74
v_add_u32 v74, s61, v74
v_add_u32 v75, s61, v75
v_lshrrev_b32 v78, 5, v0
v_lshlrev_b32 v78, 9, v78
v_sub_u32 v76, v74, v78
v_sub_u32 v77, v75, v78
s_waitcnt vmcnt(7)
s_barrier
ds_read_b64_tr_b16 a[96:97], v74 offset:0
ds_read_b64_tr_b16 a[98:99], v74 offset:512
ds_read_b64_tr_b16 a[100:101], v75 offset:0
ds_read_b64_tr_b16 a[102:103], v75 offset:512
ds_read_b64_tr_b16 a[104:105], v74 offset:2048
ds_read_b64_tr_b16 a[106:107], v76 offset:2560
ds_read_b64_tr_b16 a[108:109], v75 offset:2048
ds_read_b64_tr_b16 a[110:111], v77 offset:2560
ds_read_b64_tr_b16 a[112:113], v74 offset:3584
ds_read_b64_tr_b16 a[114:115], v74 offset:4096
ds_read_b64_tr_b16 a[116:117], v75 offset:3584
ds_read_b64_tr_b16 a[118:119], v75 offset:4096
ds_read_b64_tr_b16 a[120:121], v74 offset:5632
ds_read_b64_tr_b16 a[122:123], v76 offset:6144
ds_read_b64_tr_b16 a[124:125], v75 offset:5632
ds_read_b64_tr_b16 a[126:127], v77 offset:6144
ds_read_b64_tr_b16 a[128:129], v74 offset:7168
ds_read_b64_tr_b16 a[130:131], v74 offset:7680
ds_read_b64_tr_b16 a[132:133], v75 offset:7168
ds_read_b64_tr_b16 a[134:135], v75 offset:7680
ds_read_b64_tr_b16 a[136:137], v74 offset:9216
ds_read_b64_tr_b16 a[138:139], v76 offset:9728
ds_read_b64_tr_b16 a[140:141], v75 offset:9216
ds_read_b64_tr_b16 a[142:143], v77 offset:9728
ds_read_b64_tr_b16 a[144:145], v74 offset:10752
ds_read_b64_tr_b16 a[146:147], v74 offset:11264
ds_read_b64_tr_b16 a[148:149], v75 offset:10752
ds_read_b64_tr_b16 a[150:151], v75 offset:11264
ds_read_b64_tr_b16 a[152:153], v74 offset:12800
ds_read_b64_tr_b16 a[154:155], v76 offset:13312
ds_read_b64_tr_b16 a[156:157], v75 offset:12800
ds_read_b64_tr_b16 a[158:159], v77 offset:13312
v_pk_mul_f32 v[168:169], v[58:59], v[158:159] op_sel:[0,1] op_sel_hi:[1,1]
v_exp_f32 v168, v168 clamp
v_exp_f32 v169, v169 clamp
v_pk_fma_f32 v[58:59], v[58:59], v[158:159], s[84:85] op_sel_hi:[1,0,1]
v_pk_add_f32 v[168:169], v[168:169], s[86:87]
v_max_f32 v168, v168, v58
v_max_f32 v169, v169, v59
v_cvt_pk_bf16_f32 v142, v168, v169
v_pk_mul_f32 v[170:171], v[60:61], v[158:159] op_sel:[0,1] op_sel_hi:[1,1]
v_exp_f32 v170, v170 clamp
v_exp_f32 v171, v171 clamp
v_pk_fma_f32 v[60:61], v[60:61], v[158:159], s[84:85] op_sel_hi:[1,0,1]
v_pk_add_f32 v[170:171], v[170:171], s[86:87]
v_max_f32 v170, v170, v60
v_max_f32 v171, v171, v61
v_cvt_pk_bf16_f32 v143, v170, v171
s_waitcnt lgkmcnt(0)
s_barrier
s_add_u32 m0, s78, 86016
s_add_u32 s63, s67, 802816
buffer_load_dwordx4 v136, s[16:19], s63 offen offset:0 lds
s_add_u32 s63, s67, 830464
buffer_load_dwordx4 v136, s[16:19], s63 offen offset:1024 lds
s_add_u32 s63, s67, 858112
buffer_load_dwordx4 v136, s[16:19], s63 offen offset:2048 lds
s_add_u32 s63, s67, 885760
buffer_load_dwordx4 v136, s[16:19], s63 offen offset:3072 lds
s_add_u32 m0, s78, 90112
s_add_u32 s63, s67, 917504
buffer_load_dwordx4 v136, s[16:19], s63 offen offset:0 lds
s_add_u32 s63, s67, 945152
buffer_load_dwordx4 v136, s[16:19], s63 offen offset:1024 lds
s_add_u32 s63, s67, 972800
buffer_load_dwordx4 v136, s[16:19], s63 offen offset:2048 lds
v_pk_mul_f32 v[168:169], v[62:63], v[158:159] op_sel:[0,1] op_sel_hi:[1,1]
v_exp_f32 v168, v168 clamp
v_exp_f32 v169, v169 clamp
v_pk_fma_f32 v[62:63], v[62:63], v[158:159], s[84:85] op_sel_hi:[1,0,1]
v_pk_add_f32 v[168:169], v[168:169], s[86:87]
v_max_f32 v168, v168, v62
v_max_f32 v169, v169, v63
v_cvt_pk_bf16_f32 v144, v168, v169
v_pk_mul_f32 v[170:171], v[64:65], v[158:159] op_sel:[0,1] op_sel_hi:[1,1]
v_exp_f32 v170, v170 clamp
v_exp_f32 v171, v171 clamp
v_pk_fma_f32 v[64:65], v[64:65], v[158:159], s[84:85] op_sel_hi:[1,0,1]
v_pk_add_f32 v[170:171], v[170:171], s[86:87]
v_max_f32 v170, v170, v64
v_max_f32 v171, v171, v65
v_cvt_pk_bf16_f32 v145, v170, v171
v_pk_mul_f32 v[168:169], v[66:67], v[158:159] op_sel:[0,1] op_sel_hi:[1,1]
v_exp_f32 v168, v168 clamp
v_exp_f32 v169, v169 clamp
v_pk_fma_f32 v[66:67], v[66:67], v[158:159], s[84:85] op_sel_hi:[1,0,1]
v_pk_add_f32 v[168:169], v[168:169], s[86:87]
v_max_f32 v168, v168, v66
v_max_f32 v169, v169, v67
v_cvt_pk_bf16_f32 v146, v168, v169
v_pk_mul_f32 v[170:171], v[68:69], v[158:159] op_sel:[0,1] op_sel_hi:[1,1]
v_exp_f32 v170, v170 clamp
v_exp_f32 v171, v171 clamp
v_pk_fma_f32 v[68:69], v[68:69], v[158:159], s[84:85] op_sel_hi:[1,0,1]
v_pk_add_f32 v[170:171], v[170:171], s[86:87]
v_max_f32 v170, v170, v68
v_max_f32 v171, v171, v69
v_cvt_pk_bf16_f32 v147, v170, v171
s_waitcnt vmcnt(7)
s_barrier
ds_read_b64_tr_b16 a[160:161], v74 offset:28672
ds_read_b64_tr_b16 a[162:163], v74 offset:29184
ds_read_b64_tr_b16 a[164:165], v75 offset:28672
ds_read_b64_tr_b16 a[166:167], v75 offset:29184
ds_read_b64_tr_b16 a[168:169], v74 offset:30720
ds_read_b64_tr_b16 a[170:171], v76 offset:31232
ds_read_b64_tr_b16 a[172:173], v75 offset:30720
ds_read_b64_tr_b16 a[174:175], v77 offset:31232
ds_read_b64_tr_b16 a[176:177], v74 offset:32256
ds_read_b64_tr_b16 a[178:179], v74 offset:32768
ds_read_b64_tr_b16 a[180:181], v75 offset:32256
ds_read_b64_tr_b16 a[182:183], v75 offset:32768
ds_read_b64_tr_b16 a[184:185], v74 offset:34304
ds_read_b64_tr_b16 a[186:187], v76 offset:34816
ds_read_b64_tr_b16 a[188:189], v75 offset:34304
ds_read_b64_tr_b16 a[190:191], v77 offset:34816
ds_read_b64_tr_b16 a[192:193], v74 offset:35840
ds_read_b64_tr_b16 a[194:195], v74 offset:36352
ds_read_b64_tr_b16 a[196:197], v75 offset:35840
ds_read_b64_tr_b16 a[198:199], v75 offset:36352
ds_read_b64_tr_b16 a[200:201], v74 offset:37888
ds_read_b64_tr_b16 a[202:203], v76 offset:38400
ds_read_b64_tr_b16 a[204:205], v75 offset:37888
ds_read_b64_tr_b16 a[206:207], v77 offset:38400
ds_read_b64_tr_b16 a[208:209], v74 offset:39424
ds_read_b64_tr_b16 a[210:211], v74 offset:39936
ds_read_b64_tr_b16 a[212:213], v75 offset:39424
ds_read_b64_tr_b16 a[214:215], v75 offset:39936
ds_read_b64_tr_b16 a[216:217], v74 offset:41472
ds_read_b64_tr_b16 a[218:219], v76 offset:41984
ds_read_b64_tr_b16 a[220:221], v75 offset:41472
ds_read_b64_tr_b16 a[222:223], v77 offset:41984
v_pk_mul_f32 v[168:169], v[70:71], v[158:159] op_sel:[0,1] op_sel_hi:[1,1]
v_exp_f32 v168, v168 clamp
v_exp_f32 v169, v169 clamp
v_pk_fma_f32 v[70:71], v[70:71], v[158:159], s[84:85] op_sel_hi:[1,0,1]
v_pk_add_f32 v[168:169], v[168:169], s[86:87]
v_max_f32 v168, v168, v70
v_max_f32 v169, v169, v71
v_cvt_pk_bf16_f32 v148, v168, v169
v_pk_mul_f32 v[170:171], v[72:73], v[158:159] op_sel:[0,1] op_sel_hi:[1,1]
v_exp_f32 v170, v170 clamp
v_exp_f32 v171, v171 clamp
v_pk_fma_f32 v[72:73], v[72:73], v[158:159], s[84:85] op_sel_hi:[1,0,1]
v_pk_add_f32 v[170:171], v[170:171], s[86:87]
v_max_f32 v170, v170, v72
v_max_f32 v171, v171, v73
v_cvt_pk_bf16_f32 v149, v170, v171
s_waitcnt lgkmcnt(0)
s_barrier
s_add_u32 m0, s78, 114688
s_add_u32 s63, s67, 1204224
buffer_load_dwordx4 v136, s[16:19], s63 offen offset:0 lds
s_add_u32 s63, s67, 1231872
buffer_load_dwordx4 v136, s[16:19], s63 offen offset:1024 lds
s_add_u32 s63, s67, 1259520
buffer_load_dwordx4 v136, s[16:19], s63 offen offset:2048 lds
s_add_u32 s63, s67, 1287168
buffer_load_dwordx4 v136, s[16:19], s63 offen offset:3072 lds
s_add_u32 m0, s78, 118784
s_add_u32 s63, s67, 1318912
buffer_load_dwordx4 v136, s[16:19], s63 offen offset:0 lds
s_add_u32 s63, s67, 1346560
buffer_load_dwordx4 v136, s[16:19], s63 offen offset:1024 lds
s_add_u32 s63, s67, 1374208
buffer_load_dwordx4 v136, s[16:19], s63 offen offset:2048 lds
s_waitcnt vmcnt(43)
LC_20:
v_max_u32 v58, v28, v29
v_cmp_eq_u32 vcc, -1, v58
v_lshlrev_b32 v60, 16, v28
v_and_b32 v61, 0xffff0000, v28
v_lshlrev_b32 v62, 16, v29
v_and_b32 v63, 0xffff0000, v29
s_cbranch_vccnz LS_21
LO_22:
v_pk_add_f32 v[90:91], v[60:61], 0
v_pk_add_f32 v[92:93], v[62:63], 0
s_waitcnt vmcnt(42)
LC_23:
v_max_u32 v58, v30, v31
v_cmp_eq_u32 vcc, -1, v58
v_lshlrev_b32 v60, 16, v30
v_and_b32 v61, 0xffff0000, v30
v_lshlrev_b32 v62, 16, v31
v_and_b32 v63, 0xffff0000, v31
s_cbranch_vccnz LS_24
LO_25:
v_pk_add_f32 v[90:91], v[90:91], v[60:61]
v_pk_add_f32 v[92:93], v[92:93], v[62:63]
s_waitcnt vmcnt(41)
LC_26:
v_max_u32 v58, v32, v33
v_cmp_eq_u32 vcc, -1, v58
v_lshlrev_b32 v60, 16, v32
v_and_b32 v61, 0xffff0000, v32
v_lshlrev_b32 v62, 16, v33
v_and_b32 v63, 0xffff0000, v33
s_cbranch_vccnz LS_27
LO_28:
v_pk_add_f32 v[90:91], v[90:91], v[60:61]
v_pk_add_f32 v[92:93], v[92:93], v[62:63]
s_lshr_b32 s61, s89, 3
s_add_u32 s61, s61, 159744
v_add_u32 v163, s61, v160
v_add_u32 v162, 159744, v160
s_waitcnt vmcnt(40)
LC_29:
v_max_u32 v58, v34, v35
v_cmp_eq_u32 vcc, -1, v58
v_lshlrev_b32 v60, 16, v34
v_and_b32 v61, 0xffff0000, v34
v_lshlrev_b32 v62, 16, v35
v_and_b32 v63, 0xffff0000, v35
s_cbranch_vccnz LS_30
LO_31:
v_pk_add_f32 v[90:91], v[90:91], v[60:61]
v_pk_add_f32 v[92:93], v[92:93], v[62:63]
s_waitcnt vmcnt(39)
LC_32:
v_max_u32 v58, v36, v37
v_cmp_eq_u32 vcc, -1, v58
v_lshlrev_b32 v60, 16, v36
v_and_b32 v61, 0xffff0000, v36
v_lshlrev_b32 v62, 16, v37
v_and_b32 v63, 0xffff0000, v37
s_cbranch_vccnz LS_33
LO_34:
v_pk_add_f32 v[90:91], v[90:91], v[60:61]
v_pk_add_f32 v[92:93], v[92:93], v[62:63]
s_waitcnt vmcnt(38)
LC_35:
v_max_u32 v58, v38, v39
v_cmp_eq_u32 vcc, -1, v58
v_lshlrev_b32 v60, 16, v38
v_and_b32 v61, 0xffff0000, v38
v_lshlrev_b32 v62, 16, v39
v_and_b32 v63, 0xffff0000, v39
s_cbranch_vccnz LS_36
LO_37:
v_pk_add_f32 v[90:91], v[90:91], v[60:61]
v_pk_add_f32 v[92:93], v[92:93], v[62:63]
s_waitcnt vmcnt(37)
LC_38:
v_max_u32 v58, v40, v41
v_cmp_eq_u32 vcc, -1, v58
v_lshlrev_b32 v60, 16, v40
v_and_b32 v61, 0xffff0000, v40
v_lshlrev_b32 v62, 16, v41
v_and_b32 v63, 0xffff0000, v41
s_cbranch_vccnz LS_39
LO_40:
v_pk_add_f32 v[90:91], v[90:91], v[60:61]
v_pk_add_f32 v[92:93], v[92:93], v[62:63]
s_waitcnt vmcnt(36)
LC_41:
v_max_u32 v58, v42, v43
v_cmp_eq_u32 vcc, -1, v58
v_lshlrev_b32 v60, 16, v42
v_and_b32 v61, 0xffff0000, v42
v_lshlrev_b32 v62, 16, v43
v_and_b32 v63, 0xffff0000, v43
s_cbranch_vccnz LS_42
LO_43:
v_pk_add_f32 v[90:91], v[90:91], v[60:61]
v_pk_add_f32 v[92:93], v[92:93], v[62:63]
s_waitcnt vmcnt(35)
LC_44:
v_max_u32 v58, v44, v45
v_cmp_eq_u32 vcc, -1, v58
v_lshlrev_b32 v60, 16, v44
v_and_b32 v61, 0xffff0000, v44
v_lshlrev_b32 v62, 16, v45
v_and_b32 v63, 0xffff0000, v45
s_cbranch_vccnz LS_45
LO_46:
v_pk_add_f32 v[90:91], v[90:91], v[60:61]
v_pk_add_f32 v[92:93], v[92:93], v[62:63]
s_waitcnt vmcnt(34)
LC_47:
v_max_u32 v58, v46, v47
v_cmp_eq_u32 vcc, -1, v58
v_lshlrev_b32 v60, 16, v46
v_and_b32 v61, 0xffff0000, v46
v_lshlrev_b32 v62, 16, v47
v_and_b32 v63, 0xffff0000, v47
s_cbranch_vccnz LS_48
LO_49:
v_pk_add_f32 v[90:91], v[90:91], v[60:61]
v_pk_add_f32 v[92:93], v[92:93], v[62:63]
s_waitcnt vmcnt(33)
LC_50:
v_max_u32 v58, v48, v49
v_cmp_eq_u32 vcc, -1, v58
v_lshlrev_b32 v60, 16, v48
v_and_b32 v61, 0xffff0000, v48
v_lshlrev_b32 v62, 16, v49
v_and_b32 v63, 0xffff0000, v49
s_cbranch_vccnz LS_51
LO_52:
v_pk_add_f32 v[90:91], v[90:91], v[60:61]
v_pk_add_f32 v[92:93], v[92:93], v[62:63]
s_waitcnt vmcnt(32)
LC_53:
v_max_u32 v58, v50, v51
v_cmp_eq_u32 vcc, -1, v58
v_lshlrev_b32 v60, 16, v50
v_and_b32 v61, 0xffff0000, v50
v_lshlrev_b32 v62, 16, v51
v_and_b32 v63, 0xffff0000, v51
s_cbranch_vccnz LS_54
LO_55:
v_pk_add_f32 v[90:91], v[90:91], v[60:61]
v_pk_add_f32 v[92:93], v[92:93], v[62:63]
s_waitcnt vmcnt(31)
LC_56:
v_max_u32 v58, v52, v53
v_cmp_eq_u32 vcc, -1, v58
v_lshlrev_b32 v60, 16, v52
v_and_b32 v61, 0xffff0000, v52
v_lshlrev_b32 v62, 16, v53
v_and_b32 v63, 0xffff0000, v53
s_cbranch_vccnz LS_57
LO_58:
v_pk_add_f32 v[90:91], v[90:91], v[60:61]
v_pk_add_f32 v[92:93], v[92:93], v[62:63]
s_waitcnt vmcnt(30)
LC_59:
v_max_u32 v58, v54, v55
v_cmp_eq_u32 vcc, -1, v58
v_lshlrev_b32 v60, 16, v54
v_and_b32 v61, 0xffff0000, v54
v_lshlrev_b32 v62, 16, v55
v_and_b32 v63, 0xffff0000, v55
s_cbranch_vccnz LS_60
LO_61:
v_pk_add_f32 v[90:91], v[90:91], v[60:61]
v_pk_add_f32 v[92:93], v[92:93], v[62:63]
s_waitcnt vmcnt(29)
LC_62:
v_max_u32 v58, v56, v57
v_cmp_eq_u32 vcc, -1, v58
v_lshlrev_b32 v60, 16, v56
v_and_b32 v61, 0xffff0000, v56
v_lshlrev_b32 v62, 16, v57
v_and_b32 v63, 0xffff0000, v57
s_cbranch_vccnz LS_63
LO_64:
v_pk_add_f32 v[90:91], v[90:91], v[60:61]
v_pk_add_f32 v[92:93], v[92:93], v[62:63]
s_waitcnt vmcnt(28)
LC_65:
v_max_u32 v58, v26, v27
v_cmp_eq_u32 vcc, -1, v58
v_lshlrev_b32 v60, 16, v26
v_and_b32 v61, 0xffff0000, v26
v_lshlrev_b32 v62, 16, v27
v_and_b32 v63, 0xffff0000, v27
s_cbranch_vccnz LS_66
LO_67:
v_pk_add_f32 v[90:91], v[90:91], v[60:61]
v_pk_add_f32 v[92:93], v[92:93], v[62:63]
s_waitcnt vmcnt(7)
s_barrier
ds_read_b64_tr_b16 v[200:201], v137 offset:0
ds_read_b64_tr_b16 v[202:203], v137 offset:512
ds_read_b64_tr_b16 v[204:205], v137 offset:2048
ds_read_b64_tr_b16 v[206:207], v137 offset:2560
ds_read_b64_tr_b16 v[208:209], v137 offset:4096
ds_read_b64_tr_b16 v[210:211], v137 offset:4608
ds_read_b64_tr_b16 v[212:213], v137 offset:6144
ds_read_b64_tr_b16 v[214:215], v137 offset:6656
ds_read_b64_tr_b16 v[216:217], v137 offset:8192
ds_read_b64_tr_b16 v[218:219], v137 offset:8704
ds_read_b64_tr_b16 v[220:221], v137 offset:10240
ds_read_b64_tr_b16 v[222:223], v137 offset:10752
ds_read_b64_tr_b16 v[224:225], v137 offset:12288
ds_read_b64_tr_b16 v[226:227], v137 offset:12800
s_mul_i32 s67, s32, 401408
s_lshl_b32 s62, s38, 7
s_add_u32 s67, s67, s62
s_and_b32 s64, s32, 1
s_lshl_b32 s64, s64, 6
v_xor_b32 v130, s64, v5
v_xor_b32 v131, 64, v130
s_add_u32 s64, s78, 86016
v_add_u32 v130, s64, v130
v_add_u32 v131, s64, v131
s_waitcnt lgkmcnt(0)
s_barrier
s_mul_i32 s66, s90, 14
s_add_u32 s66, s66, s67
s_add_u32 m0, s78, 86016
s_add_u32 s63, s66, 0
buffer_load_dwordx4 v6, s[20:23], s63 offen offset:0 lds
s_add_u32 s63, s66, 6144
buffer_load_dwordx4 v6, s[20:23], s63 offen offset:1024 lds
s_add_u32 m0, s78, 88064
s_add_u32 s63, s66, 14336
buffer_load_dwordx4 v6, s[20:23], s63 offen offset:0 lds
s_add_u32 s63, s66, 20480
buffer_load_dwordx4 v6, s[20:23], s63 offen offset:1024 lds
s_add_u32 m0, s78, 90112
s_add_u32 s63, s66, 28672
buffer_load_dwordx4 v6, s[20:23], s63 offen offset:0 lds
s_add_u32 s63, s66, 34816
buffer_load_dwordx4 v6, s[20:23], s63 offen offset:1024 lds
s_cmp_lg_u32 s36, 0
s_cbranch_scc1 L_slow
v_cvt_pk_bf16_f32 v90, v90, v91
v_cvt_pk_bf16_f32 v91, v92, v93
ds_write_b64 v163, v[90:91]
s_waitcnt lgkmcnt(0)
s_barrier
ds_read_b64 v[26:27], v162 offset:0
ds_read_b64 v[28:29], v162 offset:512
ds_read_b64 v[30:31], v162 offset:1024
ds_read_b64 v[32:33], v162 offset:1536
s_waitcnt lgkmcnt(2)
v_mfma_f32_32x32x16_bf16 v[42:57], v[26:29], v[142:145], 0
s_waitcnt lgkmcnt(0)
v_mfma_f32_32x32x16_bf16 v[42:57], v[30:33], v[146:149], v[42:57]
s_nop 11
v_add_f32 v94, s86, v54
v_rcp_f32 v94, v94
s_nop 0
v_mov_b32 v95, v94
s_nop 1
v_permlane32_swap_b32 v94, v95
v_pk_mul_f32 v[42:43], v[42:43], v[94:95] op_sel:[0,1] op_sel_hi:[1,1]
v_pk_mul_f32 v[44:45], v[44:45], v[94:95] op_sel:[0,1] op_sel_hi:[1,1]
v_pk_mul_f32 v[46:47], v[46:47], v[94:95] op_sel:[0,1] op_sel_hi:[1,1]
v_pk_mul_f32 v[48:49], v[48:49], v[94:95] op_sel:[0,1] op_sel_hi:[1,1]
v_cvt_pk_bf16_f32 v58, v42, v43
v_cvt_pk_bf16_f32 v59, v44, v45
v_cvt_pk_bf16_f32 v60, v46, v47
v_cvt_pk_bf16_f32 v61, v48, v49
buffer_store_dwordx4 v[58:61], v1, s[4:7], s72 offen
v_pk_mul_f32 v[50:51], v[50:51], v[94:95] op_sel:[0,1] op_sel_hi:[1,1]
v_pk_mul_f32 v[52:53], v[52:53], v[94:95] op_sel:[0,1] op_sel_hi:[1,1]
v_pk_mul_f32 v[54:55], v[54:55], v[94:95] op_sel:[0,1] op_sel_hi:[1,1]
v_pk_mul_f32 v[56:57], v[56:57], v[94:95] op_sel:[0,1] op_sel_hi:[1,1]
v_cvt_pk_bf16_f32 v62, v50, v51
v_cvt_pk_bf16_f32 v63, v52, v53
v_cvt_pk_bf16_f32 v64, v54, v55
v_cvt_pk_bf16_f32 v65, v56, v57
v_cndmask_b32 v64, v64, 0, s[56:57]
v_cndmask_b32 v65, v65, 0, s[56:57]
buffer_store_dwordx4 v[62:65], v1, s[4:7], s72 offen offset:1024
s_cmp_ge_u32 s33, 14
s_cbranch_scc1 LR_68
v_lshrrev_b32 v58, 2, v0
v_lshrrev_b32 v59, 4, v0
v_xor_b32 v58, v58, v59
v_and_b32 v58, 1, v58
v_cmp_eq_u32 vcc, 0, v58
v_mov_b32 v59, 0x3f803f80
s_nop 0
v_cndmask_b32 v58, 0, v59, vcc
v_mov_b32 v59, v58
v_mov_b32 v60, v58
v_mov_b32 v61, v58
s_waitcnt vmcnt(8)
s_barrier
ds_read_b64_tr_b16 v[228:229], v137 offset:28672
ds_read_b64_tr_b16 v[230:231], v137 offset:29184
ds_read_b64_tr_b16 v[232:233], v137 offset:30720
ds_read_b64_tr_b16 v[234:235], v137 offset:31232
ds_read_b64_tr_b16 v[236:237], v137 offset:32768
ds_read_b64_tr_b16 v[238:239], v137 offset:33280
ds_read_b64_tr_b16 v[240:241], v137 offset:34816
ds_read_b64_tr_b16 v[242:243], v137 offset:35328
ds_read_b64_tr_b16 v[244:245], v137 offset:36864
ds_read_b64_tr_b16 v[246:247], v137 offset:37376
ds_read_b64_tr_b16 v[248:249], v137 offset:38912
ds_read_b64_tr_b16 v[250:251], v137 offset:39424
ds_read_b64_tr_b16 v[252:253], v137 offset:40960
ds_read_b64_tr_b16 v[254:255], v137 offset:41472
s_waitcnt vmcnt(0)
s_add_u32 s60, s35, 2
s_mov_b64 exec, 1
v_mov_b32 v146, s60
buffer_store_dword v146, off, s[4:7], s41
s_mov_b64 exec, -1
s_waitcnt lgkmcnt(0)
s_barrier
s_add_u32 m0, s78, 114688
s_add_u32 s63, s66, 43008
buffer_load_dwordx4 v6, s[20:23], s63 offen offset:0 lds
s_add_u32 s63, s66, 49152
buffer_load_dwordx4 v6, s[20:23], s63 offen offset:1024 lds
s_mul_i32 s66, s91, 14
s_add_u32 s66, s66, s67
s_add_u32 m0, s78, 116736
s_add_u32 s63, s66, 0
buffer_load_dwordx4 v6, s[20:23], s63 offen offset:0 lds
s_add_u32 s63, s66, 6144
buffer_load_dwordx4 v6, s[20:23], s63 offen offset:1024 lds
s_add_u32 m0, s78, 118784
s_add_u32 s63, s66, 14336
buffer_load_dwordx4 v6, s[20:23], s63 offen offset:0 lds
s_add_u32 s63, s66, 20480
buffer_load_dwordx4 v6, s[20:23], s63 offen offset:1024 lds
v_mfma_f32_16x16x32_bf16 v[62:65], v[58:61], a[224:227], 0
v_mfma_f32_16x16x32_bf16 v[62:65], v[58:61], a[228:231], v[62:65]
v_mfma_f32_16x16x32_bf16 v[62:65], v[58:61], a[232:235], v[62:65]
v_mfma_f32_16x16x32_bf16 v[62:65], v[58:61], a[236:239], v[62:65]
v_mfma_f32_16x16x32_bf16 v[62:65], v[58:61], a[240:243], v[62:65]
v_mfma_f32_16x16x32_bf16 v[62:65], v[58:61], a[244:247], v[62:65]
v_mfma_f32_16x16x32_bf16 v[62:65], v[58:61], a[248:251], v[62:65]
v_mfma_f32_16x16x32_bf16 v[62:65], v[58:61], a[252:255], v[62:65]
v_mfma_f32_16x16x32_bf16 v[62:65], v[58:61], v[176:179], v[62:65]
v_mfma_f32_16x16x32_bf16 v[62:65], v[58:61], v[180:183], v[62:65]
v_mfma_f32_16x16x32_bf16 v[62:65], v[58:61], v[184:187], v[62:65]
v_mfma_f32_16x16x32_bf16 v[62:65], v[58:61], v[188:191], v[62:65]
v_mfma_f32_16x16x32_bf16 v[62:65], v[58:61], v[192:195], v[62:65]
s_waitcnt vmcnt(13)
ds_read_b64_tr_b16 a[0:1], v130 offset:0
ds_read_b64_tr_b16 a[2:3], v130 offset:512
ds_read_b64_tr_b16 a[4:5], v131 offset:0
ds_read_b64_tr_b16 a[6:7], v131 offset:512
v_mfma_f32_16x16x32_bf16 v[62:65], v[58:61], v[196:199], v[62:65]
v_mfma_f32_16x16x32_bf16 v[62:65], v[58:61], v[200:203], v[62:65]
v_mfma_f32_16x16x32_bf16 v[62:65], v[58:61], v[204:207], v[62:65]
v_mfma_f32_16x16x32_bf16 v[62:65], v[58:61], v[208:211], v[62:65]
v_mfma_f32_16x16x32_bf16 v[62:65], v[58:61], v[212:215], v[62:65]
v_mfma_f32_16x16x32_bf16 v[62:65], v[58:61], v[216:219], v[62:65]
v_mfma_f32_16x16x32_bf16 v[62:65], v[58:61], v[220:223], v[62:65]
v_mfma_f32_16x16x32_bf16 v[62:65], v[58:61], v[224:227], v[62:65]
v_mfma_f32_16x16x32_bf16 v[62:65], v[58:61], v[228:231], v[62:65]
v_mfma_f32_16x16x32_bf16 v[62:65], v[58:61], v[232:235], v[62:65]
v_mfma_f32_16x16x32_bf16 v[62:65], v[58:61], v[236:239], v[62:65]
v_mfma_f32_16x16x32_bf16 v[62:65], v[58:61], v[240:243], v[62:65]
s_waitcnt lgkmcnt(0)
s_add_u32 m0, s78, 86016
s_add_u32 s63, s66, 28672
buffer_load_dwordx4 v6, s[20:23], s63 offen offset:0 lds
L_hop2:
s_cbranch_execz L_hop6
s_add_u32 s63, s66, 34816
buffer_load_dwordx4 v6, s[20:23], s63 offen offset:1024 lds
s_waitcnt vmcnt(13)
ds_read_b64_tr_b16 a[8:9], v130 offset:2048
ds_read_b64_tr_b16 a[10:11], v130 offset:2560
ds_read_b64_tr_b16 a[12:13], v131 offset:2048
ds_read_b64_tr_b16 a[14:15], v131 offset:2560
v_mfma_f32_16x16x32_bf16 v[62:65], v[58:61], v[244:247], v[62:65]
v_mfma_f32_16x16x32_bf16 v[62:65], v[58:61], v[248:251], v[62:65]
v_mfma_f32_16x16x32_bf16 v[62:65], v[58:61], v[252:255], v[62:65]
s_nop 7
v_cvt_pk_bf16_f32 v66, v62, v62
v_and_b32 v67, 0xffff0000, v66
v_sub_f32 v67, v62, v67
v_cvt_pk_bf16_f32 v14, v62, v67
v_and_b32 v66, 0xffff0000, v14
v_sub_f32 v67, v67, v66
v_cvt_pk_bf16_f32 v15, v67, 0
v_lshlrev_b32 v26, 16, v18
v_and_b32 v27, 0xffff0000, v18
v_lshlrev_b32 v28, 16, v19
v_and_b32 v29, 0xffff0000, v19
v_lshlrev_b32 v30, 16, v20
v_and_b32 v31, 0xffff0000, v20
v_lshlrev_b32 v32, 16, v21
v_and_b32 v33, 0xffff0000, v21
v_lshlrev_b32 v34, 16, v22
v_and_b32 v35, 0xffff0000, v22
v_lshlrev_b32 v36, 16, v23
v_and_b32 v37, 0xffff0000, v23
v_lshlrev_b32 v38, 16, v24
v_and_b32 v39, 0xffff0000, v24
v_lshlrev_b32 v40, 16, v25
v_and_b32 v41, 0xffff0000, v25
s_add_u32 s61, s89, 143360
v_add_u32 v148, s61, v1
s_xor_b32 s61, s89, 4096
s_add_u32 s61, s61, 143360
v_add_u32 v149, s61, v1
s_add_u32 s60, s35, 2
LP_70:
buffer_load_dword v152, v4, s[4:7], s40 offen sc1
s_sub_u32 s37, s37, 1
s_cmp_lt_i32 s37, 0
s_cbranch_scc1 LD_71
s_waitcnt vmcnt(0)
v_subrev_u32 v152, s60, v152
v_cmp_le_u32 vcc, 64, v152
s_and_b64 vcc, vcc, s[50:51]
s_cbranch_scc1 LP_70
LD_71:
s_add_u32 s65, s73, 0
buffer_load_dwordx4 v[58:61], v1, s[4:7], s65 offen offset:0 sc1
buffer_load_dwordx4 v[62:65], v1, s[4:7], s65 offen offset:1024 sc1
buffer_load_dwordx4 v[66:69], v1, s[4:7], s65 offen offset:2048 sc1
buffer_load_dwordx4 v[70:73], v1, s[4:7], s65 offen offset:3072 sc1
s_add_u32 s65, s73, 4096
buffer_load_dwordx4 v[74:77], v1, s[4:7], s65 offen offset:0 sc1
buffer_load_dwordx4 v[78:81], v1, s[4:7], s65 offen offset:1024 sc1
buffer_load_dwordx4 v[82:85], v1, s[4:7], s65 offen offset:2048 sc1
buffer_load_dwordx4 v[86:89], v1, s[4:7], s65 offen offset:3072 sc1
s_add_u32 s65, s73, 8192
buffer_load_dwordx4 v[90:93], v1, s[4:7], s65 offen offset:0 sc1
buffer_load_dwordx4 v[94:97], v1, s[4:7], s65 offen offset:1024 sc1
s_waitcnt vmcnt(9)
v_mfma_f32_32x32x16_bf16 v[42:57], a[100:103], v[58:61], 0
buffer_load_dwordx4 v[98:101], v1, s[4:7], s65 offen offset:2048 sc1
v_mfma_f32_32x32x16_bf16 v[26:41], a[96:99], v[58:61], v[26:41]
s_waitcnt vmcnt(9)
v_mfma_f32_32x32x16_bf16 v[42:57], a[108:111], v[62:65], v[42:57]
buffer_load_dwordx4 v[102:105], v1, s[4:7], s65 offen offset:3072 sc1
v_mfma_f32_32x32x16_bf16 v[26:41], a[104:107], v[62:65], v[26:41]
s_waitcnt vmcnt(9)
v_mfma_f32_32x32x16_bf16 v[42:57], a[116:119], v[66:69], v[42:57]
s_add_u32 s65, s73, 12288
buffer_load_dwordx4 v[106:109], v1, s[4:7], s65 offen offset:0 sc1
v_mfma_f32_32x32x16_bf16 v[26:41], a[112:115], v[66:69], v[26:41]
s_waitcnt vmcnt(9)
v_mfma_f32_32x32x16_bf16 v[42:57], a[124:127], v[70:73], v[42:57]
buffer_load_dwordx4 v[110:113], v1, s[4:7], s65 offen offset:1024 sc1
v_mfma_f32_32x32x16_bf16 v[26:41], a[120:123], v[70:73], v[26:41]
s_waitcnt vmcnt(9)
v_mfma_f32_32x32x16_bf16 v[42:57], a[132:135], v[74:77], v[42:57]
buffer_load_dwordx4 v[114:117], v1, s[4:7], s65 offen offset:2048 sc1
v_mfma_f32_32x32x16_bf16 v[26:41], a[128:131], v[74:77], v[26:41]
s_waitcnt vmcnt(9)
v_mfma_f32_32x32x16_bf16 v[42:57], a[140:143], v[78:81], v[42:57]
buffer_load_dwordx4 v[118:121], v1, s[4:7], s65 offen offset:3072 sc1
v_mfma_f32_32x32x16_bf16 v[26:41], a[136:139], v[78:81], v[26:41]
s_waitcnt lgkmcnt(0)
s_add_u32 m0, s78, 88064
s_add_u32 s63, s66, 43008
buffer_load_dwordx4 v6, s[20:23], s63 offen offset:0 lds
s_add_u32 s63, s66, 49152
buffer_load_dwordx4 v6, s[20:23], s63 offen offset:1024 lds
s_waitcnt vmcnt(30)
ds_read_b64_tr_b16 a[16:17], v130 offset:4096
ds_read_b64_tr_b16 a[18:19], v130 offset:4608
ds_read_b64_tr_b16 a[20:21], v131 offset:4096
ds_read_b64_tr_b16 a[22:23], v131 offset:4608
s_waitcnt vmcnt(11)
v_mfma_f32_32x32x16_bf16 v[42:57], a[148:151], v[82:85], v[42:57]
v_mfma_f32_32x32x16_bf16 v[26:41], a[144:147], v[82:85], v[26:41]
s_waitcnt lgkmcnt(0)
s_mul_i32 s66, s92, 14
s_add_u32 s66, s66, s67
s_add_u32 m0, s78, 90112
s_add_u32 s63, s66, 0
buffer_load_dwordx4 v6, s[20:23], s63 offen offset:0 lds
s_add_u32 s63, s66, 6144
buffer_load_dwordx4 v6, s[20:23], s63 offen offset:1024 lds
s_waitcnt vmcnt(27)
ds_read_b64_tr_b16 a[24:25], v130 offset:28672
ds_read_b64_tr_b16 a[26:27], v130 offset:29184
ds_read_b64_tr_b16 a[28:29], v131 offset:28672
ds_read_b64_tr_b16 a[30:31], v131 offset:29184
s_waitcnt vmcnt(12)
v_mfma_f32_32x32x16_bf16 v[42:57], a[156:159], v[86:89], v[42:57]
v_mfma_f32_32x32x16_bf16 v[26:41], a[152:155], v[86:89], v[26:41]
s_waitcnt lgkmcnt(0)
s_add_u32 m0, s78, 114688
s_add_u32 s63, s66, 14336
buffer_load_dwordx4 v6, s[20:23], s63 offen offset:0 lds
s_add_u32 s63, s66, 20480
buffer_load_dwordx4 v6, s[20:23], s63 offen offset:1024 lds
s_waitcnt vmcnt(27)
ds_read_b64_tr_b16 a[32:33], v130 offset:30720
ds_read_b64_tr_b16 a[34:35], v130 offset:31232
ds_read_b64_tr_b16 a[36:37], v131 offset:30720
ds_read_b64_tr_b16 a[38:39], v131 offset:31232
s_waitcnt vmcnt(13)
v_mfma_f32_32x32x16_bf16 v[42:57], a[164:167], v[90:93], v[42:57]
v_mfma_f32_32x32x16_bf16 v[26:41], a[160:163], v[90:93], v[26:41]
s_waitcnt lgkmcnt(0)
s_add_u32 m0, s78, 116736
s_add_u32 s63, s66, 28672
buffer_load_dwordx4 v6, s[20:23], s63 offen offset:0 lds
s_add_u32 s63, s66, 34816
buffer_load_dwordx4 v6, s[20:23], s63 offen offset:1024 lds
s_waitcnt vmcnt(27)
ds_read_b64_tr_b16 a[40:41], v130 offset:32768
ds_read_b64_tr_b16 a[42:43], v130 offset:33280
ds_read_b64_tr_b16 a[44:45], v131 offset:32768
ds_read_b64_tr_b16 a[46:47], v131 offset:33280
s_waitcnt vmcnt(14)
v_mfma_f32_32x32x16_bf16 v[42:57], a[172:175], v[94:97], v[42:57]
v_mfma_f32_32x32x16_bf16 v[26:41], a[168:171], v[94:97], v[26:41]
s_waitcnt lgkmcnt(0)
s_add_u32 m0, s78, 118784
s_add_u32 s63, s66, 43008
buffer_load_dwordx4 v6, s[20:23], s63 offen offset:0 lds
s_add_u32 s63, s66, 49152
buffer_load_dwordx4 v6, s[20:23], s63 offen offset:1024 lds
s_waitcnt vmcnt(27)
ds_read_b64_tr_b16 a[48:49], v130 offset:0
ds_read_b64_tr_b16 a[50:51], v130 offset:512
ds_read_b64_tr_b16 a[52:53], v131 offset:0
ds_read_b64_tr_b16 a[54:55], v131 offset:512
s_waitcnt vmcnt(15)
v_mfma_f32_32x32x16_bf16 v[42:57], a[180:183], v[98:101], v[42:57]
s_waitcnt vmcnt(14)
v_mfma_f32_32x32x16_bf16 v[42:57], a[188:191], v[102:105], v[42:57]
s_waitcnt lgkmcnt(0)
s_mul_i32 s66, s93, 14
s_add_u32 s66, s66, s67
s_add_u32 m0, s78, 86016
s_add_u32 s63, s66, 0
buffer_load_dwordx4 v6, s[20:23], s63 offen offset:0 lds
s_add_u32 s63, s66, 6144
buffer_load_dwordx4 v6, s[20:23], s63 offen offset:1024 lds
s_waitcnt vmcnt(10)
ds_read_b64_tr_b16 a[56:57], v130 offset:2048
ds_read_b64_tr_b16 a[58:59], v130 offset:2560
ds_read_b64_tr_b16 a[60:61], v131 offset:2048
ds_read_b64_tr_b16 a[62:63], v131 offset:2560
s_waitcnt vmcnt(15)
v_mfma_f32_32x32x16_bf16 v[42:57], a[196:199], v[106:109], v[42:57]
s_waitcnt vmcnt(14)
v_mfma_f32_32x32x16_bf16 v[42:57], a[204:207], v[110:113], v[42:57]
s_waitcnt lgkmcnt(0)
s_add_u32 m0, s78, 88064
s_add_u32 s63, s66, 14336
buffer_load_dwordx4 v6, s[20:23], s63 offen offset:0 lds
s_add_u32 s63, s66, 20480
buffer_load_dwordx4 v6, s[20:23], s63 offen offset:1024 lds
s_waitcnt vmcnt(10)
ds_read_b64_tr_b16 a[64:65], v130 offset:4096
ds_read_b64_tr_b16 a[66:67], v130 offset:4608
ds_read_b64_tr_b16 a[68:69], v131 offset:4096
ds_read_b64_tr_b16 a[70:71], v131 offset:4608
s_waitcnt vmcnt(15)
v_mfma_f32_32x32x16_bf16 v[42:57], a[212:215], v[114:117], v[42:57]
s_waitcnt vmcnt(14)
v_mfma_f32_32x32x16_bf16 v[42:57], a[220:223], v[118:121], v[42:57]
s_waitcnt lgkmcnt(0)
s_add_u32 m0, s78, 90112
s_add_u32 s63, s66, 28672
buffer_load_dwordx4 v6, s[20:23], s63 offen offset:0 lds
s_add_u32 s63, s66, 34816
buffer_load_dwordx4 v6, s[20:23], s63 offen offset:1024 lds
s_waitcnt vmcnt(10)
ds_read_b64_tr_b16 a[72:73], v130 offset:28672
ds_read_b64_tr_b16 a[74:75], v130 offset:29184
ds_read_b64_tr_b16 a[76:77], v131 offset:28672
ds_read_b64_tr_b16 a[78:79], v131 offset:29184
v_mfma_f32_32x32x16_bf16 v[26:41], a[176:179], v[98:101], v[26:41]
v_mfma_f32_32x32x16_bf16 v[26:41], a[184:187], v[102:105], v[26:41]
s_waitcnt lgkmcnt(0)
s_add_u32 m0, s78, 114688
s_add_u32 s63, s66, 43008
buffer_load_dwordx4 v6, s[20:23], s63 offen offset:0 lds
s_add_u32 s63, s66, 49152
buffer_load_dwordx4 v6, s[20:23], s63 offen offset:1024 lds
s_waitcnt vmcnt(10)
ds_read_b64_tr_b16 a[80:81], v130 offset:30720
ds_read_b64_tr_b16 a[82:83], v130 offset:31232
ds_read_b64_tr_b16 a[84:85], v131 offset:30720
ds_read_b64_tr_b16 a[86:87], v131 offset:31232
v_mfma_f32_32x32x16_bf16 v[26:41], a[192:195], v[106:109], v[26:41]
ds_write_b128 v148, v[42:45] offset:0
v_mfma_f32_32x32x16_bf16 v[26:41], a[200:203], v[110:113], v[26:41]
ds_write_b128 v148, v[46:49] offset:1024
s_waitcnt lgkmcnt(2)
s_mul_i32 s66, s94, 14
s_add_u32 s66, s66, s67
s_add_u32 m0, s78, 116736
s_add_u32 s63, s66, 0
buffer_load_dwordx4 v6, s[20:23], s63 offen offset:0 lds
s_add_u32 s63, s66, 6144
buffer_load_dwordx4 v6, s[20:23], s63 offen offset:1024 lds
s_waitcnt vmcnt(10)
ds_read_b64_tr_b16 a[88:89], v130 offset:32768
ds_read_b64_tr_b16 a[90:91], v130 offset:33280
ds_read_b64_tr_b16 a[92:93], v131 offset:32768
ds_read_b64_tr_b16 a[94:95], v131 offset:33280
v_mfma_f32_32x32x16_bf16 v[26:41], a[208:211], v[114:117], v[26:41]
ds_write_b128 v148, v[50:53] offset:2048
v_mfma_f32_32x32x16_bf16 v[26:41], a[216:219], v[118:121], v[26:41]
ds_write_b128 v148, v[54:57] offset:3072
s_waitcnt lgkmcnt(2)
s_add_u32 m0, s78, 118784
s_add_u32 s63, s66, 14336
buffer_load_dwordx4 v6, s[20:23], s63 offen offset:0 lds
s_add_u32 s63, s66, 20480
buffer_load_dwordx4 v6, s[20:23], s63 offen offset:1024 lds
s_waitcnt vmcnt(10)
ds_read_b64_tr_b16 a[96:97], v130 offset:0
ds_read_b64_tr_b16 a[98:99], v130 offset:512
ds_read_b64_tr_b16 a[100:101], v131 offset:0
ds_read_b64_tr_b16 a[102:103], v131 offset:512
s_waitcnt lgkmcnt(0)
s_add_u32 m0, s78, 86016
s_add_u32 s63, s66, 28672
buffer_load_dwordx4 v6, s[20:23], s63 offen offset:0 lds
s_add_u32 s63, s66, 34816
buffer_load_dwordx4 v6, s[20:23], s63 offen offset:1024 lds
s_waitcnt vmcnt(10)
ds_read_b64_tr_b16 a[104:105], v130 offset:2048
ds_read_b64_tr_b16 a[106:107], v130 offset:2560
ds_read_b64_tr_b16 a[108:109], v131 offset:2048
ds_read_b64_tr_b16 a[110:111], v131 offset:2560
s_waitcnt lgkmcnt(0)
s_barrier
ds_read_b128 v[58:61], v149 offset:0
ds_read_b128 v[62:65], v149 offset:1024
ds_read_b128 v[66:69], v149 offset:2048
ds_read_b128 v[70:73], v149 offset:3072
s_waitcnt lgkmcnt(3)
v_pk_add_f32 v[26:27], v[26:27], v[58:59]
v_pk_add_f32 v[28:29], v[28:29], v[60:61]
v_cvt_pk_bf16_f32 v18, v26, v27
v_cvt_pk_bf16_f32 v19, v28, v29
s_waitcnt lgkmcnt(2)
v_pk_add_f32 v[30:31], v[30:31], v[62:63]
v_pk_add_f32 v[32:33], v[32:33], v[64:65]
v_cvt_pk_bf16_f32 v20, v30, v31
v_cvt_pk_bf16_f32 v21, v32, v33
s_waitcnt lgkmcnt(1)
v_pk_add_f32 v[34:35], v[34:35], v[66:67]
v_pk_add_f32 v[36:37], v[36:37], v[68:69]
v_cvt_pk_bf16_f32 v22, v34, v35
v_cvt_pk_bf16_f32 v23, v36, v37
s_waitcnt lgkmcnt(0)
v_pk_add_f32 v[38:39], v[38:39], v[70:71]
v_pk_add_f32 v[40:41], v[40:41], v[72:73]
v_cvt_pk_bf16_f32 v24, v38, v39
v_cvt_pk_bf16_f32 v25, v40, v41
buffer_store_dwordx4 v[18:21], v1, s[4:7], s44 offen
buffer_store_dwordx4 v[22:25], v1, s[4:7], s44 offen offset:1024
v_dot2_f32_bf16 v146, s88, v18, 0
v_dot2_f32_bf16 v147, v18, v18, 0
v_dot2_f32_bf16 v146, s88, v19, v146
v_dot2_f32_bf16 v147, v19, v19, v147
v_dot2_f32_bf16 v146, s88, v20, v146
v_dot2_f32_bf16 v147, v20, v20, v147
v_dot2_f32_bf16 v146, s88, v21, v146
v_dot2_f32_bf16 v147, v21, v21, v147
v_dot2_f32_bf16 v146, s88, v22, v146
v_dot2_f32_bf16 v147, v22, v22, v147
v_dot2_f32_bf16 v146, s88, v23, v146
v_dot2_f32_bf16 v147, v23, v23, v147
v_dot2_f32_bf16 v146, s88, v24, v146
v_dot2_f32_bf16 v147, v24, v24, v147
v_dot2_f32_bf16 v146, s88, v25, v146
v_dot2_f32_bf16 v147, v25, v25, v147
s_nop 1
v_mov_b32 v148, v146
v_mov_b32 v149, v147
s_nop 0
v_permlane32_swap_b32 v146, v148
v_permlane32_swap_b32 v147, v149
s_mov_b32 exec_hi, 0
v_pk_add_f32 v[146:147], v[146:147], v[148:149]
buffer_store_dwordx2 v[146:147], v1, s[4:7], s45 offen
s_mov_b64 exec, -1
s_waitcnt lgkmcnt(4)
s_add_u32 m0, s78, 88064
s_add_u32 s63, s66, 43008
buffer_load_dwordx4 v6, s[20:23], s63 offen offset:0 lds
s_add_u32 s63, s66, 49152
buffer_load_dwordx4 v6, s[20:23], s63 offen offset:1024 lds
s_waitcnt vmcnt(13)
ds_read_b64_tr_b16 a[112:113], v130 offset:4096
ds_read_b64_tr_b16 a[114:115], v130 offset:4608
ds_read_b64_tr_b16 a[116:117], v131 offset:4096
ds_read_b64_tr_b16 a[118:119], v131 offset:4608
s_waitcnt lgkmcnt(0)
s_mul_i32 s66, s95, 14
s_add_u32 s66, s66, s67
s_add_u32 m0, s78, 90112
s_add_u32 s63, s66, 0
buffer_load_dwordx4 v6, s[20:23], s63 offen offset:0 lds
s_add_u32 s63, s66, 6144
buffer_load_dwordx4 v6, s[20:23], s63 offen offset:1024 lds
s_waitcnt vmcnt(13)
ds_read_b64_tr_b16 a[120:121], v130 offset:28672
ds_read_b64_tr_b16 a[122:123], v130 offset:29184
ds_read_b64_tr_b16 a[124:125], v131 offset:28672
ds_read_b64_tr_b16 a[126:127], v131 offset:29184
s_waitcnt lgkmcnt(0)
s_add_u32 m0, s78, 114688
s_add_u32 s63, s66, 14336
buffer_load_dwordx4 v6, s[20:23], s63 offen offset:0 lds
s_add_u32 s63, s66, 20480
buffer_load_dwordx4 v6, s[20:23], s63 offen offset:1024 lds
s_waitcnt vmcnt(13)
ds_read_b64_tr_b16 a[128:129], v130 offset:30720
ds_read_b64_tr_b16 a[130:131], v130 offset:31232
ds_read_b64_tr_b16 a[132:133], v131 offset:30720
ds_read_b64_tr_b16 a[134:135], v131 offset:31232
s_waitcnt vmcnt(6)
s_add_u32 s60, s35, 3
s_mov_b64 exec, 1
v_mov_b32 v146, s60
buffer_store_dword v146, off, s[4:7], s41
s_mov_b64 exec, -1
s_waitcnt lgkmcnt(0)
s_add_u32 m0, s78, 116736
s_add_u32 s63, s66, 28672
buffer_load_dwordx4 v6, s[20:23], s63 offen offset:0 lds
s_add_u32 s63, s66, 34816
buffer_load_dwordx4 v6, s[20:23], s63 offen offset:1024 lds
s_waitcnt vmcnt(14)
ds_read_b64_tr_b16 a[136:137], v130 offset:32768
ds_read_b64_tr_b16 a[138:139], v130 offset:33280
ds_read_b64_tr_b16 a[140:141], v131 offset:32768
ds_read_b64_tr_b16 a[142:143], v131 offset:33280
s_waitcnt lgkmcnt(0)
s_add_u32 m0, s78, 118784
s_add_u32 s63, s66, 43008
buffer_load_dwordx4 v6, s[20:23], s63 offen offset:0 lds
s_add_u32 s63, s66, 49152
buffer_load_dwordx4 v6, s[20:23], s63 offen offset:1024 lds
s_waitcnt vmcnt(14)
ds_read_b64_tr_b16 a[144:145], v130 offset:0
ds_read_b64_tr_b16 a[146:147], v130 offset:512
ds_read_b64_tr_b16 a[148:149], v131 offset:0
ds_read_b64_tr_b16 a[150:151], v131 offset:512
s_waitcnt lgkmcnt(0)
s_mul_i32 s66, s96, 14
s_add_u32 s66, s66, s67
s_add_u32 m0, s78, 86016
s_add_u32 s63, s66, 0
buffer_load_dwordx4 v6, s[20:23], s63 offen offset:0 lds
s_add_u32 s63, s66, 6144
buffer_load_dwordx4 v6, s[20:23], s63 offen offset:1024 lds
s_waitcnt vmcnt(11)
ds_read_b64_tr_b16 a[152:153], v130 offset:2048
ds_read_b64_tr_b16 a[154:155], v130 offset:2560
ds_read_b64_tr_b16 a[156:157], v131 offset:2048
ds_read_b64_tr_b16 a[158:159], v131 offset:2560
s_waitcnt lgkmcnt(0)
s_add_u32 m0, s78, 88064
s_add_u32 s63, s66, 14336
buffer_load_dwordx4 v6, s[20:23], s63 offen offset:0 lds
s_add_u32 s63, s66, 20480
buffer_load_dwordx4 v6, s[20:23], s63 offen offset:1024 lds
s_waitcnt vmcnt(11)
ds_read_b64_tr_b16 a[160:161], v130 offset:4096
ds_read_b64_tr_b16 a[162:163], v130 offset:4608
ds_read_b64_tr_b16 a[164:165], v131 offset:4096
ds_read_b64_tr_b16 a[166:167], v131 offset:4608
s_waitcnt lgkmcnt(0)
s_add_u32 m0, s78, 90112
s_add_u32 s63, s66, 28672
buffer_load_dwordx4 v6, s[20:23], s63 offen offset:0 lds
s_add_u32 s63, s66, 34816
buffer_load_dwordx4 v6, s[20:23], s63 offen offset:1024 lds
s_waitcnt vmcnt(11)
ds_read_b64_tr_b16 a[168:169], v130 offset:28672
ds_read_b64_tr_b16 a[170:171], v130 offset:29184
ds_read_b64_tr_b16 a[172:173], v131 offset:28672
ds_read_b64_tr_b16 a[174:175], v131 offset:29184
s_waitcnt lgkmcnt(0)
s_add_u32 m0, s78, 114688
s_add_u32 s63, s66, 43008
buffer_load_dwordx4 v6, s[20:23], s63 offen offset:0 lds
s_add_u32 s63, s66, 49152
buffer_load_dwordx4 v6, s[20:23], s63 offen offset:1024 lds
s_waitcnt vmcnt(10)
ds_read_b64_tr_b16 a[176:177], v130 offset:30720
ds_read_b64_tr_b16 a[178:179], v130 offset:31232
ds_read_b64_tr_b16 a[180:181], v131 offset:30720
ds_read_b64_tr_b16 a[182:183], v131 offset:31232
s_waitcnt vmcnt(8)
ds_read_b64_tr_b16 a[184:185], v130 offset:32768
ds_read_b64_tr_b16 a[186:187], v130 offset:33280
ds_read_b64_tr_b16 a[188:189], v131 offset:32768
ds_read_b64_tr_b16 a[190:191], v131 offset:33280
s_waitcnt vmcnt(6)
ds_read_b64_tr_b16 a[192:193], v130 offset:0
ds_read_b64_tr_b16 a[194:195], v130 offset:512
ds_read_b64_tr_b16 a[196:197], v131 offset:0
ds_read_b64_tr_b16 a[198:199], v131 offset:512
s_waitcnt vmcnt(4)
ds_read_b64_tr_b16 a[200:201], v130 offset:2048
ds_read_b64_tr_b16 a[202:203], v130 offset:2560
ds_read_b64_tr_b16 a[204:205], v131 offset:2048
ds_read_b64_tr_b16 a[206:207], v131 offset:2560
v_mov_b32 v146, s35
s_add_u32 s60, s41, 256
s_mov_b64 exec, 1
buffer_store_dword v146, off, s[4:7], s60
s_mov_b64 exec, -1
s_waitcnt vmcnt(3)
ds_read_b64_tr_b16 a[208:209], v130 offset:4096
ds_read_b64_tr_b16 a[210:211], v130 offset:4608
ds_read_b64_tr_b16 a[212:213], v131 offset:4096
ds_read_b64_tr_b16 a[214:215], v131 offset:4608
s_waitcnt vmcnt(1)
ds_read_b64_tr_b16 a[216:217], v130 offset:28672
ds_read_b64_tr_b16 a[218:219], v130 offset:29184
ds_read_b64_tr_b16 a[220:221], v131 offset:28672
ds_read_b64_tr_b16 a[222:223], v131 offset:29184
s_waitcnt lgkmcnt(0)
s_barrier
s_or_b32 s61, s34, s33
s_or_b32 s61, s61, s32
s_cmp_lg_u32 s61, 0
s_cbranch_scc1 LX_72
v_mov_b32 v148, s35
s_mov_b64 exec, 1
buffer_store_dword v148, off, s[4:7], 0 sc1
s_mov_b64 exec, -1
LX_72:
v_lshrrev_b32 v126, 5, v0
v_mul_u32_u24 v126, 1536, v126
v_add_u32 v126, v1, v126
v_add_u32 v109, 114688, v1
v_add_u32 v110, 86016, v1
v_lshlrev_b32 v108, 3, v0
v_add_u32 v108, 161792, v108
s_lshr_b32 s61, s89, 3
v_add_u32 v111, s61, v108
v_mov_b32 v106, s82
v_mov_b32 v90, 0
v_mov_b32 v91, 0
s_lshr_b32 s66, s89, 1
s_add_u32 s67, s66, s77
s_add_u32 s60, s35, 3
LP_73:
buffer_load_dword v94, v4, s[4:7], s40 offen sc1
s_sub_u32 s37, s37, 1
s_cmp_lt_i32 s37, 0
s_cbranch_scc1 LD_74
s_waitcnt vmcnt(0)
v_subrev_u32 v94, s60, v94
v_cmp_le_u32 vcc, 64, v94
s_and_b64 vcc, vcc, s[48:49]
s_cbranch_scc1 LP_73
LD_74:
s_add_u32 m0, s66, 114688
s_add_u32 s63, s67, 0
buffer_load_dwordx4 v1, s[4:7], s63 offen offset:0 sc1 lds
buffer_load_dwordx4 v1, s[4:7], s63 offen offset:1024 sc1 lds
s_add_u32 m0, s66, 122880
s_add_u32 s63, s67, 8192
buffer_load_dwordx4 v1, s[4:7], s63 offen offset:0 sc1 lds
buffer_load_dwordx4 v1, s[4:7], s63 offen offset:1024 sc1 lds
s_add_u32 m0, s66, 131072
s_add_u32 s63, s67, 16384
buffer_load_dwordx4 v1, s[4:7], s63 offen offset:0 sc1 lds
buffer_load_dwordx4 v1, s[4:7], s63 offen offset:1024 sc1 lds
s_lshr_b32 s62, s89, 2
s_add_u32 m0, s62, 139264
s_add_u32 s63, s62, s77
s_add_u32 s63, s63, 24576
buffer_load_dwordx4 v1, s[4:7], s63 offen offset:0 sc1 lds
s_waitcnt vmcnt(5)
s_barrier
ds_read_b128 v[42:45], v109 offset:0
ds_read_b128 v[46:49], v109 offset:1024
ds_read_b128 v[50:53], v109 offset:2048
ds_read_b128 v[54:57], v109 offset:3072
ds_read_b128 v[74:77], v109 offset:4096
ds_read_b128 v[78:81], v109 offset:5120
s_waitcnt lgkmcnt(2)
v_mfma_f32_32x32x16_bf16 v[26:41], a[224:227], v[42:45], 0
buffer_load_dwordx4 v[112:115], v126, s[4:7], s71 offen offset:0 sc1
ds_read_b128 v[168:171], v109 offset:6144
v_mfma_f32_32x32x16_bf16 v[26:41], a[228:231], v[46:49], v[26:41]
buffer_load_dwordx4 v[116:119], v126, s[4:7], s71 offen offset:512 sc1
s_waitcnt vmcnt(5)
s_barrier
ds_read_b128 v[172:175], v109 offset:7168
v_mfma_f32_32x32x16_bf16 v[26:41], a[232:235], v[50:53], v[26:41]
buffer_load_dwordx4 v[120:123], v126, s[4:7], s71 offen offset:1024 sc1
ds_read_b128 v[160:163], v109 offset:8192
v_mfma_f32_32x32x16_bf16 v[26:41], a[236:239], v[54:57], v[26:41]
buffer_load_dwordx4 v[124:127], v126, s[4:7], s71 offen offset:1536 sc1
ds_read_b128 v[164:167], v109 offset:9216
s_waitcnt lgkmcnt(2)
v_mfma_f32_32x32x16_bf16 v[26:41], a[240:243], v[74:77], v[26:41]
s_add_u32 m0, s66, 86016
s_add_u32 s63, s67, 57344
ds_read_b128 v[42:45], v109 offset:10240
v_mfma_f32_32x32x16_bf16 v[26:41], a[244:247], v[78:81], v[26:41]
buffer_load_dwordx4 v1, s[4:7], s63 offen offset:0 sc1 lds
ds_read_b128 v[46:49], v109 offset:11264
v_mfma_f32_32x32x16_bf16 v[26:41], a[248:251], v[168:171], v[26:41]
ds_read_b128 v[50:53], v109 offset:12288
v_mfma_f32_32x32x16_bf16 v[26:41], a[252:255], v[172:175], v[26:41]
buffer_load_dwordx4 v1, s[4:7], s63 offen offset:1024 sc1 lds
ds_read_b128 v[54:57], v109 offset:13312
s_waitcnt lgkmcnt(2)
v_mfma_f32_32x32x16_bf16 v[26:41], v[176:179], v[160:163], v[26:41]
s_add_u32 m0, s66, 94208
s_add_u32 s63, s67, 65536
ds_read_b128 v[74:77], v109 offset:14336
v_mfma_f32_32x32x16_bf16 v[26:41], v[180:183], v[164:167], v[26:41]
s_waitcnt vmcnt(6)
s_barrier
buffer_load_dwordx4 v1, s[4:7], s63 offen offset:0 sc1 lds
ds_read_b128 v[78:81], v109 offset:15360
v_mfma_f32_32x32x16_bf16 v[26:41], v[184:187], v[42:45], v[26:41]
ds_read_b128 v[168:171], v109 offset:16384
v_mfma_f32_32x32x16_bf16 v[26:41], v[188:191], v[46:49], v[26:41]
buffer_load_dwordx4 v1, s[4:7], s63 offen offset:1024 sc1 lds
ds_read_b128 v[172:175], v109 offset:17408
s_waitcnt vmcnt(4)
v_add_f32 v112, v112, v114
v_add_f32 v113, v113, v115
v_add_f32 v116, v116, v118
v_add_f32 v117, v117, v119
v_add_f32 v120, v120, v122
s_waitcnt lgkmcnt(2)
v_mfma_f32_32x32x16_bf16 v[26:41], v[192:195], v[50:53], v[26:41]
s_add_u32 m0, s66, 102400
s_add_u32 s63, s67, 73728
ds_read_b128 v[160:163], v109 offset:18432
v_add_f32 v121, v121, v123
v_add_f32 v124, v124, v126
v_add_f32 v125, v125, v127
v_cndmask_b32 v124, v124, 0, s[56:57]
v_cndmask_b32 v125, v125, 0, s[56:57]
v_add_f32 v112, v112, v116
v_mfma_f32_32x32x16_bf16 v[26:41], v[196:199], v[54:57], v[26:41]
buffer_load_dwordx4 v1, s[4:7], s63 offen offset:0 sc1 lds
ds_read_b128 v[164:167], v109 offset:19456
v_add_f32 v113, v113, v117
v_add_f32 v120, v120, v124
v_add_f32 v121, v121, v125
v_add_f32 v112, v112, v120
v_add_f32 v113, v113, v121
v_mov_b32 v114, v112
v_mfma_f32_32x32x16_bf16 v[26:41], v[200:203], v[74:77], v[26:41]
ds_read_b128 v[42:45], v109 offset:20480
v_mov_b32 v115, v113
v_mov_b32 v84, 0
v_mov_b32 v85, 0
v_permlane32_swap_b32 v112, v114
v_permlane32_swap_b32 v113, v115
v_mfma_f32_32x32x16_bf16 v[26:41], v[204:207], v[78:81], v[26:41]
buffer_load_dwordx4 v1, s[4:7], s63 offen offset:1024 sc1 lds
ds_read_b128 v[46:49], v109 offset:21504
v_add_f32 v112, v112, v114
v_add_f32 v113, v113, v115
v_mul_f32 v114, 0x3b124925, v112
v_mul_f32 v113, 0x3b124925, v113
v_fmamk_f32 v112, v114, 0xc3e00000, v112
s_waitcnt lgkmcnt(2)
v_mfma_f32_32x32x16_bf16 v[26:41], v[208:211], v[168:171], v[26:41]
s_lshr_b32 s62, s89, 2
s_add_u32 m0, s62, 110592
s_add_u32 s63, s62, s77
s_add_u32 s63, s63, 81920
ds_read_b128 v[50:53], v109 offset:22528
v_fmamk_f32 v112, v112, 0x3b124925, v114
v_fma_f32 v113, -v112, v112, v113
v_max_f32 v113, 0, v113
v_cvt_pk_bf16_f32 v114, -v112, v113
v_and_b32 v113, 0xffff0000, v114
v_mfma_f32_32x32x16_bf16 v[26:41], v[212:215], v[172:175], v[26:41]
L_hop3:
s_cbranch_execz L_hop7
buffer_load_dwordx4 v1, s[4:7], s63 offen offset:0 sc1 lds
ds_read_b128 v[54:57], v109 offset:23552
v_and_b32 v114, 0xffff, v114
v_add_f32 v113, 0x3727c5ac, v113
v_cndmask_b32 v83, v114, 0, s[56:57]
v_cvt_pk_bf16_f32 v113, v113, v113
v_lshl_or_b32 v82, v83, 16, v83
v_mfma_f32_32x32x16_bf16 v[26:41], v[216:219], v[160:163], v[26:41]
ds_read_b128 v[74:77], v109 offset:24576
v_and_b32 v113, 0xffff0000, v113
v_sqrt_f32 v113, v113
s_nop 0
v_cvt_pk_bf16_f32 v113, v113, v113
v_and_b32 v113, 0xffff0000, v113
v_mfma_f32_32x32x16_bf16 v[26:41], v[220:223], v[164:167], v[26:41]
ds_read_b128 v[78:81], v109 offset:25600
v_rcp_f32 v112, v113
s_nop 0
v_mul_f32 v113, 0x3fb8aa3b, v112
v_mov_b32 v112, v82
ds_write_b64 v111, v[112:113]
s_waitcnt lgkmcnt(3)
v_mfma_f32_32x32x16_bf16 v[26:41], v[224:227], v[42:45], v[26:41]
ds_read_b128 v[168:171], v109 offset:26624
v_mfma_f32_32x32x16_bf16 v[26:41], v[228:231], v[46:49], v[26:41]
s_waitcnt vmcnt(5) lgkmcnt(0)
s_barrier
ds_read_b128 v[172:175], v109 offset:27648
v_mfma_f32_32x32x16_bf16 v[26:41], v[232:235], v[50:53], v[26:41]
ds_read_b128 v[160:163], v110 offset:0
v_mfma_f32_32x32x16_bf16 v[26:41], v[236:239], v[54:57], v[26:41]
ds_read_b128 v[164:167], v110 offset:1024
s_waitcnt lgkmcnt(2)
v_mfma_f32_32x32x16_bf16 v[26:41], v[240:243], v[74:77], v[26:41]
s_waitcnt vmcnt(0)
s_barrier
ds_read_b64 v[86:87], v108 offset:0
ds_read_b128 v[42:45], v110 offset:2048
v_mfma_f32_32x32x16_bf16 v[26:41], v[244:247], v[78:81], v[26:41]
s_add_u32 m0, s66, 114688
s_add_u32 s63, s67, 28672
buffer_load_dwordx4 v1, s[4:7], s63 offen offset:0 sc1 lds
ds_read_b128 v[46:49], v110 offset:3072
v_mfma_f32_32x32x16_bf16 v[26:41], v[248:251], v[168:171], v[26:41]
s_waitcnt lgkmcnt(2)
v_mov_b32 v82, v86
v_and_b32 v83, 0xffff, v86
ds_read_b128 v[50:53], v110 offset:4096
v_mfma_f32_32x32x16_bf16 v[26:41], v[252:255], v[172:175], v[26:41]
buffer_load_dwordx4 v1, s[4:7], s63 offen offset:1024 sc1 lds
s_add_u32 m0, s66, 122880
s_add_u32 s63, s67, 36864
ds_read_b128 v[54:57], v110 offset:5120
v_mfma_f32_32x32x16_bf16 v[26:41], v[14:17], v[82:85], v[26:41]
buffer_load_dwordx4 v1, s[4:7], s63 offen offset:0 sc1 lds
s_waitcnt lgkmcnt(2)
v_mfma_f32_32x32x16_bf16 v[58:73], a[224:227], v[160:163], 0
buffer_load_dwordx4 v1, s[4:7], s63 offen offset:1024 sc1 lds
s_add_u32 m0, s66, 131072
s_add_u32 s63, s67, 45056
ds_read_b128 v[74:77], v110 offset:6144
v_mfma_f32_32x32x16_bf16 v[58:73], a[228:231], v[164:167], v[58:73]
buffer_load_dwordx4 v1, s[4:7], s63 offen offset:0 sc1 lds
ds_read_b128 v[78:81], v110 offset:7168
v_mfma_f32_32x32x16_bf16 v[58:73], a[232:235], v[42:45], v[58:73]
ds_read_b128 v[168:171], v110 offset:8192
v_mul_f32 v26, v26, v87
v_exp_f32 v102, -v26
v_mul_f32 v27, v27, v87
v_fma_f32 v102, v102, v106, v106
v_mfma_f32_32x32x16_bf16 v[58:73], a[236:239], v[46:49], v[58:73]
buffer_load_dwordx4 v1, s[4:7], s63 offen offset:1024 sc1 lds
ds_read_b128 v[172:175], v110 offset:9216
v_exp_f32 v103, -v27
v_mul_f32 v28, v28, v87
v_rcp_f32 v102, v102
s_waitcnt lgkmcnt(2)
v_mfma_f32_32x32x16_bf16 v[58:73], a[240:243], v[50:53], v[58:73]
s_lshr_b32 s62, s89, 2
s_add_u32 m0, s62, 139264
s_add_u32 s63, s62, s77
s_add_u32 s63, s63, 53248
ds_read_b128 v[160:163], v110 offset:10240
v_fma_f32 v103, v103, v106, v106
v_exp_f32 v104, -v28
v_mul_f32 v29, v29, v87
v_mul_f32 v26, v26, v102
v_mfma_f32_32x32x16_bf16 v[58:73], a[244:247], v[54:57], v[58:73]
buffer_load_dwordx4 v1, s[4:7], s63 offen offset:0 sc1 lds
ds_read_b128 v[164:167], v110 offset:11264
v_rcp_f32 v103, v103
v_fma_f32 v104, v104, v106, v106
v_exp_f32 v105, -v29
v_mfma_f32_32x32x16_bf16 v[58:73], a[248:251], v[74:77], v[58:73]
ds_read_b128 v[42:45], v110 offset:12288
v_mul_f32 v30, v30, v87
v_mul_f32 v27, v27, v103
v_rcp_f32 v104, v104
v_fma_f32 v105, v105, v106, v106
v_mfma_f32_32x32x16_bf16 v[58:73], a[252:255], v[78:81], v[58:73]
ds_read_b128 v[46:49], v110 offset:13312
v_exp_f32 v102, -v30
v_mul_f32 v31, v31, v87
v_mul_f32 v28, v28, v104
v_rcp_f32 v105, v105
s_waitcnt lgkmcnt(2)
v_mfma_f32_32x32x16_bf16 v[58:73], v[176:179], v[168:171], v[58:73]
ds_read_b128 v[50:53], v110 offset:14336
v_fma_f32 v102, v102, v106, v106
v_exp_f32 v103, -v31
v_mul_f32 v32, v32, v87
v_cvt_pk_bf16_f32 v94, v26, v27
v_mfma_f32_32x32x16_bf16 v[58:73], v[180:183], v[172:175], v[58:73]
ds_read_b128 v[54:57], v110 offset:15360
v_mul_f32 v29, v29, v105
v_rcp_f32 v102, v102
v_fma_f32 v103, v103, v106, v106
v_exp_f32 v104, -v32
v_mfma_f32_32x32x16_bf16 v[58:73], v[184:187], v[160:163], v[58:73]
ds_read_b128 v[74:77], v110 offset:16384
v_mul_f32 v33, v33, v87
v_mul_f32 v30, v30, v102
v_rcp_f32 v103, v103
v_fma_f32 v104, v104, v106, v106
v_mfma_f32_32x32x16_bf16 v[58:73], v[188:191], v[164:167], v[58:73]
ds_read_b128 v[78:81], v110 offset:17408
v_exp_f32 v105, -v33
v_mul_f32 v34, v34, v87
v_cvt_pk_bf16_f32 v95, v28, v29
v_mul_f32 v31, v31, v103
s_waitcnt lgkmcnt(2)
v_mfma_f32_32x32x16_bf16 v[58:73], v[192:195], v[42:45], v[58:73]
ds_read_b128 v[168:171], v110 offset:18432
v_rcp_f32 v104, v104
v_fma_f32 v105, v105, v106, v106
v_exp_f32 v102, -v34
v_mfma_f32_32x32x16_bf16 v[58:73], v[196:199], v[46:49], v[58:73]
ds_read_b128 v[172:175], v110 offset:19456
v_mul_f32 v35, v35, v87
v_mul_f32 v32, v32, v104
v_rcp_f32 v105, v105
v_fma_f32 v102, v102, v106, v106
v_mfma_f32_32x32x16_bf16 v[58:73], v[200:203], v[50:53], v[58:73]
ds_read_b128 v[160:163], v110 offset:20480
v_exp_f32 v103, -v35
v_mul_f32 v36, v36, v87
v_cvt_pk_bf16_f32 v96, v30, v31
v_mul_f32 v33, v33, v105
v_mfma_f32_32x32x16_bf16 v[58:73], v[204:207], v[54:57], v[58:73]
ds_read_b128 v[164:167], v110 offset:21504
v_rcp_f32 v102, v102
v_fma_f32 v103, v103, v106, v106
v_exp_f32 v104, -v36
s_waitcnt lgkmcnt(2)
v_mfma_f32_32x32x16_bf16 v[58:73], v[208:211], v[74:77], v[58:73]
ds_read_b128 v[42:45], v110 offset:22528
v_mul_f32 v37, v37, v87
v_mul_f32 v34, v34, v102
v_rcp_f32 v103, v103
v_fma_f32 v104, v104, v106, v106
v_mfma_f32_32x32x16_bf16 v[58:73], v[212:215], v[78:81], v[58:73]
ds_read_b128 v[46:49], v110 offset:23552
v_exp_f32 v105, -v37
v_mul_f32 v38, v38, v87
v_cvt_pk_bf16_f32 v97, v32, v33
s_add_u32 s61, s74, 0
v_mfma_f32_32x32x16_bf16 v[58:73], v[216:219], v[168:171], v[58:73]
buffer_store_dwordx4 v[94:97], v1, s[4:7], s61 offen
ds_read_b128 v[50:53], v110 offset:24576
v_mul_f32 v35, v35, v103
v_rcp_f32 v104, v104
v_fma_f32 v105, v105, v106, v106
v_mfma_f32_32x32x16_bf16 v[58:73], v[220:223], v[172:175], v[58:73]
ds_read_b128 v[54:57], v110 offset:25600
v_exp_f32 v102, -v38
v_mul_f32 v39, v39, v87
v_mul_f32 v36, v36, v104
s_waitcnt lgkmcnt(2)
v_mfma_f32_32x32x16_bf16 v[58:73], v[224:227], v[160:163], v[58:73]
ds_read_b128 v[74:77], v110 offset:26624
v_rcp_f32 v105, v105
v_fma_f32 v102, v102, v106, v106
v_exp_f32 v103, -v39
v_mfma_f32_32x32x16_bf16 v[58:73], v[228:231], v[164:167], v[58:73]
s_waitcnt vmcnt(6)
s_barrier
ds_read_b128 v[78:81], v110 offset:27648
v_mul_f32 v40, v40, v87
v_cvt_pk_bf16_f32 v98, v34, v35
v_mul_f32 v37, v37, v105
v_rcp_f32 v102, v102
v_mfma_f32_32x32x16_bf16 v[58:73], v[232:235], v[42:45], v[58:73]
ds_read_b128 v[168:171], v109 offset:0
v_fma_f32 v103, v103, v106, v106
v_exp_f32 v104, -v40
v_mul_f32 v41, v41, v87
v_mul_f32 v38, v38, v102
v_mfma_f32_32x32x16_bf16 v[58:73], v[236:239], v[46:49], v[58:73]
ds_read_b128 v[172:175], v109 offset:1024
v_rcp_f32 v103, v103
v_fma_f32 v104, v104, v106, v106
v_exp_f32 v105, -v41
s_waitcnt lgkmcnt(2)
v_mfma_f32_32x32x16_bf16 v[58:73], v[240:243], v[50:53], v[58:73]
s_waitcnt vmcnt(1)
s_barrier
ds_read_b64 v[92:93], v108 offset:1024
ds_read_b128 v[160:163], v109 offset:2048
v_cvt_pk_bf16_f32 v99, v36, v37
v_mul_f32 v39, v39, v103
v_rcp_f32 v104, v104
v_mfma_f32_32x32x16_bf16 v[58:73], v[244:247], v[54:57], v[58:73]
s_add_u32 m0, s66, 86016
s_add_u32 s63, s67, 86016
buffer_load_dwordx4 v1, s[4:7], s63 offen offset:0 sc1 lds
ds_read_b128 v[164:167], v109 offset:3072
v_fma_f32 v105, v105, v106, v106
v_mul_f32 v40, v40, v104
v_rcp_f32 v105, v105
v_mfma_f32_32x32x16_bf16 v[58:73], v[248:251], v[74:77], v[58:73]
s_waitcnt lgkmcnt(2)
v_mov_b32 v88, v92
v_and_b32 v89, 0xffff, v92
ds_read_b128 v[42:45], v109 offset:4096
v_cvt_pk_bf16_f32 v100, v38, v39
v_mul_f32 v41, v41, v105
v_mfma_f32_32x32x16_bf16 v[58:73], v[252:255], v[78:81], v[58:73]
buffer_load_dwordx4 v1, s[4:7], s63 offen offset:1024 sc1 lds
s_add_u32 m0, s66, 94208
s_add_u32 s63, s67, 94208
ds_read_b128 v[46:49], v109 offset:5120
v_cvt_pk_bf16_f32 v101, v40, v41
v_mfma_f32_32x32x16_bf16 v[58:73], v[14:17], v[88:91], v[58:73]
buffer_store_dwordx4 v[98:101], v1, s[4:7], s61 offen offset:1024
buffer_load_dwordx4 v1, s[4:7], s63 offen offset:0 sc1 lds
s_waitcnt lgkmcnt(2)
v_mfma_f32_32x32x16_bf16 v[26:41], a[224:227], v[168:171], 0
buffer_load_dwordx4 v1, s[4:7], s63 offen offset:1024 sc1 lds
s_add_u32 m0, s66, 102400
s_add_u32 s63, s67, 102400
ds_read_b128 v[50:53], v109 offset:6144
v_mfma_f32_32x32x16_bf16 v[26:41], a[228:231], v[172:175], v[26:41]
buffer_load_dwordx4 v1, s[4:7], s63 offen offset:0 sc1 lds
ds_read_b128 v[54:57], v109 offset:7168
v_mfma_f32_32x32x16_bf16 v[26:41], a[232:235], v[160:163], v[26:41]
ds_read_b128 v[74:77], v109 offset:8192
v_mul_f32 v58, v58, v93
v_exp_f32 v102, -v58
v_mul_f32 v59, v59, v93
v_fma_f32 v102, v102, v106, v106
v_mfma_f32_32x32x16_bf16 v[26:41], a[236:239], v[164:167], v[26:41]
buffer_load_dwordx4 v1, s[4:7], s63 offen offset:1024 sc1 lds
ds_read_b128 v[78:81], v109 offset:9216
v_exp_f32 v103, -v59
v_mul_f32 v60, v60, v93
v_rcp_f32 v102, v102
s_waitcnt lgkmcnt(2)
v_mfma_f32_32x32x16_bf16 v[26:41], a[240:243], v[42:45], v[26:41]
s_lshr_b32 s62, s89, 2
s_add_u32 m0, s62, 110592
s_add_u32 s63, s62, s77
s_add_u32 s63, s63, 110592
ds_read_b128 v[168:171], v109 offset:10240
v_fma_f32 v103, v103, v106, v106
v_exp_f32 v104, -v60
v_mul_f32 v61, v61, v93
v_mul_f32 v58, v58, v102
v_mfma_f32_32x32x16_bf16 v[26:41], a[244:247], v[46:49], v[26:41]
buffer_load_dwordx4 v1, s[4:7], s63 offen offset:0 sc1 lds
ds_read_b128 v[172:175], v109 offset:11264
v_rcp_f32 v103, v103
v_fma_f32 v104, v104, v106, v106
v_exp_f32 v105, -v61
v_mfma_f32_32x32x16_bf16 v[26:41], a[248:251], v[50:53], v[26:41]
ds_read_b128 v[160:163], v109 offset:12288
v_mul_f32 v62, v62, v93
v_mul_f32 v59, v59, v103
v_rcp_f32 v104, v104
v_fma_f32 v105, v105, v106, v106
v_mfma_f32_32x32x16_bf16 v[26:41], a[252:255], v[54:57], v[26:41]
ds_read_b128 v[164:167], v109 offset:13312
v_exp_f32 v102, -v62
v_mul_f32 v63, v63, v93
v_mul_f32 v60, v60, v104
v_rcp_f32 v105, v105
s_waitcnt lgkmcnt(2)
v_mfma_f32_32x32x16_bf16 v[26:41], v[176:179], v[74:77], v[26:41]
s_add_u32 s60, s35, 4
v_mov_b32 v107, s60
ds_read_b128 v[42:45], v109 offset:14336
v_fma_f32 v102, v102, v106, v106
v_exp_f32 v103, -v63
v_mul_f32 v64, v64, v93
v_cvt_pk_bf16_f32 v94, v58, v59
v_mfma_f32_32x32x16_bf16 v[26:41], v[180:183], v[78:81], v[26:41]
s_waitcnt vmcnt(5)
s_mov_b64 exec, 1
buffer_store_dword v107, off, s[4:7], s41
s_mov_b64 exec, -1
ds_read_b128 v[46:49], v109 offset:15360
v_mul_f32 v61, v61, v105
v_rcp_f32 v102, v102
v_fma_f32 v103, v103, v106, v106
v_exp_f32 v104, -v64
v_mfma_f32_32x32x16_bf16 v[26:41], v[184:187], v[168:171], v[26:41]
ds_read_b128 v[50:53], v109 offset:16384
v_mul_f32 v65, v65, v93
v_mul_f32 v62, v62, v102
v_rcp_f32 v103, v103
v_fma_f32 v104, v104, v106, v106
v_mfma_f32_32x32x16_bf16 v[26:41], v[188:191], v[172:175], v[26:41]
ds_read_b128 v[54:57], v109 offset:17408
v_exp_f32 v105, -v65
v_mul_f32 v66, v66, v93
v_cvt_pk_bf16_f32 v95, v60, v61
v_mul_f32 v63, v63, v103
s_waitcnt lgkmcnt(2)
v_mfma_f32_32x32x16_bf16 v[26:41], v[192:195], v[160:163], v[26:41]
ds_read_b128 v[74:77], v109 offset:18432
v_rcp_f32 v104, v104
v_fma_f32 v105, v105, v106, v106
v_exp_f32 v102, -v66
v_mfma_f32_32x32x16_bf16 v[26:41], v[196:199], v[164:167], v[26:41]
ds_read_b128 v[78:81], v109 offset:19456
v_mul_f32 v67, v67, v93
v_mul_f32 v64, v64, v104
v_rcp_f32 v105, v105
v_fma_f32 v102, v102, v106, v106
v_mfma_f32_32x32x16_bf16 v[26:41], v[200:203], v[42:45], v[26:41]
ds_read_b128 v[168:171], v109 offset:20480
v_exp_f32 v103, -v67
v_mul_f32 v68, v68, v93
v_cvt_pk_bf16_f32 v96, v62, v63
v_mul_f32 v65, v65, v105
v_mfma_f32_32x32x16_bf16 v[26:41], v[204:207], v[46:49], v[26:41]
ds_read_b128 v[172:175], v109 offset:21504
v_rcp_f32 v102, v102
v_fma_f32 v103, v103, v106, v106
v_exp_f32 v104, -v68
s_waitcnt lgkmcnt(2)
v_mfma_f32_32x32x16_bf16 v[26:41], v[208:211], v[50:53], v[26:41]
ds_read_b128 v[160:163], v109 offset:22528
v_mul_f32 v69, v69, v93
v_mul_f32 v66, v66, v102
v_rcp_f32 v103, v103
v_fma_f32 v104, v104, v106, v106
v_mfma_f32_32x32x16_bf16 v[26:41], v[212:215], v[54:57], v[26:41]
ds_read_b128 v[164:167], v109 offset:23552
v_exp_f32 v105, -v69
v_mul_f32 v70, v70, v93
v_cvt_pk_bf16_f32 v97, v64, v65
s_add_u32 s61, s74, 229376
v_mfma_f32_32x32x16_bf16 v[26:41], v[216:219], v[74:77], v[26:41]
buffer_store_dwordx4 v[94:97], v1, s[4:7], s61 offen
ds_read_b128 v[42:45], v109 offset:24576
v_mul_f32 v67, v67, v103
v_rcp_f32 v104, v104
v_fma_f32 v105, v105, v106, v106
v_mfma_f32_32x32x16_bf16 v[26:41], v[220:223], v[78:81], v[26:41]
ds_read_b128 v[46:49], v109 offset:25600
v_exp_f32 v102, -v70
v_mul_f32 v71, v71, v93
v_mul_f32 v68, v68, v104
s_waitcnt lgkmcnt(2)
v_mfma_f32_32x32x16_bf16 v[26:41], v[224:227], v[168:171], v[26:41]
ds_read_b128 v[50:53], v109 offset:26624
v_rcp_f32 v105, v105
v_fma_f32 v102, v102, v106, v106
v_exp_f32 v103, -v71
v_mfma_f32_32x32x16_bf16 v[26:41], v[228:231], v[172:175], v[26:41]
s_waitcnt vmcnt(8)
s_barrier
ds_read_b128 v[54:57], v109 offset:27648
v_mul_f32 v72, v72, v93
v_cvt_pk_bf16_f32 v98, v66, v67
v_mul_f32 v69, v69, v105
v_rcp_f32 v102, v102
v_mfma_f32_32x32x16_bf16 v[26:41], v[232:235], v[160:163], v[26:41]
ds_read_b128 v[74:77], v110 offset:0
v_fma_f32 v103, v103, v106, v106
v_exp_f32 v104, -v72
v_mul_f32 v73, v73, v93
v_mul_f32 v70, v70, v102
v_mfma_f32_32x32x16_bf16 v[26:41], v[236:239], v[164:167], v[26:41]
ds_read_b128 v[78:81], v110 offset:1024
v_rcp_f32 v103, v103
v_fma_f32 v104, v104, v106, v106
v_exp_f32 v105, -v73
s_waitcnt lgkmcnt(2)
v_mfma_f32_32x32x16_bf16 v[26:41], v[240:243], v[42:45], v[26:41]
s_waitcnt vmcnt(2)
s_barrier
ds_read_b64 v[86:87], v108 offset:512
ds_read_b128 v[168:171], v110 offset:2048
v_cvt_pk_bf16_f32 v99, v68, v69
v_mul_f32 v71, v71, v103
v_rcp_f32 v104, v104
v_mfma_f32_32x32x16_bf16 v[26:41], v[244:247], v[46:49], v[26:41]
ds_read_b128 v[172:175], v110 offset:3072
v_fma_f32 v105, v105, v106, v106
v_mul_f32 v72, v72, v104
v_rcp_f32 v105, v105
v_cvt_pk_bf16_f32 v100, v70, v71
v_mfma_f32_32x32x16_bf16 v[26:41], v[248:251], v[50:53], v[26:41]
s_waitcnt lgkmcnt(2)
v_mov_b32 v82, v86
v_and_b32 v83, 0xffff, v86
ds_read_b128 v[160:163], v110 offset:4096
v_mul_f32 v73, v73, v105
v_cvt_pk_bf16_f32 v101, v72, v73
v_mfma_f32_32x32x16_bf16 v[26:41], v[252:255], v[54:57], v[26:41]
buffer_store_dwordx4 v[98:101], v1, s[4:7], s61 offen offset:1024
ds_read_b128 v[164:167], v110 offset:5120
v_mfma_f32_32x32x16_bf16 v[26:41], v[14:17], v[82:85], v[26:41]
s_waitcnt lgkmcnt(2)
v_mfma_f32_32x32x16_bf16 v[58:73], a[224:227], v[74:77], 0
ds_read_b128 v[42:45], v110 offset:6144
v_mfma_f32_32x32x16_bf16 v[58:73], a[228:231], v[78:81], v[58:73]
ds_read_b128 v[46:49], v110 offset:7168
v_mfma_f32_32x32x16_bf16 v[58:73], a[232:235], v[168:171], v[58:73]
ds_read_b128 v[50:53], v110 offset:8192
s_nop 4
v_mul_f32 v26, v26, v87
v_exp_f32 v102, -v26
v_mul_f32 v27, v27, v87
v_fma_f32 v102, v102, v106, v106
v_mfma_f32_32x32x16_bf16 v[58:73], a[236:239], v[172:175], v[58:73]
ds_read_b128 v[54:57], v110 offset:9216
v_exp_f32 v103, -v27
v_mul_f32 v28, v28, v87
v_rcp_f32 v102, v102
s_waitcnt lgkmcnt(2)
v_mfma_f32_32x32x16_bf16 v[58:73], a[240:243], v[160:163], v[58:73]
ds_read_b128 v[74:77], v110 offset:10240
v_fma_f32 v103, v103, v106, v106
v_exp_f32 v104, -v28
v_mul_f32 v29, v29, v87
v_mul_f32 v26, v26, v102
v_mfma_f32_32x32x16_bf16 v[58:73], a[244:247], v[164:167], v[58:73]
ds_read_b128 v[78:81], v110 offset:11264
v_rcp_f32 v103, v103
v_fma_f32 v104, v104, v106, v106
v_exp_f32 v105, -v29
v_mfma_f32_32x32x16_bf16 v[58:73], a[248:251], v[42:45], v[58:73]
ds_read_b128 v[168:171], v110 offset:12288
v_mul_f32 v30, v30, v87
v_mul_f32 v27, v27, v103
v_rcp_f32 v104, v104
v_fma_f32 v105, v105, v106, v106
v_mfma_f32_32x32x16_bf16 v[58:73], a[252:255], v[46:49], v[58:73]
ds_read_b128 v[172:175], v110 offset:13312
v_exp_f32 v102, -v30
v_mul_f32 v31, v31, v87
v_mul_f32 v28, v28, v104
v_rcp_f32 v105, v105
s_waitcnt lgkmcnt(2)
v_mfma_f32_32x32x16_bf16 v[58:73], v[176:179], v[50:53], v[58:73]
s_add_u32 s60, s35, 5
v_mov_b32 v107, s60
ds_read_b128 v[160:163], v110 offset:14336
v_fma_f32 v102, v102, v106, v106
v_exp_f32 v103, -v31
v_mul_f32 v32, v32, v87
v_cvt_pk_bf16_f32 v94, v26, v27
v_mfma_f32_32x32x16_bf16 v[58:73], v[180:183], v[54:57], v[58:73]
s_waitcnt vmcnt(0)
s_mov_b64 exec, 1
buffer_store_dword v107, off, s[4:7], s41
s_mov_b64 exec, -1
ds_read_b128 v[164:167], v110 offset:15360
v_mul_f32 v29, v29, v105
v_rcp_f32 v102, v102
v_fma_f32 v103, v103, v106, v106
v_exp_f32 v104, -v32
v_mfma_f32_32x32x16_bf16 v[58:73], v[184:187], v[74:77], v[58:73]
ds_read_b128 v[42:45], v110 offset:16384
v_mul_f32 v33, v33, v87
v_mul_f32 v30, v30, v102
v_rcp_f32 v103, v103
v_fma_f32 v104, v104, v106, v106
v_mfma_f32_32x32x16_bf16 v[58:73], v[188:191], v[78:81], v[58:73]
ds_read_b128 v[46:49], v110 offset:17408
v_exp_f32 v105, -v33
v_mul_f32 v34, v34, v87
v_cvt_pk_bf16_f32 v95, v28, v29
v_mul_f32 v31, v31, v103
s_waitcnt lgkmcnt(2)
v_mfma_f32_32x32x16_bf16 v[58:73], v[192:195], v[168:171], v[58:73]
ds_read_b128 v[50:53], v110 offset:18432
v_rcp_f32 v104, v104
v_fma_f32 v105, v105, v106, v106
v_exp_f32 v102, -v34
v_mfma_f32_32x32x16_bf16 v[58:73], v[196:199], v[172:175], v[58:73]
ds_read_b128 v[54:57], v110 offset:19456
v_mul_f32 v35, v35, v87
v_mul_f32 v32, v32, v104
v_rcp_f32 v105, v105
v_fma_f32 v102, v102, v106, v106
v_mfma_f32_32x32x16_bf16 v[58:73], v[200:203], v[160:163], v[58:73]
ds_read_b128 v[74:77], v110 offset:20480
v_exp_f32 v103, -v35
v_mul_f32 v36, v36, v87
v_cvt_pk_bf16_f32 v96, v30, v31
v_mul_f32 v33, v33, v105
v_mfma_f32_32x32x16_bf16 v[58:73], v[204:207], v[164:167], v[58:73]
buffer_load_dword v107, v4, s[4:7], s40 offen sc1
ds_read_b128 v[78:81], v110 offset:21504
v_rcp_f32 v102, v102
v_fma_f32 v103, v103, v106, v106
v_exp_f32 v104, -v36
s_waitcnt lgkmcnt(2)
v_mfma_f32_32x32x16_bf16 v[58:73], v[208:211], v[42:45], v[58:73]
ds_read_b128 v[168:171], v110 offset:22528
v_mul_f32 v37, v37, v87
v_mul_f32 v34, v34, v102
v_rcp_f32 v103, v103
v_fma_f32 v104, v104, v106, v106
v_mfma_f32_32x32x16_bf16 v[58:73], v[212:215], v[46:49], v[58:73]
ds_read_b128 v[172:175], v110 offset:23552
v_exp_f32 v105, -v37
v_mul_f32 v38, v38, v87
v_cvt_pk_bf16_f32 v97, v32, v33
s_add_u32 s61, s74, 114688
v_mfma_f32_32x32x16_bf16 v[58:73], v[216:219], v[50:53], v[58:73]
buffer_store_dwordx4 v[94:97], v1, s[4:7], s61 offen
ds_read_b128 v[160:163], v110 offset:24576
v_mul_f32 v35, v35, v103
v_rcp_f32 v104, v104
v_fma_f32 v105, v105, v106, v106
v_mfma_f32_32x32x16_bf16 v[58:73], v[220:223], v[54:57], v[58:73]
ds_read_b128 v[164:167], v110 offset:25600
v_exp_f32 v102, -v38
v_mul_f32 v39, v39, v87
v_mul_f32 v36, v36, v104
s_waitcnt lgkmcnt(2)
v_mfma_f32_32x32x16_bf16 v[58:73], v[224:227], v[74:77], v[58:73]
ds_read_b128 v[42:45], v110 offset:26624
v_rcp_f32 v105, v105
v_fma_f32 v102, v102, v106, v106
v_exp_f32 v103, -v39
v_mfma_f32_32x32x16_bf16 v[58:73], v[228:231], v[78:81], v[58:73]
s_add_u32 s60, s35, s39
s_add_u32 s60, s60, 4
s_waitcnt vmcnt(1)
LC_75:
v_subrev_u32 v107, s60, v107
v_cmp_le_u32 vcc, 64, v107
s_and_b64 vcc, vcc, s[52:53]
s_cbranch_scc1 LS_76
LD_77:
s_add_u32 s65, s75, s90
buffer_load_dwordx4 v[112:115], v1, s[4:7], s65 offen offset:0 sc1
ds_read_b128 v[46:49], v110 offset:27648
v_mul_f32 v40, v40, v87
v_cvt_pk_bf16_f32 v98, v34, v35
v_mul_f32 v37, v37, v105
v_rcp_f32 v102, v102
v_mfma_f32_32x32x16_bf16 v[58:73], v[232:235], v[168:171], v[58:73]
buffer_load_dwordx4 v[116:119], v1, s[4:7], s65 offen offset:1024 sc1
v_fma_f32 v103, v103, v106, v106
v_exp_f32 v104, -v40
v_mul_f32 v41, v41, v87
v_mul_f32 v38, v38, v102
v_mfma_f32_32x32x16_bf16 v[58:73], v[236:239], v[172:175], v[58:73]
buffer_load_dwordx4 v[120:123], v1, s[4:7], s65 offen offset:2048 sc1
v_rcp_f32 v103, v103
v_fma_f32 v104, v104, v106, v106
v_exp_f32 v105, -v41
s_waitcnt lgkmcnt(0)
v_mfma_f32_32x32x16_bf16 v[58:73], v[240:243], v[160:163], v[58:73]
ds_read_b64 v[92:93], v108 offset:1536
buffer_load_dwordx4 v[124:127], v1, s[4:7], s65 offen offset:3072 sc1
v_cvt_pk_bf16_f32 v99, v36, v37
v_mul_f32 v39, v39, v103
v_rcp_f32 v104, v104
v_mfma_f32_32x32x16_bf16 v[58:73], v[244:247], v[164:167], v[58:73]
s_add_u32 s65, s75, s91
buffer_load_dwordx4 v[128:131], v1, s[4:7], s65 offen offset:0 sc1
v_fma_f32 v105, v105, v106, v106
v_mul_f32 v40, v40, v104
v_rcp_f32 v105, v105
v_mfma_f32_32x32x16_bf16 v[58:73], v[248:251], v[42:45], v[58:73]
s_waitcnt lgkmcnt(0)
v_mov_b32 v88, v92
v_and_b32 v89, 0xffff, v92
buffer_load_dwordx4 v[132:135], v1, s[4:7], s65 offen offset:1024 sc1
v_cvt_pk_bf16_f32 v100, v38, v39
v_mul_f32 v41, v41, v105
v_mfma_f32_32x32x16_bf16 v[58:73], v[252:255], v[46:49], v[58:73]
buffer_load_dwordx4 v[136:139], v1, s[4:7], s65 offen offset:2048 sc1
v_cvt_pk_bf16_f32 v101, v40, v41
v_mfma_f32_32x32x16_bf16 v[58:73], v[14:17], v[88:91], v[58:73]
buffer_store_dwordx4 v[98:101], v1, s[4:7], s61 offen offset:1024
buffer_load_dwordx4 v[140:143], v1, s[4:7], s65 offen offset:3072 sc1
s_waitcnt vmcnt(8)
v_mfma_f32_32x32x16_bf16 v[26:41], a[0:3], v[112:115], 0
v_mfma_f32_32x32x16_bf16 v[42:57], a[4:7], v[112:115], 0
s_nop 6
v_pk_mul_f32 v[58:59], v[58:59], v[92:93] op_sel:[0,1] op_sel_hi:[1,1]
v_pk_mul_f32 v[60:61], v[60:61], v[92:93] op_sel:[0,1] op_sel_hi:[1,1]
v_exp_f32 v102, -v58
v_exp_f32 v103, -v59
v_exp_f32 v104, -v60
v_exp_f32 v105, -v61
v_pk_fma_f32 v[102:103], v[102:103], s[82:83], s[82:83]
v_pk_fma_f32 v[104:105], v[104:105], s[82:83], s[82:83]
v_rcp_f32 v102, v102
v_rcp_f32 v103, v103
v_rcp_f32 v104, v104
v_rcp_f32 v105, v105
v_pk_mul_f32 v[58:59], v[58:59], v[102:103]
v_pk_mul_f32 v[60:61], v[60:61], v[104:105]
v_cvt_pk_bf16_f32 v94, v58, v59
v_cvt_pk_bf16_f32 v95, v60, v61
s_add_u32 s65, s75, s92
buffer_load_dwordx4 v[144:147], v1, s[4:7], s65 offen offset:0 sc1
buffer_load_dwordx4 v[148:151], v1, s[4:7], s65 offen offset:1024 sc1
v_pk_mul_f32 v[62:63], v[62:63], v[92:93] op_sel:[0,1] op_sel_hi:[1,1]
v_pk_mul_f32 v[64:65], v[64:65], v[92:93] op_sel:[0,1] op_sel_hi:[1,1]
v_exp_f32 v102, -v62
v_exp_f32 v103, -v63
v_exp_f32 v104, -v64
v_exp_f32 v105, -v65
v_pk_fma_f32 v[102:103], v[102:103], s[82:83], s[82:83]
v_pk_fma_f32 v[104:105], v[104:105], s[82:83], s[82:83]
L_hop4:
s_cbranch_execz L_hop8
v_rcp_f32 v102, v102
v_rcp_f32 v103, v103
v_rcp_f32 v104, v104
v_rcp_f32 v105, v105
v_pk_mul_f32 v[62:63], v[62:63], v[102:103]
v_pk_mul_f32 v[64:65], v[64:65], v[104:105]
v_cvt_pk_bf16_f32 v96, v62, v63
v_cvt_pk_bf16_f32 v97, v64, v65
buffer_load_dwordx4 v[152:155], v1, s[4:7], s65 offen offset:2048 sc1
buffer_load_dwordx4 v[156:159], v1, s[4:7], s65 offen offset:3072 sc1
s_add_u32 s61, s74, 344064
buffer_store_dwordx4 v[94:97], v1, s[4:7], s61 offen
v_pk_mul_f32 v[66:67], v[66:67], v[92:93] op_sel:[0,1] op_sel_hi:[1,1]
v_pk_mul_f32 v[68:69], v[68:69], v[92:93] op_sel:[0,1] op_sel_hi:[1,1]
v_exp_f32 v102, -v66
v_exp_f32 v103, -v67
v_exp_f32 v104, -v68
v_exp_f32 v105, -v69
v_pk_fma_f32 v[102:103], v[102:103], s[82:83], s[82:83]
v_pk_fma_f32 v[104:105], v[104:105], s[82:83], s[82:83]
v_rcp_f32 v102, v102
v_rcp_f32 v103, v103
v_rcp_f32 v104, v104
v_rcp_f32 v105, v105
v_pk_mul_f32 v[66:67], v[66:67], v[102:103]
v_pk_mul_f32 v[68:69], v[68:69], v[104:105]
v_cvt_pk_bf16_f32 v98, v66, v67
v_cvt_pk_bf16_f32 v99, v68, v69
v_pk_mul_f32 v[70:71], v[70:71], v[92:93] op_sel:[0,1] op_sel_hi:[1,1]
v_pk_mul_f32 v[72:73], v[72:73], v[92:93] op_sel:[0,1] op_sel_hi:[1,1]
v_exp_f32 v102, -v70
v_exp_f32 v103, -v71
v_exp_f32 v104, -v72
v_exp_f32 v105, -v73
v_pk_fma_f32 v[102:103], v[102:103], s[82:83], s[82:83]
v_pk_fma_f32 v[104:105], v[104:105], s[82:83], s[82:83]
v_rcp_f32 v102, v102
v_rcp_f32 v103, v103
v_rcp_f32 v104, v104
v_rcp_f32 v105, v105
v_pk_mul_f32 v[70:71], v[70:71], v[102:103]
v_pk_mul_f32 v[72:73], v[72:73], v[104:105]
v_cvt_pk_bf16_f32 v100, v70, v71
v_cvt_pk_bf16_f32 v101, v72, v73
buffer_store_dwordx4 v[98:101], v1, s[4:7], s61 offen offset:1024
s_waitcnt vmcnt(13)
v_mfma_f32_32x32x16_bf16 v[26:41], a[8:11], v[116:119], v[26:41]
s_add_u32 s60, s35, 6
v_mov_b32 v107, s60
s_add_u32 s65, s75, s93
buffer_load_dwordx4 v[112:115], v1, s[4:7], s65 offen offset:0 sc1
v_mfma_f32_32x32x16_bf16 v[42:57], a[12:15], v[116:119], v[42:57]
s_waitcnt vmcnt(8)
s_mov_b64 exec, 1
buffer_store_dword v107, off, s[4:7], s41
s_mov_b64 exec, -1
buffer_load_dwordx4 v[116:119], v1, s[4:7], s65 offen offset:1024 sc1
s_waitcnt vmcnt(15)
v_mfma_f32_32x32x16_bf16 v[26:41], a[16:19], v[120:123], v[26:41]
v_mfma_f32_32x32x16_bf16 v[42:57], a[20:23], v[120:123], v[42:57]
buffer_load_dwordx4 v[120:123], v1, s[4:7], s65 offen offset:2048 sc1
s_waitcnt vmcnt(15)
v_mfma_f32_32x32x16_bf16 v[26:41], a[24:27], v[124:127], v[26:41]
v_mfma_f32_32x32x16_bf16 v[42:57], a[28:31], v[124:127], v[42:57]
buffer_load_dwordx4 v[124:127], v1, s[4:7], s65 offen offset:3072 sc1
s_waitcnt vmcnt(15)
v_mfma_f32_32x32x16_bf16 v[26:41], a[32:35], v[128:131], v[26:41]
v_mfma_f32_32x32x16_bf16 v[42:57], a[36:39], v[128:131], v[42:57]
s_add_u32 s65, s75, s94
buffer_load_dwordx4 v[128:131], v1, s[4:7], s65 offen offset:0 sc1
s_waitcnt vmcnt(15)
v_mfma_f32_32x32x16_bf16 v[26:41], a[40:43], v[132:135], v[26:41]
v_mfma_f32_32x32x16_bf16 v[42:57], a[44:47], v[132:135], v[42:57]
buffer_load_dwordx4 v[132:135], v1, s[4:7], s65 offen offset:1024 sc1
s_waitcnt vmcnt(15)
v_mfma_f32_32x32x16_bf16 v[26:41], a[48:51], v[136:139], v[26:41]
s_add_u32 s60, s35, 7
v_mov_b32 v107, s60
v_mfma_f32_32x32x16_bf16 v[42:57], a[52:55], v[136:139], v[42:57]
s_waitcnt vmcnt(7)
s_mov_b64 exec, 1
buffer_store_dword v107, off, s[4:7], s41
s_mov_b64 exec, -1
buffer_load_dwordx4 v[136:139], v1, s[4:7], s65 offen offset:2048 sc1
s_waitcnt vmcnt(15)
v_mfma_f32_32x32x16_bf16 v[26:41], a[56:59], v[140:143], v[26:41]
v_mfma_f32_32x32x16_bf16 v[42:57], a[60:63], v[140:143], v[42:57]
buffer_load_dwordx4 v[140:143], v1, s[4:7], s65 offen offset:3072 sc1
s_waitcnt vmcnt(15)
v_mfma_f32_32x32x16_bf16 v[26:41], a[64:67], v[144:147], v[26:41]
v_mfma_f32_32x32x16_bf16 v[42:57], a[68:71], v[144:147], v[42:57]
s_add_u32 s65, s75, s95
buffer_load_dwordx4 v[144:147], v1, s[4:7], s65 offen offset:0 sc1
s_waitcnt vmcnt(15)
v_mfma_f32_32x32x16_bf16 v[26:41], a[72:75], v[148:151], v[26:41]
v_mfma_f32_32x32x16_bf16 v[42:57], a[76:79], v[148:151], v[42:57]
buffer_load_dwordx4 v[148:151], v1, s[4:7], s65 offen offset:1024 sc1
s_waitcnt vmcnt(15)
v_mfma_f32_32x32x16_bf16 v[26:41], a[80:83], v[152:155], v[26:41]
v_mfma_f32_32x32x16_bf16 v[42:57], a[84:87], v[152:155], v[42:57]
buffer_load_dwordx4 v[152:155], v1, s[4:7], s65 offen offset:2048 sc1
s_waitcnt vmcnt(15)
v_mfma_f32_32x32x16_bf16 v[26:41], a[88:91], v[156:159], v[26:41]
v_mfma_f32_32x32x16_bf16 v[42:57], a[92:95], v[156:159], v[42:57]
buffer_load_dwordx4 v[156:159], v1, s[4:7], s65 offen offset:3072 sc1
s_waitcnt vmcnt(13)
v_mfma_f32_32x32x16_bf16 v[26:41], a[96:99], v[112:115], v[26:41]
buffer_load_dword v107, v4, s[4:7], s40 offen sc1
v_mfma_f32_32x32x16_bf16 v[42:57], a[100:103], v[112:115], v[42:57]
s_add_u32 s65, s75, s96
buffer_load_dwordx4 v[112:115], v1, s[4:7], s65 offen offset:0 sc1
s_waitcnt vmcnt(13)
v_mfma_f32_32x32x16_bf16 v[26:41], a[104:107], v[116:119], v[26:41]
v_mfma_f32_32x32x16_bf16 v[42:57], a[108:111], v[116:119], v[42:57]
buffer_load_dwordx4 v[116:119], v1, s[4:7], s65 offen offset:1024 sc1
s_waitcnt vmcnt(13)
v_mfma_f32_32x32x16_bf16 v[26:41], a[112:115], v[120:123], v[26:41]
v_mfma_f32_32x32x16_bf16 v[42:57], a[116:119], v[120:123], v[42:57]
buffer_load_dwordx4 v[120:123], v1, s[4:7], s65 offen offset:2048 sc1
s_waitcnt vmcnt(13)
v_mfma_f32_32x32x16_bf16 v[26:41], a[120:123], v[124:127], v[26:41]
v_mfma_f32_32x32x16_bf16 v[42:57], a[124:127], v[124:127], v[42:57]
buffer_load_dwordx4 v[124:127], v1, s[4:7], s65 offen offset:3072 sc1
s_waitcnt vmcnt(13)
v_mfma_f32_32x32x16_bf16 v[26:41], a[128:131], v[128:131], v[26:41]
v_mfma_f32_32x32x16_bf16 v[42:57], a[132:135], v[128:131], v[42:57]
s_waitcnt vmcnt(12)
v_mfma_f32_32x32x16_bf16 v[26:41], a[136:139], v[132:135], v[26:41]
v_mfma_f32_32x32x16_bf16 v[42:57], a[140:143], v[132:135], v[42:57]
s_waitcnt vmcnt(10)
v_mfma_f32_32x32x16_bf16 v[26:41], a[144:147], v[136:139], v[26:41]
s_add_u32 s60, s35, s39
s_add_u32 s60, s60, 6
s_waitcnt vmcnt(4)
LC_78:
v_subrev_u32 v107, s60, v107
v_cmp_le_u32 vcc, 64, v107
s_and_b64 vcc, vcc, s[52:53]
s_cbranch_scc1 LS_79
LD_80:
s_add_u32 s65, s3, s90
buffer_load_dwordx4 v[128:131], v1, s[4:7], s65 offen offset:0 sc1
v_mfma_f32_32x32x16_bf16 v[42:57], a[148:151], v[136:139], v[42:57]
buffer_load_dwordx4 v[132:135], v1, s[4:7], s65 offen offset:1024 sc1
s_waitcnt vmcnt(11)
v_mfma_f32_32x32x16_bf16 v[26:41], a[152:155], v[140:143], v[26:41]
buffer_load_dwordx4 v[136:139], v1, s[4:7], s65 offen offset:2048 sc1
v_mfma_f32_32x32x16_bf16 v[42:57], a[156:159], v[140:143], v[42:57]
buffer_load_dwordx4 v[140:143], v1, s[4:7], s65 offen offset:3072 sc1
s_waitcnt vmcnt(12)
v_mfma_f32_32x32x16_bf16 v[26:41], a[160:163], v[144:147], v[26:41]
s_and_b32 s61, s32, 1
s_mul_i32 s62, s61, 12288
s_add_u32 s62, s62, 86016
v_add_u32 v90, s62, v1
v_mfma_f32_32x32x16_bf16 v[42:57], a[164:167], v[144:147], v[42:57]
s_add_u32 s65, s3, s91
buffer_load_dwordx4 v[144:147], v1, s[4:7], s65 offen offset:0 sc1
s_waitcnt vmcnt(12)
v_mfma_f32_32x32x16_bf16 v[26:41], a[168:171], v[148:151], v[26:41]
s_xor_b32 s61, s61, 1
s_mul_i32 s62, s61, 12288
s_add_u32 s62, s62, 86016
v_add_u32 v91, s62, v1
v_mfma_f32_32x32x16_bf16 v[42:57], a[172:175], v[148:151], v[42:57]
buffer_load_dwordx4 v[148:151], v1, s[4:7], s65 offen offset:1024 sc1
s_waitcnt vmcnt(12)
v_mfma_f32_32x32x16_bf16 v[26:41], a[176:179], v[152:155], v[26:41]
v_mfma_f32_32x32x16_bf16 v[42:57], a[180:183], v[152:155], v[42:57]
buffer_load_dwordx4 v[152:155], v1, s[4:7], s65 offen offset:2048 sc1
s_waitcnt vmcnt(12)
v_mfma_f32_32x32x16_bf16 v[26:41], a[184:187], v[156:159], v[26:41]
v_mfma_f32_32x32x16_bf16 v[42:57], a[188:191], v[156:159], v[42:57]
buffer_load_dwordx4 v[156:159], v1, s[4:7], s65 offen offset:3072 sc1
s_waitcnt vmcnt(11)
v_mfma_f32_32x32x16_bf16 v[26:41], a[192:195], v[112:115], v[26:41]
v_mfma_f32_32x32x16_bf16 v[42:57], a[196:199], v[112:115], v[42:57]
s_add_u32 s65, s3, s92
buffer_load_dwordx4 v[112:115], v1, s[4:7], s65 offen offset:0 sc1
s_waitcnt vmcnt(11)
v_mfma_f32_32x32x16_bf16 v[26:41], a[200:203], v[116:119], v[26:41]
v_mfma_f32_32x32x16_bf16 v[42:57], a[204:207], v[116:119], v[42:57]
buffer_load_dwordx4 v[116:119], v1, s[4:7], s65 offen offset:1024 sc1
s_waitcnt vmcnt(11)
v_mfma_f32_32x32x16_bf16 v[26:41], a[208:211], v[120:123], v[26:41]
v_mfma_f32_32x32x16_bf16 v[42:57], a[212:215], v[120:123], v[42:57]
buffer_load_dwordx4 v[120:123], v1, s[4:7], s65 offen offset:2048 sc1
s_waitcnt vmcnt(11)
v_mfma_f32_32x32x16_bf16 v[26:41], a[216:219], v[124:127], v[26:41]
v_mfma_f32_32x32x16_bf16 v[42:57], a[220:223], v[124:127], v[42:57]
buffer_load_dwordx4 v[124:127], v1, s[4:7], s65 offen offset:3072 sc1
s_cmp_lt_u32 s32, 2
s_cbranch_scc0 LB_81
s_waitcnt vmcnt(11)
v_mfma_f32_32x32x16_bf16 v[58:73], a[0:3], v[128:131], 0
v_mfma_f32_32x32x16_bf16 v[74:89], a[4:7], v[128:131], 0
s_add_u32 s65, s3, s93
buffer_load_dwordx4 v[128:131], v1, s[4:7], s65 offen offset:0 sc1
s_waitcnt vmcnt(11)
v_mfma_f32_32x32x16_bf16 v[58:73], a[8:11], v[132:135], v[58:73]
s_nop 1
ds_write_b128 v91, v[42:45] offset:28672
v_lshlrev_b32 v92, 16, v18
v_and_b32 v93, 0xffff0000, v18
v_add_f32 v26, v26, v92
v_add_f32 v27, v27, v93
v_lshlrev_b32 v92, 16, v19
v_mfma_f32_32x32x16_bf16 v[74:89], a[12:15], v[132:135], v[74:89]
buffer_load_dwordx4 v[132:135], v1, s[4:7], s65 offen offset:1024 sc1
v_and_b32 v93, 0xffff0000, v19
v_add_f32 v28, v28, v92
v_add_f32 v29, v29, v93
v_lshlrev_b32 v92, 16, v20
s_waitcnt vmcnt(11)
v_mfma_f32_32x32x16_bf16 v[58:73], a[16:19], v[136:139], v[58:73]
ds_write_b128 v91, v[46:49] offset:29696
v_and_b32 v93, 0xffff0000, v20
v_add_f32 v30, v30, v92
v_add_f32 v31, v31, v93
v_lshlrev_b32 v92, 16, v21
v_and_b32 v93, 0xffff0000, v21
v_mfma_f32_32x32x16_bf16 v[74:89], a[20:23], v[136:139], v[74:89]
buffer_load_dwordx4 v[136:139], v1, s[4:7], s65 offen offset:2048 sc1
v_add_f32 v32, v32, v92
v_add_f32 v33, v33, v93
v_lshlrev_b32 v92, 16, v22
v_and_b32 v93, 0xffff0000, v22
s_waitcnt vmcnt(11)
v_mfma_f32_32x32x16_bf16 v[58:73], a[24:27], v[140:143], v[58:73]
ds_write_b128 v91, v[50:53] offset:30720
v_add_f32 v34, v34, v92
v_add_f32 v35, v35, v93
v_lshlrev_b32 v92, 16, v23
v_and_b32 v93, 0xffff0000, v23
v_add_f32 v36, v36, v92
v_mfma_f32_32x32x16_bf16 v[74:89], a[28:31], v[140:143], v[74:89]
buffer_load_dwordx4 v[140:143], v1, s[4:7], s65 offen offset:3072 sc1
v_add_f32 v37, v37, v93
v_lshlrev_b32 v92, 16, v24
v_and_b32 v93, 0xffff0000, v24
v_add_f32 v38, v38, v92
s_waitcnt vmcnt(11)
v_mfma_f32_32x32x16_bf16 v[58:73], a[32:35], v[144:147], v[58:73]
ds_write_b128 v91, v[54:57] offset:31744
v_add_f32 v39, v39, v93
v_lshlrev_b32 v92, 16, v25
v_and_b32 v93, 0xffff0000, v25
v_add_f32 v40, v40, v92
v_add_f32 v41, v41, v93
v_mfma_f32_32x32x16_bf16 v[74:89], a[36:39], v[144:147], v[74:89]
s_add_u32 s65, s3, s94
buffer_load_dwordx4 v[144:147], v1, s[4:7], s65 offen offset:0 sc1
s_waitcnt vmcnt(11)
v_mfma_f32_32x32x16_bf16 v[58:73], a[40:43], v[148:151], v[58:73]
v_mfma_f32_32x32x16_bf16 v[74:89], a[44:47], v[148:151], v[74:89]
buffer_load_dwordx4 v[148:151], v1, s[4:7], s65 offen offset:1024 sc1
s_waitcnt vmcnt(11)
v_mfma_f32_32x32x16_bf16 v[58:73], a[48:51], v[152:155], v[58:73]
v_mfma_f32_32x32x16_bf16 v[74:89], a[52:55], v[152:155], v[74:89]
buffer_load_dwordx4 v[152:155], v1, s[4:7], s65 offen offset:2048 sc1
s_waitcnt vmcnt(11)
v_mfma_f32_32x32x16_bf16 v[58:73], a[56:59], v[156:159], v[58:73]
v_mfma_f32_32x32x16_bf16 v[74:89], a[60:63], v[156:159], v[74:89]
buffer_load_dwordx4 v[156:159], v1, s[4:7], s65 offen offset:3072 sc1
s_waitcnt vmcnt(11)
v_mfma_f32_32x32x16_bf16 v[58:73], a[64:67], v[112:115], v[58:73]
v_mfma_f32_32x32x16_bf16 v[74:89], a[68:71], v[112:115], v[74:89]
s_add_u32 s65, s3, s95
buffer_load_dwordx4 v[112:115], v1, s[4:7], s65 offen offset:0 sc1
s_waitcnt vmcnt(11)
v_mfma_f32_32x32x16_bf16 v[58:73], a[72:75], v[116:119], v[58:73]
s_waitcnt lgkmcnt(0)
s_barrier
v_mfma_f32_32x32x16_bf16 v[74:89], a[76:79], v[116:119], v[74:89]
buffer_load_dwordx4 v[116:119], v1, s[4:7], s65 offen offset:1024 sc1
s_waitcnt vmcnt(11)
v_mfma_f32_32x32x16_bf16 v[58:73], a[80:83], v[120:123], v[58:73]
ds_read_b128 v[42:45], v90 offset:28672
ds_read_b128 v[46:49], v90 offset:29696
ds_read_b128 v[50:53], v90 offset:30720
ds_read_b128 v[54:57], v90 offset:31744
v_mfma_f32_32x32x16_bf16 v[74:89], a[84:87], v[120:123], v[74:89]
buffer_load_dwordx4 v[120:123], v1, s[4:7], s65 offen offset:2048 sc1
s_waitcnt vmcnt(11)
v_mfma_f32_32x32x16_bf16 v[58:73], a[88:91], v[124:127], v[58:73]
s_waitcnt lgkmcnt(0)
v_add_f32 v26, v26, v42
v_add_f32 v27, v27, v43
v_add_f32 v28, v28, v44
v_add_f32 v29, v29, v45
v_add_f32 v30, v30, v46
v_mfma_f32_32x32x16_bf16 v[74:89], a[92:95], v[124:127], v[74:89]
buffer_load_dwordx4 v[124:127], v1, s[4:7], s65 offen offset:3072 sc1
v_add_f32 v31, v31, v47
v_add_f32 v32, v32, v48
v_add_f32 v33, v33, v49
v_add_f32 v34, v34, v50
s_waitcnt vmcnt(11)
v_mfma_f32_32x32x16_bf16 v[58:73], a[96:99], v[128:131], v[58:73]
v_add_f32 v35, v35, v51
v_add_f32 v36, v36, v52
v_add_f32 v37, v37, v53
v_add_f32 v38, v38, v54
v_add_f32 v39, v39, v55
v_add_f32 v40, v40, v56
v_mfma_f32_32x32x16_bf16 v[74:89], a[100:103], v[128:131], v[74:89]
s_add_u32 s65, s3, s96
buffer_load_dwordx4 v[128:131], v1, s[4:7], s65 offen offset:0 sc1
v_add_f32 v41, v41, v57
s_waitcnt vmcnt(11)
v_mfma_f32_32x32x16_bf16 v[58:73], a[104:107], v[132:135], v[58:73]
ds_read_b128 v[42:45], v90 offset:32768
ds_read_b128 v[46:49], v90 offset:33792
ds_read_b128 v[50:53], v90 offset:34816
ds_read_b128 v[54:57], v90 offset:35840
v_mfma_f32_32x32x16_bf16 v[74:89], a[108:111], v[132:135], v[74:89]
buffer_load_dwordx4 v[132:135], v1, s[4:7], s65 offen offset:1024 sc1
s_waitcnt vmcnt(11)
v_mfma_f32_32x32x16_bf16 v[58:73], a[112:115], v[136:139], v[58:73]
s_waitcnt lgkmcnt(0)
v_add_f32 v26, v26, v42
v_add_f32 v27, v27, v43
v_add_f32 v28, v28, v44
v_add_f32 v29, v29, v45
v_add_f32 v30, v30, v46
v_mfma_f32_32x32x16_bf16 v[74:89], a[116:119], v[136:139], v[74:89]
buffer_load_dwordx4 v[136:139], v1, s[4:7], s65 offen offset:2048 sc1
v_add_f32 v31, v31, v47
v_add_f32 v32, v32, v48
v_add_f32 v33, v33, v49
v_add_f32 v34, v34, v50
s_waitcnt vmcnt(11)
v_mfma_f32_32x32x16_bf16 v[58:73], a[120:123], v[140:143], v[58:73]
v_add_f32 v35, v35, v51
v_add_f32 v36, v36, v52
v_add_f32 v37, v37, v53
v_add_f32 v38, v38, v54
v_add_f32 v39, v39, v55
v_add_f32 v40, v40, v56
v_mfma_f32_32x32x16_bf16 v[74:89], a[124:127], v[140:143], v[74:89]
buffer_load_dwordx4 v[140:143], v1, s[4:7], s65 offen offset:3072 sc1
v_add_f32 v41, v41, v57
s_waitcnt vmcnt(11)
v_mfma_f32_32x32x16_bf16 v[74:89], a[132:135], v[144:147], v[74:89]
ds_read_b128 v[42:45], v90 offset:36864
ds_read_b128 v[46:49], v90 offset:37888
ds_read_b128 v[50:53], v90 offset:38912
ds_read_b128 v[54:57], v90 offset:39936
s_waitcnt vmcnt(10)
v_mfma_f32_32x32x16_bf16 v[74:89], a[140:143], v[148:151], v[74:89]
s_waitcnt lgkmcnt(0)
s_waitcnt vmcnt(9)
v_mfma_f32_32x32x16_bf16 v[74:89], a[148:151], v[152:155], v[74:89]
v_add_f32 v26, v26, v42
v_add_f32 v27, v27, v43
v_add_f32 v28, v28, v44
v_add_f32 v29, v29, v45
v_add_f32 v30, v30, v46
s_waitcnt vmcnt(8)
v_mfma_f32_32x32x16_bf16 v[74:89], a[156:159], v[156:159], v[74:89]
v_add_f32 v31, v31, v47
v_add_f32 v32, v32, v48
v_add_f32 v33, v33, v49
v_add_f32 v34, v34, v50
v_add_f32 v35, v35, v51
s_waitcnt vmcnt(7)
v_mfma_f32_32x32x16_bf16 v[74:89], a[164:167], v[112:115], v[74:89]
v_add_f32 v36, v36, v52
v_add_f32 v37, v37, v53
v_add_f32 v38, v38, v54
v_add_f32 v39, v39, v55
v_add_f32 v40, v40, v56
s_waitcnt vmcnt(6)
v_mfma_f32_32x32x16_bf16 v[74:89], a[172:175], v[116:119], v[74:89]
v_add_f32 v41, v41, v57
v_cvt_pk_bf16_f32 v18, v26, v27
v_cvt_pk_bf16_f32 v19, v28, v29
v_cvt_pk_bf16_f32 v20, v30, v31
v_cvt_pk_bf16_f32 v21, v32, v33
s_waitcnt vmcnt(5)
v_mfma_f32_32x32x16_bf16 v[74:89], a[180:183], v[120:123], v[74:89]
v_cvt_pk_bf16_f32 v22, v34, v35
v_cvt_pk_bf16_f32 v23, v36, v37
v_cvt_pk_bf16_f32 v24, v38, v39
v_cvt_pk_bf16_f32 v25, v40, v41
s_waitcnt vmcnt(4)
v_mfma_f32_32x32x16_bf16 v[74:89], a[188:191], v[124:127], v[74:89]
buffer_store_dwordx4 v[18:21], v1, s[4:7], s44 offen
buffer_store_dwordx4 v[22:25], v1, s[4:7], s44 offen offset:1024
v_dot2_f32_bf16 v92, s88, v18, 0
v_dot2_f32_bf16 v93, v18, v18, 0
v_dot2_f32_bf16 v92, s88, v19, v92
v_dot2_f32_bf16 v93, v19, v19, v93
v_dot2_f32_bf16 v92, s88, v20, v92
v_dot2_f32_bf16 v93, v20, v20, v93
v_dot2_f32_bf16 v92, s88, v21, v92
v_dot2_f32_bf16 v93, v21, v21, v93
v_dot2_f32_bf16 v92, s88, v22, v92
v_dot2_f32_bf16 v93, v22, v22, v93
v_dot2_f32_bf16 v92, s88, v23, v92
v_dot2_f32_bf16 v93, v23, v23, v93
v_dot2_f32_bf16 v92, s88, v24, v92
v_dot2_f32_bf16 v93, v24, v24, v93
v_dot2_f32_bf16 v92, s88, v25, v92
v_dot2_f32_bf16 v93, v25, v25, v93
s_nop 1
v_mov_b32 v94, v92
v_mov_b32 v95, v93
s_nop 0
v_permlane32_swap_b32 v92, v94
v_permlane32_swap_b32 v93, v95
s_mov_b32 exec_hi, 0
v_pk_add_f32 v[92:93], v[92:93], v[94:95]
buffer_store_dwordx2 v[92:93], v1, s[4:7], s45 offen
s_mov_b64 exec, -1
s_waitcnt vmcnt(6)
v_mfma_f32_32x32x16_bf16 v[74:89], a[196:199], v[128:131], v[74:89]
s_waitcnt vmcnt(5)
v_mfma_f32_32x32x16_bf16 v[74:89], a[204:207], v[132:135], v[74:89]
s_waitcnt vmcnt(4)
v_mfma_f32_32x32x16_bf16 v[74:89], a[212:215], v[136:139], v[74:89]
s_waitcnt vmcnt(3)
v_mfma_f32_32x32x16_bf16 v[74:89], a[220:223], v[140:143], v[74:89]
v_mfma_f32_32x32x16_bf16 v[58:73], a[128:131], v[144:147], v[58:73]
v_mfma_f32_32x32x16_bf16 v[58:73], a[136:139], v[148:151], v[58:73]
s_nop 9
ds_write_b128 v91, v[74:77] offset:4096
v_mfma_f32_32x32x16_bf16 v[58:73], a[144:147], v[152:155], v[58:73]
ds_write_b128 v91, v[78:81] offset:5120
v_mfma_f32_32x32x16_bf16 v[58:73], a[152:155], v[156:159], v[58:73]
ds_write_b128 v91, v[82:85] offset:6144
v_mfma_f32_32x32x16_bf16 v[58:73], a[160:163], v[112:115], v[58:73]
ds_write_b128 v91, v[86:89] offset:7168
v_mfma_f32_32x32x16_bf16 v[58:73], a[168:171], v[116:119], v[58:73]
s_waitcnt lgkmcnt(0)
s_barrier
v_mfma_f32_32x32x16_bf16 v[58:73], a[176:179], v[120:123], v[58:73]
v_mfma_f32_32x32x16_bf16 v[58:73], a[184:187], v[124:127], v[58:73]
v_mfma_f32_32x32x16_bf16 v[58:73], a[192:195], v[128:131], v[58:73]
v_mfma_f32_32x32x16_bf16 v[58:73], a[200:203], v[132:135], v[58:73]
s_waitcnt vmcnt(0)
s_add_u32 s60, s35, 9
s_mov_b64 exec, 1
v_mov_b32 v92, s60
buffer_store_dword v92, off, s[4:7], s41
s_mov_b64 exec, -1
v_mfma_f32_32x32x16_bf16 v[58:73], a[208:211], v[136:139], v[58:73]
v_mfma_f32_32x32x16_bf16 v[58:73], a[216:219], v[140:143], v[58:73]
s_nop 11
ds_write_b128 v90, v[58:61] offset:8192
ds_write_b128 v90, v[62:65] offset:9216
ds_write_b128 v90, v[66:69] offset:10240
ds_write_b128 v90, v[70:73] offset:11264
s_waitcnt lgkmcnt(0)
s_barrier
s_branch LJ_82
LB_81:
L_hop15:
s_cbranch_execz L_hopret
s_waitcnt vmcnt(11)
v_mfma_f32_32x32x16_bf16 v[58:73], a[0:3], v[128:131], 0
v_mfma_f32_32x32x16_bf16 v[74:89], a[4:7], v[128:131], 0
s_add_u32 s65, s3, s93
buffer_load_dwordx4 v[128:131], v1, s[4:7], s65 offen offset:0 sc1
s_waitcnt vmcnt(11)
v_mfma_f32_32x32x16_bf16 v[58:73], a[8:11], v[132:135], v[58:73]
s_nop 0
ds_write_b128 v91, v[42:45] offset:32768
v_mfma_f32_32x32x16_bf16 v[74:89], a[12:15], v[132:135], v[74:89]
buffer_load_dwordx4 v[132:135], v1, s[4:7], s65 offen offset:1024 sc1
s_waitcnt vmcnt(11)
v_mfma_f32_32x32x16_bf16 v[58:73], a[16:19], v[136:139], v[58:73]
ds_write_b128 v91, v[46:49] offset:33792
v_mfma_f32_32x32x16_bf16 v[74:89], a[20:23], v[136:139], v[74:89]
buffer_load_dwordx4 v[136:139], v1, s[4:7], s65 offen offset:2048 sc1
s_waitcnt vmcnt(11)
v_mfma_f32_32x32x16_bf16 v[58:73], a[24:27], v[140:143], v[58:73]
ds_write_b128 v91, v[50:53] offset:34816
v_mfma_f32_32x32x16_bf16 v[74:89], a[28:31], v[140:143], v[74:89]
buffer_load_dwordx4 v[140:143], v1, s[4:7], s65 offen offset:3072 sc1
s_waitcnt vmcnt(11)
v_mfma_f32_32x32x16_bf16 v[58:73], a[32:35], v[144:147], v[58:73]
ds_write_b128 v91, v[54:57] offset:35840
v_mfma_f32_32x32x16_bf16 v[74:89], a[36:39], v[144:147], v[74:89]
s_add_u32 s65, s3, s94
buffer_load_dwordx4 v[144:147], v1, s[4:7], s65 offen offset:0 sc1
s_waitcnt vmcnt(11)
v_mfma_f32_32x32x16_bf16 v[58:73], a[40:43], v[148:151], v[58:73]
ds_write_b128 v90, v[26:29] offset:36864
v_mfma_f32_32x32x16_bf16 v[74:89], a[44:47], v[148:151], v[74:89]
buffer_load_dwordx4 v[148:151], v1, s[4:7], s65 offen offset:1024 sc1
s_waitcnt vmcnt(11)
v_mfma_f32_32x32x16_bf16 v[58:73], a[48:51], v[152:155], v[58:73]
ds_write_b128 v90, v[30:33] offset:37888
v_mfma_f32_32x32x16_bf16 v[74:89], a[52:55], v[152:155], v[74:89]
buffer_load_dwordx4 v[152:155], v1, s[4:7], s65 offen offset:2048 sc1
s_waitcnt vmcnt(11)
v_mfma_f32_32x32x16_bf16 v[58:73], a[56:59], v[156:159], v[58:73]
ds_write_b128 v90, v[34:37] offset:38912
v_mfma_f32_32x32x16_bf16 v[74:89], a[60:63], v[156:159], v[74:89]
buffer_load_dwordx4 v[156:159], v1, s[4:7], s65 offen offset:3072 sc1
s_waitcnt vmcnt(11)
v_mfma_f32_32x32x16_bf16 v[58:73], a[64:67], v[112:115], v[58:73]
ds_write_b128 v90, v[38:41] offset:39936
v_mfma_f32_32x32x16_bf16 v[74:89], a[68:71], v[112:115], v[74:89]
s_add_u32 s65, s3, s95
buffer_load_dwordx4 v[112:115], v1, s[4:7], s65 offen offset:0 sc1
s_waitcnt vmcnt(11)
v_mfma_f32_32x32x16_bf16 v[58:73], a[72:75], v[116:119], v[58:73]
s_waitcnt lgkmcnt(0)
s_barrier
v_mfma_f32_32x32x16_bf16 v[74:89], a[76:79], v[116:119], v[74:89]
buffer_load_dwordx4 v[116:119], v1, s[4:7], s65 offen offset:1024 sc1
v_lshlrev_b32 v26, 16, v18
v_and_b32 v27, 0xffff0000, v18
v_lshlrev_b32 v28, 16, v19
v_and_b32 v29, 0xffff0000, v19
s_waitcnt vmcnt(11)
v_mfma_f32_32x32x16_bf16 v[58:73], a[80:83], v[120:123], v[58:73]
v_lshlrev_b32 v30, 16, v20
v_and_b32 v31, 0xffff0000, v20
v_lshlrev_b32 v32, 16, v21
v_and_b32 v33, 0xffff0000, v21
v_lshlrev_b32 v34, 16, v22
v_and_b32 v35, 0xffff0000, v22
v_mfma_f32_32x32x16_bf16 v[74:89], a[84:87], v[120:123], v[74:89]
buffer_load_dwordx4 v[120:123], v1, s[4:7], s65 offen offset:2048 sc1
v_lshlrev_b32 v36, 16, v23
v_and_b32 v37, 0xffff0000, v23
v_lshlrev_b32 v38, 16, v24
v_and_b32 v39, 0xffff0000, v24
s_waitcnt vmcnt(11)
v_mfma_f32_32x32x16_bf16 v[58:73], a[88:91], v[124:127], v[58:73]
v_lshlrev_b32 v40, 16, v25
v_and_b32 v41, 0xffff0000, v25
v_mfma_f32_32x32x16_bf16 v[74:89], a[92:95], v[124:127], v[74:89]
buffer_load_dwordx4 v[124:127], v1, s[4:7], s65 offen offset:3072 sc1
s_waitcnt vmcnt(11)
v_mfma_f32_32x32x16_bf16 v[58:73], a[96:99], v[128:131], v[58:73]
v_mfma_f32_32x32x16_bf16 v[74:89], a[100:103], v[128:131], v[74:89]
s_add_u32 s65, s3, s96
buffer_load_dwordx4 v[128:131], v1, s[4:7], s65 offen offset:0 sc1
s_waitcnt vmcnt(11)
v_mfma_f32_32x32x16_bf16 v[58:73], a[104:107], v[132:135], v[58:73]
v_mfma_f32_32x32x16_bf16 v[74:89], a[108:111], v[132:135], v[74:89]
buffer_load_dwordx4 v[132:135], v1, s[4:7], s65 offen offset:1024 sc1
s_waitcnt vmcnt(11)
v_mfma_f32_32x32x16_bf16 v[58:73], a[112:115], v[136:139], v[58:73]
v_mfma_f32_32x32x16_bf16 v[74:89], a[116:119], v[136:139], v[74:89]
buffer_load_dwordx4 v[136:139], v1, s[4:7], s65 offen offset:2048 sc1
s_waitcnt vmcnt(11)
v_mfma_f32_32x32x16_bf16 v[58:73], a[120:123], v[140:143], v[58:73]
v_mfma_f32_32x32x16_bf16 v[74:89], a[124:127], v[140:143], v[74:89]
buffer_load_dwordx4 v[140:143], v1, s[4:7], s65 offen offset:3072 sc1
s_waitcnt vmcnt(11)
v_mfma_f32_32x32x16_bf16 v[74:89], a[132:135], v[144:147], v[74:89]
s_waitcnt vmcnt(10)
v_mfma_f32_32x32x16_bf16 v[74:89], a[140:143], v[148:151], v[74:89]
s_waitcnt vmcnt(9)
v_mfma_f32_32x32x16_bf16 v[74:89], a[148:151], v[152:155], v[74:89]
s_waitcnt vmcnt(8)
v_mfma_f32_32x32x16_bf16 v[74:89], a[156:159], v[156:159], v[74:89]
s_waitcnt vmcnt(7)
v_mfma_f32_32x32x16_bf16 v[74:89], a[164:167], v[112:115], v[74:89]
s_waitcnt vmcnt(6)
v_mfma_f32_32x32x16_bf16 v[74:89], a[172:175], v[116:119], v[74:89]
s_waitcnt vmcnt(5)
v_mfma_f32_32x32x16_bf16 v[74:89], a[180:183], v[120:123], v[74:89]
s_waitcnt vmcnt(4)
v_mfma_f32_32x32x16_bf16 v[74:89], a[188:191], v[124:127], v[74:89]
s_waitcnt vmcnt(3)
v_mfma_f32_32x32x16_bf16 v[74:89], a[196:199], v[128:131], v[74:89]
s_waitcnt vmcnt(2)
v_mfma_f32_32x32x16_bf16 v[74:89], a[204:207], v[132:135], v[74:89]
s_waitcnt vmcnt(1)
v_mfma_f32_32x32x16_bf16 v[74:89], a[212:215], v[136:139], v[74:89]
s_waitcnt vmcnt(0)
v_mfma_f32_32x32x16_bf16 v[74:89], a[220:223], v[140:143], v[74:89]
v_mfma_f32_32x32x16_bf16 v[58:73], a[128:131], v[144:147], v[58:73]
v_mfma_f32_32x32x16_bf16 v[58:73], a[136:139], v[148:151], v[58:73]
s_nop 9
ds_write_b128 v91, v[74:77] offset:0
v_mfma_f32_32x32x16_bf16 v[58:73], a[144:147], v[152:155], v[58:73]
ds_write_b128 v91, v[78:81] offset:1024
v_mfma_f32_32x32x16_bf16 v[58:73], a[152:155], v[156:159], v[58:73]
ds_write_b128 v91, v[82:85] offset:2048
v_mfma_f32_32x32x16_bf16 v[58:73], a[160:163], v[112:115], v[58:73]
ds_write_b128 v91, v[86:89] offset:3072
v_mfma_f32_32x32x16_bf16 v[58:73], a[168:171], v[116:119], v[58:73]
s_waitcnt lgkmcnt(0)
s_barrier
v_mfma_f32_32x32x16_bf16 v[58:73], a[176:179], v[120:123], v[58:73]
ds_read_b128 v[42:45], v90 offset:0
ds_read_b128 v[46:49], v90 offset:1024
ds_read_b128 v[50:53], v90 offset:2048
ds_read_b128 v[54:57], v90 offset:3072
v_mfma_f32_32x32x16_bf16 v[58:73], a[184:187], v[124:127], v[58:73]
ds_read_b128 v[74:77], v90 offset:4096
ds_read_b128 v[78:81], v90 offset:5120
ds_read_b128 v[82:85], v90 offset:6144
ds_read_b128 v[86:89], v90 offset:7168
v_mfma_f32_32x32x16_bf16 v[58:73], a[192:195], v[128:131], v[58:73]
v_mfma_f32_32x32x16_bf16 v[58:73], a[200:203], v[132:135], v[58:73]
s_waitcnt lgkmcnt(0)
v_add_f32 v26, v26, v42
v_add_f32 v27, v27, v43
v_add_f32 v28, v28, v44
v_add_f32 v29, v29, v45
v_add_f32 v30, v30, v46
v_mfma_f32_32x32x16_bf16 v[58:73], a[208:211], v[136:139], v[58:73]
v_add_f32 v31, v31, v47
v_add_f32 v32, v32, v48
v_add_f32 v33, v33, v49
v_add_f32 v34, v34, v50
v_add_f32 v35, v35, v51
v_add_f32 v36, v36, v52
v_mfma_f32_32x32x16_bf16 v[58:73], a[216:219], v[140:143], v[58:73]
v_add_f32 v37, v37, v53
v_add_f32 v38, v38, v54
v_add_f32 v39, v39, v55
v_add_f32 v40, v40, v56
v_add_f32 v41, v41, v57
v_pk_add_f32 v[26:27], v[26:27], v[74:75]
v_pk_add_f32 v[28:29], v[28:29], v[76:77]
v_pk_add_f32 v[30:31], v[30:31], v[78:79]
v_pk_add_f32 v[32:33], v[32:33], v[80:81]
v_pk_add_f32 v[34:35], v[34:35], v[82:83]
v_pk_add_f32 v[36:37], v[36:37], v[84:85]
v_pk_add_f32 v[38:39], v[38:39], v[86:87]
v_pk_add_f32 v[40:41], v[40:41], v[88:89]
v_pk_add_f32 v[26:27], v[26:27], v[58:59]
v_pk_add_f32 v[28:29], v[28:29], v[60:61]
v_pk_add_f32 v[30:31], v[30:31], v[62:63]
v_pk_add_f32 v[32:33], v[32:33], v[64:65]
v_pk_add_f32 v[34:35], v[34:35], v[66:67]
v_pk_add_f32 v[36:37], v[36:37], v[68:69]
v_pk_add_f32 v[38:39], v[38:39], v[70:71]
v_pk_add_f32 v[40:41], v[40:41], v[72:73]
s_barrier
ds_read_b128 v[42:45], v90 offset:8192
ds_read_b128 v[46:49], v90 offset:9216
ds_read_b128 v[50:53], v90 offset:10240
ds_read_b128 v[54:57], v90 offset:11264
s_waitcnt lgkmcnt(3)
v_pk_add_f32 v[26:27], v[26:27], v[42:43]
v_pk_add_f32 v[28:29], v[28:29], v[44:45]
v_cvt_pk_bf16_f32 v18, v26, v27
v_cvt_pk_bf16_f32 v19, v28, v29
L_hop5:
s_cbranch_execz L_hop9
s_waitcnt lgkmcnt(2)
v_pk_add_f32 v[30:31], v[30:31], v[46:47]
v_pk_add_f32 v[32:33], v[32:33], v[48:49]
v_cvt_pk_bf16_f32 v20, v30, v31
v_cvt_pk_bf16_f32 v21, v32, v33
s_waitcnt lgkmcnt(1)
v_pk_add_f32 v[34:35], v[34:35], v[50:51]
v_pk_add_f32 v[36:37], v[36:37], v[52:53]
v_cvt_pk_bf16_f32 v22, v34, v35
v_cvt_pk_bf16_f32 v23, v36, v37
s_waitcnt lgkmcnt(0)
v_pk_add_f32 v[38:39], v[38:39], v[54:55]
v_pk_add_f32 v[40:41], v[40:41], v[56:57]
v_cvt_pk_bf16_f32 v24, v38, v39
v_cvt_pk_bf16_f32 v25, v40, v41
buffer_store_dwordx4 v[18:21], v1, s[4:7], s44 offen
buffer_store_dwordx4 v[22:25], v1, s[4:7], s44 offen offset:1024
v_dot2_f32_bf16 v92, s88, v18, 0
v_dot2_f32_bf16 v93, v18, v18, 0
v_dot2_f32_bf16 v92, s88, v19, v92
v_dot2_f32_bf16 v93, v19, v19, v93
v_dot2_f32_bf16 v92, s88, v20, v92
v_dot2_f32_bf16 v93, v20, v20, v93
v_dot2_f32_bf16 v92, s88, v21, v92
v_dot2_f32_bf16 v93, v21, v21, v93
v_dot2_f32_bf16 v92, s88, v22, v92
v_dot2_f32_bf16 v93, v22, v22, v93
v_dot2_f32_bf16 v92, s88, v23, v92
v_dot2_f32_bf16 v93, v23, v23, v93
v_dot2_f32_bf16 v92, s88, v24, v92
v_dot2_f32_bf16 v93, v24, v24, v93
v_dot2_f32_bf16 v92, s88, v25, v92
v_dot2_f32_bf16 v93, v25, v25, v93
s_nop 1
v_mov_b32 v94, v92
v_mov_b32 v95, v93
s_nop 0
v_permlane32_swap_b32 v92, v94
v_permlane32_swap_b32 v93, v95
s_mov_b32 exec_hi, 0
v_pk_add_f32 v[92:93], v[92:93], v[94:95]
buffer_store_dwordx2 v[92:93], v1, s[4:7], s45 offen
s_mov_b64 exec, -1
s_add_u32 s60, s35, 9
v_mov_b32 v96, s60
s_mov_b64 exec, 1
s_waitcnt vmcnt(0)
buffer_store_dword v96, off, s[4:7], s41
s_mov_b64 exec, -1
LJ_82:
L_hop16:
s_cbranch_execz L_hopret
s_branch LQ_69
LR_68:
s_waitcnt vmcnt(0)
s_add_u32 s60, s35, 2
s_mov_b64 exec, 1
v_mov_b32 v28, s60
buffer_store_dword v28, off, s[4:7], s41
s_mov_b64 exec, -1
v_lshlrev_b32 v26, 7, v0
s_and_b32 s61, s33, 1
s_lshl2_add_u32 s61, s61, s32
s_lshl_b32 s61, s61, 14
s_add_u32 s61, s61, s40
buffer_load_dword v27, v26, s[4:7], s61 offen
s_add_u32 s61, s61, 8192
buffer_load_dword v27, v26, s[4:7], s61 offen
s_add_u32 s40, s40, 256
s_add_u32 s60, s35, 0
LP_83:
s_sleep 8
buffer_load_dword v28, v4, s[4:7], s40 offen sc1
s_sub_u32 s37, s37, 1
s_cmp_lt_i32 s37, 0
s_cbranch_scc1 LD_84
s_waitcnt vmcnt(0)
v_subrev_u32 v28, s60, v28
v_cmp_le_u32 vcc, 64, v28
s_and_b64 vcc, vcc, 1
s_cbranch_scc1 LP_83
LD_84:
s_sub_u32 s40, s40, 256
s_and_b32 s61, s33, 1
s_lshl2_add_u32 s61, s61, s32
s_mul_i32 s61, s61, 10240
s_add_u32 s61, s61, s40
s_add_u32 s61, s61, 163840
s_add_u32 s62, s61, 0
buffer_load_dword v27, v26, s[4:7], s62 offen
s_add_u32 s62, s62, 8192
s_mov_b64 exec, 0xffff
buffer_load_dword v27, v26, s[4:7], s62 offen
s_mov_b64 exec, -1
s_add_u32 s62, s61, 229376
buffer_load_dword v27, v26, s[4:7], s62 offen
s_add_u32 s62, s62, 8192
s_mov_b64 exec, 0xffff
buffer_load_dword v27, v26, s[4:7], s62 offen
s_mov_b64 exec, -1
s_add_u32 s62, s61, 114688
buffer_load_dword v27, v26, s[4:7], s62 offen
s_add_u32 s62, s62, 8192
s_mov_b64 exec, 0xffff
buffer_load_dword v27, v26, s[4:7], s62 offen
s_mov_b64 exec, -1
s_add_u32 s62, s61, 344064
buffer_load_dword v27, v26, s[4:7], s62 offen
s_add_u32 s62, s62, 8192
s_mov_b64 exec, 0xffff
buffer_load_dword v27, v26, s[4:7], s62 offen
s_mov_b64 exec, -1
s_mov_b32 s62, 0x33333333
s_mov_b32 s63, 0x333333
s_add_u32 s60, s35, 9
LP_85:
s_sleep 8
buffer_load_dword v28, v4, s[4:7], s40 offen sc1
s_sub_u32 s37, s37, 1
s_cmp_lt_i32 s37, 0
s_cbranch_scc1 LD_86
s_waitcnt vmcnt(0)
v_subrev_u32 v28, s60, v28
v_cmp_le_u32 vcc, 64, v28
s_and_b64 vcc, vcc, s[62:63]
s_cbranch_scc1 LP_85
LD_86:
LQ_69:
v_lshrrev_b32 v172, 5, v0
v_mul_u32_u24 v172, 1536, v172
v_add_u32 v172, v1, v172
s_add_u32 s60, s35, 9
LP_87:
buffer_load_dword v142, v4, s[4:7], s40 offen sc1
s_sub_u32 s37, s37, 1
s_cmp_lt_i32 s37, 0
s_cbranch_scc1 LD_88
s_waitcnt vmcnt(0)
v_subrev_u32 v142, s60, v142
v_cmp_le_u32 vcc, 64, v142
s_and_b64 vcc, vcc, s[46:47]
s_cbranch_scc1 LP_87
LD_88:
s_add_u32 s65, s70, 0
buffer_load_dwordx4 v[94:97], v1, s[4:7], s65 offen offset:0 sc1
buffer_load_dwordx4 v[98:101], v1, s[4:7], s65 offen offset:1024 sc1
buffer_load_dwordx4 v[102:105], v1, s[4:7], s65 offen offset:2048 sc1
buffer_load_dwordx4 v[106:109], v1, s[4:7], s65 offen offset:3072 sc1
s_add_u32 s65, s70, 4096
buffer_load_dwordx4 v[110:113], v1, s[4:7], s65 offen offset:0 sc1
buffer_load_dwordx4 v[114:117], v1, s[4:7], s65 offen offset:1024 sc1
buffer_load_dwordx4 v[118:121], v1, s[4:7], s65 offen offset:2048 sc1
buffer_load_dwordx4 v[122:125], v1, s[4:7], s65 offen offset:3072 sc1
ds_read_b64_tr_b16 v[74:75], v2 offset:0
ds_read_b64_tr_b16 v[76:77], v2 offset:256
ds_read_b64_tr_b16 v[78:79], v2 offset:28672
ds_read_b64_tr_b16 v[80:81], v2 offset:28928
ds_read_b64_tr_b16 v[82:83], v3 offset:0
ds_read_b64_tr_b16 v[84:85], v3 offset:256
ds_read_b64_tr_b16 v[86:87], v2 offset:1024
ds_read_b64_tr_b16 v[88:89], v2 offset:1280
s_waitcnt vmcnt(7) lgkmcnt(6)
v_mfma_f32_32x32x16_bf16 v[26:41], v[94:97], v[74:77], 0
s_add_u32 s65, s70, 8192
buffer_load_dwordx4 v[126:129], v1, s[4:7], s65 offen offset:0 sc1
ds_read_b64_tr_b16 v[90:91], v2 offset:29696
ds_read_b64_tr_b16 v[92:93], v2 offset:29952
s_waitcnt lgkmcnt(6)
v_mfma_f32_32x32x16_bf16 v[42:57], v[94:97], v[78:81], 0
ds_read_b64_tr_b16 v[74:75], v3 offset:1024
ds_read_b64_tr_b16 v[76:77], v3 offset:1280
s_waitcnt lgkmcnt(6)
v_mfma_f32_32x32x16_bf16 v[58:73], v[82:85], v[94:97], 0
buffer_load_dwordx4 v[130:133], v1, s[4:7], s65 offen offset:1024 sc1
ds_read_b64_tr_b16 v[78:79], v2 offset:2048
ds_read_b64_tr_b16 v[80:81], v2 offset:2304
s_waitcnt vmcnt(8) lgkmcnt(6)
v_mfma_f32_32x32x16_bf16 v[26:41], v[98:101], v[86:89], v[26:41]
ds_read_b64_tr_b16 v[82:83], v2 offset:30720
ds_read_b64_tr_b16 v[84:85], v2 offset:30976
s_waitcnt lgkmcnt(6)
v_mfma_f32_32x32x16_bf16 v[42:57], v[98:101], v[90:93], v[42:57]
buffer_load_dwordx4 v[134:137], v1, s[4:7], s65 offen offset:2048 sc1
ds_read_b64_tr_b16 v[86:87], v3 offset:2048
ds_read_b64_tr_b16 v[88:89], v3 offset:2304
s_waitcnt lgkmcnt(6)
v_mfma_f32_32x32x16_bf16 v[58:73], v[74:77], v[98:101], v[58:73]
ds_read_b64_tr_b16 v[90:91], v2 offset:3072
ds_read_b64_tr_b16 v[92:93], v2 offset:3328
s_waitcnt vmcnt(8) lgkmcnt(6)
v_mfma_f32_32x32x16_bf16 v[26:41], v[102:105], v[78:81], v[26:41]
buffer_load_dwordx4 v[138:141], v1, s[4:7], s65 offen offset:3072 sc1
ds_read_b64_tr_b16 v[74:75], v2 offset:31744
ds_read_b64_tr_b16 v[76:77], v2 offset:32000
s_waitcnt lgkmcnt(6)
v_mfma_f32_32x32x16_bf16 v[42:57], v[102:105], v[82:85], v[42:57]
buffer_load_dwordx4 v[158:161], v172, s[4:7], s71 offen offset:0 sc1
ds_read_b64_tr_b16 v[78:79], v3 offset:3072
ds_read_b64_tr_b16 v[80:81], v3 offset:3328
s_waitcnt lgkmcnt(6)
v_mfma_f32_32x32x16_bf16 v[58:73], v[86:89], v[102:105], v[58:73]
s_add_u32 s65, s70, 12288
buffer_load_dwordx4 v[94:97], v1, s[4:7], s65 offen offset:0 sc1
ds_read_b64_tr_b16 v[82:83], v2 offset:4096
ds_read_b64_tr_b16 v[84:85], v2 offset:4352
s_waitcnt vmcnt(10) lgkmcnt(6)
v_mfma_f32_32x32x16_bf16 v[26:41], v[106:109], v[90:93], v[26:41]
buffer_load_dwordx4 v[162:165], v172, s[4:7], s71 offen offset:512 sc1
ds_read_b64_tr_b16 v[86:87], v2 offset:32768
ds_read_b64_tr_b16 v[88:89], v2 offset:33024
s_waitcnt lgkmcnt(6)
v_mfma_f32_32x32x16_bf16 v[42:57], v[106:109], v[74:77], v[42:57]
buffer_load_dwordx4 v[98:101], v1, s[4:7], s65 offen offset:1024 sc1
ds_read_b64_tr_b16 v[90:91], v3 offset:4096
ds_read_b64_tr_b16 v[92:93], v3 offset:4352
s_waitcnt lgkmcnt(6)
v_mfma_f32_32x32x16_bf16 v[58:73], v[78:81], v[106:109], v[58:73]
buffer_load_dwordx4 v[166:169], v172, s[4:7], s71 offen offset:1024 sc1
ds_read_b64_tr_b16 v[74:75], v2 offset:5120
ds_read_b64_tr_b16 v[76:77], v2 offset:5376
s_waitcnt vmcnt(12) lgkmcnt(6)
v_mfma_f32_32x32x16_bf16 v[26:41], v[110:113], v[82:85], v[26:41]
buffer_load_dwordx4 v[102:105], v1, s[4:7], s65 offen offset:2048 sc1
ds_read_b64_tr_b16 v[78:79], v2 offset:33792
ds_read_b64_tr_b16 v[80:81], v2 offset:34048
s_waitcnt lgkmcnt(6)
v_mfma_f32_32x32x16_bf16 v[42:57], v[110:113], v[86:89], v[42:57]
buffer_load_dwordx4 v[170:173], v172, s[4:7], s71 offen offset:1536 sc1
ds_read_b64_tr_b16 v[82:83], v3 offset:5120
ds_read_b64_tr_b16 v[84:85], v3 offset:5376
s_waitcnt lgkmcnt(6)
v_mfma_f32_32x32x16_bf16 v[58:73], v[90:93], v[110:113], v[58:73]
buffer_load_dwordx4 v[106:109], v1, s[4:7], s65 offen offset:3072 sc1
ds_read_b64_tr_b16 v[86:87], v2 offset:6144
ds_read_b64_tr_b16 v[88:89], v2 offset:6400
s_waitcnt vmcnt(14) lgkmcnt(6)
v_mfma_f32_32x32x16_bf16 v[26:41], v[114:117], v[74:77], v[26:41]
ds_read_b64_tr_b16 v[90:91], v2 offset:34816
ds_read_b64_tr_b16 v[92:93], v2 offset:35072
s_waitcnt lgkmcnt(6)
v_mfma_f32_32x32x16_bf16 v[42:57], v[114:117], v[78:81], v[42:57]
s_add_u32 s65, s70, 16384
buffer_load_dwordx4 v[110:113], v1, s[4:7], s65 offen offset:0 sc1
ds_read_b64_tr_b16 v[74:75], v3 offset:6144
ds_read_b64_tr_b16 v[76:77], v3 offset:6400
s_waitcnt lgkmcnt(6)
v_mfma_f32_32x32x16_bf16 v[58:73], v[82:85], v[114:117], v[58:73]
ds_read_b64_tr_b16 v[78:79], v2 offset:7168
ds_read_b64_tr_b16 v[80:81], v2 offset:7424
s_waitcnt vmcnt(14) lgkmcnt(6)
v_mfma_f32_32x32x16_bf16 v[26:41], v[118:121], v[86:89], v[26:41]
buffer_load_dwordx4 v[114:117], v1, s[4:7], s65 offen offset:1024 sc1
ds_read_b64_tr_b16 v[82:83], v2 offset:35840
ds_read_b64_tr_b16 v[84:85], v2 offset:36096
s_waitcnt lgkmcnt(6)
v_mfma_f32_32x32x16_bf16 v[42:57], v[118:121], v[90:93], v[42:57]
ds_read_b64_tr_b16 v[86:87], v3 offset:7168
ds_read_b64_tr_b16 v[88:89], v3 offset:7424
s_waitcnt lgkmcnt(6)
v_mfma_f32_32x32x16_bf16 v[58:73], v[74:77], v[118:121], v[58:73]
buffer_load_dwordx4 v[118:121], v1, s[4:7], s65 offen offset:2048 sc1
ds_read_b64_tr_b16 v[90:91], v2 offset:8192
ds_read_b64_tr_b16 v[92:93], v2 offset:8448
s_waitcnt vmcnt(15) lgkmcnt(6)
v_mfma_f32_32x32x16_bf16 v[26:41], v[122:125], v[78:81], v[26:41]
ds_read_b64_tr_b16 v[74:75], v2 offset:36864
ds_read_b64_tr_b16 v[76:77], v2 offset:37120
s_waitcnt lgkmcnt(6)
v_mfma_f32_32x32x16_bf16 v[42:57], v[122:125], v[82:85], v[42:57]
ds_read_b64_tr_b16 v[78:79], v2 offset:9216
ds_read_b64_tr_b16 v[80:81], v2 offset:9472
s_waitcnt vmcnt(4)
v_add_f32 v158, v158, v160
v_add_f32 v159, v159, v161
s_waitcnt lgkmcnt(6)
v_mfma_f32_32x32x16_bf16 v[58:73], v[86:89], v[122:125], v[58:73]
buffer_load_dwordx4 v[122:125], v1, s[4:7], s65 offen offset:3072 sc1
ds_read_b64_tr_b16 v[82:83], v2 offset:37888
ds_read_b64_tr_b16 v[84:85], v2 offset:38144
v_add_f32 v162, v162, v164
v_add_f32 v163, v163, v165
s_waitcnt vmcnt(15) lgkmcnt(6)
v_mfma_f32_32x32x16_bf16 v[26:41], v[126:129], v[90:93], v[26:41]
ds_read_b64_tr_b16 v[86:87], v2 offset:10240
ds_read_b64_tr_b16 v[88:89], v2 offset:10496
v_add_f32 v166, v166, v168
v_add_f32 v167, v167, v169
v_add_f32 v170, v170, v172
s_waitcnt lgkmcnt(6)
v_mfma_f32_32x32x16_bf16 v[42:57], v[126:129], v[74:77], v[42:57]
s_add_u32 s65, s70, 20480
buffer_load_dwordx4 v[126:129], v1, s[4:7], s65 offen offset:0 sc1
ds_read_b64_tr_b16 v[90:91], v2 offset:38912
ds_read_b64_tr_b16 v[92:93], v2 offset:39168
v_add_f32 v171, v171, v173
v_cndmask_b32 v170, v170, 0, s[56:57]
s_waitcnt vmcnt(15) lgkmcnt(6)
v_mfma_f32_32x32x16_bf16 v[26:41], v[130:133], v[78:81], v[26:41]
ds_read_b64_tr_b16 v[74:75], v2 offset:11264
ds_read_b64_tr_b16 v[76:77], v2 offset:11520
v_cndmask_b32 v171, v171, 0, s[56:57]
v_add_f32 v158, v158, v162
v_add_f32 v159, v159, v163
s_waitcnt lgkmcnt(6)
v_mfma_f32_32x32x16_bf16 v[42:57], v[130:133], v[82:85], v[42:57]
buffer_load_dwordx4 v[130:133], v1, s[4:7], s65 offen offset:1024 sc1
ds_read_b64_tr_b16 v[78:79], v2 offset:39936
ds_read_b64_tr_b16 v[80:81], v2 offset:40192
v_add_f32 v166, v166, v170
v_add_f32 v167, v167, v171
s_waitcnt vmcnt(15) lgkmcnt(6)
v_mfma_f32_32x32x16_bf16 v[26:41], v[134:137], v[86:89], v[26:41]
ds_read_b64_tr_b16 v[82:83], v2 offset:12288
ds_read_b64_tr_b16 v[84:85], v2 offset:12544
v_add_f32 v158, v158, v166
v_add_f32 v159, v159, v167
v_mov_b32 v160, v158
s_waitcnt lgkmcnt(6)
v_mfma_f32_32x32x16_bf16 v[42:57], v[134:137], v[90:93], v[42:57]
buffer_load_dwordx4 v[134:137], v1, s[4:7], s65 offen offset:2048 sc1
ds_read_b64_tr_b16 v[86:87], v2 offset:40960
ds_read_b64_tr_b16 v[88:89], v2 offset:41216
v_mov_b32 v161, v159
v_mov_b32 v174, 0
s_waitcnt vmcnt(15) lgkmcnt(6)
v_mfma_f32_32x32x16_bf16 v[26:41], v[138:141], v[74:77], v[26:41]
ds_read_b64_tr_b16 v[90:91], v2 offset:13312
ds_read_b64_tr_b16 v[92:93], v2 offset:13568
v_mov_b32 v175, 0
v_permlane32_swap_b32 v158, v160
v_permlane32_swap_b32 v159, v161
s_waitcnt lgkmcnt(6)
v_mfma_f32_32x32x16_bf16 v[42:57], v[138:141], v[78:81], v[42:57]
buffer_load_dwordx4 v[138:141], v1, s[4:7], s65 offen offset:3072 sc1
ds_read_b64_tr_b16 v[74:75], v2 offset:41984
ds_read_b64_tr_b16 v[76:77], v2 offset:42240
v_add_f32 v158, v158, v160
v_add_f32 v159, v159, v161
s_waitcnt vmcnt(14) lgkmcnt(6)
v_mfma_f32_32x32x16_bf16 v[26:41], v[94:97], v[82:85], v[26:41]
ds_read_b64_tr_b16 v[78:79], v2 offset:14336
ds_read_b64_tr_b16 v[80:81], v2 offset:14592
v_mul_f32 v160, 0x3b124925, v158
v_mul_f32 v159, 0x3b124925, v159
v_fmamk_f32 v158, v160, 0xc3e00000, v158
s_waitcnt lgkmcnt(6)
v_mfma_f32_32x32x16_bf16 v[42:57], v[94:97], v[86:89], v[42:57]
s_add_u32 s65, s70, 24576
buffer_load_dwordx4 v[94:97], v1, s[4:7], s65 offen offset:0 sc1
ds_read_b64_tr_b16 v[82:83], v2 offset:43008
ds_read_b64_tr_b16 v[84:85], v2 offset:43264
v_fmamk_f32 v158, v158, 0x3b124925, v160
v_fma_f32 v159, -v158, v158, v159
s_waitcnt vmcnt(13) lgkmcnt(6)
v_mfma_f32_32x32x16_bf16 v[26:41], v[98:101], v[90:93], v[26:41]
ds_read_b64_tr_b16 v[86:87], v2 offset:15360
ds_read_b64_tr_b16 v[88:89], v2 offset:15616
v_max_f32 v159, 0, v159
v_cvt_pk_bf16_f32 v160, -v158, v159
v_and_b32 v159, 0xffff0000, v160
s_waitcnt lgkmcnt(6)
v_mfma_f32_32x32x16_bf16 v[42:57], v[98:101], v[74:77], v[42:57]
buffer_load_dwordx4 v[98:101], v1, s[4:7], s65 offen offset:1024 sc1
ds_read_b64_tr_b16 v[90:91], v2 offset:44032
ds_read_b64_tr_b16 v[92:93], v2 offset:44288
v_and_b32 v160, 0xffff, v160
v_add_f32 v159, 0x3727c5ac, v159
s_waitcnt vmcnt(12) lgkmcnt(6)
v_mfma_f32_32x32x16_bf16 v[26:41], v[102:105], v[78:81], v[26:41]
ds_read_b64_tr_b16 v[74:75], v2 offset:16384
ds_read_b64_tr_b16 v[76:77], v2 offset:16640
v_cndmask_b32 v173, v160, 0, s[56:57]
v_cvt_pk_bf16_f32 v159, v159, v159
v_lshl_or_b32 v172, v173, 16, v173
s_waitcnt lgkmcnt(6)
v_mfma_f32_32x32x16_bf16 v[42:57], v[102:105], v[82:85], v[42:57]
buffer_load_dwordx4 v[102:105], v1, s[4:7], s65 offen offset:2048 sc1
ds_read_b64_tr_b16 v[78:79], v2 offset:45056
ds_read_b64_tr_b16 v[80:81], v2 offset:45312
v_and_b32 v159, 0xffff0000, v159
v_sqrt_f32 v159, v159
s_waitcnt vmcnt(11) lgkmcnt(6)
v_mfma_f32_32x32x16_bf16 v[26:41], v[106:109], v[86:89], v[26:41]
ds_read_b64_tr_b16 v[82:83], v2 offset:17408
ds_read_b64_tr_b16 v[84:85], v2 offset:17664
v_cvt_pk_bf16_f32 v159, v159, v159
v_and_b32 v159, 0xffff0000, v159
v_rcp_f32 v158, v159
s_waitcnt lgkmcnt(6)
v_mfma_f32_32x32x16_bf16 v[42:57], v[106:109], v[90:93], v[42:57]
buffer_load_dwordx4 v[106:109], v1, s[4:7], s65 offen offset:3072 sc1
ds_read_b64_tr_b16 v[86:87], v2 offset:46080
ds_read_b64_tr_b16 v[88:89], v2 offset:46336
v_mul_f32 v159, 0x3fb8aa3b, v158
s_lshl_b32 s64, s32, 7
s_waitcnt vmcnt(11) lgkmcnt(6)
v_mfma_f32_32x32x16_bf16 v[26:41], v[110:113], v[74:77], v[26:41]
ds_read_b64_tr_b16 v[90:91], v2 offset:18432
ds_read_b64_tr_b16 v[92:93], v2 offset:18688
s_add_u32 s64, s64, 161792
v_and_b32 v168, 31, v0
v_lshl_add_u32 v168, v168, 2, s64
s_waitcnt lgkmcnt(6)
v_mfma_f32_32x32x16_bf16 v[42:57], v[110:113], v[78:81], v[42:57]
ds_read_b64_tr_b16 v[74:75], v2 offset:47104
ds_read_b64_tr_b16 v[76:77], v2 offset:47360
v_lshrrev_b32 v169, 5, v0
v_lshl_add_u32 v169, v169, 4, s64
ds_write_b32 v168, v158
s_waitcnt vmcnt(10) lgkmcnt(7)
v_mfma_f32_32x32x16_bf16 v[26:41], v[114:117], v[82:85], v[26:41]
ds_read_b64_tr_b16 v[78:79], v2 offset:19456
ds_read_b64_tr_b16 v[80:81], v2 offset:19712
ds_read_b128 v[142:145], v169 offset:0
ds_read_b128 v[146:149], v169 offset:32
ds_read_b128 v[150:153], v169 offset:64
s_waitcnt lgkmcnt(10)
v_mfma_f32_32x32x16_bf16 v[42:57], v[114:117], v[86:89], v[42:57]
ds_read_b64_tr_b16 v[82:83], v2 offset:48128
ds_read_b64_tr_b16 v[84:85], v2 offset:48384
ds_read_b128 v[154:157], v169 offset:96
v_mov_b32 v160, 0x3f803f80
v_mov_b32 v161, 0x3f803f80
s_waitcnt vmcnt(9) lgkmcnt(11)
v_mfma_f32_32x32x16_bf16 v[26:41], v[118:121], v[90:93], v[26:41]
ds_read_b64_tr_b16 v[86:87], v2 offset:20480
ds_read_b64_tr_b16 v[88:89], v2 offset:20736
v_mov_b32 v162, 0x3f803f80
v_mov_b32 v163, 0x3f803f80
v_mov_b32 v164, 0x3f803f80
s_waitcnt lgkmcnt(11)
v_mfma_f32_32x32x16_bf16 v[42:57], v[118:121], v[74:77], v[42:57]
ds_read_b64_tr_b16 v[90:91], v2 offset:21504
ds_read_b64_tr_b16 v[92:93], v2 offset:21760
v_mov_b32 v165, 0x3f803f80
v_mov_b32 v166, 0x3f803f80
v_mov_b32 v167, 0x3f803f80
s_waitcnt vmcnt(8) lgkmcnt(10)
v_mfma_f32_32x32x16_bf16 v[26:41], v[122:125], v[78:81], v[26:41]
ds_read_b64_tr_b16 v[74:75], v2 offset:22528
ds_read_b64_tr_b16 v[76:77], v2 offset:22784
s_waitcnt lgkmcnt(7)
v_mfma_f32_32x32x16_bf16 v[42:57], v[122:125], v[82:85], v[42:57]
ds_read_b64_tr_b16 v[78:79], v2 offset:23552
ds_read_b64_tr_b16 v[80:81], v2 offset:23808
s_waitcnt vmcnt(7) lgkmcnt(6)
v_mfma_f32_32x32x16_bf16 v[26:41], v[126:129], v[86:89], v[26:41]
ds_read_b64_tr_b16 v[82:83], v2 offset:24576
ds_read_b64_tr_b16 v[84:85], v2 offset:24832
s_waitcnt vmcnt(6) lgkmcnt(6)
v_mfma_f32_32x32x16_bf16 v[26:41], v[130:133], v[90:93], v[26:41]
ds_read_b64_tr_b16 v[86:87], v2 offset:25600
ds_read_b64_tr_b16 v[88:89], v2 offset:25856
s_waitcnt vmcnt(5) lgkmcnt(6)
v_mfma_f32_32x32x16_bf16 v[26:41], v[134:137], v[74:77], v[26:41]
ds_read_b64_tr_b16 v[90:91], v2 offset:26624
ds_read_b64_tr_b16 v[92:93], v2 offset:26880
s_waitcnt vmcnt(4) lgkmcnt(6)
v_mfma_f32_32x32x16_bf16 v[26:41], v[138:141], v[78:81], v[26:41]
ds_read_b64_tr_b16 v[74:75], v2 offset:27648
ds_read_b64_tr_b16 v[76:77], v2 offset:27904
s_waitcnt vmcnt(3) lgkmcnt(6)
v_mfma_f32_32x32x16_bf16 v[26:41], v[94:97], v[82:85], v[26:41]
ds_read_b64_tr_b16 v[78:79], v2 offset:49152
ds_read_b64_tr_b16 v[80:81], v2 offset:49408
s_waitcnt vmcnt(2) lgkmcnt(6)
v_mfma_f32_32x32x16_bf16 v[26:41], v[98:101], v[86:89], v[26:41]
ds_read_b64_tr_b16 v[82:83], v2 offset:50176
ds_read_b64_tr_b16 v[84:85], v2 offset:50432
s_waitcnt vmcnt(1) lgkmcnt(6)
v_mfma_f32_32x32x16_bf16 v[26:41], v[102:105], v[90:93], v[26:41]
ds_read_b64_tr_b16 v[86:87], v2 offset:51200
ds_read_b64_tr_b16 v[88:89], v2 offset:51456
s_waitcnt vmcnt(0) lgkmcnt(6)
v_mfma_f32_32x32x16_bf16 v[26:41], v[106:109], v[74:77], v[26:41]
ds_read_b64_tr_b16 v[90:91], v2 offset:52224
ds_read_b64_tr_b16 v[92:93], v2 offset:52480
v_mfma_f32_32x32x16_bf16 v[26:41], v[172:175], v[8:11], v[26:41]
s_waitcnt lgkmcnt(6)
v_mfma_f32_32x32x16_bf16 v[42:57], v[126:129], v[78:81], v[42:57]
ds_read_b64_tr_b16 v[74:75], v2 offset:53248
ds_read_b64_tr_b16 v[76:77], v2 offset:53504
s_waitcnt lgkmcnt(6)
v_mfma_f32_32x32x16_bf16 v[42:57], v[130:133], v[82:85], v[42:57]
ds_read_b64_tr_b16 v[78:79], v2 offset:54272
ds_read_b64_tr_b16 v[80:81], v2 offset:54528
s_waitcnt lgkmcnt(15)
s_nop 2
v_mul_f32 v26, v26, v142
v_mul_f32 v27, v27, v143
s_waitcnt lgkmcnt(6)
v_mfma_f32_32x32x16_bf16 v[42:57], v[134:137], v[86:89], v[42:57]
ds_read_b64_tr_b16 v[82:83], v2 offset:55296
ds_read_b64_tr_b16 v[84:85], v2 offset:55552
v_mul_f32 v168, s82, v26
v_mul_f32 v169, s82, v27
v_exp_f32 v168, v168 clamp
s_waitcnt lgkmcnt(6)
v_mfma_f32_32x32x16_bf16 v[42:57], v[138:141], v[90:93], v[42:57]
ds_read_b64_tr_b16 v[86:87], v2 offset:56320
ds_read_b64_tr_b16 v[88:89], v2 offset:56576
v_exp_f32 v169, v169 clamp
v_add_f32 v26, s84, v26
s_waitcnt lgkmcnt(6)
v_mfma_f32_32x32x16_bf16 v[42:57], v[94:97], v[74:77], v[42:57]
v_add_f32 v27, s84, v27
v_add_f32 v168, s86, v168
v_add_f32 v169, s86, v169
v_max_f32 v168, v168, v26
v_max_f32 v169, v169, v27
s_waitcnt lgkmcnt(4)
v_mfma_f32_32x32x16_bf16 v[42:57], v[98:101], v[78:81], v[42:57]
v_cvt_pk_bf16_f32 v26, v168, v169
v_mul_f32 v28, v28, v144
v_mul_f32 v29, v29, v145
v_mul_f32 v170, s82, v28
v_mul_f32 v171, s82, v29
s_waitcnt lgkmcnt(2)
v_mfma_f32_32x32x16_bf16 v[42:57], v[102:105], v[82:85], v[42:57]
v_exp_f32 v170, v170 clamp
v_exp_f32 v171, v171 clamp
v_add_f32 v28, s84, v28
s_waitcnt lgkmcnt(0)
v_mfma_f32_32x32x16_bf16 v[42:57], v[106:109], v[86:89], v[42:57]
v_add_f32 v29, s84, v29
v_add_f32 v170, s86, v170
v_add_f32 v171, s86, v171
v_max_f32 v170, v170, v28
v_max_f32 v171, v171, v29
v_cvt_pk_bf16_f32 v27, v170, v171
v_mfma_f32_32x32x16_bf16 v[42:57], v[172:175], v[10:13], v[42:57]
v_pk_mul_f32 v[30:31], v[30:31], v[146:147]
v_pk_mul_f32 v[168:169], v[30:31], s[82:83]
v_exp_f32 v168, v168 clamp
v_exp_f32 v169, v169 clamp
v_pk_add_f32 v[30:31], v[30:31], s[84:85]
v_pk_add_f32 v[168:169], v[168:169], s[86:87]
v_max_f32 v168, v168, v30
v_max_f32 v169, v169, v31
v_cvt_pk_bf16_f32 v28, v168, v169
v_pk_mul_f32 v[32:33], v[32:33], v[148:149]
v_pk_mul_f32 v[170:171], v[32:33], s[82:83]
v_exp_f32 v170, v170 clamp
v_exp_f32 v171, v171 clamp
v_pk_add_f32 v[32:33], v[32:33], s[84:85]
v_pk_add_f32 v[170:171], v[170:171], s[86:87]
v_max_f32 v170, v170, v32
v_max_f32 v171, v171, v33
v_cvt_pk_bf16_f32 v29, v170, v171
v_pk_mul_f32 v[34:35], v[34:35], v[150:151]
v_pk_mul_f32 v[168:169], v[34:35], s[82:83]
v_exp_f32 v168, v168 clamp
v_exp_f32 v169, v169 clamp
v_pk_add_f32 v[34:35], v[34:35], s[84:85]
v_pk_add_f32 v[168:169], v[168:169], s[86:87]
v_max_f32 v168, v168, v34
v_max_f32 v169, v169, v35
v_cvt_pk_bf16_f32 v30, v168, v169
v_pk_mul_f32 v[36:37], v[36:37], v[152:153]
v_pk_mul_f32 v[170:171], v[36:37], s[82:83]
v_exp_f32 v170, v170 clamp
v_exp_f32 v171, v171 clamp
v_pk_add_f32 v[36:37], v[36:37], s[84:85]
v_pk_add_f32 v[170:171], v[170:171], s[86:87]
v_max_f32 v170, v170, v36
v_max_f32 v171, v171, v37
v_cvt_pk_bf16_f32 v31, v170, v171
v_pk_mul_f32 v[38:39], v[38:39], v[154:155]
v_pk_mul_f32 v[168:169], v[38:39], s[82:83]
v_exp_f32 v168, v168 clamp
v_exp_f32 v169, v169 clamp
v_pk_add_f32 v[38:39], v[38:39], s[84:85]
v_pk_add_f32 v[168:169], v[168:169], s[86:87]
v_max_f32 v168, v168, v38
v_max_f32 v169, v169, v39
v_cvt_pk_bf16_f32 v32, v168, v169
v_pk_mul_f32 v[40:41], v[40:41], v[156:157]
v_pk_mul_f32 v[170:171], v[40:41], s[82:83]
v_exp_f32 v170, v170 clamp
v_exp_f32 v171, v171 clamp
v_pk_add_f32 v[40:41], v[40:41], s[84:85]
v_pk_add_f32 v[170:171], v[170:171], s[86:87]
v_max_f32 v170, v170, v40
v_max_f32 v171, v171, v41
v_cvt_pk_bf16_f32 v33, v170, v171
v_pk_mul_f32 v[42:43], v[42:43], v[142:143]
v_pk_mul_f32 v[44:45], v[44:45], v[144:145]
v_pk_mul_f32 v[46:47], v[46:47], v[146:147]
v_pk_mul_f32 v[48:49], v[48:49], v[148:149]
v_pk_mul_f32 v[50:51], v[50:51], v[150:151]
v_pk_mul_f32 v[52:53], v[52:53], v[152:153]
v_pk_mul_f32 v[54:55], v[54:55], v[154:155]
v_pk_mul_f32 v[56:57], v[56:57], v[156:157]
s_mov_b64 exec, s[54:55]
v_cvt_pk_bf16_f32 v160, v42, v43
v_cvt_pk_bf16_f32 v161, v44, v45
v_cvt_pk_bf16_f32 v162, v46, v47
v_cvt_pk_bf16_f32 v163, v48, v49
v_cvt_pk_bf16_f32 v164, v50, v51
v_cvt_pk_bf16_f32 v165, v52, v53
v_cvt_pk_bf16_f32 v166, v54, v55
v_cvt_pk_bf16_f32 v167, v56, v57
s_mov_b64 exec, -1
s_add_u32 s61, s89, 143360
v_add_u32 v168, s61, v1
v_mfma_f32_32x32x16_bf16 v[42:57], v[26:29], v[160:163], 0
v_mfma_f32_32x32x16_bf16 v[42:57], v[30:33], v[164:167], v[42:57]
s_lshr_b32 s61, s89, 2
s_add_u32 s61, s61, 143360
v_add_u32 v169, s61, v1
s_add_u32 s42, s42, 1048576
s_add_u32 s43, s43, 1048576
s_nop 6
ds_write_b128 v168, v[42:45] offset:0
ds_write_b128 v168, v[46:49] offset:1024
ds_write_b128 v168, v[50:53] offset:2048
ds_write_b128 v168, v[54:57] offset:3072
s_waitcnt lgkmcnt(0)
s_barrier
ds_read_b128 v[26:29], v169 offset:0
ds_read_b128 v[30:33], v169 offset:4096
ds_read_b128 v[34:37], v169 offset:8192
ds_read_b128 v[38:41], v169 offset:12288
L_hop6:
s_cbranch_execz L_hop10
v_lshlrev_b32 v160, 3, v0
v_mov_b32 v161, s81
v_cndmask_b32 v161, -2, v161, s[56:57]
s_waitcnt lgkmcnt(2)
v_pk_add_f32 v[26:27], v[26:27], v[30:31]
v_pk_add_f32 v[28:29], v[28:29], v[32:33]
s_waitcnt lgkmcnt(0)
v_pk_add_f32 v[34:35], v[34:35], v[38:39]
v_pk_add_f32 v[36:37], v[36:37], v[40:41]
v_pk_add_f32 v[26:27], v[26:27], v[34:35]
v_pk_add_f32 v[28:29], v[28:29], v[36:37]
v_cvt_pk_bf16_f32 v26, v26, v27
v_cvt_pk_bf16_f32 v27, v28, v29
v_min_u32 v26, v161, v26
v_min_u32 v27, v161, v27
buffer_store_dwordx2 v[26:27], v160, s[4:7], s42 offen sc1
ds_read_b64_tr_b16 v[74:75], v3 offset:16384
ds_read_b64_tr_b16 v[76:77], v3 offset:16640
ds_read_b64_tr_b16 v[78:79], v3 offset:17408
ds_read_b64_tr_b16 v[80:81], v3 offset:17664
ds_read_b64_tr_b16 v[82:83], v3 offset:18432
ds_read_b64_tr_b16 v[84:85], v3 offset:18688
ds_read_b64_tr_b16 v[86:87], v3 offset:19456
ds_read_b64_tr_b16 v[88:89], v3 offset:19712
s_waitcnt lgkmcnt(6)
v_mfma_f32_32x32x16_bf16 v[58:73], v[74:77], v[110:113], v[58:73]
s_add_u32 s65, s70, 8192
buffer_load_dwordx4 v[110:113], v1, s[4:7], s65 offen sc1
ds_read_b64_tr_b16 v[90:91], v3 offset:20480
ds_read_b64_tr_b16 v[92:93], v3 offset:20736
s_waitcnt lgkmcnt(6)
v_mfma_f32_32x32x16_bf16 v[58:73], v[78:81], v[114:117], v[58:73]
s_add_u32 s65, s70, 9216
buffer_load_dwordx4 v[114:117], v1, s[4:7], s65 offen sc1
ds_read_b64_tr_b16 v[74:75], v3 offset:21504
ds_read_b64_tr_b16 v[76:77], v3 offset:21760
s_waitcnt lgkmcnt(6)
v_mfma_f32_32x32x16_bf16 v[58:73], v[82:85], v[118:121], v[58:73]
s_add_u32 s65, s70, 10240
buffer_load_dwordx4 v[118:121], v1, s[4:7], s65 offen sc1
ds_read_b64_tr_b16 v[78:79], v3 offset:22528
ds_read_b64_tr_b16 v[80:81], v3 offset:22784
s_waitcnt lgkmcnt(6)
v_mfma_f32_32x32x16_bf16 v[58:73], v[86:89], v[122:125], v[58:73]
s_add_u32 s65, s70, 11264
buffer_load_dwordx4 v[122:125], v1, s[4:7], s65 offen sc1
ds_read_b64_tr_b16 v[82:83], v3 offset:23552
ds_read_b64_tr_b16 v[84:85], v3 offset:23808
s_waitcnt lgkmcnt(6)
v_mfma_f32_32x32x16_bf16 v[58:73], v[90:93], v[126:129], v[58:73]
s_add_u32 s65, s70, 12288
buffer_load_dwordx4 v[126:129], v1, s[4:7], s65 offen sc1
ds_read_b64_tr_b16 v[86:87], v3 offset:24576
ds_read_b64_tr_b16 v[88:89], v3 offset:24832
s_waitcnt lgkmcnt(6)
v_mfma_f32_32x32x16_bf16 v[58:73], v[74:77], v[130:133], v[58:73]
s_add_u32 s65, s70, 13312
buffer_load_dwordx4 v[130:133], v1, s[4:7], s65 offen sc1
ds_read_b64_tr_b16 v[90:91], v3 offset:25600
ds_read_b64_tr_b16 v[92:93], v3 offset:25856
s_waitcnt lgkmcnt(6)
v_mfma_f32_32x32x16_bf16 v[58:73], v[78:81], v[134:137], v[58:73]
s_add_u32 s65, s70, 14336
buffer_load_dwordx4 v[134:137], v1, s[4:7], s65 offen sc1
ds_read_b64_tr_b16 v[74:75], v3 offset:26624
ds_read_b64_tr_b16 v[76:77], v3 offset:26880
s_waitcnt lgkmcnt(6)
v_mfma_f32_32x32x16_bf16 v[58:73], v[82:85], v[138:141], v[58:73]
s_add_u32 s65, s70, 15360
buffer_load_dwordx4 v[138:141], v1, s[4:7], s65 offen sc1
ds_read_b64_tr_b16 v[78:79], v3 offset:27648
ds_read_b64_tr_b16 v[80:81], v3 offset:27904
s_waitcnt lgkmcnt(6)
v_mfma_f32_32x32x16_bf16 v[58:73], v[86:89], v[94:97], v[58:73]
s_add_u32 m0, s80, 0
s_add_u32 s63, s79, 0
buffer_load_dwordx4 v6, s[12:15], s63 offen offset:0 lds
ds_read_b64_tr_b16 v[82:83], v3 offset:8192
ds_read_b64_tr_b16 v[84:85], v3 offset:8448
s_waitcnt lgkmcnt(6)
v_mfma_f32_32x32x16_bf16 v[58:73], v[90:93], v[98:101], v[58:73]
s_add_u32 s63, s79, 6144
buffer_load_dwordx4 v6, s[12:15], s63 offen offset:1024 lds
ds_read_b64_tr_b16 v[86:87], v3 offset:9216
ds_read_b64_tr_b16 v[88:89], v3 offset:9472
s_waitcnt lgkmcnt(6)
v_mfma_f32_32x32x16_bf16 v[58:73], v[74:77], v[102:105], v[58:73]
s_add_u32 s63, s79, 12288
buffer_load_dwordx4 v6, s[12:15], s63 offen offset:2048 lds
ds_read_b64_tr_b16 v[90:91], v3 offset:10240
ds_read_b64_tr_b16 v[92:93], v3 offset:10496
s_waitcnt lgkmcnt(6)
v_mfma_f32_32x32x16_bf16 v[58:73], v[78:81], v[106:109], v[58:73]
s_add_u32 s63, s79, 18432
buffer_load_dwordx4 v6, s[12:15], s63 offen offset:3072 lds
ds_read_b64_tr_b16 v[74:75], v3 offset:11264
ds_read_b64_tr_b16 v[76:77], v3 offset:11520
s_waitcnt vmcnt(11) lgkmcnt(6)
v_mfma_f32_32x32x16_bf16 v[58:73], v[82:85], v[110:113], v[58:73]
s_add_u32 m0, s80, 4096
s_add_u32 s63, s79, 28672
buffer_load_dwordx4 v6, s[12:15], s63 offen offset:0 lds
ds_read_b64_tr_b16 v[78:79], v3 offset:12288
ds_read_b64_tr_b16 v[80:81], v3 offset:12544
s_waitcnt vmcnt(11) lgkmcnt(6)
v_mfma_f32_32x32x16_bf16 v[58:73], v[86:89], v[114:117], v[58:73]
s_add_u32 s63, s79, 34816
buffer_load_dwordx4 v6, s[12:15], s63 offen offset:1024 lds
ds_read_b64_tr_b16 v[82:83], v3 offset:13312
ds_read_b64_tr_b16 v[84:85], v3 offset:13568
s_waitcnt vmcnt(11) lgkmcnt(6)
v_mfma_f32_32x32x16_bf16 v[58:73], v[90:93], v[118:121], v[58:73]
s_add_u32 s63, s79, 40960
buffer_load_dwordx4 v6, s[12:15], s63 offen offset:2048 lds
ds_read_b64_tr_b16 v[86:87], v3 offset:14336
ds_read_b64_tr_b16 v[88:89], v3 offset:14592
s_waitcnt vmcnt(11) lgkmcnt(6)
v_mfma_f32_32x32x16_bf16 v[58:73], v[74:77], v[122:125], v[58:73]
s_add_u32 s63, s79, 47104
buffer_load_dwordx4 v6, s[12:15], s63 offen offset:3072 lds
ds_read_b64_tr_b16 v[90:91], v3 offset:15360
ds_read_b64_tr_b16 v[92:93], v3 offset:15616
s_waitcnt vmcnt(11) lgkmcnt(6)
v_mfma_f32_32x32x16_bf16 v[58:73], v[78:81], v[126:129], v[58:73]
s_add_u32 m0, s80, 8192
s_add_u32 s63, s79, 57344
buffer_load_dwordx4 v6, s[12:15], s63 offen offset:0 lds
s_waitcnt vmcnt(11) lgkmcnt(4)
v_mfma_f32_32x32x16_bf16 v[58:73], v[82:85], v[130:133], v[58:73]
s_add_u32 s63, s79, 63488
buffer_load_dwordx4 v6, s[12:15], s63 offen offset:1024 lds
s_waitcnt vmcnt(11) lgkmcnt(2)
v_mfma_f32_32x32x16_bf16 v[58:73], v[86:89], v[134:137], v[58:73]
s_add_u32 s63, s79, 69632
buffer_load_dwordx4 v6, s[12:15], s63 offen offset:2048 lds
s_waitcnt vmcnt(11) lgkmcnt(0)
v_mfma_f32_32x32x16_bf16 v[58:73], v[90:93], v[138:141], v[58:73]
s_add_u32 s63, s79, 75776
buffer_load_dwordx4 v6, s[12:15], s63 offen offset:3072 lds
v_mfma_f32_32x32x16_bf16 v[58:73], v[12:15], v[172:175], v[58:73]
s_add_u32 m0, s80, 12288
s_add_u32 s63, s79, 86016
buffer_load_dwordx4 v6, s[12:15], s63 offen offset:0 lds
s_add_u32 s63, s79, 92160
buffer_load_dwordx4 v6, s[12:15], s63 offen offset:1024 lds
s_nop 6
v_pk_mul_f32 v[168:169], v[58:59], v[158:159] op_sel:[0,1] op_sel_hi:[1,1]
v_exp_f32 v168, v168 clamp
v_exp_f32 v169, v169 clamp
v_pk_fma_f32 v[58:59], v[58:59], v[158:159], s[84:85] op_sel_hi:[1,0,1]
v_pk_add_f32 v[168:169], v[168:169], s[86:87]
v_max_f32 v168, v168, v58
v_max_f32 v169, v169, v59
v_cvt_pk_bf16_f32 v142, v168, v169
v_pk_mul_f32 v[170:171], v[60:61], v[158:159] op_sel:[0,1] op_sel_hi:[1,1]
v_exp_f32 v170, v170 clamp
v_exp_f32 v171, v171 clamp
v_pk_fma_f32 v[60:61], v[60:61], v[158:159], s[84:85] op_sel_hi:[1,0,1]
v_pk_add_f32 v[170:171], v[170:171], s[86:87]
v_max_f32 v170, v170, v60
v_max_f32 v171, v171, v61
v_cvt_pk_bf16_f32 v143, v170, v171
v_pk_mul_f32 v[168:169], v[62:63], v[158:159] op_sel:[0,1] op_sel_hi:[1,1]
v_exp_f32 v168, v168 clamp
v_exp_f32 v169, v169 clamp
v_pk_fma_f32 v[62:63], v[62:63], v[158:159], s[84:85] op_sel_hi:[1,0,1]
v_pk_add_f32 v[168:169], v[168:169], s[86:87]
v_max_f32 v168, v168, v62
v_max_f32 v169, v169, v63
v_cvt_pk_bf16_f32 v144, v168, v169
v_pk_mul_f32 v[170:171], v[64:65], v[158:159] op_sel:[0,1] op_sel_hi:[1,1]
v_exp_f32 v170, v170 clamp
v_exp_f32 v171, v171 clamp
v_pk_fma_f32 v[64:65], v[64:65], v[158:159], s[84:85] op_sel_hi:[1,0,1]
v_pk_add_f32 v[170:171], v[170:171], s[86:87]
v_max_f32 v170, v170, v64
v_max_f32 v171, v171, v65
v_cvt_pk_bf16_f32 v145, v170, v171
v_pk_mul_f32 v[168:169], v[66:67], v[158:159] op_sel:[0,1] op_sel_hi:[1,1]
v_exp_f32 v168, v168 clamp
v_exp_f32 v169, v169 clamp
v_pk_fma_f32 v[66:67], v[66:67], v[158:159], s[84:85] op_sel_hi:[1,0,1]
v_pk_add_f32 v[168:169], v[168:169], s[86:87]
v_max_f32 v168, v168, v66
v_max_f32 v169, v169, v67
v_cvt_pk_bf16_f32 v146, v168, v169
v_pk_mul_f32 v[170:171], v[68:69], v[158:159] op_sel:[0,1] op_sel_hi:[1,1]
v_exp_f32 v170, v170 clamp
v_exp_f32 v171, v171 clamp
v_pk_fma_f32 v[68:69], v[68:69], v[158:159], s[84:85] op_sel_hi:[1,0,1]
v_pk_add_f32 v[170:171], v[170:171], s[86:87]
v_max_f32 v170, v170, v68
v_max_f32 v171, v171, v69
v_cvt_pk_bf16_f32 v147, v170, v171
v_pk_mul_f32 v[168:169], v[70:71], v[158:159] op_sel:[0,1] op_sel_hi:[1,1]
v_exp_f32 v168, v168 clamp
v_exp_f32 v169, v169 clamp
v_pk_fma_f32 v[70:71], v[70:71], v[158:159], s[84:85] op_sel_hi:[1,0,1]
v_pk_add_f32 v[168:169], v[168:169], s[86:87]
v_max_f32 v168, v168, v70
v_max_f32 v169, v169, v71
v_cvt_pk_bf16_f32 v148, v168, v169
v_pk_mul_f32 v[170:171], v[72:73], v[158:159] op_sel:[0,1] op_sel_hi:[1,1]
v_exp_f32 v170, v170 clamp
v_exp_f32 v171, v171 clamp
v_pk_fma_f32 v[72:73], v[72:73], v[158:159], s[84:85] op_sel_hi:[1,0,1]
v_pk_add_f32 v[170:171], v[170:171], s[86:87]
v_max_f32 v170, v170, v72
v_max_f32 v171, v171, v73
v_cvt_pk_bf16_f32 v149, v170, v171
s_add_u32 s65, s43, 0
buffer_load_dwordx2 v[28:29], v160, s[4:7], s65 offen offset:0 sc1
buffer_load_dwordx2 v[30:31], v160, s[4:7], s65 offen offset:512 sc1
buffer_load_dwordx2 v[32:33], v160, s[4:7], s65 offen offset:1024 sc1
buffer_load_dwordx2 v[34:35], v160, s[4:7], s65 offen offset:1536 sc1
buffer_load_dwordx2 v[36:37], v160, s[4:7], s65 offen offset:2048 sc1
buffer_load_dwordx2 v[38:39], v160, s[4:7], s65 offen offset:2560 sc1
buffer_load_dwordx2 v[40:41], v160, s[4:7], s65 offen offset:3072 sc1
buffer_load_dwordx2 v[42:43], v160, s[4:7], s65 offen offset:3584 sc1
s_add_u32 s65, s43, 4096
buffer_load_dwordx2 v[44:45], v160, s[4:7], s65 offen offset:0 sc1
buffer_load_dwordx2 v[46:47], v160, s[4:7], s65 offen offset:512 sc1
buffer_load_dwordx2 v[48:49], v160, s[4:7], s65 offen offset:1024 sc1
buffer_load_dwordx2 v[50:51], v160, s[4:7], s65 offen offset:1536 sc1
buffer_load_dwordx2 v[52:53], v160, s[4:7], s65 offen offset:2048 sc1
buffer_load_dwordx2 v[54:55], v160, s[4:7], s65 offen offset:2560 sc1
buffer_load_dwordx2 v[56:57], v160, s[4:7], s65 offen offset:3072 sc1
buffer_load_dwordx2 v[26:27], v160, s[4:7], s65 offen offset:3584 sc1
s_waitcnt vmcnt(15)
LC_108:
v_max_u32 v94, v28, v29
v_cmp_eq_u32 vcc, -1, v94
v_lshlrev_b32 v96, 16, v28
v_and_b32 v97, 0xffff0000, v28
v_lshlrev_b32 v98, 16, v29
v_and_b32 v99, 0xffff0000, v29
s_cbranch_vccnz LS_109
LO_110:
v_pk_add_f32 v[90:91], v[96:97], 0
v_pk_add_f32 v[92:93], v[98:99], 0
s_waitcnt vmcnt(14)
LC_111:
v_max_u32 v94, v30, v31
v_cmp_eq_u32 vcc, -1, v94
v_lshlrev_b32 v96, 16, v30
v_and_b32 v97, 0xffff0000, v30
v_lshlrev_b32 v98, 16, v31
v_and_b32 v99, 0xffff0000, v31
s_cbranch_vccnz LS_112
LO_113:
v_pk_add_f32 v[90:91], v[90:91], v[96:97]
v_pk_add_f32 v[92:93], v[92:93], v[98:99]
s_waitcnt vmcnt(13)
LC_114:
v_max_u32 v94, v32, v33
v_cmp_eq_u32 vcc, -1, v94
v_lshlrev_b32 v96, 16, v32
v_and_b32 v97, 0xffff0000, v32
v_lshlrev_b32 v98, 16, v33
v_and_b32 v99, 0xffff0000, v33
s_cbranch_vccnz LS_115
LO_116:
v_pk_add_f32 v[90:91], v[90:91], v[96:97]
v_pk_add_f32 v[92:93], v[92:93], v[98:99]
s_lshr_b32 s61, s89, 3
s_add_u32 s61, s61, 159744
v_add_u32 v163, s61, v160
v_add_u32 v162, 159744, v160
s_waitcnt vmcnt(12)
LC_117:
v_max_u32 v94, v34, v35
v_cmp_eq_u32 vcc, -1, v94
v_lshlrev_b32 v96, 16, v34
v_and_b32 v97, 0xffff0000, v34
v_lshlrev_b32 v98, 16, v35
v_and_b32 v99, 0xffff0000, v35
s_cbranch_vccnz LS_118
LO_119:
v_pk_add_f32 v[90:91], v[90:91], v[96:97]
v_pk_add_f32 v[92:93], v[92:93], v[98:99]
s_waitcnt vmcnt(11)
LC_120:
v_max_u32 v94, v36, v37
v_cmp_eq_u32 vcc, -1, v94
v_lshlrev_b32 v96, 16, v36
v_and_b32 v97, 0xffff0000, v36
v_lshlrev_b32 v98, 16, v37
v_and_b32 v99, 0xffff0000, v37
s_cbranch_vccnz LS_121
LO_122:
v_pk_add_f32 v[90:91], v[90:91], v[96:97]
v_pk_add_f32 v[92:93], v[92:93], v[98:99]
s_waitcnt vmcnt(10)
LC_123:
v_max_u32 v94, v38, v39
v_cmp_eq_u32 vcc, -1, v94
v_lshlrev_b32 v96, 16, v38
v_and_b32 v97, 0xffff0000, v38
v_lshlrev_b32 v98, 16, v39
v_and_b32 v99, 0xffff0000, v39
s_cbranch_vccnz LS_124
LO_125:
v_pk_add_f32 v[90:91], v[90:91], v[96:97]
v_pk_add_f32 v[92:93], v[92:93], v[98:99]
s_waitcnt vmcnt(9)
LC_126:
v_max_u32 v94, v40, v41
v_cmp_eq_u32 vcc, -1, v94
v_lshlrev_b32 v96, 16, v40
v_and_b32 v97, 0xffff0000, v40
v_lshlrev_b32 v98, 16, v41
v_and_b32 v99, 0xffff0000, v41
s_cbranch_vccnz LS_127
LO_128:
v_pk_add_f32 v[90:91], v[90:91], v[96:97]
v_pk_add_f32 v[92:93], v[92:93], v[98:99]
s_waitcnt vmcnt(8)
LC_129:
v_max_u32 v94, v42, v43
v_cmp_eq_u32 vcc, -1, v94
v_lshlrev_b32 v96, 16, v42
v_and_b32 v97, 0xffff0000, v42
v_lshlrev_b32 v98, 16, v43
v_and_b32 v99, 0xffff0000, v43
s_cbranch_vccnz LS_130
LO_131:
v_pk_add_f32 v[90:91], v[90:91], v[96:97]
v_pk_add_f32 v[92:93], v[92:93], v[98:99]
s_waitcnt vmcnt(7)
LC_132:
v_max_u32 v94, v44, v45
v_cmp_eq_u32 vcc, -1, v94
v_lshlrev_b32 v96, 16, v44
v_and_b32 v97, 0xffff0000, v44
v_lshlrev_b32 v98, 16, v45
v_and_b32 v99, 0xffff0000, v45
s_cbranch_vccnz LS_133
LO_134:
v_pk_add_f32 v[90:91], v[90:91], v[96:97]
v_pk_add_f32 v[92:93], v[92:93], v[98:99]
s_waitcnt vmcnt(6)
LC_135:
v_max_u32 v94, v46, v47
v_cmp_eq_u32 vcc, -1, v94
v_lshlrev_b32 v96, 16, v46
v_and_b32 v97, 0xffff0000, v46
v_lshlrev_b32 v98, 16, v47
v_and_b32 v99, 0xffff0000, v47
s_cbranch_vccnz LS_136
LO_137:
v_pk_add_f32 v[90:91], v[90:91], v[96:97]
v_pk_add_f32 v[92:93], v[92:93], v[98:99]
s_waitcnt vmcnt(5)
LC_138:
v_max_u32 v94, v48, v49
v_cmp_eq_u32 vcc, -1, v94
v_lshlrev_b32 v96, 16, v48
v_and_b32 v97, 0xffff0000, v48
v_lshlrev_b32 v98, 16, v49
v_and_b32 v99, 0xffff0000, v49
s_cbranch_vccnz LS_139
LO_140:
v_pk_add_f32 v[90:91], v[90:91], v[96:97]
v_pk_add_f32 v[92:93], v[92:93], v[98:99]
s_waitcnt vmcnt(4)
LC_141:
v_max_u32 v94, v50, v51
v_cmp_eq_u32 vcc, -1, v94
v_lshlrev_b32 v96, 16, v50
v_and_b32 v97, 0xffff0000, v50
v_lshlrev_b32 v98, 16, v51
v_and_b32 v99, 0xffff0000, v51
s_cbranch_vccnz LS_142
LO_143:
v_pk_add_f32 v[90:91], v[90:91], v[96:97]
v_pk_add_f32 v[92:93], v[92:93], v[98:99]
s_waitcnt vmcnt(3)
LC_144:
v_max_u32 v94, v52, v53
v_cmp_eq_u32 vcc, -1, v94
v_lshlrev_b32 v96, 16, v52
v_and_b32 v97, 0xffff0000, v52
v_lshlrev_b32 v98, 16, v53
v_and_b32 v99, 0xffff0000, v53
s_cbranch_vccnz LS_145
LO_146:
v_pk_add_f32 v[90:91], v[90:91], v[96:97]
v_pk_add_f32 v[92:93], v[92:93], v[98:99]
s_waitcnt vmcnt(2)
LC_147:
v_max_u32 v94, v54, v55
v_cmp_eq_u32 vcc, -1, v94
v_lshlrev_b32 v96, 16, v54
v_and_b32 v97, 0xffff0000, v54
v_lshlrev_b32 v98, 16, v55
v_and_b32 v99, 0xffff0000, v55
s_cbranch_vccnz LS_148
LO_149:
v_pk_add_f32 v[90:91], v[90:91], v[96:97]
v_pk_add_f32 v[92:93], v[92:93], v[98:99]
s_waitcnt vmcnt(1)
LC_150:
v_max_u32 v94, v56, v57
v_cmp_eq_u32 vcc, -1, v94
v_lshlrev_b32 v96, 16, v56
v_and_b32 v97, 0xffff0000, v56
v_lshlrev_b32 v98, 16, v57
v_and_b32 v99, 0xffff0000, v57
s_cbranch_vccnz LS_151
LO_152:
v_pk_add_f32 v[90:91], v[90:91], v[96:97]
v_pk_add_f32 v[92:93], v[92:93], v[98:99]
s_waitcnt vmcnt(0)
LC_153:
v_max_u32 v94, v26, v27
v_cmp_eq_u32 vcc, -1, v94
v_lshlrev_b32 v96, 16, v26
v_and_b32 v97, 0xffff0000, v26
v_lshlrev_b32 v98, 16, v27
v_and_b32 v99, 0xffff0000, v27
s_cbranch_vccnz LS_154
LO_155:
v_pk_add_f32 v[90:91], v[90:91], v[96:97]
v_pk_add_f32 v[92:93], v[92:93], v[98:99]
v_cvt_pk_bf16_f32 v90, v90, v91
v_cvt_pk_bf16_f32 v91, v92, v93
ds_write_b64 v163, v[90:91]
s_waitcnt lgkmcnt(0)
s_barrier
ds_read_b64 v[26:27], v162 offset:0
ds_read_b64 v[28:29], v162 offset:512
ds_read_b64 v[30:31], v162 offset:1024
ds_read_b64 v[32:33], v162 offset:1536
s_waitcnt lgkmcnt(2)
v_mfma_f32_32x32x16_bf16 v[42:57], v[26:29], v[142:145], 0
s_waitcnt lgkmcnt(0)
v_mfma_f32_32x32x16_bf16 v[42:57], v[30:33], v[146:149], v[42:57]
s_nop 11
v_add_f32 v94, s86, v54
v_rcp_f32 v94, v94
s_nop 0
v_mov_b32 v95, v94
s_nop 1
v_permlane32_swap_b32 v94, v95
v_pk_mul_f32 v[42:43], v[42:43], v[94:95] op_sel:[0,1] op_sel_hi:[1,1]
v_pk_mul_f32 v[44:45], v[44:45], v[94:95] op_sel:[0,1] op_sel_hi:[1,1]
v_pk_mul_f32 v[46:47], v[46:47], v[94:95] op_sel:[0,1] op_sel_hi:[1,1]
v_pk_mul_f32 v[48:49], v[48:49], v[94:95] op_sel:[0,1] op_sel_hi:[1,1]
v_cvt_pk_bf16_f32 v58, v42, v43
v_cvt_pk_bf16_f32 v59, v44, v45
v_cvt_pk_bf16_f32 v60, v46, v47
v_cvt_pk_bf16_f32 v61, v48, v49
buffer_store_dwordx4 v[58:61], v1, s[4:7], s72 offen
v_pk_mul_f32 v[50:51], v[50:51], v[94:95] op_sel:[0,1] op_sel_hi:[1,1]
v_pk_mul_f32 v[52:53], v[52:53], v[94:95] op_sel:[0,1] op_sel_hi:[1,1]
v_pk_mul_f32 v[54:55], v[54:55], v[94:95] op_sel:[0,1] op_sel_hi:[1,1]
v_pk_mul_f32 v[56:57], v[56:57], v[94:95] op_sel:[0,1] op_sel_hi:[1,1]
v_cvt_pk_bf16_f32 v62, v50, v51
v_cvt_pk_bf16_f32 v63, v52, v53
v_cvt_pk_bf16_f32 v64, v54, v55
v_cvt_pk_bf16_f32 v65, v56, v57
v_cndmask_b32 v64, v64, 0, s[56:57]
v_cndmask_b32 v65, v65, 0, s[56:57]
buffer_store_dwordx4 v[62:65], v1, s[4:7], s72 offen offset:1024
s_add_u32 s60, s35, 10
v_mov_b32 v96, s60
s_mov_b64 exec, 1
s_waitcnt vmcnt(0)
buffer_store_dword v96, off, s[4:7], s41
s_mov_b64 exec, -1
s_cmp_ge_u32 s33, 14
s_cbranch_scc1 LR_156
s_and_b32 s61, s32, 1
s_lshl_b32 s62, s61, 6
s_mul_i32 s61, s61, 28672
s_add_u32 s61, s61, 86016
v_xor_b32 v142, s62, v5
v_xor_b32 v143, 64, v142
v_add_u32 v142, s61, v142
v_add_u32 v143, s61, v143
v_lshrrev_b32 v147, 5, v0
v_lshlrev_b32 v147, 9, v147
v_sub_u32 v144, v142, v147
v_sub_u32 v145, v143, v147
v_lshlrev_b32 v26, 16, v18
v_and_b32 v27, 0xffff0000, v18
v_lshlrev_b32 v28, 16, v19
v_and_b32 v29, 0xffff0000, v19
v_lshlrev_b32 v30, 16, v20
v_and_b32 v31, 0xffff0000, v20
v_lshlrev_b32 v32, 16, v21
v_and_b32 v33, 0xffff0000, v21
v_lshlrev_b32 v34, 16, v22
v_and_b32 v35, 0xffff0000, v22
v_lshlrev_b32 v36, 16, v23
v_and_b32 v37, 0xffff0000, v23
v_lshlrev_b32 v38, 16, v24
v_and_b32 v39, 0xffff0000, v24
v_lshlrev_b32 v40, 16, v25
v_and_b32 v41, 0xffff0000, v25
s_add_u32 s61, s89, 143360
v_add_u32 v148, s61, v1
s_xor_b32 s61, s89, 4096
s_add_u32 s61, s61, 143360
v_add_u32 v149, s61, v1
s_add_u32 s60, s35, 10
LP_158:
buffer_load_dword v152, v4, s[4:7], s40 offen sc1
s_sub_u32 s37, s37, 1
s_cmp_lt_i32 s37, 0
s_cbranch_scc1 LD_159
s_waitcnt vmcnt(0)
v_subrev_u32 v152, s60, v152
v_cmp_le_u32 vcc, 64, v152
s_and_b64 vcc, vcc, s[50:51]
s_cbranch_scc1 LP_158
LD_159:
s_add_u32 s65, s73, 0
buffer_load_dwordx4 v[58:61], v1, s[4:7], s65 offen offset:0 sc1
buffer_load_dwordx4 v[62:65], v1, s[4:7], s65 offen offset:1024 sc1
buffer_load_dwordx4 v[66:69], v1, s[4:7], s65 offen offset:2048 sc1
buffer_load_dwordx4 v[70:73], v1, s[4:7], s65 offen offset:3072 sc1
s_add_u32 s65, s73, 4096
buffer_load_dwordx4 v[74:77], v1, s[4:7], s65 offen offset:0 sc1
buffer_load_dwordx4 v[78:81], v1, s[4:7], s65 offen offset:1024 sc1
buffer_load_dwordx4 v[82:85], v1, s[4:7], s65 offen offset:2048 sc1
buffer_load_dwordx4 v[86:89], v1, s[4:7], s65 offen offset:3072 sc1
s_add_u32 s65, s73, 8192
buffer_load_dwordx4 v[90:93], v1, s[4:7], s65 offen offset:0 sc1
buffer_load_dwordx4 v[94:97], v1, s[4:7], s65 offen offset:1024 sc1
ds_read_b64_tr_b16 v[122:123], v143 offset:0
ds_read_b64_tr_b16 v[124:125], v143 offset:512
ds_read_b64_tr_b16 v[126:127], v142 offset:0
ds_read_b64_tr_b16 v[128:129], v142 offset:512
ds_read_b64_tr_b16 v[130:131], v143 offset:2048
ds_read_b64_tr_b16 v[132:133], v145 offset:2560
ds_read_b64_tr_b16 v[134:135], v142 offset:2048
ds_read_b64_tr_b16 v[136:137], v144 offset:2560
s_waitcnt vmcnt(9) lgkmcnt(6)
v_mfma_f32_32x32x16_bf16 v[42:57], v[122:125], v[58:61], 0
buffer_load_dwordx4 v[98:101], v1, s[4:7], s65 offen offset:2048 sc1
ds_read_b64_tr_b16 v[138:139], v143 offset:3584
ds_read_b64_tr_b16 v[140:141], v143 offset:4096
s_waitcnt lgkmcnt(6)
v_mfma_f32_32x32x16_bf16 v[26:41], v[126:129], v[58:61], v[26:41]
ds_read_b64_tr_b16 v[122:123], v142 offset:3584
ds_read_b64_tr_b16 v[124:125], v142 offset:4096
s_waitcnt vmcnt(9) lgkmcnt(6)
v_mfma_f32_32x32x16_bf16 v[42:57], v[130:133], v[62:65], v[42:57]
buffer_load_dwordx4 v[102:105], v1, s[4:7], s65 offen offset:3072 sc1
ds_read_b64_tr_b16 v[126:127], v143 offset:5632
ds_read_b64_tr_b16 v[128:129], v145 offset:6144
s_waitcnt lgkmcnt(6)
v_mfma_f32_32x32x16_bf16 v[26:41], v[134:137], v[62:65], v[26:41]
ds_read_b64_tr_b16 v[130:131], v142 offset:5632
ds_read_b64_tr_b16 v[132:133], v144 offset:6144
s_waitcnt vmcnt(9) lgkmcnt(6)
v_mfma_f32_32x32x16_bf16 v[42:57], v[138:141], v[66:69], v[42:57]
s_add_u32 s65, s73, 12288
buffer_load_dwordx4 v[106:109], v1, s[4:7], s65 offen offset:0 sc1
ds_read_b64_tr_b16 v[134:135], v143 offset:7168
ds_read_b64_tr_b16 v[136:137], v143 offset:7680
s_waitcnt lgkmcnt(6)
v_mfma_f32_32x32x16_bf16 v[26:41], v[122:125], v[66:69], v[26:41]
ds_read_b64_tr_b16 v[138:139], v142 offset:7168
ds_read_b64_tr_b16 v[140:141], v142 offset:7680
s_waitcnt vmcnt(9) lgkmcnt(6)
v_mfma_f32_32x32x16_bf16 v[42:57], v[126:129], v[70:73], v[42:57]
buffer_load_dwordx4 v[110:113], v1, s[4:7], s65 offen offset:1024 sc1
ds_read_b64_tr_b16 v[122:123], v143 offset:9216
ds_read_b64_tr_b16 v[124:125], v145 offset:9728
s_waitcnt lgkmcnt(6)
v_mfma_f32_32x32x16_bf16 v[26:41], v[130:133], v[70:73], v[26:41]
ds_read_b64_tr_b16 v[126:127], v142 offset:9216
ds_read_b64_tr_b16 v[128:129], v144 offset:9728
s_waitcnt vmcnt(9) lgkmcnt(6)
v_mfma_f32_32x32x16_bf16 v[42:57], v[134:137], v[74:77], v[42:57]
buffer_load_dwordx4 v[114:117], v1, s[4:7], s65 offen offset:2048 sc1
ds_read_b64_tr_b16 v[130:131], v143 offset:10752
ds_read_b64_tr_b16 v[132:133], v143 offset:11264
s_waitcnt lgkmcnt(6)
v_mfma_f32_32x32x16_bf16 v[26:41], v[138:141], v[74:77], v[26:41]
ds_read_b64_tr_b16 v[134:135], v142 offset:10752
ds_read_b64_tr_b16 v[136:137], v142 offset:11264
s_waitcnt vmcnt(9) lgkmcnt(6)
v_mfma_f32_32x32x16_bf16 v[42:57], v[122:125], v[78:81], v[42:57]
buffer_load_dwordx4 v[118:121], v1, s[4:7], s65 offen offset:3072 sc1
ds_read_b64_tr_b16 v[138:139], v143 offset:12800
ds_read_b64_tr_b16 v[140:141], v145 offset:13312
s_waitcnt lgkmcnt(6)
v_mfma_f32_32x32x16_bf16 v[26:41], v[126:129], v[78:81], v[26:41]
ds_read_b64_tr_b16 v[122:123], v142 offset:12800
ds_read_b64_tr_b16 v[124:125], v144 offset:13312
s_waitcnt vmcnt(9) lgkmcnt(6)
v_mfma_f32_32x32x16_bf16 v[42:57], v[130:133], v[82:85], v[42:57]
ds_read_b64_tr_b16 v[126:127], v143 offset:14336
ds_read_b64_tr_b16 v[128:129], v143 offset:14848
s_waitcnt lgkmcnt(6)
v_mfma_f32_32x32x16_bf16 v[26:41], v[134:137], v[82:85], v[26:41]
ds_read_b64_tr_b16 v[130:131], v142 offset:14336
ds_read_b64_tr_b16 v[132:133], v142 offset:14848
s_waitcnt vmcnt(8) lgkmcnt(6)
v_mfma_f32_32x32x16_bf16 v[42:57], v[138:141], v[86:89], v[42:57]
ds_read_b64_tr_b16 v[134:135], v143 offset:16384
ds_read_b64_tr_b16 v[136:137], v145 offset:16896
s_waitcnt lgkmcnt(6)
v_mfma_f32_32x32x16_bf16 v[26:41], v[122:125], v[86:89], v[26:41]
ds_read_b64_tr_b16 v[138:139], v142 offset:16384
ds_read_b64_tr_b16 v[140:141], v144 offset:16896
s_waitcnt vmcnt(7) lgkmcnt(6)
v_mfma_f32_32x32x16_bf16 v[42:57], v[126:129], v[90:93], v[42:57]
ds_read_b64_tr_b16 v[122:123], v143 offset:17920
ds_read_b64_tr_b16 v[124:125], v143 offset:18432
s_waitcnt lgkmcnt(6)
v_mfma_f32_32x32x16_bf16 v[26:41], v[130:133], v[90:93], v[26:41]
ds_read_b64_tr_b16 v[126:127], v143 offset:19968
ds_read_b64_tr_b16 v[128:129], v145 offset:20480
s_waitcnt vmcnt(6) lgkmcnt(6)
v_mfma_f32_32x32x16_bf16 v[42:57], v[134:137], v[94:97], v[42:57]
ds_read_b64_tr_b16 v[130:131], v143 offset:21504
ds_read_b64_tr_b16 v[132:133], v143 offset:22016
s_waitcnt lgkmcnt(6)
v_mfma_f32_32x32x16_bf16 v[26:41], v[138:141], v[94:97], v[26:41]
ds_read_b64_tr_b16 v[134:135], v143 offset:23552
ds_read_b64_tr_b16 v[136:137], v145 offset:24064
s_waitcnt vmcnt(5) lgkmcnt(6)
v_mfma_f32_32x32x16_bf16 v[42:57], v[122:125], v[98:101], v[42:57]
ds_read_b64_tr_b16 v[138:139], v143 offset:25088
ds_read_b64_tr_b16 v[140:141], v143 offset:25600
s_waitcnt vmcnt(4) lgkmcnt(6)
v_mfma_f32_32x32x16_bf16 v[42:57], v[126:129], v[102:105], v[42:57]
ds_read_b64_tr_b16 v[122:123], v143 offset:27136
ds_read_b64_tr_b16 v[124:125], v145 offset:27648
s_waitcnt vmcnt(3) lgkmcnt(6)
v_mfma_f32_32x32x16_bf16 v[42:57], v[130:133], v[106:109], v[42:57]
ds_read_b64_tr_b16 v[126:127], v142 offset:17920
ds_read_b64_tr_b16 v[128:129], v142 offset:18432
s_waitcnt vmcnt(2) lgkmcnt(6)
v_mfma_f32_32x32x16_bf16 v[42:57], v[134:137], v[110:113], v[42:57]
ds_read_b64_tr_b16 v[130:131], v142 offset:19968
ds_read_b64_tr_b16 v[132:133], v144 offset:20480
s_waitcnt vmcnt(1) lgkmcnt(6)
v_mfma_f32_32x32x16_bf16 v[42:57], v[138:141], v[114:117], v[42:57]
ds_read_b64_tr_b16 v[134:135], v142 offset:21504
ds_read_b64_tr_b16 v[136:137], v142 offset:22016
s_waitcnt vmcnt(0) lgkmcnt(6)
v_mfma_f32_32x32x16_bf16 v[42:57], v[122:125], v[118:121], v[42:57]
ds_read_b64_tr_b16 v[138:139], v142 offset:23552
ds_read_b64_tr_b16 v[140:141], v144 offset:24064
s_waitcnt lgkmcnt(6)
v_mfma_f32_32x32x16_bf16 v[26:41], v[126:129], v[98:101], v[26:41]
ds_read_b64_tr_b16 v[122:123], v142 offset:25088
ds_read_b64_tr_b16 v[124:125], v142 offset:25600
s_waitcnt lgkmcnt(6)
v_mfma_f32_32x32x16_bf16 v[26:41], v[130:133], v[102:105], v[26:41]
ds_read_b64_tr_b16 v[126:127], v142 offset:27136
L_hop7:
s_cbranch_execz L_hop11
ds_read_b64_tr_b16 v[128:129], v144 offset:27648
s_waitcnt lgkmcnt(6)
v_mfma_f32_32x32x16_bf16 v[26:41], v[134:137], v[106:109], v[26:41]
ds_write_b128 v148, v[42:45] offset:0
s_waitcnt lgkmcnt(5)
v_mfma_f32_32x32x16_bf16 v[26:41], v[138:141], v[110:113], v[26:41]
ds_write_b128 v148, v[46:49] offset:1024
s_waitcnt lgkmcnt(4)
v_mfma_f32_32x32x16_bf16 v[26:41], v[122:125], v[114:117], v[26:41]
ds_write_b128 v148, v[50:53] offset:2048
s_waitcnt lgkmcnt(3)
v_mfma_f32_32x32x16_bf16 v[26:41], v[126:129], v[118:121], v[26:41]
ds_write_b128 v148, v[54:57] offset:3072
s_waitcnt lgkmcnt(0)
s_barrier
ds_read_b128 v[58:61], v149 offset:0
ds_read_b128 v[62:65], v149 offset:1024
ds_read_b128 v[66:69], v149 offset:2048
ds_read_b128 v[70:73], v149 offset:3072
s_waitcnt lgkmcnt(3)
s_nop 3
v_pk_add_f32 v[26:27], v[26:27], v[58:59]
v_pk_add_f32 v[28:29], v[28:29], v[60:61]
v_cvt_pk_bf16_f32 v18, v26, v27
v_cvt_pk_bf16_f32 v19, v28, v29
s_waitcnt lgkmcnt(2)
v_pk_add_f32 v[30:31], v[30:31], v[62:63]
v_pk_add_f32 v[32:33], v[32:33], v[64:65]
v_cvt_pk_bf16_f32 v20, v30, v31
v_cvt_pk_bf16_f32 v21, v32, v33
s_waitcnt lgkmcnt(1)
v_pk_add_f32 v[34:35], v[34:35], v[66:67]
v_pk_add_f32 v[36:37], v[36:37], v[68:69]
v_cvt_pk_bf16_f32 v22, v34, v35
v_cvt_pk_bf16_f32 v23, v36, v37
s_waitcnt lgkmcnt(0)
v_pk_add_f32 v[38:39], v[38:39], v[70:71]
v_pk_add_f32 v[40:41], v[40:41], v[72:73]
v_cvt_pk_bf16_f32 v24, v38, v39
v_cvt_pk_bf16_f32 v25, v40, v41
buffer_store_dwordx4 v[18:21], v1, s[4:7], s44 offen
buffer_store_dwordx4 v[22:25], v1, s[4:7], s44 offen offset:1024
v_dot2_f32_bf16 v146, s88, v18, 0
v_dot2_f32_bf16 v147, v18, v18, 0
v_dot2_f32_bf16 v146, s88, v19, v146
v_dot2_f32_bf16 v147, v19, v19, v147
v_dot2_f32_bf16 v146, s88, v20, v146
v_dot2_f32_bf16 v147, v20, v20, v147
v_dot2_f32_bf16 v146, s88, v21, v146
v_dot2_f32_bf16 v147, v21, v21, v147
v_dot2_f32_bf16 v146, s88, v22, v146
v_dot2_f32_bf16 v147, v22, v22, v147
v_dot2_f32_bf16 v146, s88, v23, v146
v_dot2_f32_bf16 v147, v23, v23, v147
v_dot2_f32_bf16 v146, s88, v24, v146
v_dot2_f32_bf16 v147, v24, v24, v147
v_dot2_f32_bf16 v146, s88, v25, v146
v_dot2_f32_bf16 v147, v25, v25, v147
s_nop 1
v_mov_b32 v148, v146
v_mov_b32 v149, v147
s_nop 0
v_permlane32_swap_b32 v146, v148
v_permlane32_swap_b32 v147, v149
s_mov_b32 exec_hi, 0
v_pk_add_f32 v[146:147], v[146:147], v[148:149]
buffer_store_dwordx2 v[146:147], v1, s[4:7], s45 offen
s_mov_b64 exec, -1
s_add_u32 s60, s35, 11
v_mov_b32 v150, s60
s_mov_b64 exec, 1
s_waitcnt vmcnt(0)
buffer_store_dword v150, off, s[4:7], s41
s_mov_b64 exec, -1
v_lshrrev_b32 v126, 5, v0
v_mul_u32_u24 v126, 1536, v126
v_add_u32 v126, v1, v126
v_add_u32 v109, 114688, v1
v_add_u32 v110, 86016, v1
v_lshlrev_b32 v108, 3, v0
v_add_u32 v108, 161792, v108
s_lshr_b32 s61, s89, 3
v_add_u32 v111, s61, v108
v_mov_b32 v106, s82
v_mov_b32 v90, 0
v_mov_b32 v91, 0
s_lshr_b32 s66, s89, 1
s_add_u32 s67, s66, s77
s_add_u32 s60, s35, 11
LP_160:
buffer_load_dword v94, v4, s[4:7], s40 offen sc1
s_sub_u32 s37, s37, 1
s_cmp_lt_i32 s37, 0
s_cbranch_scc1 LD_161
s_waitcnt vmcnt(0)
v_subrev_u32 v94, s60, v94
v_cmp_le_u32 vcc, 64, v94
s_and_b64 vcc, vcc, s[48:49]
s_cbranch_scc1 LP_160
LD_161:
s_add_u32 m0, s66, 114688
s_add_u32 s63, s67, 0
buffer_load_dwordx4 v1, s[4:7], s63 offen offset:0 sc1 lds
buffer_load_dwordx4 v1, s[4:7], s63 offen offset:1024 sc1 lds
s_add_u32 m0, s66, 122880
s_add_u32 s63, s67, 8192
buffer_load_dwordx4 v1, s[4:7], s63 offen offset:0 sc1 lds
buffer_load_dwordx4 v1, s[4:7], s63 offen offset:1024 sc1 lds
s_add_u32 m0, s66, 131072
s_add_u32 s63, s67, 16384
buffer_load_dwordx4 v1, s[4:7], s63 offen offset:0 sc1 lds
buffer_load_dwordx4 v1, s[4:7], s63 offen offset:1024 sc1 lds
s_lshr_b32 s62, s89, 2
s_add_u32 m0, s62, 139264
s_add_u32 s63, s62, s77
s_add_u32 s63, s63, 24576
buffer_load_dwordx4 v1, s[4:7], s63 offen offset:0 sc1 lds
s_waitcnt vmcnt(5)
s_barrier
ds_read_b128 v[42:45], v109 offset:0
ds_read_b128 v[46:49], v109 offset:1024
ds_read_b128 v[50:53], v109 offset:2048
ds_read_b128 v[54:57], v109 offset:3072
ds_read_b128 v[74:77], v109 offset:4096
ds_read_b128 v[78:81], v109 offset:5120
s_waitcnt lgkmcnt(2)
v_mfma_f32_32x32x16_bf16 v[26:41], a[224:227], v[42:45], 0
buffer_load_dwordx4 v[112:115], v126, s[4:7], s71 offen offset:0 sc1
ds_read_b128 v[168:171], v109 offset:6144
v_mfma_f32_32x32x16_bf16 v[26:41], a[228:231], v[46:49], v[26:41]
buffer_load_dwordx4 v[116:119], v126, s[4:7], s71 offen offset:512 sc1
s_waitcnt vmcnt(5)
s_barrier
ds_read_b128 v[172:175], v109 offset:7168
v_mfma_f32_32x32x16_bf16 v[26:41], a[232:235], v[50:53], v[26:41]
buffer_load_dwordx4 v[120:123], v126, s[4:7], s71 offen offset:1024 sc1
ds_read_b128 v[160:163], v109 offset:8192
v_mfma_f32_32x32x16_bf16 v[26:41], a[236:239], v[54:57], v[26:41]
buffer_load_dwordx4 v[124:127], v126, s[4:7], s71 offen offset:1536 sc1
ds_read_b128 v[164:167], v109 offset:9216
s_waitcnt lgkmcnt(2)
v_mfma_f32_32x32x16_bf16 v[26:41], a[240:243], v[74:77], v[26:41]
s_add_u32 m0, s66, 86016
s_add_u32 s63, s67, 57344
ds_read_b128 v[42:45], v109 offset:10240
v_mfma_f32_32x32x16_bf16 v[26:41], a[244:247], v[78:81], v[26:41]
buffer_load_dwordx4 v1, s[4:7], s63 offen offset:0 sc1 lds
ds_read_b128 v[46:49], v109 offset:11264
v_mfma_f32_32x32x16_bf16 v[26:41], a[248:251], v[168:171], v[26:41]
ds_read_b128 v[50:53], v109 offset:12288
v_mfma_f32_32x32x16_bf16 v[26:41], a[252:255], v[172:175], v[26:41]
buffer_load_dwordx4 v1, s[4:7], s63 offen offset:1024 sc1 lds
ds_read_b128 v[54:57], v109 offset:13312
s_waitcnt lgkmcnt(2)
v_mfma_f32_32x32x16_bf16 v[26:41], v[176:179], v[160:163], v[26:41]
s_add_u32 m0, s66, 94208
s_add_u32 s63, s67, 65536
ds_read_b128 v[74:77], v109 offset:14336
v_mfma_f32_32x32x16_bf16 v[26:41], v[180:183], v[164:167], v[26:41]
s_waitcnt vmcnt(6)
s_barrier
buffer_load_dwordx4 v1, s[4:7], s63 offen offset:0 sc1 lds
ds_read_b128 v[78:81], v109 offset:15360
v_mfma_f32_32x32x16_bf16 v[26:41], v[184:187], v[42:45], v[26:41]
ds_read_b128 v[168:171], v109 offset:16384
v_mfma_f32_32x32x16_bf16 v[26:41], v[188:191], v[46:49], v[26:41]
buffer_load_dwordx4 v1, s[4:7], s63 offen offset:1024 sc1 lds
ds_read_b128 v[172:175], v109 offset:17408
s_waitcnt vmcnt(4)
v_add_f32 v112, v112, v114
v_add_f32 v113, v113, v115
v_add_f32 v116, v116, v118
v_add_f32 v117, v117, v119
v_add_f32 v120, v120, v122
s_waitcnt lgkmcnt(2)
v_mfma_f32_32x32x16_bf16 v[26:41], v[192:195], v[50:53], v[26:41]
s_add_u32 m0, s66, 102400
s_add_u32 s63, s67, 73728
ds_read_b128 v[160:163], v109 offset:18432
v_add_f32 v121, v121, v123
v_add_f32 v124, v124, v126
v_add_f32 v125, v125, v127
v_cndmask_b32 v124, v124, 0, s[56:57]
v_cndmask_b32 v125, v125, 0, s[56:57]
v_add_f32 v112, v112, v116
v_mfma_f32_32x32x16_bf16 v[26:41], v[196:199], v[54:57], v[26:41]
buffer_load_dwordx4 v1, s[4:7], s63 offen offset:0 sc1 lds
ds_read_b128 v[164:167], v109 offset:19456
v_add_f32 v113, v113, v117
v_add_f32 v120, v120, v124
v_add_f32 v121, v121, v125
v_add_f32 v112, v112, v120
v_add_f32 v113, v113, v121
v_mov_b32 v114, v112
v_mfma_f32_32x32x16_bf16 v[26:41], v[200:203], v[74:77], v[26:41]
ds_read_b128 v[42:45], v109 offset:20480
v_mov_b32 v115, v113
v_mov_b32 v84, 0
v_mov_b32 v85, 0
v_permlane32_swap_b32 v112, v114
v_permlane32_swap_b32 v113, v115
v_mfma_f32_32x32x16_bf16 v[26:41], v[204:207], v[78:81], v[26:41]
buffer_load_dwordx4 v1, s[4:7], s63 offen offset:1024 sc1 lds
ds_read_b128 v[46:49], v109 offset:21504
v_add_f32 v112, v112, v114
v_add_f32 v113, v113, v115
v_mul_f32 v114, 0x3b124925, v112
v_mul_f32 v113, 0x3b124925, v113
v_fmamk_f32 v112, v114, 0xc3e00000, v112
s_waitcnt lgkmcnt(2)
v_mfma_f32_32x32x16_bf16 v[26:41], v[208:211], v[168:171], v[26:41]
s_lshr_b32 s62, s89, 2
s_add_u32 m0, s62, 110592
s_add_u32 s63, s62, s77
s_add_u32 s63, s63, 81920
ds_read_b128 v[50:53], v109 offset:22528
v_fmamk_f32 v112, v112, 0x3b124925, v114
v_fma_f32 v113, -v112, v112, v113
v_max_f32 v113, 0, v113
v_cvt_pk_bf16_f32 v114, -v112, v113
v_and_b32 v113, 0xffff0000, v114
v_mfma_f32_32x32x16_bf16 v[26:41], v[212:215], v[172:175], v[26:41]
buffer_load_dwordx4 v1, s[4:7], s63 offen offset:0 sc1 lds
ds_read_b128 v[54:57], v109 offset:23552
v_and_b32 v114, 0xffff, v114
v_add_f32 v113, 0x3727c5ac, v113
v_cndmask_b32 v83, v114, 0, s[56:57]
v_cvt_pk_bf16_f32 v113, v113, v113
v_lshl_or_b32 v82, v83, 16, v83
v_mfma_f32_32x32x16_bf16 v[26:41], v[216:219], v[160:163], v[26:41]
ds_read_b128 v[74:77], v109 offset:24576
v_and_b32 v113, 0xffff0000, v113
v_sqrt_f32 v113, v113
s_nop 0
v_cvt_pk_bf16_f32 v113, v113, v113
v_and_b32 v113, 0xffff0000, v113
v_mfma_f32_32x32x16_bf16 v[26:41], v[220:223], v[164:167], v[26:41]
ds_read_b128 v[78:81], v109 offset:25600
v_rcp_f32 v112, v113
s_nop 0
v_mul_f32 v113, 0x3fb8aa3b, v112
v_mov_b32 v112, v82
ds_write_b64 v111, v[112:113]
s_waitcnt lgkmcnt(3)
v_mfma_f32_32x32x16_bf16 v[26:41], v[224:227], v[42:45], v[26:41]
ds_read_b128 v[168:171], v109 offset:26624
v_mfma_f32_32x32x16_bf16 v[26:41], v[228:231], v[46:49], v[26:41]
s_waitcnt vmcnt(5) lgkmcnt(0)
s_barrier
ds_read_b128 v[172:175], v109 offset:27648
v_mfma_f32_32x32x16_bf16 v[26:41], v[232:235], v[50:53], v[26:41]
ds_read_b128 v[160:163], v110 offset:0
v_mfma_f32_32x32x16_bf16 v[26:41], v[236:239], v[54:57], v[26:41]
ds_read_b128 v[164:167], v110 offset:1024
s_waitcnt lgkmcnt(2)
v_mfma_f32_32x32x16_bf16 v[26:41], v[240:243], v[74:77], v[26:41]
s_waitcnt vmcnt(0)
s_barrier
ds_read_b64 v[86:87], v108 offset:0
ds_read_b128 v[42:45], v110 offset:2048
v_mfma_f32_32x32x16_bf16 v[26:41], v[244:247], v[78:81], v[26:41]
s_add_u32 m0, s66, 114688
s_add_u32 s63, s67, 28672
buffer_load_dwordx4 v1, s[4:7], s63 offen offset:0 sc1 lds
ds_read_b128 v[46:49], v110 offset:3072
v_mfma_f32_32x32x16_bf16 v[26:41], v[248:251], v[168:171], v[26:41]
s_waitcnt lgkmcnt(2)
v_mov_b32 v82, v86
v_and_b32 v83, 0xffff, v86
ds_read_b128 v[50:53], v110 offset:4096
v_mfma_f32_32x32x16_bf16 v[26:41], v[252:255], v[172:175], v[26:41]
buffer_load_dwordx4 v1, s[4:7], s63 offen offset:1024 sc1 lds
s_add_u32 m0, s66, 122880
s_add_u32 s63, s67, 36864
ds_read_b128 v[54:57], v110 offset:5120
v_mfma_f32_32x32x16_bf16 v[26:41], v[14:17], v[82:85], v[26:41]
buffer_load_dwordx4 v1, s[4:7], s63 offen offset:0 sc1 lds
s_waitcnt lgkmcnt(2)
v_mfma_f32_32x32x16_bf16 v[58:73], a[224:227], v[160:163], 0
buffer_load_dwordx4 v1, s[4:7], s63 offen offset:1024 sc1 lds
s_add_u32 m0, s66, 131072
s_add_u32 s63, s67, 45056
ds_read_b128 v[74:77], v110 offset:6144
v_mfma_f32_32x32x16_bf16 v[58:73], a[228:231], v[164:167], v[58:73]
buffer_load_dwordx4 v1, s[4:7], s63 offen offset:0 sc1 lds
ds_read_b128 v[78:81], v110 offset:7168
v_mfma_f32_32x32x16_bf16 v[58:73], a[232:235], v[42:45], v[58:73]
ds_read_b128 v[168:171], v110 offset:8192
v_mul_f32 v26, v26, v87
v_exp_f32 v102, -v26
v_mul_f32 v27, v27, v87
v_fma_f32 v102, v102, v106, v106
v_mfma_f32_32x32x16_bf16 v[58:73], a[236:239], v[46:49], v[58:73]
buffer_load_dwordx4 v1, s[4:7], s63 offen offset:1024 sc1 lds
ds_read_b128 v[172:175], v110 offset:9216
v_exp_f32 v103, -v27
v_mul_f32 v28, v28, v87
v_rcp_f32 v102, v102
s_waitcnt lgkmcnt(2)
v_mfma_f32_32x32x16_bf16 v[58:73], a[240:243], v[50:53], v[58:73]
s_lshr_b32 s62, s89, 2
s_add_u32 m0, s62, 139264
s_add_u32 s63, s62, s77
s_add_u32 s63, s63, 53248
ds_read_b128 v[160:163], v110 offset:10240
v_fma_f32 v103, v103, v106, v106
v_exp_f32 v104, -v28
v_mul_f32 v29, v29, v87
v_mul_f32 v26, v26, v102
v_mfma_f32_32x32x16_bf16 v[58:73], a[244:247], v[54:57], v[58:73]
buffer_load_dwordx4 v1, s[4:7], s63 offen offset:0 sc1 lds
ds_read_b128 v[164:167], v110 offset:11264
v_rcp_f32 v103, v103
v_fma_f32 v104, v104, v106, v106
v_exp_f32 v105, -v29
v_mfma_f32_32x32x16_bf16 v[58:73], a[248:251], v[74:77], v[58:73]
ds_read_b128 v[42:45], v110 offset:12288
v_mul_f32 v30, v30, v87
v_mul_f32 v27, v27, v103
v_rcp_f32 v104, v104
v_fma_f32 v105, v105, v106, v106
v_mfma_f32_32x32x16_bf16 v[58:73], a[252:255], v[78:81], v[58:73]
ds_read_b128 v[46:49], v110 offset:13312
v_exp_f32 v102, -v30
v_mul_f32 v31, v31, v87
v_mul_f32 v28, v28, v104
v_rcp_f32 v105, v105
s_waitcnt lgkmcnt(2)
v_mfma_f32_32x32x16_bf16 v[58:73], v[176:179], v[168:171], v[58:73]
ds_read_b128 v[50:53], v110 offset:14336
v_fma_f32 v102, v102, v106, v106
v_exp_f32 v103, -v31
v_mul_f32 v32, v32, v87
v_cvt_pk_bf16_f32 v94, v26, v27
v_mfma_f32_32x32x16_bf16 v[58:73], v[180:183], v[172:175], v[58:73]
ds_read_b128 v[54:57], v110 offset:15360
v_mul_f32 v29, v29, v105
v_rcp_f32 v102, v102
v_fma_f32 v103, v103, v106, v106
v_exp_f32 v104, -v32
v_mfma_f32_32x32x16_bf16 v[58:73], v[184:187], v[160:163], v[58:73]
ds_read_b128 v[74:77], v110 offset:16384
v_mul_f32 v33, v33, v87
v_mul_f32 v30, v30, v102
v_rcp_f32 v103, v103
v_fma_f32 v104, v104, v106, v106
v_mfma_f32_32x32x16_bf16 v[58:73], v[188:191], v[164:167], v[58:73]
ds_read_b128 v[78:81], v110 offset:17408
v_exp_f32 v105, -v33
v_mul_f32 v34, v34, v87
v_cvt_pk_bf16_f32 v95, v28, v29
v_mul_f32 v31, v31, v103
s_waitcnt lgkmcnt(2)
v_mfma_f32_32x32x16_bf16 v[58:73], v[192:195], v[42:45], v[58:73]
ds_read_b128 v[168:171], v110 offset:18432
v_rcp_f32 v104, v104
v_fma_f32 v105, v105, v106, v106
v_exp_f32 v102, -v34
v_mfma_f32_32x32x16_bf16 v[58:73], v[196:199], v[46:49], v[58:73]
ds_read_b128 v[172:175], v110 offset:19456
v_mul_f32 v35, v35, v87
v_mul_f32 v32, v32, v104
v_rcp_f32 v105, v105
v_fma_f32 v102, v102, v106, v106
v_mfma_f32_32x32x16_bf16 v[58:73], v[200:203], v[50:53], v[58:73]
ds_read_b128 v[160:163], v110 offset:20480
v_exp_f32 v103, -v35
v_mul_f32 v36, v36, v87
v_cvt_pk_bf16_f32 v96, v30, v31
v_mul_f32 v33, v33, v105
v_mfma_f32_32x32x16_bf16 v[58:73], v[204:207], v[54:57], v[58:73]
ds_read_b128 v[164:167], v110 offset:21504
v_rcp_f32 v102, v102
v_fma_f32 v103, v103, v106, v106
v_exp_f32 v104, -v36
s_waitcnt lgkmcnt(2)
v_mfma_f32_32x32x16_bf16 v[58:73], v[208:211], v[74:77], v[58:73]
ds_read_b128 v[42:45], v110 offset:22528
v_mul_f32 v37, v37, v87
v_mul_f32 v34, v34, v102
v_rcp_f32 v103, v103
v_fma_f32 v104, v104, v106, v106
v_mfma_f32_32x32x16_bf16 v[58:73], v[212:215], v[78:81], v[58:73]
ds_read_b128 v[46:49], v110 offset:23552
v_exp_f32 v105, -v37
v_mul_f32 v38, v38, v87
v_cvt_pk_bf16_f32 v97, v32, v33
s_add_u32 s61, s74, 0
v_mfma_f32_32x32x16_bf16 v[58:73], v[216:219], v[168:171], v[58:73]
buffer_store_dwordx4 v[94:97], v1, s[4:7], s61 offen
ds_read_b128 v[50:53], v110 offset:24576
v_mul_f32 v35, v35, v103
v_rcp_f32 v104, v104
v_fma_f32 v105, v105, v106, v106
v_mfma_f32_32x32x16_bf16 v[58:73], v[220:223], v[172:175], v[58:73]
ds_read_b128 v[54:57], v110 offset:25600
v_exp_f32 v102, -v38
v_mul_f32 v39, v39, v87
v_mul_f32 v36, v36, v104
s_waitcnt lgkmcnt(2)
v_mfma_f32_32x32x16_bf16 v[58:73], v[224:227], v[160:163], v[58:73]
ds_read_b128 v[74:77], v110 offset:26624
v_rcp_f32 v105, v105
v_fma_f32 v102, v102, v106, v106
v_exp_f32 v103, -v39
v_mfma_f32_32x32x16_bf16 v[58:73], v[228:231], v[164:167], v[58:73]
s_waitcnt vmcnt(6)
s_barrier
ds_read_b128 v[78:81], v110 offset:27648
v_mul_f32 v40, v40, v87
v_cvt_pk_bf16_f32 v98, v34, v35
v_mul_f32 v37, v37, v105
v_rcp_f32 v102, v102
v_mfma_f32_32x32x16_bf16 v[58:73], v[232:235], v[42:45], v[58:73]
ds_read_b128 v[168:171], v109 offset:0
v_fma_f32 v103, v103, v106, v106
v_exp_f32 v104, -v40
v_mul_f32 v41, v41, v87
v_mul_f32 v38, v38, v102
v_mfma_f32_32x32x16_bf16 v[58:73], v[236:239], v[46:49], v[58:73]
ds_read_b128 v[172:175], v109 offset:1024
v_rcp_f32 v103, v103
v_fma_f32 v104, v104, v106, v106
v_exp_f32 v105, -v41
s_waitcnt lgkmcnt(2)
v_mfma_f32_32x32x16_bf16 v[58:73], v[240:243], v[50:53], v[58:73]
s_waitcnt vmcnt(1)
s_barrier
ds_read_b64 v[92:93], v108 offset:1024
ds_read_b128 v[160:163], v109 offset:2048
v_cvt_pk_bf16_f32 v99, v36, v37
v_mul_f32 v39, v39, v103
v_rcp_f32 v104, v104
v_mfma_f32_32x32x16_bf16 v[58:73], v[244:247], v[54:57], v[58:73]
s_add_u32 m0, s66, 86016
s_add_u32 s63, s67, 86016
buffer_load_dwordx4 v1, s[4:7], s63 offen offset:0 sc1 lds
ds_read_b128 v[164:167], v109 offset:3072
v_fma_f32 v105, v105, v106, v106
v_mul_f32 v40, v40, v104
v_rcp_f32 v105, v105
v_mfma_f32_32x32x16_bf16 v[58:73], v[248:251], v[74:77], v[58:73]
s_waitcnt lgkmcnt(2)
v_mov_b32 v88, v92
v_and_b32 v89, 0xffff, v92
ds_read_b128 v[42:45], v109 offset:4096
v_cvt_pk_bf16_f32 v100, v38, v39
v_mul_f32 v41, v41, v105
v_mfma_f32_32x32x16_bf16 v[58:73], v[252:255], v[78:81], v[58:73]
buffer_load_dwordx4 v1, s[4:7], s63 offen offset:1024 sc1 lds
s_add_u32 m0, s66, 94208
s_add_u32 s63, s67, 94208
ds_read_b128 v[46:49], v109 offset:5120
v_cvt_pk_bf16_f32 v101, v40, v41
v_mfma_f32_32x32x16_bf16 v[58:73], v[14:17], v[88:91], v[58:73]
buffer_store_dwordx4 v[98:101], v1, s[4:7], s61 offen offset:1024
buffer_load_dwordx4 v1, s[4:7], s63 offen offset:0 sc1 lds
s_waitcnt lgkmcnt(2)
v_mfma_f32_32x32x16_bf16 v[26:41], a[224:227], v[168:171], 0
buffer_load_dwordx4 v1, s[4:7], s63 offen offset:1024 sc1 lds
s_add_u32 m0, s66, 102400
s_add_u32 s63, s67, 102400
ds_read_b128 v[50:53], v109 offset:6144
v_mfma_f32_32x32x16_bf16 v[26:41], a[228:231], v[172:175], v[26:41]
buffer_load_dwordx4 v1, s[4:7], s63 offen offset:0 sc1 lds
ds_read_b128 v[54:57], v109 offset:7168
v_mfma_f32_32x32x16_bf16 v[26:41], a[232:235], v[160:163], v[26:41]
ds_read_b128 v[74:77], v109 offset:8192
v_mul_f32 v58, v58, v93
v_exp_f32 v102, -v58
v_mul_f32 v59, v59, v93
v_fma_f32 v102, v102, v106, v106
v_mfma_f32_32x32x16_bf16 v[26:41], a[236:239], v[164:167], v[26:41]
buffer_load_dwordx4 v1, s[4:7], s63 offen offset:1024 sc1 lds
ds_read_b128 v[78:81], v109 offset:9216
v_exp_f32 v103, -v59
v_mul_f32 v60, v60, v93
v_rcp_f32 v102, v102
s_waitcnt lgkmcnt(2)
v_mfma_f32_32x32x16_bf16 v[26:41], a[240:243], v[42:45], v[26:41]
s_lshr_b32 s62, s89, 2
s_add_u32 m0, s62, 110592
s_add_u32 s63, s62, s77
s_add_u32 s63, s63, 110592
ds_read_b128 v[168:171], v109 offset:10240
v_fma_f32 v103, v103, v106, v106
v_exp_f32 v104, -v60
v_mul_f32 v61, v61, v93
v_mul_f32 v58, v58, v102
v_mfma_f32_32x32x16_bf16 v[26:41], a[244:247], v[46:49], v[26:41]
buffer_load_dwordx4 v1, s[4:7], s63 offen offset:0 sc1 lds
ds_read_b128 v[172:175], v109 offset:11264
v_rcp_f32 v103, v103
v_fma_f32 v104, v104, v106, v106
v_exp_f32 v105, -v61
v_mfma_f32_32x32x16_bf16 v[26:41], a[248:251], v[50:53], v[26:41]
ds_read_b128 v[160:163], v109 offset:12288
v_mul_f32 v62, v62, v93
v_mul_f32 v59, v59, v103
v_rcp_f32 v104, v104
v_fma_f32 v105, v105, v106, v106
v_mfma_f32_32x32x16_bf16 v[26:41], a[252:255], v[54:57], v[26:41]
ds_read_b128 v[164:167], v109 offset:13312
v_exp_f32 v102, -v62
v_mul_f32 v63, v63, v93
v_mul_f32 v60, v60, v104
v_rcp_f32 v105, v105
s_waitcnt lgkmcnt(2)
v_mfma_f32_32x32x16_bf16 v[26:41], v[176:179], v[74:77], v[26:41]
s_add_u32 s60, s35, 12
v_mov_b32 v107, s60
ds_read_b128 v[42:45], v109 offset:14336
v_fma_f32 v102, v102, v106, v106
v_exp_f32 v103, -v63
v_mul_f32 v64, v64, v93
v_cvt_pk_bf16_f32 v94, v58, v59
v_mfma_f32_32x32x16_bf16 v[26:41], v[180:183], v[78:81], v[26:41]
s_waitcnt vmcnt(5)
s_mov_b64 exec, 1
buffer_store_dword v107, off, s[4:7], s41
s_mov_b64 exec, -1
ds_read_b128 v[46:49], v109 offset:15360
v_mul_f32 v61, v61, v105
v_rcp_f32 v102, v102
v_fma_f32 v103, v103, v106, v106
v_exp_f32 v104, -v64
v_mfma_f32_32x32x16_bf16 v[26:41], v[184:187], v[168:171], v[26:41]
ds_read_b128 v[50:53], v109 offset:16384
v_mul_f32 v65, v65, v93
v_mul_f32 v62, v62, v102
v_rcp_f32 v103, v103
v_fma_f32 v104, v104, v106, v106
v_mfma_f32_32x32x16_bf16 v[26:41], v[188:191], v[172:175], v[26:41]
ds_read_b128 v[54:57], v109 offset:17408
v_exp_f32 v105, -v65
v_mul_f32 v66, v66, v93
v_cvt_pk_bf16_f32 v95, v60, v61
v_mul_f32 v63, v63, v103
s_waitcnt lgkmcnt(2)
v_mfma_f32_32x32x16_bf16 v[26:41], v[192:195], v[160:163], v[26:41]
ds_read_b128 v[74:77], v109 offset:18432
v_rcp_f32 v104, v104
v_fma_f32 v105, v105, v106, v106
v_exp_f32 v102, -v66
v_mfma_f32_32x32x16_bf16 v[26:41], v[196:199], v[164:167], v[26:41]
ds_read_b128 v[78:81], v109 offset:19456
v_mul_f32 v67, v67, v93
v_mul_f32 v64, v64, v104
v_rcp_f32 v105, v105
v_fma_f32 v102, v102, v106, v106
v_mfma_f32_32x32x16_bf16 v[26:41], v[200:203], v[42:45], v[26:41]
ds_read_b128 v[168:171], v109 offset:20480
v_exp_f32 v103, -v67
v_mul_f32 v68, v68, v93
v_cvt_pk_bf16_f32 v96, v62, v63
v_mul_f32 v65, v65, v105
v_mfma_f32_32x32x16_bf16 v[26:41], v[204:207], v[46:49], v[26:41]
ds_read_b128 v[172:175], v109 offset:21504
v_rcp_f32 v102, v102
v_fma_f32 v103, v103, v106, v106
v_exp_f32 v104, -v68
s_waitcnt lgkmcnt(2)
v_mfma_f32_32x32x16_bf16 v[26:41], v[208:211], v[50:53], v[26:41]
ds_read_b128 v[160:163], v109 offset:22528
v_mul_f32 v69, v69, v93
v_mul_f32 v66, v66, v102
v_rcp_f32 v103, v103
v_fma_f32 v104, v104, v106, v106
v_mfma_f32_32x32x16_bf16 v[26:41], v[212:215], v[54:57], v[26:41]
ds_read_b128 v[164:167], v109 offset:23552
v_exp_f32 v105, -v69
v_mul_f32 v70, v70, v93
v_cvt_pk_bf16_f32 v97, v64, v65
s_add_u32 s61, s74, 229376
v_mfma_f32_32x32x16_bf16 v[26:41], v[216:219], v[74:77], v[26:41]
buffer_store_dwordx4 v[94:97], v1, s[4:7], s61 offen
ds_read_b128 v[42:45], v109 offset:24576
v_mul_f32 v67, v67, v103
v_rcp_f32 v104, v104
v_fma_f32 v105, v105, v106, v106
v_mfma_f32_32x32x16_bf16 v[26:41], v[220:223], v[78:81], v[26:41]
ds_read_b128 v[46:49], v109 offset:25600
v_exp_f32 v102, -v70
v_mul_f32 v71, v71, v93
v_mul_f32 v68, v68, v104
s_waitcnt lgkmcnt(2)
v_mfma_f32_32x32x16_bf16 v[26:41], v[224:227], v[168:171], v[26:41]
ds_read_b128 v[50:53], v109 offset:26624
v_rcp_f32 v105, v105
v_fma_f32 v102, v102, v106, v106
v_exp_f32 v103, -v71
v_mfma_f32_32x32x16_bf16 v[26:41], v[228:231], v[172:175], v[26:41]
s_waitcnt vmcnt(8)
s_barrier
ds_read_b128 v[54:57], v109 offset:27648
v_mul_f32 v72, v72, v93
v_cvt_pk_bf16_f32 v98, v66, v67
v_mul_f32 v69, v69, v105
v_rcp_f32 v102, v102
v_mfma_f32_32x32x16_bf16 v[26:41], v[232:235], v[160:163], v[26:41]
ds_read_b128 v[74:77], v110 offset:0
v_fma_f32 v103, v103, v106, v106
v_exp_f32 v104, -v72
v_mul_f32 v73, v73, v93
v_mul_f32 v70, v70, v102
v_mfma_f32_32x32x16_bf16 v[26:41], v[236:239], v[164:167], v[26:41]
ds_read_b128 v[78:81], v110 offset:1024
v_rcp_f32 v103, v103
v_fma_f32 v104, v104, v106, v106
v_exp_f32 v105, -v73
s_waitcnt lgkmcnt(2)
v_mfma_f32_32x32x16_bf16 v[26:41], v[240:243], v[42:45], v[26:41]
s_waitcnt vmcnt(2)
s_barrier
ds_read_b64 v[86:87], v108 offset:512
ds_read_b128 v[168:171], v110 offset:2048
v_cvt_pk_bf16_f32 v99, v68, v69
v_mul_f32 v71, v71, v103
v_rcp_f32 v104, v104
v_mfma_f32_32x32x16_bf16 v[26:41], v[244:247], v[46:49], v[26:41]
ds_read_b128 v[172:175], v110 offset:3072
v_fma_f32 v105, v105, v106, v106
v_mul_f32 v72, v72, v104
v_rcp_f32 v105, v105
v_cvt_pk_bf16_f32 v100, v70, v71
v_mfma_f32_32x32x16_bf16 v[26:41], v[248:251], v[50:53], v[26:41]
L_hop8:
s_cbranch_execz L_hop12
s_waitcnt lgkmcnt(2)
v_mov_b32 v82, v86
v_and_b32 v83, 0xffff, v86
ds_read_b128 v[160:163], v110 offset:4096
v_mul_f32 v73, v73, v105
v_cvt_pk_bf16_f32 v101, v72, v73
v_mfma_f32_32x32x16_bf16 v[26:41], v[252:255], v[54:57], v[26:41]
buffer_store_dwordx4 v[98:101], v1, s[4:7], s61 offen offset:1024
ds_read_b128 v[164:167], v110 offset:5120
v_mfma_f32_32x32x16_bf16 v[26:41], v[14:17], v[82:85], v[26:41]
s_waitcnt lgkmcnt(2)
v_mfma_f32_32x32x16_bf16 v[58:73], a[224:227], v[74:77], 0
ds_read_b128 v[42:45], v110 offset:6144
v_mfma_f32_32x32x16_bf16 v[58:73], a[228:231], v[78:81], v[58:73]
ds_read_b128 v[46:49], v110 offset:7168
v_mfma_f32_32x32x16_bf16 v[58:73], a[232:235], v[168:171], v[58:73]
ds_read_b128 v[50:53], v110 offset:8192
s_nop 4
v_mul_f32 v26, v26, v87
v_exp_f32 v102, -v26
v_mul_f32 v27, v27, v87
v_fma_f32 v102, v102, v106, v106
v_mfma_f32_32x32x16_bf16 v[58:73], a[236:239], v[172:175], v[58:73]
ds_read_b128 v[54:57], v110 offset:9216
v_exp_f32 v103, -v27
v_mul_f32 v28, v28, v87
v_rcp_f32 v102, v102
s_waitcnt lgkmcnt(2)
v_mfma_f32_32x32x16_bf16 v[58:73], a[240:243], v[160:163], v[58:73]
ds_read_b128 v[74:77], v110 offset:10240
v_fma_f32 v103, v103, v106, v106
v_exp_f32 v104, -v28
v_mul_f32 v29, v29, v87
v_mul_f32 v26, v26, v102
v_mfma_f32_32x32x16_bf16 v[58:73], a[244:247], v[164:167], v[58:73]
ds_read_b128 v[78:81], v110 offset:11264
v_rcp_f32 v103, v103
v_fma_f32 v104, v104, v106, v106
v_exp_f32 v105, -v29
v_mfma_f32_32x32x16_bf16 v[58:73], a[248:251], v[42:45], v[58:73]
ds_read_b128 v[168:171], v110 offset:12288
v_mul_f32 v30, v30, v87
v_mul_f32 v27, v27, v103
v_rcp_f32 v104, v104
v_fma_f32 v105, v105, v106, v106
v_mfma_f32_32x32x16_bf16 v[58:73], a[252:255], v[46:49], v[58:73]
ds_read_b128 v[172:175], v110 offset:13312
v_exp_f32 v102, -v30
v_mul_f32 v31, v31, v87
v_mul_f32 v28, v28, v104
v_rcp_f32 v105, v105
s_waitcnt lgkmcnt(2)
v_mfma_f32_32x32x16_bf16 v[58:73], v[176:179], v[50:53], v[58:73]
s_add_u32 s60, s35, 13
v_mov_b32 v107, s60
ds_read_b128 v[160:163], v110 offset:14336
v_fma_f32 v102, v102, v106, v106
v_exp_f32 v103, -v31
v_mul_f32 v32, v32, v87
v_cvt_pk_bf16_f32 v94, v26, v27
v_mfma_f32_32x32x16_bf16 v[58:73], v[180:183], v[54:57], v[58:73]
s_waitcnt vmcnt(0)
s_mov_b64 exec, 1
buffer_store_dword v107, off, s[4:7], s41
s_mov_b64 exec, -1
ds_read_b128 v[164:167], v110 offset:15360
v_mul_f32 v29, v29, v105
v_rcp_f32 v102, v102
v_fma_f32 v103, v103, v106, v106
v_exp_f32 v104, -v32
v_mfma_f32_32x32x16_bf16 v[58:73], v[184:187], v[74:77], v[58:73]
ds_read_b128 v[42:45], v110 offset:16384
v_mul_f32 v33, v33, v87
v_mul_f32 v30, v30, v102
v_rcp_f32 v103, v103
v_fma_f32 v104, v104, v106, v106
v_mfma_f32_32x32x16_bf16 v[58:73], v[188:191], v[78:81], v[58:73]
ds_read_b128 v[46:49], v110 offset:17408
v_exp_f32 v105, -v33
v_mul_f32 v34, v34, v87
v_cvt_pk_bf16_f32 v95, v28, v29
v_mul_f32 v31, v31, v103
s_waitcnt lgkmcnt(2)
v_mfma_f32_32x32x16_bf16 v[58:73], v[192:195], v[168:171], v[58:73]
ds_read_b128 v[50:53], v110 offset:18432
v_rcp_f32 v104, v104
v_fma_f32 v105, v105, v106, v106
v_exp_f32 v102, -v34
v_mfma_f32_32x32x16_bf16 v[58:73], v[196:199], v[172:175], v[58:73]
ds_read_b128 v[54:57], v110 offset:19456
v_mul_f32 v35, v35, v87
v_mul_f32 v32, v32, v104
v_rcp_f32 v105, v105
v_fma_f32 v102, v102, v106, v106
v_mfma_f32_32x32x16_bf16 v[58:73], v[200:203], v[160:163], v[58:73]
ds_read_b128 v[74:77], v110 offset:20480
v_exp_f32 v103, -v35
v_mul_f32 v36, v36, v87
v_cvt_pk_bf16_f32 v96, v30, v31
v_mul_f32 v33, v33, v105
v_mfma_f32_32x32x16_bf16 v[58:73], v[204:207], v[164:167], v[58:73]
buffer_load_dword v107, v4, s[4:7], s40 offen sc1
ds_read_b128 v[78:81], v110 offset:21504
v_rcp_f32 v102, v102
v_fma_f32 v103, v103, v106, v106
v_exp_f32 v104, -v36
s_waitcnt lgkmcnt(2)
v_mfma_f32_32x32x16_bf16 v[58:73], v[208:211], v[42:45], v[58:73]
ds_read_b128 v[168:171], v110 offset:22528
v_mul_f32 v37, v37, v87
v_mul_f32 v34, v34, v102
v_rcp_f32 v103, v103
v_fma_f32 v104, v104, v106, v106
v_mfma_f32_32x32x16_bf16 v[58:73], v[212:215], v[46:49], v[58:73]
ds_read_b128 v[172:175], v110 offset:23552
v_exp_f32 v105, -v37
v_mul_f32 v38, v38, v87
v_cvt_pk_bf16_f32 v97, v32, v33
s_add_u32 s61, s74, 114688
v_mfma_f32_32x32x16_bf16 v[58:73], v[216:219], v[50:53], v[58:73]
buffer_store_dwordx4 v[94:97], v1, s[4:7], s61 offen
ds_read_b128 v[160:163], v110 offset:24576
v_mul_f32 v35, v35, v103
v_rcp_f32 v104, v104
v_fma_f32 v105, v105, v106, v106
v_mfma_f32_32x32x16_bf16 v[58:73], v[220:223], v[54:57], v[58:73]
ds_read_b128 v[164:167], v110 offset:25600
v_exp_f32 v102, -v38
v_mul_f32 v39, v39, v87
v_mul_f32 v36, v36, v104
s_waitcnt lgkmcnt(2)
v_mfma_f32_32x32x16_bf16 v[58:73], v[224:227], v[74:77], v[58:73]
ds_read_b128 v[42:45], v110 offset:26624
v_rcp_f32 v105, v105
v_fma_f32 v102, v102, v106, v106
v_exp_f32 v103, -v39
v_mfma_f32_32x32x16_bf16 v[58:73], v[228:231], v[78:81], v[58:73]
s_add_u32 s60, s35, s39
s_add_u32 s60, s60, 12
s_waitcnt vmcnt(1)
LC_162:
v_subrev_u32 v107, s60, v107
v_cmp_le_u32 vcc, 64, v107
s_and_b64 vcc, vcc, s[52:53]
s_cbranch_scc1 LS_163
LD_164:
s_add_u32 s65, s75, s90
buffer_load_dwordx4 v[112:115], v1, s[4:7], s65 offen offset:0 sc1
ds_read_b128 v[46:49], v110 offset:27648
v_mul_f32 v40, v40, v87
v_cvt_pk_bf16_f32 v98, v34, v35
v_mul_f32 v37, v37, v105
v_rcp_f32 v102, v102
v_mfma_f32_32x32x16_bf16 v[58:73], v[232:235], v[168:171], v[58:73]
buffer_load_dwordx4 v[116:119], v1, s[4:7], s65 offen offset:1024 sc1
v_fma_f32 v103, v103, v106, v106
v_exp_f32 v104, -v40
v_mul_f32 v41, v41, v87
v_mul_f32 v38, v38, v102
v_mfma_f32_32x32x16_bf16 v[58:73], v[236:239], v[172:175], v[58:73]
buffer_load_dwordx4 v[120:123], v1, s[4:7], s65 offen offset:2048 sc1
v_rcp_f32 v103, v103
v_fma_f32 v104, v104, v106, v106
v_exp_f32 v105, -v41
s_waitcnt lgkmcnt(0)
v_mfma_f32_32x32x16_bf16 v[58:73], v[240:243], v[160:163], v[58:73]
ds_read_b64 v[92:93], v108 offset:1536
buffer_load_dwordx4 v[124:127], v1, s[4:7], s65 offen offset:3072 sc1
v_cvt_pk_bf16_f32 v99, v36, v37
v_mul_f32 v39, v39, v103
v_rcp_f32 v104, v104
v_mfma_f32_32x32x16_bf16 v[58:73], v[244:247], v[164:167], v[58:73]
s_add_u32 s65, s75, s91
buffer_load_dwordx4 v[128:131], v1, s[4:7], s65 offen offset:0 sc1
v_fma_f32 v105, v105, v106, v106
v_mul_f32 v40, v40, v104
v_rcp_f32 v105, v105
v_mfma_f32_32x32x16_bf16 v[58:73], v[248:251], v[42:45], v[58:73]
s_waitcnt lgkmcnt(0)
v_mov_b32 v88, v92
v_and_b32 v89, 0xffff, v92
buffer_load_dwordx4 v[132:135], v1, s[4:7], s65 offen offset:1024 sc1
v_cvt_pk_bf16_f32 v100, v38, v39
v_mul_f32 v41, v41, v105
v_mfma_f32_32x32x16_bf16 v[58:73], v[252:255], v[46:49], v[58:73]
buffer_load_dwordx4 v[136:139], v1, s[4:7], s65 offen offset:2048 sc1
v_cvt_pk_bf16_f32 v101, v40, v41
v_mfma_f32_32x32x16_bf16 v[58:73], v[14:17], v[88:91], v[58:73]
buffer_store_dwordx4 v[98:101], v1, s[4:7], s61 offen offset:1024
buffer_load_dwordx4 v[140:143], v1, s[4:7], s65 offen offset:3072 sc1
s_waitcnt vmcnt(8)
v_mfma_f32_32x32x16_bf16 v[26:41], a[0:3], v[112:115], 0
v_mfma_f32_32x32x16_bf16 v[42:57], a[4:7], v[112:115], 0
s_nop 6
v_pk_mul_f32 v[58:59], v[58:59], v[92:93] op_sel:[0,1] op_sel_hi:[1,1]
v_pk_mul_f32 v[60:61], v[60:61], v[92:93] op_sel:[0,1] op_sel_hi:[1,1]
v_exp_f32 v102, -v58
v_exp_f32 v103, -v59
v_exp_f32 v104, -v60
v_exp_f32 v105, -v61
v_pk_fma_f32 v[102:103], v[102:103], s[82:83], s[82:83]
v_pk_fma_f32 v[104:105], v[104:105], s[82:83], s[82:83]
v_rcp_f32 v102, v102
v_rcp_f32 v103, v103
v_rcp_f32 v104, v104
v_rcp_f32 v105, v105
v_pk_mul_f32 v[58:59], v[58:59], v[102:103]
v_pk_mul_f32 v[60:61], v[60:61], v[104:105]
v_cvt_pk_bf16_f32 v94, v58, v59
v_cvt_pk_bf16_f32 v95, v60, v61
s_add_u32 s65, s75, s92
buffer_load_dwordx4 v[144:147], v1, s[4:7], s65 offen offset:0 sc1
buffer_load_dwordx4 v[148:151], v1, s[4:7], s65 offen offset:1024 sc1
v_pk_mul_f32 v[62:63], v[62:63], v[92:93] op_sel:[0,1] op_sel_hi:[1,1]
v_pk_mul_f32 v[64:65], v[64:65], v[92:93] op_sel:[0,1] op_sel_hi:[1,1]
v_exp_f32 v102, -v62
v_exp_f32 v103, -v63
v_exp_f32 v104, -v64
v_exp_f32 v105, -v65
v_pk_fma_f32 v[102:103], v[102:103], s[82:83], s[82:83]
v_pk_fma_f32 v[104:105], v[104:105], s[82:83], s[82:83]
v_rcp_f32 v102, v102
v_rcp_f32 v103, v103
v_rcp_f32 v104, v104
v_rcp_f32 v105, v105
v_pk_mul_f32 v[62:63], v[62:63], v[102:103]
v_pk_mul_f32 v[64:65], v[64:65], v[104:105]
v_cvt_pk_bf16_f32 v96, v62, v63
v_cvt_pk_bf16_f32 v97, v64, v65
buffer_load_dwordx4 v[152:155], v1, s[4:7], s65 offen offset:2048 sc1
buffer_load_dwordx4 v[156:159], v1, s[4:7], s65 offen offset:3072 sc1
s_add_u32 s61, s74, 344064
buffer_store_dwordx4 v[94:97], v1, s[4:7], s61 offen
v_pk_mul_f32 v[66:67], v[66:67], v[92:93] op_sel:[0,1] op_sel_hi:[1,1]
v_pk_mul_f32 v[68:69], v[68:69], v[92:93] op_sel:[0,1] op_sel_hi:[1,1]
v_exp_f32 v102, -v66
v_exp_f32 v103, -v67
v_exp_f32 v104, -v68
v_exp_f32 v105, -v69
v_pk_fma_f32 v[102:103], v[102:103], s[82:83], s[82:83]
v_pk_fma_f32 v[104:105], v[104:105], s[82:83], s[82:83]
v_rcp_f32 v102, v102
v_rcp_f32 v103, v103
v_rcp_f32 v104, v104
v_rcp_f32 v105, v105
v_pk_mul_f32 v[66:67], v[66:67], v[102:103]
v_pk_mul_f32 v[68:69], v[68:69], v[104:105]
v_cvt_pk_bf16_f32 v98, v66, v67
v_cvt_pk_bf16_f32 v99, v68, v69
v_pk_mul_f32 v[70:71], v[70:71], v[92:93] op_sel:[0,1] op_sel_hi:[1,1]
v_pk_mul_f32 v[72:73], v[72:73], v[92:93] op_sel:[0,1] op_sel_hi:[1,1]
v_exp_f32 v102, -v70
v_exp_f32 v103, -v71
v_exp_f32 v104, -v72
v_exp_f32 v105, -v73
v_pk_fma_f32 v[102:103], v[102:103], s[82:83], s[82:83]
v_pk_fma_f32 v[104:105], v[104:105], s[82:83], s[82:83]
v_rcp_f32 v102, v102
v_rcp_f32 v103, v103
v_rcp_f32 v104, v104
v_rcp_f32 v105, v105
v_pk_mul_f32 v[70:71], v[70:71], v[102:103]
v_pk_mul_f32 v[72:73], v[72:73], v[104:105]
v_cvt_pk_bf16_f32 v100, v70, v71
v_cvt_pk_bf16_f32 v101, v72, v73
buffer_store_dwordx4 v[98:101], v1, s[4:7], s61 offen offset:1024
s_waitcnt vmcnt(13)
v_mfma_f32_32x32x16_bf16 v[26:41], a[8:11], v[116:119], v[26:41]
s_add_u32 s60, s35, 14
v_mov_b32 v107, s60
s_add_u32 s65, s75, s93
buffer_load_dwordx4 v[112:115], v1, s[4:7], s65 offen offset:0 sc1
v_mfma_f32_32x32x16_bf16 v[42:57], a[12:15], v[116:119], v[42:57]
s_waitcnt vmcnt(8)
s_mov_b64 exec, 1
buffer_store_dword v107, off, s[4:7], s41
s_mov_b64 exec, -1
buffer_load_dwordx4 v[116:119], v1, s[4:7], s65 offen offset:1024 sc1
s_waitcnt vmcnt(15)
v_mfma_f32_32x32x16_bf16 v[26:41], a[16:19], v[120:123], v[26:41]
v_mfma_f32_32x32x16_bf16 v[42:57], a[20:23], v[120:123], v[42:57]
buffer_load_dwordx4 v[120:123], v1, s[4:7], s65 offen offset:2048 sc1
s_waitcnt vmcnt(15)
v_mfma_f32_32x32x16_bf16 v[26:41], a[24:27], v[124:127], v[26:41]
v_mfma_f32_32x32x16_bf16 v[42:57], a[28:31], v[124:127], v[42:57]
buffer_load_dwordx4 v[124:127], v1, s[4:7], s65 offen offset:3072 sc1
s_waitcnt vmcnt(15)
v_mfma_f32_32x32x16_bf16 v[26:41], a[32:35], v[128:131], v[26:41]
v_mfma_f32_32x32x16_bf16 v[42:57], a[36:39], v[128:131], v[42:57]
s_add_u32 s65, s75, s94
buffer_load_dwordx4 v[128:131], v1, s[4:7], s65 offen offset:0 sc1
s_waitcnt vmcnt(15)
v_mfma_f32_32x32x16_bf16 v[26:41], a[40:43], v[132:135], v[26:41]
v_mfma_f32_32x32x16_bf16 v[42:57], a[44:47], v[132:135], v[42:57]
buffer_load_dwordx4 v[132:135], v1, s[4:7], s65 offen offset:1024 sc1
s_waitcnt vmcnt(15)
v_mfma_f32_32x32x16_bf16 v[26:41], a[48:51], v[136:139], v[26:41]
s_add_u32 s60, s35, 15
v_mov_b32 v107, s60
v_mfma_f32_32x32x16_bf16 v[42:57], a[52:55], v[136:139], v[42:57]
s_waitcnt vmcnt(7)
s_mov_b64 exec, 1
buffer_store_dword v107, off, s[4:7], s41
s_mov_b64 exec, -1
buffer_load_dwordx4 v[136:139], v1, s[4:7], s65 offen offset:2048 sc1
s_waitcnt vmcnt(15)
v_mfma_f32_32x32x16_bf16 v[26:41], a[56:59], v[140:143], v[26:41]
v_mfma_f32_32x32x16_bf16 v[42:57], a[60:63], v[140:143], v[42:57]
buffer_load_dwordx4 v[140:143], v1, s[4:7], s65 offen offset:3072 sc1
s_waitcnt vmcnt(15)
v_mfma_f32_32x32x16_bf16 v[26:41], a[64:67], v[144:147], v[26:41]
v_mfma_f32_32x32x16_bf16 v[42:57], a[68:71], v[144:147], v[42:57]
s_add_u32 s65, s75, s95
buffer_load_dwordx4 v[144:147], v1, s[4:7], s65 offen offset:0 sc1
s_waitcnt vmcnt(15)
v_mfma_f32_32x32x16_bf16 v[26:41], a[72:75], v[148:151], v[26:41]
v_mfma_f32_32x32x16_bf16 v[42:57], a[76:79], v[148:151], v[42:57]
buffer_load_dwordx4 v[148:151], v1, s[4:7], s65 offen offset:1024 sc1
s_waitcnt vmcnt(15)
v_mfma_f32_32x32x16_bf16 v[26:41], a[80:83], v[152:155], v[26:41]
v_mfma_f32_32x32x16_bf16 v[42:57], a[84:87], v[152:155], v[42:57]
buffer_load_dwordx4 v[152:155], v1, s[4:7], s65 offen offset:2048 sc1
s_waitcnt vmcnt(15)
v_mfma_f32_32x32x16_bf16 v[26:41], a[88:91], v[156:159], v[26:41]
v_mfma_f32_32x32x16_bf16 v[42:57], a[92:95], v[156:159], v[42:57]
buffer_load_dwordx4 v[156:159], v1, s[4:7], s65 offen offset:3072 sc1
s_waitcnt vmcnt(13)
v_mfma_f32_32x32x16_bf16 v[26:41], a[96:99], v[112:115], v[26:41]
buffer_load_dword v107, v4, s[4:7], s40 offen sc1
v_mfma_f32_32x32x16_bf16 v[42:57], a[100:103], v[112:115], v[42:57]
s_add_u32 s65, s75, s96
buffer_load_dwordx4 v[112:115], v1, s[4:7], s65 offen offset:0 sc1
s_waitcnt vmcnt(13)
v_mfma_f32_32x32x16_bf16 v[26:41], a[104:107], v[116:119], v[26:41]
v_mfma_f32_32x32x16_bf16 v[42:57], a[108:111], v[116:119], v[42:57]
buffer_load_dwordx4 v[116:119], v1, s[4:7], s65 offen offset:1024 sc1
s_waitcnt vmcnt(13)
v_mfma_f32_32x32x16_bf16 v[26:41], a[112:115], v[120:123], v[26:41]
v_mfma_f32_32x32x16_bf16 v[42:57], a[116:119], v[120:123], v[42:57]
buffer_load_dwordx4 v[120:123], v1, s[4:7], s65 offen offset:2048 sc1
s_waitcnt vmcnt(13)
v_mfma_f32_32x32x16_bf16 v[26:41], a[120:123], v[124:127], v[26:41]
v_mfma_f32_32x32x16_bf16 v[42:57], a[124:127], v[124:127], v[42:57]
buffer_load_dwordx4 v[124:127], v1, s[4:7], s65 offen offset:3072 sc1
s_waitcnt vmcnt(13)
v_mfma_f32_32x32x16_bf16 v[26:41], a[128:131], v[128:131], v[26:41]
v_mfma_f32_32x32x16_bf16 v[42:57], a[132:135], v[128:131], v[42:57]
s_waitcnt vmcnt(12)
v_mfma_f32_32x32x16_bf16 v[26:41], a[136:139], v[132:135], v[26:41]
v_mfma_f32_32x32x16_bf16 v[42:57], a[140:143], v[132:135], v[42:57]
s_waitcnt vmcnt(10)
v_mfma_f32_32x32x16_bf16 v[26:41], a[144:147], v[136:139], v[26:41]
s_add_u32 s60, s35, s39
s_add_u32 s60, s60, 14
s_waitcnt vmcnt(4)
LC_165:
v_subrev_u32 v107, s60, v107
v_cmp_le_u32 vcc, 64, v107
s_and_b64 vcc, vcc, s[52:53]
s_cbranch_scc1 LS_166
LD_167:
s_add_u32 s65, s3, s90
buffer_load_dwordx4 v[128:131], v1, s[4:7], s65 offen offset:0 sc1
v_mfma_f32_32x32x16_bf16 v[42:57], a[148:151], v[136:139], v[42:57]
buffer_load_dwordx4 v[132:135], v1, s[4:7], s65 offen offset:1024 sc1
s_waitcnt vmcnt(11)
v_mfma_f32_32x32x16_bf16 v[26:41], a[152:155], v[140:143], v[26:41]
buffer_load_dwordx4 v[136:139], v1, s[4:7], s65 offen offset:2048 sc1
v_mfma_f32_32x32x16_bf16 v[42:57], a[156:159], v[140:143], v[42:57]
buffer_load_dwordx4 v[140:143], v1, s[4:7], s65 offen offset:3072 sc1
s_waitcnt vmcnt(12)
v_mfma_f32_32x32x16_bf16 v[26:41], a[160:163], v[144:147], v[26:41]
s_and_b32 s61, s32, 1
s_mul_i32 s62, s61, 12288
s_add_u32 s62, s62, 86016
v_add_u32 v90, s62, v1
v_mfma_f32_32x32x16_bf16 v[42:57], a[164:167], v[144:147], v[42:57]
s_add_u32 s65, s3, s91
buffer_load_dwordx4 v[144:147], v1, s[4:7], s65 offen offset:0 sc1
s_waitcnt vmcnt(12)
v_mfma_f32_32x32x16_bf16 v[26:41], a[168:171], v[148:151], v[26:41]
s_xor_b32 s61, s61, 1
s_mul_i32 s62, s61, 12288
s_add_u32 s62, s62, 86016
v_add_u32 v91, s62, v1
v_mfma_f32_32x32x16_bf16 v[42:57], a[172:175], v[148:151], v[42:57]
buffer_load_dwordx4 v[148:151], v1, s[4:7], s65 offen offset:1024 sc1
s_waitcnt vmcnt(12)
v_mfma_f32_32x32x16_bf16 v[26:41], a[176:179], v[152:155], v[26:41]
v_mfma_f32_32x32x16_bf16 v[42:57], a[180:183], v[152:155], v[42:57]
buffer_load_dwordx4 v[152:155], v1, s[4:7], s65 offen offset:2048 sc1
s_waitcnt vmcnt(12)
v_mfma_f32_32x32x16_bf16 v[26:41], a[184:187], v[156:159], v[26:41]
v_mfma_f32_32x32x16_bf16 v[42:57], a[188:191], v[156:159], v[42:57]
buffer_load_dwordx4 v[156:159], v1, s[4:7], s65 offen offset:3072 sc1
s_waitcnt vmcnt(11)
v_mfma_f32_32x32x16_bf16 v[26:41], a[192:195], v[112:115], v[26:41]
v_mfma_f32_32x32x16_bf16 v[42:57], a[196:199], v[112:115], v[42:57]
s_add_u32 s65, s3, s92
buffer_load_dwordx4 v[112:115], v1, s[4:7], s65 offen offset:0 sc1
s_waitcnt vmcnt(11)
v_mfma_f32_32x32x16_bf16 v[26:41], a[200:203], v[116:119], v[26:41]
v_mfma_f32_32x32x16_bf16 v[42:57], a[204:207], v[116:119], v[42:57]
buffer_load_dwordx4 v[116:119], v1, s[4:7], s65 offen offset:1024 sc1
s_waitcnt vmcnt(11)
v_mfma_f32_32x32x16_bf16 v[26:41], a[208:211], v[120:123], v[26:41]
v_mfma_f32_32x32x16_bf16 v[42:57], a[212:215], v[120:123], v[42:57]
buffer_load_dwordx4 v[120:123], v1, s[4:7], s65 offen offset:2048 sc1
s_waitcnt vmcnt(11)
v_mfma_f32_32x32x16_bf16 v[26:41], a[216:219], v[124:127], v[26:41]
v_mfma_f32_32x32x16_bf16 v[42:57], a[220:223], v[124:127], v[42:57]
buffer_load_dwordx4 v[124:127], v1, s[4:7], s65 offen offset:3072 sc1
s_cmp_lt_u32 s32, 2
s_cbranch_scc0 LB_168
s_waitcnt vmcnt(11)
v_mfma_f32_32x32x16_bf16 v[58:73], a[0:3], v[128:131], 0
v_mfma_f32_32x32x16_bf16 v[74:89], a[4:7], v[128:131], 0
s_add_u32 s65, s3, s93
buffer_load_dwordx4 v[128:131], v1, s[4:7], s65 offen offset:0 sc1
s_waitcnt vmcnt(11)
v_mfma_f32_32x32x16_bf16 v[58:73], a[8:11], v[132:135], v[58:73]
s_nop 1
ds_write_b128 v91, v[42:45] offset:28672
v_lshlrev_b32 v92, 16, v18
v_and_b32 v93, 0xffff0000, v18
v_add_f32 v26, v26, v92
v_add_f32 v27, v27, v93
v_lshlrev_b32 v92, 16, v19
v_mfma_f32_32x32x16_bf16 v[74:89], a[12:15], v[132:135], v[74:89]
buffer_load_dwordx4 v[132:135], v1, s[4:7], s65 offen offset:1024 sc1
v_and_b32 v93, 0xffff0000, v19
v_add_f32 v28, v28, v92
v_add_f32 v29, v29, v93
v_lshlrev_b32 v92, 16, v20
s_waitcnt vmcnt(11)
v_mfma_f32_32x32x16_bf16 v[58:73], a[16:19], v[136:139], v[58:73]
ds_write_b128 v91, v[46:49] offset:29696
v_and_b32 v93, 0xffff0000, v20
v_add_f32 v30, v30, v92
v_add_f32 v31, v31, v93
v_lshlrev_b32 v92, 16, v21
v_and_b32 v93, 0xffff0000, v21
v_mfma_f32_32x32x16_bf16 v[74:89], a[20:23], v[136:139], v[74:89]
buffer_load_dwordx4 v[136:139], v1, s[4:7], s65 offen offset:2048 sc1
v_add_f32 v32, v32, v92
v_add_f32 v33, v33, v93
v_lshlrev_b32 v92, 16, v22
v_and_b32 v93, 0xffff0000, v22
s_waitcnt vmcnt(11)
v_mfma_f32_32x32x16_bf16 v[58:73], a[24:27], v[140:143], v[58:73]
ds_write_b128 v91, v[50:53] offset:30720
v_add_f32 v34, v34, v92
v_add_f32 v35, v35, v93
v_lshlrev_b32 v92, 16, v23
v_and_b32 v93, 0xffff0000, v23
v_add_f32 v36, v36, v92
v_mfma_f32_32x32x16_bf16 v[74:89], a[28:31], v[140:143], v[74:89]
buffer_load_dwordx4 v[140:143], v1, s[4:7], s65 offen offset:3072 sc1
v_add_f32 v37, v37, v93
v_lshlrev_b32 v92, 16, v24
v_and_b32 v93, 0xffff0000, v24
v_add_f32 v38, v38, v92
s_waitcnt vmcnt(11)
v_mfma_f32_32x32x16_bf16 v[58:73], a[32:35], v[144:147], v[58:73]
ds_write_b128 v91, v[54:57] offset:31744
v_add_f32 v39, v39, v93
v_lshlrev_b32 v92, 16, v25
v_and_b32 v93, 0xffff0000, v25
v_add_f32 v40, v40, v92
v_add_f32 v41, v41, v93
v_mfma_f32_32x32x16_bf16 v[74:89], a[36:39], v[144:147], v[74:89]
s_add_u32 s65, s3, s94
buffer_load_dwordx4 v[144:147], v1, s[4:7], s65 offen offset:0 sc1
s_waitcnt vmcnt(11)
v_mfma_f32_32x32x16_bf16 v[58:73], a[40:43], v[148:151], v[58:73]
v_mfma_f32_32x32x16_bf16 v[74:89], a[44:47], v[148:151], v[74:89]
buffer_load_dwordx4 v[148:151], v1, s[4:7], s65 offen offset:1024 sc1
s_waitcnt vmcnt(11)
v_mfma_f32_32x32x16_bf16 v[58:73], a[48:51], v[152:155], v[58:73]
v_mfma_f32_32x32x16_bf16 v[74:89], a[52:55], v[152:155], v[74:89]
buffer_load_dwordx4 v[152:155], v1, s[4:7], s65 offen offset:2048 sc1
s_waitcnt vmcnt(11)
v_mfma_f32_32x32x16_bf16 v[58:73], a[56:59], v[156:159], v[58:73]
v_mfma_f32_32x32x16_bf16 v[74:89], a[60:63], v[156:159], v[74:89]
buffer_load_dwordx4 v[156:159], v1, s[4:7], s65 offen offset:3072 sc1
s_waitcnt vmcnt(11)
v_mfma_f32_32x32x16_bf16 v[58:73], a[64:67], v[112:115], v[58:73]
v_mfma_f32_32x32x16_bf16 v[74:89], a[68:71], v[112:115], v[74:89]
s_add_u32 s65, s3, s95
buffer_load_dwordx4 v[112:115], v1, s[4:7], s65 offen offset:0 sc1
s_waitcnt vmcnt(11)
v_mfma_f32_32x32x16_bf16 v[58:73], a[72:75], v[116:119], v[58:73]
s_waitcnt lgkmcnt(0)
s_barrier
v_mfma_f32_32x32x16_bf16 v[74:89], a[76:79], v[116:119], v[74:89]
buffer_load_dwordx4 v[116:119], v1, s[4:7], s65 offen offset:1024 sc1
s_waitcnt vmcnt(11)
v_mfma_f32_32x32x16_bf16 v[58:73], a[80:83], v[120:123], v[58:73]
ds_read_b128 v[42:45], v90 offset:28672
ds_read_b128 v[46:49], v90 offset:29696
ds_read_b128 v[50:53], v90 offset:30720
ds_read_b128 v[54:57], v90 offset:31744
v_mfma_f32_32x32x16_bf16 v[74:89], a[84:87], v[120:123], v[74:89]
buffer_load_dwordx4 v[120:123], v1, s[4:7], s65 offen offset:2048 sc1
s_waitcnt vmcnt(11)
v_mfma_f32_32x32x16_bf16 v[58:73], a[88:91], v[124:127], v[58:73]
s_waitcnt lgkmcnt(0)
v_add_f32 v26, v26, v42
v_add_f32 v27, v27, v43
v_add_f32 v28, v28, v44
v_add_f32 v29, v29, v45
v_add_f32 v30, v30, v46
v_mfma_f32_32x32x16_bf16 v[74:89], a[92:95], v[124:127], v[74:89]
buffer_load_dwordx4 v[124:127], v1, s[4:7], s65 offen offset:3072 sc1
v_add_f32 v31, v31, v47
v_add_f32 v32, v32, v48
v_add_f32 v33, v33, v49
v_add_f32 v34, v34, v50
s_waitcnt vmcnt(11)
v_mfma_f32_32x32x16_bf16 v[58:73], a[96:99], v[128:131], v[58:73]
v_add_f32 v35, v35, v51
v_add_f32 v36, v36, v52
v_add_f32 v37, v37, v53
v_add_f32 v38, v38, v54
v_add_f32 v39, v39, v55
v_add_f32 v40, v40, v56
v_mfma_f32_32x32x16_bf16 v[74:89], a[100:103], v[128:131], v[74:89]
s_add_u32 s65, s3, s96
buffer_load_dwordx4 v[128:131], v1, s[4:7], s65 offen offset:0 sc1
v_add_f32 v41, v41, v57
s_waitcnt vmcnt(11)
v_mfma_f32_32x32x16_bf16 v[58:73], a[104:107], v[132:135], v[58:73]
ds_read_b128 v[42:45], v90 offset:32768
ds_read_b128 v[46:49], v90 offset:33792
ds_read_b128 v[50:53], v90 offset:34816
ds_read_b128 v[54:57], v90 offset:35840
v_mfma_f32_32x32x16_bf16 v[74:89], a[108:111], v[132:135], v[74:89]
buffer_load_dwordx4 v[132:135], v1, s[4:7], s65 offen offset:1024 sc1
s_waitcnt vmcnt(11)
v_mfma_f32_32x32x16_bf16 v[58:73], a[112:115], v[136:139], v[58:73]
s_waitcnt lgkmcnt(0)
v_add_f32 v26, v26, v42
v_add_f32 v27, v27, v43
v_add_f32 v28, v28, v44
v_add_f32 v29, v29, v45
v_add_f32 v30, v30, v46
v_mfma_f32_32x32x16_bf16 v[74:89], a[116:119], v[136:139], v[74:89]
buffer_load_dwordx4 v[136:139], v1, s[4:7], s65 offen offset:2048 sc1
v_add_f32 v31, v31, v47
v_add_f32 v32, v32, v48
v_add_f32 v33, v33, v49
v_add_f32 v34, v34, v50
s_waitcnt vmcnt(11)
v_mfma_f32_32x32x16_bf16 v[58:73], a[120:123], v[140:143], v[58:73]
v_add_f32 v35, v35, v51
v_add_f32 v36, v36, v52
v_add_f32 v37, v37, v53
v_add_f32 v38, v38, v54
v_add_f32 v39, v39, v55
v_add_f32 v40, v40, v56
v_mfma_f32_32x32x16_bf16 v[74:89], a[124:127], v[140:143], v[74:89]
buffer_load_dwordx4 v[140:143], v1, s[4:7], s65 offen offset:3072 sc1
v_add_f32 v41, v41, v57
s_waitcnt vmcnt(11)
v_mfma_f32_32x32x16_bf16 v[74:89], a[132:135], v[144:147], v[74:89]
ds_read_b128 v[42:45], v90 offset:36864
ds_read_b128 v[46:49], v90 offset:37888
ds_read_b128 v[50:53], v90 offset:38912
ds_read_b128 v[54:57], v90 offset:39936
s_waitcnt vmcnt(10)
v_mfma_f32_32x32x16_bf16 v[74:89], a[140:143], v[148:151], v[74:89]
s_waitcnt lgkmcnt(0)
s_waitcnt vmcnt(9)
v_mfma_f32_32x32x16_bf16 v[74:89], a[148:151], v[152:155], v[74:89]
v_add_f32 v26, v26, v42
v_add_f32 v27, v27, v43
v_add_f32 v28, v28, v44
v_add_f32 v29, v29, v45
v_add_f32 v30, v30, v46
s_waitcnt vmcnt(8)
v_mfma_f32_32x32x16_bf16 v[74:89], a[156:159], v[156:159], v[74:89]
v_add_f32 v31, v31, v47
v_add_f32 v32, v32, v48
v_add_f32 v33, v33, v49
v_add_f32 v34, v34, v50
v_add_f32 v35, v35, v51
s_waitcnt vmcnt(7)
v_mfma_f32_32x32x16_bf16 v[74:89], a[164:167], v[112:115], v[74:89]
v_add_f32 v36, v36, v52
v_add_f32 v37, v37, v53
v_add_f32 v38, v38, v54
v_add_f32 v39, v39, v55
v_add_f32 v40, v40, v56
s_waitcnt vmcnt(6)
v_mfma_f32_32x32x16_bf16 v[74:89], a[172:175], v[116:119], v[74:89]
v_add_f32 v41, v41, v57
v_cvt_pk_bf16_f32 v18, v26, v27
v_cvt_pk_bf16_f32 v19, v28, v29
v_cvt_pk_bf16_f32 v20, v30, v31
v_cvt_pk_bf16_f32 v21, v32, v33
s_waitcnt vmcnt(5)
v_mfma_f32_32x32x16_bf16 v[74:89], a[180:183], v[120:123], v[74:89]
v_cvt_pk_bf16_f32 v22, v34, v35
v_cvt_pk_bf16_f32 v23, v36, v37
v_cvt_pk_bf16_f32 v24, v38, v39
v_cvt_pk_bf16_f32 v25, v40, v41
s_waitcnt vmcnt(4)
v_mfma_f32_32x32x16_bf16 v[74:89], a[188:191], v[124:127], v[74:89]
v_and_b32 v92, 31, v0
v_mul_u32_u24 v92, 896, v92
v_lshrrev_b32 v93, 5, v0
v_lshl_add_u32 v92, v93, 4, v92
buffer_store_dwordx4 v[18:21], v92, s[28:31], s76 offen
buffer_store_dwordx4 v[22:25], v92, s[28:31], s76 offen offset:32
s_waitcnt vmcnt(5)
v_mfma_f32_32x32x16_bf16 v[74:89], a[196:199], v[128:131], v[74:89]
s_waitcnt vmcnt(4)
v_mfma_f32_32x32x16_bf16 v[74:89], a[204:207], v[132:135], v[74:89]
s_waitcnt vmcnt(3)
v_mfma_f32_32x32x16_bf16 v[74:89], a[212:215], v[136:139], v[74:89]
s_waitcnt vmcnt(2)
v_mfma_f32_32x32x16_bf16 v[74:89], a[220:223], v[140:143], v[74:89]
v_mfma_f32_32x32x16_bf16 v[58:73], a[128:131], v[144:147], v[58:73]
v_mfma_f32_32x32x16_bf16 v[58:73], a[136:139], v[148:151], v[58:73]
s_nop 9
ds_write_b128 v91, v[74:77] offset:4096
v_mfma_f32_32x32x16_bf16 v[58:73], a[144:147], v[152:155], v[58:73]
ds_write_b128 v91, v[78:81] offset:5120
v_mfma_f32_32x32x16_bf16 v[58:73], a[152:155], v[156:159], v[58:73]
ds_write_b128 v91, v[82:85] offset:6144
v_mfma_f32_32x32x16_bf16 v[58:73], a[160:163], v[112:115], v[58:73]
ds_write_b128 v91, v[86:89] offset:7168
v_mfma_f32_32x32x16_bf16 v[58:73], a[168:171], v[116:119], v[58:73]
s_waitcnt lgkmcnt(0)
s_barrier
v_mfma_f32_32x32x16_bf16 v[58:73], a[176:179], v[120:123], v[58:73]
v_mfma_f32_32x32x16_bf16 v[58:73], a[184:187], v[124:127], v[58:73]
v_mfma_f32_32x32x16_bf16 v[58:73], a[192:195], v[128:131], v[58:73]
v_mfma_f32_32x32x16_bf16 v[58:73], a[200:203], v[132:135], v[58:73]
v_mfma_f32_32x32x16_bf16 v[58:73], a[208:211], v[136:139], v[58:73]
v_mfma_f32_32x32x16_bf16 v[58:73], a[216:219], v[140:143], v[58:73]
s_nop 11
ds_write_b128 v90, v[58:61] offset:8192
ds_write_b128 v90, v[62:65] offset:9216
ds_write_b128 v90, v[66:69] offset:10240
ds_write_b128 v90, v[70:73] offset:11264
s_waitcnt lgkmcnt(0)
s_barrier
s_branch LJ_169
LB_168:
L_hop17:
s_cbranch_execz L_hopret
s_waitcnt vmcnt(11)
L_hop9:
s_cbranch_execz L_hop13
v_mfma_f32_32x32x16_bf16 v[58:73], a[0:3], v[128:131], 0
v_mfma_f32_32x32x16_bf16 v[74:89], a[4:7], v[128:131], 0
s_add_u32 s65, s3, s93
buffer_load_dwordx4 v[128:131], v1, s[4:7], s65 offen offset:0 sc1
s_waitcnt vmcnt(11)
v_mfma_f32_32x32x16_bf16 v[58:73], a[8:11], v[132:135], v[58:73]
s_nop 0
ds_write_b128 v91, v[42:45] offset:32768
v_mfma_f32_32x32x16_bf16 v[74:89], a[12:15], v[132:135], v[74:89]
buffer_load_dwordx4 v[132:135], v1, s[4:7], s65 offen offset:1024 sc1
s_waitcnt vmcnt(11)
v_mfma_f32_32x32x16_bf16 v[58:73], a[16:19], v[136:139], v[58:73]
ds_write_b128 v91, v[46:49] offset:33792
v_mfma_f32_32x32x16_bf16 v[74:89], a[20:23], v[136:139], v[74:89]
buffer_load_dwordx4 v[136:139], v1, s[4:7], s65 offen offset:2048 sc1
s_waitcnt vmcnt(11)
v_mfma_f32_32x32x16_bf16 v[58:73], a[24:27], v[140:143], v[58:73]
ds_write_b128 v91, v[50:53] offset:34816
v_mfma_f32_32x32x16_bf16 v[74:89], a[28:31], v[140:143], v[74:89]
buffer_load_dwordx4 v[140:143], v1, s[4:7], s65 offen offset:3072 sc1
s_waitcnt vmcnt(11)
v_mfma_f32_32x32x16_bf16 v[58:73], a[32:35], v[144:147], v[58:73]
ds_write_b128 v91, v[54:57] offset:35840
v_mfma_f32_32x32x16_bf16 v[74:89], a[36:39], v[144:147], v[74:89]
s_add_u32 s65, s3, s94
buffer_load_dwordx4 v[144:147], v1, s[4:7], s65 offen offset:0 sc1
s_waitcnt vmcnt(11)
v_mfma_f32_32x32x16_bf16 v[58:73], a[40:43], v[148:151], v[58:73]
ds_write_b128 v90, v[26:29] offset:36864
v_mfma_f32_32x32x16_bf16 v[74:89], a[44:47], v[148:151], v[74:89]
buffer_load_dwordx4 v[148:151], v1, s[4:7], s65 offen offset:1024 sc1
s_waitcnt vmcnt(11)
v_mfma_f32_32x32x16_bf16 v[58:73], a[48:51], v[152:155], v[58:73]
ds_write_b128 v90, v[30:33] offset:37888
v_mfma_f32_32x32x16_bf16 v[74:89], a[52:55], v[152:155], v[74:89]
buffer_load_dwordx4 v[152:155], v1, s[4:7], s65 offen offset:2048 sc1
s_waitcnt vmcnt(11)
v_mfma_f32_32x32x16_bf16 v[58:73], a[56:59], v[156:159], v[58:73]
ds_write_b128 v90, v[34:37] offset:38912
v_mfma_f32_32x32x16_bf16 v[74:89], a[60:63], v[156:159], v[74:89]
buffer_load_dwordx4 v[156:159], v1, s[4:7], s65 offen offset:3072 sc1
s_waitcnt vmcnt(11)
v_mfma_f32_32x32x16_bf16 v[58:73], a[64:67], v[112:115], v[58:73]
ds_write_b128 v90, v[38:41] offset:39936
v_mfma_f32_32x32x16_bf16 v[74:89], a[68:71], v[112:115], v[74:89]
s_add_u32 s65, s3, s95
buffer_load_dwordx4 v[112:115], v1, s[4:7], s65 offen offset:0 sc1
s_waitcnt vmcnt(11)
v_mfma_f32_32x32x16_bf16 v[58:73], a[72:75], v[116:119], v[58:73]
s_waitcnt lgkmcnt(0)
s_barrier
v_mfma_f32_32x32x16_bf16 v[74:89], a[76:79], v[116:119], v[74:89]
buffer_load_dwordx4 v[116:119], v1, s[4:7], s65 offen offset:1024 sc1
v_lshlrev_b32 v26, 16, v18
v_and_b32 v27, 0xffff0000, v18
v_lshlrev_b32 v28, 16, v19
v_and_b32 v29, 0xffff0000, v19
s_waitcnt vmcnt(11)
v_mfma_f32_32x32x16_bf16 v[58:73], a[80:83], v[120:123], v[58:73]
v_lshlrev_b32 v30, 16, v20
v_and_b32 v31, 0xffff0000, v20
v_lshlrev_b32 v32, 16, v21
v_and_b32 v33, 0xffff0000, v21
v_lshlrev_b32 v34, 16, v22
v_and_b32 v35, 0xffff0000, v22
v_mfma_f32_32x32x16_bf16 v[74:89], a[84:87], v[120:123], v[74:89]
buffer_load_dwordx4 v[120:123], v1, s[4:7], s65 offen offset:2048 sc1
v_lshlrev_b32 v36, 16, v23
v_and_b32 v37, 0xffff0000, v23
v_lshlrev_b32 v38, 16, v24
v_and_b32 v39, 0xffff0000, v24
s_waitcnt vmcnt(11)
v_mfma_f32_32x32x16_bf16 v[58:73], a[88:91], v[124:127], v[58:73]
v_lshlrev_b32 v40, 16, v25
v_and_b32 v41, 0xffff0000, v25
v_mfma_f32_32x32x16_bf16 v[74:89], a[92:95], v[124:127], v[74:89]
buffer_load_dwordx4 v[124:127], v1, s[4:7], s65 offen offset:3072 sc1
s_waitcnt vmcnt(11)
v_mfma_f32_32x32x16_bf16 v[58:73], a[96:99], v[128:131], v[58:73]
v_mfma_f32_32x32x16_bf16 v[74:89], a[100:103], v[128:131], v[74:89]
s_add_u32 s65, s3, s96
buffer_load_dwordx4 v[128:131], v1, s[4:7], s65 offen offset:0 sc1
s_waitcnt vmcnt(11)
v_mfma_f32_32x32x16_bf16 v[58:73], a[104:107], v[132:135], v[58:73]
v_mfma_f32_32x32x16_bf16 v[74:89], a[108:111], v[132:135], v[74:89]
buffer_load_dwordx4 v[132:135], v1, s[4:7], s65 offen offset:1024 sc1
s_waitcnt vmcnt(11)
v_mfma_f32_32x32x16_bf16 v[58:73], a[112:115], v[136:139], v[58:73]
v_mfma_f32_32x32x16_bf16 v[74:89], a[116:119], v[136:139], v[74:89]
buffer_load_dwordx4 v[136:139], v1, s[4:7], s65 offen offset:2048 sc1
s_waitcnt vmcnt(11)
v_mfma_f32_32x32x16_bf16 v[58:73], a[120:123], v[140:143], v[58:73]
v_mfma_f32_32x32x16_bf16 v[74:89], a[124:127], v[140:143], v[74:89]
buffer_load_dwordx4 v[140:143], v1, s[4:7], s65 offen offset:3072 sc1
s_waitcnt vmcnt(11)
v_mfma_f32_32x32x16_bf16 v[74:89], a[132:135], v[144:147], v[74:89]
s_waitcnt vmcnt(10)
v_mfma_f32_32x32x16_bf16 v[74:89], a[140:143], v[148:151], v[74:89]
s_waitcnt vmcnt(9)
v_mfma_f32_32x32x16_bf16 v[74:89], a[148:151], v[152:155], v[74:89]
s_waitcnt vmcnt(8)
v_mfma_f32_32x32x16_bf16 v[74:89], a[156:159], v[156:159], v[74:89]
s_waitcnt vmcnt(7)
v_mfma_f32_32x32x16_bf16 v[74:89], a[164:167], v[112:115], v[74:89]
s_waitcnt vmcnt(6)
v_mfma_f32_32x32x16_bf16 v[74:89], a[172:175], v[116:119], v[74:89]
s_waitcnt vmcnt(5)
v_mfma_f32_32x32x16_bf16 v[74:89], a[180:183], v[120:123], v[74:89]
s_waitcnt vmcnt(4)
v_mfma_f32_32x32x16_bf16 v[74:89], a[188:191], v[124:127], v[74:89]
s_waitcnt vmcnt(3)
v_mfma_f32_32x32x16_bf16 v[74:89], a[196:199], v[128:131], v[74:89]
s_waitcnt vmcnt(2)
v_mfma_f32_32x32x16_bf16 v[74:89], a[204:207], v[132:135], v[74:89]
s_waitcnt vmcnt(1)
v_mfma_f32_32x32x16_bf16 v[74:89], a[212:215], v[136:139], v[74:89]
s_waitcnt vmcnt(0)
v_mfma_f32_32x32x16_bf16 v[74:89], a[220:223], v[140:143], v[74:89]
v_mfma_f32_32x32x16_bf16 v[58:73], a[128:131], v[144:147], v[58:73]
v_mfma_f32_32x32x16_bf16 v[58:73], a[136:139], v[148:151], v[58:73]
s_nop 9
ds_write_b128 v91, v[74:77] offset:0
v_mfma_f32_32x32x16_bf16 v[58:73], a[144:147], v[152:155], v[58:73]
ds_write_b128 v91, v[78:81] offset:1024
v_mfma_f32_32x32x16_bf16 v[58:73], a[152:155], v[156:159], v[58:73]
ds_write_b128 v91, v[82:85] offset:2048
v_mfma_f32_32x32x16_bf16 v[58:73], a[160:163], v[112:115], v[58:73]
ds_write_b128 v91, v[86:89] offset:3072
v_mfma_f32_32x32x16_bf16 v[58:73], a[168:171], v[116:119], v[58:73]
s_waitcnt lgkmcnt(0)
s_barrier
v_mfma_f32_32x32x16_bf16 v[58:73], a[176:179], v[120:123], v[58:73]
ds_read_b128 v[42:45], v90 offset:0
ds_read_b128 v[46:49], v90 offset:1024
ds_read_b128 v[50:53], v90 offset:2048
ds_read_b128 v[54:57], v90 offset:3072
v_mfma_f32_32x32x16_bf16 v[58:73], a[184:187], v[124:127], v[58:73]
ds_read_b128 v[74:77], v90 offset:4096
ds_read_b128 v[78:81], v90 offset:5120
ds_read_b128 v[82:85], v90 offset:6144
ds_read_b128 v[86:89], v90 offset:7168
v_mfma_f32_32x32x16_bf16 v[58:73], a[192:195], v[128:131], v[58:73]
v_mfma_f32_32x32x16_bf16 v[58:73], a[200:203], v[132:135], v[58:73]
s_waitcnt lgkmcnt(0)
v_add_f32 v26, v26, v42
v_add_f32 v27, v27, v43
v_add_f32 v28, v28, v44
v_add_f32 v29, v29, v45
v_add_f32 v30, v30, v46
v_mfma_f32_32x32x16_bf16 v[58:73], a[208:211], v[136:139], v[58:73]
v_add_f32 v31, v31, v47
v_add_f32 v32, v32, v48
v_add_f32 v33, v33, v49
v_add_f32 v34, v34, v50
v_add_f32 v35, v35, v51
v_add_f32 v36, v36, v52
v_mfma_f32_32x32x16_bf16 v[58:73], a[216:219], v[140:143], v[58:73]
v_add_f32 v37, v37, v53
v_add_f32 v38, v38, v54
v_add_f32 v39, v39, v55
v_add_f32 v40, v40, v56
v_add_f32 v41, v41, v57
v_pk_add_f32 v[26:27], v[26:27], v[74:75]
v_pk_add_f32 v[28:29], v[28:29], v[76:77]
v_pk_add_f32 v[30:31], v[30:31], v[78:79]
v_pk_add_f32 v[32:33], v[32:33], v[80:81]
v_pk_add_f32 v[34:35], v[34:35], v[82:83]
v_pk_add_f32 v[36:37], v[36:37], v[84:85]
v_pk_add_f32 v[38:39], v[38:39], v[86:87]
v_pk_add_f32 v[40:41], v[40:41], v[88:89]
v_pk_add_f32 v[26:27], v[26:27], v[58:59]
v_pk_add_f32 v[28:29], v[28:29], v[60:61]
v_pk_add_f32 v[30:31], v[30:31], v[62:63]
v_pk_add_f32 v[32:33], v[32:33], v[64:65]
v_pk_add_f32 v[34:35], v[34:35], v[66:67]
v_pk_add_f32 v[36:37], v[36:37], v[68:69]
v_pk_add_f32 v[38:39], v[38:39], v[70:71]
v_pk_add_f32 v[40:41], v[40:41], v[72:73]
s_barrier
ds_read_b128 v[42:45], v90 offset:8192
ds_read_b128 v[46:49], v90 offset:9216
ds_read_b128 v[50:53], v90 offset:10240
ds_read_b128 v[54:57], v90 offset:11264
s_waitcnt lgkmcnt(3)
v_pk_add_f32 v[26:27], v[26:27], v[42:43]
v_pk_add_f32 v[28:29], v[28:29], v[44:45]
v_cvt_pk_bf16_f32 v18, v26, v27
v_cvt_pk_bf16_f32 v19, v28, v29
s_waitcnt lgkmcnt(2)
v_pk_add_f32 v[30:31], v[30:31], v[46:47]
v_pk_add_f32 v[32:33], v[32:33], v[48:49]
v_cvt_pk_bf16_f32 v20, v30, v31
v_cvt_pk_bf16_f32 v21, v32, v33
s_waitcnt lgkmcnt(1)
v_pk_add_f32 v[34:35], v[34:35], v[50:51]
v_pk_add_f32 v[36:37], v[36:37], v[52:53]
v_cvt_pk_bf16_f32 v22, v34, v35
v_cvt_pk_bf16_f32 v23, v36, v37
s_waitcnt lgkmcnt(0)
v_pk_add_f32 v[38:39], v[38:39], v[54:55]
v_pk_add_f32 v[40:41], v[40:41], v[56:57]
v_cvt_pk_bf16_f32 v24, v38, v39
v_cvt_pk_bf16_f32 v25, v40, v41
v_and_b32 v92, 31, v0
v_mul_u32_u24 v92, 896, v92
v_lshrrev_b32 v93, 5, v0
v_lshl_add_u32 v92, v93, 4, v92
buffer_store_dwordx4 v[18:21], v92, s[28:31], s76 offen
buffer_store_dwordx4 v[22:25], v92, s[28:31], s76 offen offset:32
LJ_169:
LR_156:
s_endpgm
L_hop10:
s_cbranch_execz L_hop14
LM_again:
s_sub_u32 s37, s37, 1
s_cmp_lt_i32 s37, 0
s_cbranch_scc1 LM_done
s_movk_i32 s63, 4096
buffer_load_dword v122, v123, s[4:7], s63 offen sc1
s_waitcnt vmcnt(0)
s_branch LM_check
LS_76:
s_sub_u32 s37, s37, 1
s_cmp_lt_i32 s37, 0
s_cbranch_scc1 LD_77
buffer_load_dword v107, v4, s[4:7], s40 offen sc1
s_waitcnt vmcnt(0)
s_branch LC_75
LS_79:
s_sub_u32 s37, s37, 1
s_cmp_lt_i32 s37, 0
s_cbranch_scc1 LD_80
buffer_load_dword v107, v4, s[4:7], s40 offen sc1
s_waitcnt vmcnt(0)
s_branch LC_78
LS_163:
s_sub_u32 s37, s37, 1
s_cmp_lt_i32 s37, 0
s_cbranch_scc1 LD_164
buffer_load_dword v107, v4, s[4:7], s40 offen sc1
s_waitcnt vmcnt(0)
s_branch LC_162
L_hop11:
s_cbranch_execz L_hop15
LS_166:
s_sub_u32 s37, s37, 1
s_cmp_lt_i32 s37, 0
s_cbranch_scc1 LD_167
buffer_load_dword v107, v4, s[4:7], s40 offen sc1
s_waitcnt vmcnt(0)
s_branch LC_165
LS_21:
s_cmp_lt_i32 s37, 0
s_cbranch_scc1 LO_22
s_call_b64 s[98:99], LK_1
s_branch LC_20
LS_24:
s_cmp_lt_i32 s37, 0
s_cbranch_scc1 LO_25
s_call_b64 s[98:99], LK_1
s_branch LC_23
LS_27:
s_cmp_lt_i32 s37, 0
s_cbranch_scc1 LO_28
s_call_b64 s[98:99], LK_1
s_branch LC_26
LS_30:
s_cmp_lt_i32 s37, 0
s_cbranch_scc1 LO_31
s_call_b64 s[98:99], LK_1
s_branch LC_29
LS_33:
s_cmp_lt_i32 s37, 0
s_cbranch_scc1 LO_34
s_call_b64 s[98:99], LK_1
s_branch LC_32
LS_36:
s_cmp_lt_i32 s37, 0
s_cbranch_scc1 LO_37
s_call_b64 s[98:99], LK_1
s_branch LC_35
LS_39:
s_cmp_lt_i32 s37, 0
s_cbranch_scc1 LO_40
s_call_b64 s[98:99], LK_1
s_branch LC_38
LS_42:
s_cmp_lt_i32 s37, 0
s_cbranch_scc1 LO_43
s_call_b64 s[98:99], LK_1
s_branch LC_41
LS_45:
s_cmp_lt_i32 s37, 0
s_cbranch_scc1 LO_46
s_call_b64 s[98:99], LK_1
s_branch LC_44
LS_48:
s_cmp_lt_i32 s37, 0
s_cbranch_scc1 LO_49
s_call_b64 s[98:99], LK_1
s_branch LC_47
LS_51:
s_cmp_lt_i32 s37, 0
s_cbranch_scc1 LO_52
s_call_b64 s[98:99], LK_1
s_branch LC_50
LS_54:
s_cmp_lt_i32 s37, 0
s_cbranch_scc1 LO_55
s_call_b64 s[98:99], LK_1
s_branch LC_53
LS_57:
s_cmp_lt_i32 s37, 0
s_cbranch_scc1 LO_58
s_call_b64 s[98:99], LK_1
s_branch LC_56
LS_60:
s_cmp_lt_i32 s37, 0
s_cbranch_scc1 LO_61
s_call_b64 s[98:99], LK_1
s_branch LC_59
LS_63:
s_cmp_lt_i32 s37, 0
s_cbranch_scc1 LO_64
s_call_b64 s[98:99], LK_1
s_branch LC_62
L_hop12:
s_cbranch_execz L_hop16
LS_66:
s_cmp_lt_i32 s37, 0
s_cbranch_scc1 LO_67
s_call_b64 s[98:99], LK_1
s_branch LC_65
LS_109:
s_cmp_lt_i32 s37, 0
s_cbranch_scc1 LO_110
s_call_b64 s[98:99], LK_89
s_branch LC_108
LS_112:
s_cmp_lt_i32 s37, 0
s_cbranch_scc1 LO_113
s_call_b64 s[98:99], LK_89
s_branch LC_111
LS_115:
s_cmp_lt_i32 s37, 0
s_cbranch_scc1 LO_116
s_call_b64 s[98:99], LK_89
s_branch LC_114
LS_118:
s_cmp_lt_i32 s37, 0
s_cbranch_scc1 LO_119
s_call_b64 s[98:99], LK_89
s_branch LC_117
LS_121:
s_cmp_lt_i32 s37, 0
s_cbranch_scc1 LO_122
s_call_b64 s[98:99], LK_89
s_branch LC_120
LS_124:
s_cmp_lt_i32 s37, 0
s_cbranch_scc1 LO_125
s_call_b64 s[98:99], LK_89
s_branch LC_123
LS_127:
s_cmp_lt_i32 s37, 0
s_cbranch_scc1 LO_128
s_call_b64 s[98:99], LK_89
s_branch LC_126
LS_130:
s_cmp_lt_i32 s37, 0
s_cbranch_scc1 LO_131
s_call_b64 s[98:99], LK_89
s_branch LC_129
LS_133:
s_cmp_lt_i32 s37, 0
s_cbranch_scc1 LO_134
s_call_b64 s[98:99], LK_89
s_branch LC_132
LS_136:
s_cmp_lt_i32 s37, 0
s_cbranch_scc1 LO_137
s_call_b64 s[98:99], LK_89
s_branch LC_135
LS_139:
s_cmp_lt_i32 s37, 0
s_cbranch_scc1 LO_140
s_call_b64 s[98:99], LK_89
s_branch LC_138
LS_142:
s_cmp_lt_i32 s37, 0
s_cbranch_scc1 LO_143
s_call_b64 s[98:99], LK_89
s_branch LC_141
LS_145:
s_cmp_lt_i32 s37, 0
s_cbranch_scc1 LO_146
s_call_b64 s[98:99], LK_89
s_branch LC_144
LS_148:
s_cmp_lt_i32 s37, 0
s_cbranch_scc1 LO_149
s_call_b64 s[98:99], LK_89
s_branch LC_147
LS_151:
s_cmp_lt_i32 s37, 0
s_cbranch_scc1 LO_152
s_call_b64 s[98:99], LK_89
s_branch LC_150
LS_154:
s_cmp_lt_i32 s37, 0
s_cbranch_scc1 LO_155
s_call_b64 s[98:99], LK_89
s_branch LC_153
L_hop13:
s_cbranch_execz L_hop17
LK_1:
s_waitcnt vmcnt(0)
LL_2:
s_mov_b32 s68, 0
v_max_u32 v58, v28, v29
v_cmp_eq_u32 vcc, -1, v58
s_cbranch_vccz LN_4
s_add_u32 s63, s43, 0
buffer_load_dwordx2 v[28:29], v160, s[4:7], s63 offen sc1
s_mov_b32 s68, 1
LN_4:
v_max_u32 v58, v30, v31
v_cmp_eq_u32 vcc, -1, v58
s_cbranch_vccz LN_5
s_add_u32 s63, s43, 512
buffer_load_dwordx2 v[30:31], v160, s[4:7], s63 offen sc1
s_mov_b32 s68, 1
LN_5:
v_max_u32 v58, v32, v33
v_cmp_eq_u32 vcc, -1, v58
s_cbranch_vccz LN_6
s_add_u32 s63, s43, 1024
buffer_load_dwordx2 v[32:33], v160, s[4:7], s63 offen sc1
s_mov_b32 s68, 1
LN_6:
v_max_u32 v58, v34, v35
v_cmp_eq_u32 vcc, -1, v58
s_cbranch_vccz LN_7
s_add_u32 s63, s43, 1536
buffer_load_dwordx2 v[34:35], v160, s[4:7], s63 offen sc1
s_mov_b32 s68, 1
LN_7:
v_max_u32 v58, v36, v37
v_cmp_eq_u32 vcc, -1, v58
s_cbranch_vccz LN_8
s_add_u32 s63, s43, 2048
buffer_load_dwordx2 v[36:37], v160, s[4:7], s63 offen sc1
s_mov_b32 s68, 1
LN_8:
v_max_u32 v58, v38, v39
v_cmp_eq_u32 vcc, -1, v58
s_cbranch_vccz LN_9
s_add_u32 s63, s43, 2560
buffer_load_dwordx2 v[38:39], v160, s[4:7], s63 offen sc1
s_mov_b32 s68, 1
LN_9:
v_max_u32 v58, v40, v41
v_cmp_eq_u32 vcc, -1, v58
s_cbranch_vccz LN_10
s_add_u32 s63, s43, 3072
buffer_load_dwordx2 v[40:41], v160, s[4:7], s63 offen sc1
s_mov_b32 s68, 1
LN_10:
v_max_u32 v58, v42, v43
v_cmp_eq_u32 vcc, -1, v58
s_cbranch_vccz LN_11
s_add_u32 s63, s43, 3584
buffer_load_dwordx2 v[42:43], v160, s[4:7], s63 offen sc1
s_mov_b32 s68, 1
LN_11:
v_max_u32 v58, v44, v45
v_cmp_eq_u32 vcc, -1, v58
s_cbranch_vccz LN_12
s_add_u32 s63, s43, 4096
buffer_load_dwordx2 v[44:45], v160, s[4:7], s63 offen sc1
s_mov_b32 s68, 1
LN_12:
v_max_u32 v58, v46, v47
v_cmp_eq_u32 vcc, -1, v58
s_cbranch_vccz LN_13
s_add_u32 s63, s43, 4608
buffer_load_dwordx2 v[46:47], v160, s[4:7], s63 offen sc1
s_mov_b32 s68, 1
LN_13:
v_max_u32 v58, v48, v49
v_cmp_eq_u32 vcc, -1, v58
s_cbranch_vccz LN_14
s_add_u32 s63, s43, 5120
buffer_load_dwordx2 v[48:49], v160, s[4:7], s63 offen sc1
s_mov_b32 s68, 1
LN_14:
v_max_u32 v58, v50, v51
v_cmp_eq_u32 vcc, -1, v58
s_cbranch_vccz LN_15
s_add_u32 s63, s43, 5632
buffer_load_dwordx2 v[50:51], v160, s[4:7], s63 offen sc1
s_mov_b32 s68, 1
LN_15:
v_max_u32 v58, v52, v53
v_cmp_eq_u32 vcc, -1, v58
s_cbranch_vccz LN_16
s_add_u32 s63, s43, 6144
buffer_load_dwordx2 v[52:53], v160, s[4:7], s63 offen sc1
s_mov_b32 s68, 1
LN_16:
v_max_u32 v58, v54, v55
v_cmp_eq_u32 vcc, -1, v58
s_cbranch_vccz LN_17
s_add_u32 s63, s43, 6656
buffer_load_dwordx2 v[54:55], v160, s[4:7], s63 offen sc1
s_mov_b32 s68, 1
LN_17:
v_max_u32 v58, v56, v57
v_cmp_eq_u32 vcc, -1, v58
s_cbranch_vccz LN_18
s_add_u32 s63, s43, 7168
buffer_load_dwordx2 v[56:57], v160, s[4:7], s63 offen sc1
s_mov_b32 s68, 1
LN_18:
v_max_u32 v58, v26, v27
v_cmp_eq_u32 vcc, -1, v58
s_cbranch_vccz LN_19
s_add_u32 s63, s43, 7680
buffer_load_dwordx2 v[26:27], v160, s[4:7], s63 offen sc1
s_mov_b32 s68, 1
LN_19:
s_cmp_eq_u32 s68, 0
s_cbranch_scc1 LT_3
s_sub_u32 s37, s37, 1
s_waitcnt vmcnt(0)
s_cmp_ge_i32 s37, 0
s_cbranch_scc1 LL_2
LT_3:
s_setpc_b64 s[98:99]
L_hop14:
s_cbranch_execz L_hopret
LK_89:
s_waitcnt vmcnt(0)
LL_90:
s_mov_b32 s68, 0
v_max_u32 v94, v28, v29
v_cmp_eq_u32 vcc, -1, v94
s_cbranch_vccz LN_92
s_add_u32 s63, s43, 0
buffer_load_dwordx2 v[28:29], v160, s[4:7], s63 offen sc1
s_mov_b32 s68, 1
LN_92:
v_max_u32 v94, v30, v31
v_cmp_eq_u32 vcc, -1, v94
s_cbranch_vccz LN_93
s_add_u32 s63, s43, 512
buffer_load_dwordx2 v[30:31], v160, s[4:7], s63 offen sc1
s_mov_b32 s68, 1
LN_93:
v_max_u32 v94, v32, v33
v_cmp_eq_u32 vcc, -1, v94
s_cbranch_vccz LN_94
s_add_u32 s63, s43, 1024
buffer_load_dwordx2 v[32:33], v160, s[4:7], s63 offen sc1
s_mov_b32 s68, 1
LN_94:
v_max_u32 v94, v34, v35
v_cmp_eq_u32 vcc, -1, v94
s_cbranch_vccz LN_95
s_add_u32 s63, s43, 1536
buffer_load_dwordx2 v[34:35], v160, s[4:7], s63 offen sc1
s_mov_b32 s68, 1
LN_95:
v_max_u32 v94, v36, v37
v_cmp_eq_u32 vcc, -1, v94
s_cbranch_vccz LN_96
s_add_u32 s63, s43, 2048
buffer_load_dwordx2 v[36:37], v160, s[4:7], s63 offen sc1
s_mov_b32 s68, 1
LN_96:
v_max_u32 v94, v38, v39
v_cmp_eq_u32 vcc, -1, v94
s_cbranch_vccz LN_97
s_add_u32 s63, s43, 2560
buffer_load_dwordx2 v[38:39], v160, s[4:7], s63 offen sc1
s_mov_b32 s68, 1
LN_97:
v_max_u32 v94, v40, v41
v_cmp_eq_u32 vcc, -1, v94
s_cbranch_vccz LN_98
s_add_u32 s63, s43, 3072
buffer_load_dwordx2 v[40:41], v160, s[4:7], s63 offen sc1
s_mov_b32 s68, 1
LN_98:
v_max_u32 v94, v42, v43
v_cmp_eq_u32 vcc, -1, v94
s_cbranch_vccz LN_99
s_add_u32 s63, s43, 3584
buffer_load_dwordx2 v[42:43], v160, s[4:7], s63 offen sc1
s_mov_b32 s68, 1
LN_99:
v_max_u32 v94, v44, v45
v_cmp_eq_u32 vcc, -1, v94
s_cbranch_vccz LN_100
s_add_u32 s63, s43, 4096
buffer_load_dwordx2 v[44:45], v160, s[4:7], s63 offen sc1
s_mov_b32 s68, 1
LN_100:
v_max_u32 v94, v46, v47
v_cmp_eq_u32 vcc, -1, v94
s_cbranch_vccz LN_101
s_add_u32 s63, s43, 4608
buffer_load_dwordx2 v[46:47], v160, s[4:7], s63 offen sc1
s_mov_b32 s68, 1
LN_101:
v_max_u32 v94, v48, v49
v_cmp_eq_u32 vcc, -1, v94
s_cbranch_vccz LN_102
s_add_u32 s63, s43, 5120
buffer_load_dwordx2 v[48:49], v160, s[4:7], s63 offen sc1
s_mov_b32 s68, 1
LN_102:
v_max_u32 v94, v50, v51
v_cmp_eq_u32 vcc, -1, v94
s_cbranch_vccz LN_103
s_add_u32 s63, s43, 5632
buffer_load_dwordx2 v[50:51], v160, s[4:7], s63 offen sc1
s_mov_b32 s68, 1
LN_103:
v_max_u32 v94, v52, v53
v_cmp_eq_u32 vcc, -1, v94
s_cbranch_vccz LN_104
s_add_u32 s63, s43, 6144
buffer_load_dwordx2 v[52:53], v160, s[4:7], s63 offen sc1
s_mov_b32 s68, 1
LN_104:
v_max_u32 v94, v54, v55
v_cmp_eq_u32 vcc, -1, v94
s_cbranch_vccz LN_105
s_add_u32 s63, s43, 6656
buffer_load_dwordx2 v[54:55], v160, s[4:7], s63 offen sc1
s_mov_b32 s68, 1
LN_105:
v_max_u32 v94, v56, v57
v_cmp_eq_u32 vcc, -1, v94
s_cbranch_vccz LN_106
s_add_u32 s63, s43, 7168
buffer_load_dwordx2 v[56:57], v160, s[4:7], s63 offen sc1
s_mov_b32 s68, 1
LN_106:
v_max_u32 v94, v26, v27
v_cmp_eq_u32 vcc, -1, v94
s_cbranch_vccz LN_107
s_add_u32 s63, s43, 7680
buffer_load_dwordx2 v[26:27], v160, s[4:7], s63 offen sc1
s_mov_b32 s68, 1
LN_107:
s_cmp_eq_u32 s68, 0
s_cbranch_scc1 LT_91
s_sub_u32 s37, s37, 1
s_waitcnt vmcnt(0)
s_cmp_ge_i32 s37, 0
s_cbranch_scc1 LL_90
LT_91:
s_setpc_b64 s[98:99]
L_slow:
v_cvt_pk_bf16_f32 v90, v90, v91
v_cvt_pk_bf16_f32 v91, v92, v93
ds_write_b64 v163, v[90:91]
s_waitcnt lgkmcnt(0)
s_barrier
ds_read_b64 v[26:27], v162 offset:0
ds_read_b64 v[28:29], v162 offset:512
ds_read_b64 v[30:31], v162 offset:1024
ds_read_b64 v[32:33], v162 offset:1536
s_waitcnt lgkmcnt(2)
v_mfma_f32_32x32x16_bf16 v[42:57], v[26:29], v[142:145], 0
s_waitcnt lgkmcnt(0)
v_mfma_f32_32x32x16_bf16 v[42:57], v[30:33], v[146:149], v[42:57]
s_nop 11
v_add_f32 v94, s86, v54
v_rcp_f32 v94, v94
s_nop 0
v_mov_b32 v95, v94
s_nop 1
v_permlane32_swap_b32 v94, v95
v_pk_mul_f32 v[42:43], v[42:43], v[94:95] op_sel:[0,1] op_sel_hi:[1,1]
v_pk_mul_f32 v[44:45], v[44:45], v[94:95] op_sel:[0,1] op_sel_hi:[1,1]
v_pk_mul_f32 v[46:47], v[46:47], v[94:95] op_sel:[0,1] op_sel_hi:[1,1]
v_pk_mul_f32 v[48:49], v[48:49], v[94:95] op_sel:[0,1] op_sel_hi:[1,1]
v_cvt_pk_bf16_f32 v58, v42, v43
v_cvt_pk_bf16_f32 v59, v44, v45
v_cvt_pk_bf16_f32 v60, v46, v47
v_cvt_pk_bf16_f32 v61, v48, v49
buffer_store_dwordx4 v[58:61], v1, s[4:7], s72 offen sc1
v_pk_mul_f32 v[50:51], v[50:51], v[94:95] op_sel:[0,1] op_sel_hi:[1,1]
v_pk_mul_f32 v[52:53], v[52:53], v[94:95] op_sel:[0,1] op_sel_hi:[1,1]
v_pk_mul_f32 v[54:55], v[54:55], v[94:95] op_sel:[0,1] op_sel_hi:[1,1]
v_pk_mul_f32 v[56:57], v[56:57], v[94:95] op_sel:[0,1] op_sel_hi:[1,1]
v_cvt_pk_bf16_f32 v62, v50, v51
v_cvt_pk_bf16_f32 v63, v52, v53
v_cvt_pk_bf16_f32 v64, v54, v55
v_cvt_pk_bf16_f32 v65, v56, v57
v_cndmask_b32 v64, v64, 0, s[56:57]
v_cndmask_b32 v65, v65, 0, s[56:57]
buffer_store_dwordx4 v[62:65], v1, s[4:7], s72 offen offset:1024 sc1
s_cmp_ge_u32 s33, 14
s_cbranch_scc1 LR_170
v_lshrrev_b32 v58, 2, v0
v_lshrrev_b32 v59, 4, v0
v_xor_b32 v58, v58, v59
v_and_b32 v58, 1, v58
v_cmp_eq_u32 vcc, 0, v58
v_mov_b32 v59, 0x3f803f80
s_nop 0
v_cndmask_b32 v58, 0, v59, vcc
v_mov_b32 v59, v58
v_mov_b32 v60, v58
v_mov_b32 v61, v58
s_waitcnt vmcnt(8)
s_barrier
ds_read_b64_tr_b16 v[228:229], v137 offset:28672
ds_read_b64_tr_b16 v[230:231], v137 offset:29184
ds_read_b64_tr_b16 v[232:233], v137 offset:30720
ds_read_b64_tr_b16 v[234:235], v137 offset:31232
ds_read_b64_tr_b16 v[236:237], v137 offset:32768
ds_read_b64_tr_b16 v[238:239], v137 offset:33280
ds_read_b64_tr_b16 v[240:241], v137 offset:34816
ds_read_b64_tr_b16 v[242:243], v137 offset:35328
ds_read_b64_tr_b16 v[244:245], v137 offset:36864
ds_read_b64_tr_b16 v[246:247], v137 offset:37376
ds_read_b64_tr_b16 v[248:249], v137 offset:38912
ds_read_b64_tr_b16 v[250:251], v137 offset:39424
ds_read_b64_tr_b16 v[252:253], v137 offset:40960
ds_read_b64_tr_b16 v[254:255], v137 offset:41472
s_waitcnt vmcnt(0)
s_add_u32 s60, s35, 2
s_mov_b64 exec, 1
v_mov_b32 v146, s60
buffer_store_dword v146, off, s[4:7], s41 sc1
s_mov_b64 exec, -1
s_waitcnt lgkmcnt(0)
s_barrier
s_add_u32 m0, s78, 114688
s_add_u32 s63, s66, 43008
buffer_load_dwordx4 v6, s[20:23], s63 offen offset:0 lds
s_add_u32 s63, s66, 49152
buffer_load_dwordx4 v6, s[20:23], s63 offen offset:1024 lds
s_mul_i32 s66, s91, 14
s_add_u32 s66, s66, s67
s_add_u32 m0, s78, 116736
s_add_u32 s63, s66, 0
buffer_load_dwordx4 v6, s[20:23], s63 offen offset:0 lds
s_add_u32 s63, s66, 6144
buffer_load_dwordx4 v6, s[20:23], s63 offen offset:1024 lds
s_add_u32 m0, s78, 118784
s_add_u32 s63, s66, 14336
buffer_load_dwordx4 v6, s[20:23], s63 offen offset:0 lds
s_add_u32 s63, s66, 20480
buffer_load_dwordx4 v6, s[20:23], s63 offen offset:1024 lds
v_mfma_f32_16x16x32_bf16 v[62:65], v[58:61], a[224:227], 0
v_mfma_f32_16x16x32_bf16 v[62:65], v[58:61], a[228:231], v[62:65]
v_mfma_f32_16x16x32_bf16 v[62:65], v[58:61], a[232:235], v[62:65]
v_mfma_f32_16x16x32_bf16 v[62:65], v[58:61], a[236:239], v[62:65]
v_mfma_f32_16x16x32_bf16 v[62:65], v[58:61], a[240:243], v[62:65]
v_mfma_f32_16x16x32_bf16 v[62:65], v[58:61], a[244:247], v[62:65]
v_mfma_f32_16x16x32_bf16 v[62:65], v[58:61], a[248:251], v[62:65]
v_mfma_f32_16x16x32_bf16 v[62:65], v[58:61], a[252:255], v[62:65]
v_mfma_f32_16x16x32_bf16 v[62:65], v[58:61], v[176:179], v[62:65]
v_mfma_f32_16x16x32_bf16 v[62:65], v[58:61], v[180:183], v[62:65]
v_mfma_f32_16x16x32_bf16 v[62:65], v[58:61], v[184:187], v[62:65]
v_mfma_f32_16x16x32_bf16 v[62:65], v[58:61], v[188:191], v[62:65]
v_mfma_f32_16x16x32_bf16 v[62:65], v[58:61], v[192:195], v[62:65]
s_waitcnt vmcnt(13)
ds_read_b64_tr_b16 a[0:1], v130 offset:0
ds_read_b64_tr_b16 a[2:3], v130 offset:512
ds_read_b64_tr_b16 a[4:5], v131 offset:0
ds_read_b64_tr_b16 a[6:7], v131 offset:512
v_mfma_f32_16x16x32_bf16 v[62:65], v[58:61], v[196:199], v[62:65]
v_mfma_f32_16x16x32_bf16 v[62:65], v[58:61], v[200:203], v[62:65]
v_mfma_f32_16x16x32_bf16 v[62:65], v[58:61], v[204:207], v[62:65]
v_mfma_f32_16x16x32_bf16 v[62:65], v[58:61], v[208:211], v[62:65]
v_mfma_f32_16x16x32_bf16 v[62:65], v[58:61], v[212:215], v[62:65]
v_mfma_f32_16x16x32_bf16 v[62:65], v[58:61], v[216:219], v[62:65]
v_mfma_f32_16x16x32_bf16 v[62:65], v[58:61], v[220:223], v[62:65]
v_mfma_f32_16x16x32_bf16 v[62:65], v[58:61], v[224:227], v[62:65]
v_mfma_f32_16x16x32_bf16 v[62:65], v[58:61], v[228:231], v[62:65]
v_mfma_f32_16x16x32_bf16 v[62:65], v[58:61], v[232:235], v[62:65]
v_mfma_f32_16x16x32_bf16 v[62:65], v[58:61], v[236:239], v[62:65]
v_mfma_f32_16x16x32_bf16 v[62:65], v[58:61], v[240:243], v[62:65]
s_waitcnt lgkmcnt(0)
s_add_u32 m0, s78, 86016
s_add_u32 s63, s66, 28672
buffer_load_dwordx4 v6, s[20:23], s63 offen offset:0 lds
s_add_u32 s63, s66, 34816
buffer_load_dwordx4 v6, s[20:23], s63 offen offset:1024 lds
s_waitcnt vmcnt(13)
ds_read_b64_tr_b16 a[8:9], v130 offset:2048
ds_read_b64_tr_b16 a[10:11], v130 offset:2560
ds_read_b64_tr_b16 a[12:13], v131 offset:2048
ds_read_b64_tr_b16 a[14:15], v131 offset:2560
v_mfma_f32_16x16x32_bf16 v[62:65], v[58:61], v[244:247], v[62:65]
v_mfma_f32_16x16x32_bf16 v[62:65], v[58:61], v[248:251], v[62:65]
v_mfma_f32_16x16x32_bf16 v[62:65], v[58:61], v[252:255], v[62:65]
s_nop 7
v_cvt_pk_bf16_f32 v66, v62, v62
v_and_b32 v67, 0xffff0000, v66
v_sub_f32 v67, v62, v67
v_cvt_pk_bf16_f32 v14, v62, v67
v_and_b32 v66, 0xffff0000, v14
v_sub_f32 v67, v67, v66
v_cvt_pk_bf16_f32 v15, v67, 0
v_lshlrev_b32 v26, 16, v18
v_and_b32 v27, 0xffff0000, v18
v_lshlrev_b32 v28, 16, v19
v_and_b32 v29, 0xffff0000, v19
v_lshlrev_b32 v30, 16, v20
v_and_b32 v31, 0xffff0000, v20
v_lshlrev_b32 v32, 16, v21
v_and_b32 v33, 0xffff0000, v21
v_lshlrev_b32 v34, 16, v22
v_and_b32 v35, 0xffff0000, v22
v_lshlrev_b32 v36, 16, v23
v_and_b32 v37, 0xffff0000, v23
v_lshlrev_b32 v38, 16, v24
v_and_b32 v39, 0xffff0000, v24
v_lshlrev_b32 v40, 16, v25
v_and_b32 v41, 0xffff0000, v25
s_add_u32 s61, s89, 143360
v_add_u32 v148, s61, v1
s_xor_b32 s61, s89, 4096
s_add_u32 s61, s61, 143360
v_add_u32 v149, s61, v1
s_add_u32 s60, s35, 2
LP_172:
buffer_load_dword v152, v4, s[4:7], s40 offen sc1
s_sub_u32 s37, s37, 1
s_cmp_lt_i32 s37, 0
s_cbranch_scc1 LD_173
s_waitcnt vmcnt(0)
v_subrev_u32 v152, s60, v152
v_cmp_le_u32 vcc, 64, v152
s_and_b64 vcc, vcc, s[50:51]
s_cbranch_scc1 LP_172
LD_173:
s_add_u32 s65, s73, 0
buffer_load_dwordx4 v[58:61], v1, s[4:7], s65 offen offset:0 sc1
buffer_load_dwordx4 v[62:65], v1, s[4:7], s65 offen offset:1024 sc1
buffer_load_dwordx4 v[66:69], v1, s[4:7], s65 offen offset:2048 sc1
buffer_load_dwordx4 v[70:73], v1, s[4:7], s65 offen offset:3072 sc1
s_add_u32 s65, s73, 4096
buffer_load_dwordx4 v[74:77], v1, s[4:7], s65 offen offset:0 sc1
buffer_load_dwordx4 v[78:81], v1, s[4:7], s65 offen offset:1024 sc1
buffer_load_dwordx4 v[82:85], v1, s[4:7], s65 offen offset:2048 sc1
buffer_load_dwordx4 v[86:89], v1, s[4:7], s65 offen offset:3072 sc1
s_add_u32 s65, s73, 8192
buffer_load_dwordx4 v[90:93], v1, s[4:7], s65 offen offset:0 sc1
buffer_load_dwordx4 v[94:97], v1, s[4:7], s65 offen offset:1024 sc1
s_waitcnt vmcnt(9)
v_mfma_f32_32x32x16_bf16 v[42:57], a[100:103], v[58:61], 0
buffer_load_dwordx4 v[98:101], v1, s[4:7], s65 offen offset:2048 sc1
v_mfma_f32_32x32x16_bf16 v[26:41], a[96:99], v[58:61], v[26:41]
s_waitcnt vmcnt(9)
v_mfma_f32_32x32x16_bf16 v[42:57], a[108:111], v[62:65], v[42:57]
buffer_load_dwordx4 v[102:105], v1, s[4:7], s65 offen offset:3072 sc1
v_mfma_f32_32x32x16_bf16 v[26:41], a[104:107], v[62:65], v[26:41]
s_waitcnt vmcnt(9)
v_mfma_f32_32x32x16_bf16 v[42:57], a[116:119], v[66:69], v[42:57]
s_add_u32 s65, s73, 12288
buffer_load_dwordx4 v[106:109], v1, s[4:7], s65 offen offset:0 sc1
v_mfma_f32_32x32x16_bf16 v[26:41], a[112:115], v[66:69], v[26:41]
s_waitcnt vmcnt(9)
v_mfma_f32_32x32x16_bf16 v[42:57], a[124:127], v[70:73], v[42:57]
buffer_load_dwordx4 v[110:113], v1, s[4:7], s65 offen offset:1024 sc1
v_mfma_f32_32x32x16_bf16 v[26:41], a[120:123], v[70:73], v[26:41]
s_waitcnt vmcnt(9)
v_mfma_f32_32x32x16_bf16 v[42:57], a[132:135], v[74:77], v[42:57]
buffer_load_dwordx4 v[114:117], v1, s[4:7], s65 offen offset:2048 sc1
v_mfma_f32_32x32x16_bf16 v[26:41], a[128:131], v[74:77], v[26:41]
s_waitcnt vmcnt(9)
v_mfma_f32_32x32x16_bf16 v[42:57], a[140:143], v[78:81], v[42:57]
buffer_load_dwordx4 v[118:121], v1, s[4:7], s65 offen offset:3072 sc1
v_mfma_f32_32x32x16_bf16 v[26:41], a[136:139], v[78:81], v[26:41]
s_waitcnt lgkmcnt(0)
s_add_u32 m0, s78, 88064
s_add_u32 s63, s66, 43008
buffer_load_dwordx4 v6, s[20:23], s63 offen offset:0 lds
s_add_u32 s63, s66, 49152
buffer_load_dwordx4 v6, s[20:23], s63 offen offset:1024 lds
s_waitcnt vmcnt(30)
ds_read_b64_tr_b16 a[16:17], v130 offset:4096
ds_read_b64_tr_b16 a[18:19], v130 offset:4608
ds_read_b64_tr_b16 a[20:21], v131 offset:4096
ds_read_b64_tr_b16 a[22:23], v131 offset:4608
s_waitcnt vmcnt(11)
v_mfma_f32_32x32x16_bf16 v[42:57], a[148:151], v[82:85], v[42:57]
v_mfma_f32_32x32x16_bf16 v[26:41], a[144:147], v[82:85], v[26:41]
s_waitcnt lgkmcnt(0)
s_mul_i32 s66, s92, 14
s_add_u32 s66, s66, s67
s_add_u32 m0, s78, 90112
s_add_u32 s63, s66, 0
buffer_load_dwordx4 v6, s[20:23], s63 offen offset:0 lds
s_add_u32 s63, s66, 6144
buffer_load_dwordx4 v6, s[20:23], s63 offen offset:1024 lds
s_waitcnt vmcnt(27)
ds_read_b64_tr_b16 a[24:25], v130 offset:28672
ds_read_b64_tr_b16 a[26:27], v130 offset:29184
ds_read_b64_tr_b16 a[28:29], v131 offset:28672
ds_read_b64_tr_b16 a[30:31], v131 offset:29184
s_waitcnt vmcnt(12)
v_mfma_f32_32x32x16_bf16 v[42:57], a[156:159], v[86:89], v[42:57]
v_mfma_f32_32x32x16_bf16 v[26:41], a[152:155], v[86:89], v[26:41]
s_waitcnt lgkmcnt(0)
s_add_u32 m0, s78, 114688
s_add_u32 s63, s66, 14336
buffer_load_dwordx4 v6, s[20:23], s63 offen offset:0 lds
s_add_u32 s63, s66, 20480
buffer_load_dwordx4 v6, s[20:23], s63 offen offset:1024 lds
s_waitcnt vmcnt(27)
ds_read_b64_tr_b16 a[32:33], v130 offset:30720
ds_read_b64_tr_b16 a[34:35], v130 offset:31232
ds_read_b64_tr_b16 a[36:37], v131 offset:30720
ds_read_b64_tr_b16 a[38:39], v131 offset:31232
s_waitcnt vmcnt(13)
v_mfma_f32_32x32x16_bf16 v[42:57], a[164:167], v[90:93], v[42:57]
v_mfma_f32_32x32x16_bf16 v[26:41], a[160:163], v[90:93], v[26:41]
s_waitcnt lgkmcnt(0)
s_add_u32 m0, s78, 116736
s_add_u32 s63, s66, 28672
buffer_load_dwordx4 v6, s[20:23], s63 offen offset:0 lds
s_add_u32 s63, s66, 34816
buffer_load_dwordx4 v6, s[20:23], s63 offen offset:1024 lds
s_waitcnt vmcnt(27)
ds_read_b64_tr_b16 a[40:41], v130 offset:32768
ds_read_b64_tr_b16 a[42:43], v130 offset:33280
ds_read_b64_tr_b16 a[44:45], v131 offset:32768
ds_read_b64_tr_b16 a[46:47], v131 offset:33280
s_waitcnt vmcnt(14)
v_mfma_f32_32x32x16_bf16 v[42:57], a[172:175], v[94:97], v[42:57]
v_mfma_f32_32x32x16_bf16 v[26:41], a[168:171], v[94:97], v[26:41]
s_waitcnt lgkmcnt(0)
s_add_u32 m0, s78, 118784
s_add_u32 s63, s66, 43008
buffer_load_dwordx4 v6, s[20:23], s63 offen offset:0 lds
s_add_u32 s63, s66, 49152
buffer_load_dwordx4 v6, s[20:23], s63 offen offset:1024 lds
s_waitcnt vmcnt(27)
ds_read_b64_tr_b16 a[48:49], v130 offset:0
ds_read_b64_tr_b16 a[50:51], v130 offset:512
ds_read_b64_tr_b16 a[52:53], v131 offset:0
ds_read_b64_tr_b16 a[54:55], v131 offset:512
s_waitcnt vmcnt(15)
v_mfma_f32_32x32x16_bf16 v[42:57], a[180:183], v[98:101], v[42:57]
s_waitcnt vmcnt(14)
v_mfma_f32_32x32x16_bf16 v[42:57], a[188:191], v[102:105], v[42:57]
s_waitcnt lgkmcnt(0)
s_mul_i32 s66, s93, 14
s_add_u32 s66, s66, s67
s_add_u32 m0, s78, 86016
s_add_u32 s63, s66, 0
buffer_load_dwordx4 v6, s[20:23], s63 offen offset:0 lds
s_add_u32 s63, s66, 6144
buffer_load_dwordx4 v6, s[20:23], s63 offen offset:1024 lds
s_waitcnt vmcnt(10)
ds_read_b64_tr_b16 a[56:57], v130 offset:2048
ds_read_b64_tr_b16 a[58:59], v130 offset:2560
ds_read_b64_tr_b16 a[60:61], v131 offset:2048
ds_read_b64_tr_b16 a[62:63], v131 offset:2560
s_waitcnt vmcnt(15)
v_mfma_f32_32x32x16_bf16 v[42:57], a[196:199], v[106:109], v[42:57]
s_waitcnt vmcnt(14)
v_mfma_f32_32x32x16_bf16 v[42:57], a[204:207], v[110:113], v[42:57]
s_waitcnt lgkmcnt(0)
s_add_u32 m0, s78, 88064
s_add_u32 s63, s66, 14336
buffer_load_dwordx4 v6, s[20:23], s63 offen offset:0 lds
s_add_u32 s63, s66, 20480
buffer_load_dwordx4 v6, s[20:23], s63 offen offset:1024 lds
s_waitcnt vmcnt(10)
ds_read_b64_tr_b16 a[64:65], v130 offset:4096
ds_read_b64_tr_b16 a[66:67], v130 offset:4608
ds_read_b64_tr_b16 a[68:69], v131 offset:4096
ds_read_b64_tr_b16 a[70:71], v131 offset:4608
s_waitcnt vmcnt(15)
v_mfma_f32_32x32x16_bf16 v[42:57], a[212:215], v[114:117], v[42:57]
s_waitcnt vmcnt(14)
v_mfma_f32_32x32x16_bf16 v[42:57], a[220:223], v[118:121], v[42:57]
s_waitcnt lgkmcnt(0)
s_add_u32 m0, s78, 90112
s_add_u32 s63, s66, 28672
buffer_load_dwordx4 v6, s[20:23], s63 offen offset:0 lds
s_add_u32 s63, s66, 34816
buffer_load_dwordx4 v6, s[20:23], s63 offen offset:1024 lds
s_waitcnt vmcnt(10)
ds_read_b64_tr_b16 a[72:73], v130 offset:28672
ds_read_b64_tr_b16 a[74:75], v130 offset:29184
ds_read_b64_tr_b16 a[76:77], v131 offset:28672
ds_read_b64_tr_b16 a[78:79], v131 offset:29184
v_mfma_f32_32x32x16_bf16 v[26:41], a[176:179], v[98:101], v[26:41]
v_mfma_f32_32x32x16_bf16 v[26:41], a[184:187], v[102:105], v[26:41]
s_waitcnt lgkmcnt(0)
s_add_u32 m0, s78, 114688
s_add_u32 s63, s66, 43008
buffer_load_dwordx4 v6, s[20:23], s63 offen offset:0 lds
s_add_u32 s63, s66, 49152
buffer_load_dwordx4 v6, s[20:23], s63 offen offset:1024 lds
s_waitcnt vmcnt(10)
ds_read_b64_tr_b16 a[80:81], v130 offset:30720
ds_read_b64_tr_b16 a[82:83], v130 offset:31232
ds_read_b64_tr_b16 a[84:85], v131 offset:30720
ds_read_b64_tr_b16 a[86:87], v131 offset:31232
v_mfma_f32_32x32x16_bf16 v[26:41], a[192:195], v[106:109], v[26:41]
ds_write_b128 v148, v[42:45] offset:0
v_mfma_f32_32x32x16_bf16 v[26:41], a[200:203], v[110:113], v[26:41]
ds_write_b128 v148, v[46:49] offset:1024
s_waitcnt lgkmcnt(2)
s_mul_i32 s66, s94, 14
s_add_u32 s66, s66, s67
s_add_u32 m0, s78, 116736
s_add_u32 s63, s66, 0
buffer_load_dwordx4 v6, s[20:23], s63 offen offset:0 lds
s_add_u32 s63, s66, 6144
buffer_load_dwordx4 v6, s[20:23], s63 offen offset:1024 lds
s_waitcnt vmcnt(10)
ds_read_b64_tr_b16 a[88:89], v130 offset:32768
ds_read_b64_tr_b16 a[90:91], v130 offset:33280
ds_read_b64_tr_b16 a[92:93], v131 offset:32768
ds_read_b64_tr_b16 a[94:95], v131 offset:33280
v_mfma_f32_32x32x16_bf16 v[26:41], a[208:211], v[114:117], v[26:41]
ds_write_b128 v148, v[50:53] offset:2048
v_mfma_f32_32x32x16_bf16 v[26:41], a[216:219], v[118:121], v[26:41]
ds_write_b128 v148, v[54:57] offset:3072
s_waitcnt lgkmcnt(2)
s_add_u32 m0, s78, 118784
s_add_u32 s63, s66, 14336
buffer_load_dwordx4 v6, s[20:23], s63 offen offset:0 lds
s_add_u32 s63, s66, 20480
buffer_load_dwordx4 v6, s[20:23], s63 offen offset:1024 lds
s_waitcnt vmcnt(10)
ds_read_b64_tr_b16 a[96:97], v130 offset:0
ds_read_b64_tr_b16 a[98:99], v130 offset:512
ds_read_b64_tr_b16 a[100:101], v131 offset:0
ds_read_b64_tr_b16 a[102:103], v131 offset:512
s_waitcnt lgkmcnt(0)
s_add_u32 m0, s78, 86016
s_add_u32 s63, s66, 28672
buffer_load_dwordx4 v6, s[20:23], s63 offen offset:0 lds
s_add_u32 s63, s66, 34816
buffer_load_dwordx4 v6, s[20:23], s63 offen offset:1024 lds
s_waitcnt vmcnt(10)
ds_read_b64_tr_b16 a[104:105], v130 offset:2048
ds_read_b64_tr_b16 a[106:107], v130 offset:2560
ds_read_b64_tr_b16 a[108:109], v131 offset:2048
ds_read_b64_tr_b16 a[110:111], v131 offset:2560
s_waitcnt lgkmcnt(0)
s_barrier
ds_read_b128 v[58:61], v149 offset:0
ds_read_b128 v[62:65], v149 offset:1024
ds_read_b128 v[66:69], v149 offset:2048
ds_read_b128 v[70:73], v149 offset:3072
s_waitcnt lgkmcnt(3)
v_pk_add_f32 v[26:27], v[26:27], v[58:59]
v_pk_add_f32 v[28:29], v[28:29], v[60:61]
v_cvt_pk_bf16_f32 v18, v26, v27
v_cvt_pk_bf16_f32 v19, v28, v29
s_waitcnt lgkmcnt(2)
v_pk_add_f32 v[30:31], v[30:31], v[62:63]
v_pk_add_f32 v[32:33], v[32:33], v[64:65]
v_cvt_pk_bf16_f32 v20, v30, v31
v_cvt_pk_bf16_f32 v21, v32, v33
s_waitcnt lgkmcnt(1)
v_pk_add_f32 v[34:35], v[34:35], v[66:67]
v_pk_add_f32 v[36:37], v[36:37], v[68:69]
v_cvt_pk_bf16_f32 v22, v34, v35
v_cvt_pk_bf16_f32 v23, v36, v37
s_waitcnt lgkmcnt(0)
v_pk_add_f32 v[38:39], v[38:39], v[70:71]
v_pk_add_f32 v[40:41], v[40:41], v[72:73]
v_cvt_pk_bf16_f32 v24, v38, v39
v_cvt_pk_bf16_f32 v25, v40, v41
buffer_store_dwordx4 v[18:21], v1, s[4:7], s44 offen sc1
buffer_store_dwordx4 v[22:25], v1, s[4:7], s44 offen offset:1024 sc1
v_dot2_f32_bf16 v146, s88, v18, 0
v_dot2_f32_bf16 v147, v18, v18, 0
v_dot2_f32_bf16 v146, s88, v19, v146
v_dot2_f32_bf16 v147, v19, v19, v147
v_dot2_f32_bf16 v146, s88, v20, v146
v_dot2_f32_bf16 v147, v20, v20, v147
v_dot2_f32_bf16 v146, s88, v21, v146
v_dot2_f32_bf16 v147, v21, v21, v147
v_dot2_f32_bf16 v146, s88, v22, v146
v_dot2_f32_bf16 v147, v22, v22, v147
v_dot2_f32_bf16 v146, s88, v23, v146
v_dot2_f32_bf16 v147, v23, v23, v147
v_dot2_f32_bf16 v146, s88, v24, v146
v_dot2_f32_bf16 v147, v24, v24, v147
v_dot2_f32_bf16 v146, s88, v25, v146
v_dot2_f32_bf16 v147, v25, v25, v147
s_nop 1
v_mov_b32 v148, v146
v_mov_b32 v149, v147
s_nop 0
v_permlane32_swap_b32 v146, v148
v_permlane32_swap_b32 v147, v149
s_mov_b32 exec_hi, 0
v_pk_add_f32 v[146:147], v[146:147], v[148:149]
buffer_store_dwordx2 v[146:147], v1, s[4:7], s45 offen sc1
s_mov_b64 exec, -1
s_waitcnt lgkmcnt(4)
s_add_u32 m0, s78, 88064
s_add_u32 s63, s66, 43008
buffer_load_dwordx4 v6, s[20:23], s63 offen offset:0 lds
s_add_u32 s63, s66, 49152
buffer_load_dwordx4 v6, s[20:23], s63 offen offset:1024 lds
s_waitcnt vmcnt(13)
ds_read_b64_tr_b16 a[112:113], v130 offset:4096
ds_read_b64_tr_b16 a[114:115], v130 offset:4608
ds_read_b64_tr_b16 a[116:117], v131 offset:4096
ds_read_b64_tr_b16 a[118:119], v131 offset:4608
s_waitcnt lgkmcnt(0)
s_mul_i32 s66, s95, 14
s_add_u32 s66, s66, s67
s_add_u32 m0, s78, 90112
s_add_u32 s63, s66, 0
buffer_load_dwordx4 v6, s[20:23], s63 offen offset:0 lds
s_add_u32 s63, s66, 6144
buffer_load_dwordx4 v6, s[20:23], s63 offen offset:1024 lds
s_waitcnt vmcnt(13)
ds_read_b64_tr_b16 a[120:121], v130 offset:28672
ds_read_b64_tr_b16 a[122:123], v130 offset:29184
ds_read_b64_tr_b16 a[124:125], v131 offset:28672
ds_read_b64_tr_b16 a[126:127], v131 offset:29184
s_waitcnt lgkmcnt(0)
s_add_u32 m0, s78, 114688
s_add_u32 s63, s66, 14336
buffer_load_dwordx4 v6, s[20:23], s63 offen offset:0 lds
s_add_u32 s63, s66, 20480
buffer_load_dwordx4 v6, s[20:23], s63 offen offset:1024 lds
s_waitcnt vmcnt(13)
ds_read_b64_tr_b16 a[128:129], v130 offset:30720
ds_read_b64_tr_b16 a[130:131], v130 offset:31232
ds_read_b64_tr_b16 a[132:133], v131 offset:30720
ds_read_b64_tr_b16 a[134:135], v131 offset:31232
s_waitcnt vmcnt(6)
s_add_u32 s60, s35, 3
s_mov_b64 exec, 1
v_mov_b32 v146, s60
buffer_store_dword v146, off, s[4:7], s41 sc1
s_mov_b64 exec, -1
s_waitcnt lgkmcnt(0)
s_add_u32 m0, s78, 116736
s_add_u32 s63, s66, 28672
buffer_load_dwordx4 v6, s[20:23], s63 offen offset:0 lds
s_add_u32 s63, s66, 34816
buffer_load_dwordx4 v6, s[20:23], s63 offen offset:1024 lds
s_waitcnt vmcnt(14)
ds_read_b64_tr_b16 a[136:137], v130 offset:32768
ds_read_b64_tr_b16 a[138:139], v130 offset:33280
ds_read_b64_tr_b16 a[140:141], v131 offset:32768
ds_read_b64_tr_b16 a[142:143], v131 offset:33280
s_waitcnt lgkmcnt(0)
s_add_u32 m0, s78, 118784
s_add_u32 s63, s66, 43008
buffer_load_dwordx4 v6, s[20:23], s63 offen offset:0 lds
s_add_u32 s63, s66, 49152
buffer_load_dwordx4 v6, s[20:23], s63 offen offset:1024 lds
s_waitcnt vmcnt(14)
ds_read_b64_tr_b16 a[144:145], v130 offset:0
ds_read_b64_tr_b16 a[146:147], v130 offset:512
ds_read_b64_tr_b16 a[148:149], v131 offset:0
ds_read_b64_tr_b16 a[150:151], v131 offset:512
s_waitcnt lgkmcnt(0)
s_mul_i32 s66, s96, 14
s_add_u32 s66, s66, s67
s_add_u32 m0, s78, 86016
s_add_u32 s63, s66, 0
buffer_load_dwordx4 v6, s[20:23], s63 offen offset:0 lds
s_add_u32 s63, s66, 6144
buffer_load_dwordx4 v6, s[20:23], s63 offen offset:1024 lds
s_waitcnt vmcnt(11)
ds_read_b64_tr_b16 a[152:153], v130 offset:2048
ds_read_b64_tr_b16 a[154:155], v130 offset:2560
ds_read_b64_tr_b16 a[156:157], v131 offset:2048
ds_read_b64_tr_b16 a[158:159], v131 offset:2560
s_waitcnt lgkmcnt(0)
s_add_u32 m0, s78, 88064
s_add_u32 s63, s66, 14336
buffer_load_dwordx4 v6, s[20:23], s63 offen offset:0 lds
s_add_u32 s63, s66, 20480
buffer_load_dwordx4 v6, s[20:23], s63 offen offset:1024 lds
s_waitcnt vmcnt(11)
ds_read_b64_tr_b16 a[160:161], v130 offset:4096
ds_read_b64_tr_b16 a[162:163], v130 offset:4608
ds_read_b64_tr_b16 a[164:165], v131 offset:4096
ds_read_b64_tr_b16 a[166:167], v131 offset:4608
s_waitcnt lgkmcnt(0)
s_add_u32 m0, s78, 90112
s_add_u32 s63, s66, 28672
buffer_load_dwordx4 v6, s[20:23], s63 offen offset:0 lds
s_add_u32 s63, s66, 34816
buffer_load_dwordx4 v6, s[20:23], s63 offen offset:1024 lds
s_waitcnt vmcnt(11)
ds_read_b64_tr_b16 a[168:169], v130 offset:28672
ds_read_b64_tr_b16 a[170:171], v130 offset:29184
ds_read_b64_tr_b16 a[172:173], v131 offset:28672
ds_read_b64_tr_b16 a[174:175], v131 offset:29184
s_waitcnt lgkmcnt(0)
s_add_u32 m0, s78, 114688
s_add_u32 s63, s66, 43008
buffer_load_dwordx4 v6, s[20:23], s63 offen offset:0 lds
s_add_u32 s63, s66, 49152
buffer_load_dwordx4 v6, s[20:23], s63 offen offset:1024 lds
s_waitcnt vmcnt(10)
ds_read_b64_tr_b16 a[176:177], v130 offset:30720
ds_read_b64_tr_b16 a[178:179], v130 offset:31232
ds_read_b64_tr_b16 a[180:181], v131 offset:30720
ds_read_b64_tr_b16 a[182:183], v131 offset:31232
s_waitcnt vmcnt(8)
ds_read_b64_tr_b16 a[184:185], v130 offset:32768
ds_read_b64_tr_b16 a[186:187], v130 offset:33280
ds_read_b64_tr_b16 a[188:189], v131 offset:32768
ds_read_b64_tr_b16 a[190:191], v131 offset:33280
s_waitcnt vmcnt(6)
ds_read_b64_tr_b16 a[192:193], v130 offset:0
ds_read_b64_tr_b16 a[194:195], v130 offset:512
ds_read_b64_tr_b16 a[196:197], v131 offset:0
ds_read_b64_tr_b16 a[198:199], v131 offset:512
s_waitcnt vmcnt(4)
ds_read_b64_tr_b16 a[200:201], v130 offset:2048
ds_read_b64_tr_b16 a[202:203], v130 offset:2560
ds_read_b64_tr_b16 a[204:205], v131 offset:2048
ds_read_b64_tr_b16 a[206:207], v131 offset:2560
v_mov_b32 v146, s35
s_add_u32 s60, s41, 256
s_mov_b64 exec, 1
buffer_store_dword v146, off, s[4:7], s60 sc1
s_mov_b64 exec, -1
s_waitcnt vmcnt(3)
ds_read_b64_tr_b16 a[208:209], v130 offset:4096
ds_read_b64_tr_b16 a[210:211], v130 offset:4608
ds_read_b64_tr_b16 a[212:213], v131 offset:4096
ds_read_b64_tr_b16 a[214:215], v131 offset:4608
s_waitcnt vmcnt(1)
ds_read_b64_tr_b16 a[216:217], v130 offset:28672
ds_read_b64_tr_b16 a[218:219], v130 offset:29184
ds_read_b64_tr_b16 a[220:221], v131 offset:28672
ds_read_b64_tr_b16 a[222:223], v131 offset:29184
s_waitcnt lgkmcnt(0)
s_barrier
s_or_b32 s61, s34, s33
s_or_b32 s61, s61, s32
s_cmp_lg_u32 s61, 0
s_cbranch_scc1 LX_174
v_mov_b32 v148, s35
s_mov_b64 exec, 1
buffer_store_dword v148, off, s[4:7], 0 sc1
s_mov_b64 exec, -1
LX_174:
v_lshrrev_b32 v126, 5, v0
v_mul_u32_u24 v126, 1536, v126
v_add_u32 v126, v1, v126
v_add_u32 v109, 114688, v1
v_add_u32 v110, 86016, v1
v_lshlrev_b32 v108, 3, v0
v_add_u32 v108, 161792, v108
s_lshr_b32 s61, s89, 3
v_add_u32 v111, s61, v108
v_mov_b32 v106, s82
v_mov_b32 v90, 0
v_mov_b32 v91, 0
s_lshr_b32 s66, s89, 1
s_add_u32 s67, s66, s77
s_add_u32 s60, s35, 3
LP_175:
buffer_load_dword v94, v4, s[4:7], s40 offen sc1
s_sub_u32 s37, s37, 1
s_cmp_lt_i32 s37, 0
s_cbranch_scc1 LD_176
s_waitcnt vmcnt(0)
v_subrev_u32 v94, s60, v94
v_cmp_le_u32 vcc, 64, v94
s_and_b64 vcc, vcc, s[48:49]
s_cbranch_scc1 LP_175
LD_176:
s_add_u32 m0, s66, 114688
s_add_u32 s63, s67, 0
buffer_load_dwordx4 v1, s[4:7], s63 offen offset:0 sc1 lds
buffer_load_dwordx4 v1, s[4:7], s63 offen offset:1024 sc1 lds
s_add_u32 m0, s66, 122880
s_add_u32 s63, s67, 8192
buffer_load_dwordx4 v1, s[4:7], s63 offen offset:0 sc1 lds
buffer_load_dwordx4 v1, s[4:7], s63 offen offset:1024 sc1 lds
s_add_u32 m0, s66, 131072
s_add_u32 s63, s67, 16384
buffer_load_dwordx4 v1, s[4:7], s63 offen offset:0 sc1 lds
buffer_load_dwordx4 v1, s[4:7], s63 offen offset:1024 sc1 lds
s_lshr_b32 s62, s89, 2
s_add_u32 m0, s62, 139264
s_add_u32 s63, s62, s77
s_add_u32 s63, s63, 24576
buffer_load_dwordx4 v1, s[4:7], s63 offen offset:0 sc1 lds
s_waitcnt vmcnt(5)
s_barrier
ds_read_b128 v[42:45], v109 offset:0
ds_read_b128 v[46:49], v109 offset:1024
ds_read_b128 v[50:53], v109 offset:2048
ds_read_b128 v[54:57], v109 offset:3072
ds_read_b128 v[74:77], v109 offset:4096
ds_read_b128 v[78:81], v109 offset:5120
s_waitcnt lgkmcnt(2)
v_mfma_f32_32x32x16_bf16 v[26:41], a[224:227], v[42:45], 0
buffer_load_dwordx4 v[112:115], v126, s[4:7], s71 offen offset:0 sc1
ds_read_b128 v[168:171], v109 offset:6144
v_mfma_f32_32x32x16_bf16 v[26:41], a[228:231], v[46:49], v[26:41]
buffer_load_dwordx4 v[116:119], v126, s[4:7], s71 offen offset:512 sc1
s_waitcnt vmcnt(5)
s_barrier
ds_read_b128 v[172:175], v109 offset:7168
v_mfma_f32_32x32x16_bf16 v[26:41], a[232:235], v[50:53], v[26:41]
buffer_load_dwordx4 v[120:123], v126, s[4:7], s71 offen offset:1024 sc1
ds_read_b128 v[160:163], v109 offset:8192
v_mfma_f32_32x32x16_bf16 v[26:41], a[236:239], v[54:57], v[26:41]
buffer_load_dwordx4 v[124:127], v126, s[4:7], s71 offen offset:1536 sc1
ds_read_b128 v[164:167], v109 offset:9216
s_waitcnt lgkmcnt(2)
v_mfma_f32_32x32x16_bf16 v[26:41], a[240:243], v[74:77], v[26:41]
s_add_u32 m0, s66, 86016
s_add_u32 s63, s67, 57344
ds_read_b128 v[42:45], v109 offset:10240
v_mfma_f32_32x32x16_bf16 v[26:41], a[244:247], v[78:81], v[26:41]
buffer_load_dwordx4 v1, s[4:7], s63 offen offset:0 sc1 lds
ds_read_b128 v[46:49], v109 offset:11264
v_mfma_f32_32x32x16_bf16 v[26:41], a[248:251], v[168:171], v[26:41]
ds_read_b128 v[50:53], v109 offset:12288
v_mfma_f32_32x32x16_bf16 v[26:41], a[252:255], v[172:175], v[26:41]
buffer_load_dwordx4 v1, s[4:7], s63 offen offset:1024 sc1 lds
ds_read_b128 v[54:57], v109 offset:13312
s_waitcnt lgkmcnt(2)
v_mfma_f32_32x32x16_bf16 v[26:41], v[176:179], v[160:163], v[26:41]
s_add_u32 m0, s66, 94208
s_add_u32 s63, s67, 65536
ds_read_b128 v[74:77], v109 offset:14336
v_mfma_f32_32x32x16_bf16 v[26:41], v[180:183], v[164:167], v[26:41]
s_waitcnt vmcnt(6)
s_barrier
buffer_load_dwordx4 v1, s[4:7], s63 offen offset:0 sc1 lds
ds_read_b128 v[78:81], v109 offset:15360
v_mfma_f32_32x32x16_bf16 v[26:41], v[184:187], v[42:45], v[26:41]
ds_read_b128 v[168:171], v109 offset:16384
v_mfma_f32_32x32x16_bf16 v[26:41], v[188:191], v[46:49], v[26:41]
buffer_load_dwordx4 v1, s[4:7], s63 offen offset:1024 sc1 lds
ds_read_b128 v[172:175], v109 offset:17408
s_waitcnt vmcnt(4)
v_add_f32 v112, v112, v114
v_add_f32 v113, v113, v115
v_add_f32 v116, v116, v118
v_add_f32 v117, v117, v119
v_add_f32 v120, v120, v122
s_waitcnt lgkmcnt(2)
v_mfma_f32_32x32x16_bf16 v[26:41], v[192:195], v[50:53], v[26:41]
s_add_u32 m0, s66, 102400
s_add_u32 s63, s67, 73728
ds_read_b128 v[160:163], v109 offset:18432
v_add_f32 v121, v121, v123
v_add_f32 v124, v124, v126
v_add_f32 v125, v125, v127
v_cndmask_b32 v124, v124, 0, s[56:57]
v_cndmask_b32 v125, v125, 0, s[56:57]
v_add_f32 v112, v112, v116
v_mfma_f32_32x32x16_bf16 v[26:41], v[196:199], v[54:57], v[26:41]
buffer_load_dwordx4 v1, s[4:7], s63 offen offset:0 sc1 lds
ds_read_b128 v[164:167], v109 offset:19456
v_add_f32 v113, v113, v117
v_add_f32 v120, v120, v124
v_add_f32 v121, v121, v125
v_add_f32 v112, v112, v120
v_add_f32 v113, v113, v121
v_mov_b32 v114, v112
v_mfma_f32_32x32x16_bf16 v[26:41], v[200:203], v[74:77], v[26:41]
ds_read_b128 v[42:45], v109 offset:20480
v_mov_b32 v115, v113
v_mov_b32 v84, 0
v_mov_b32 v85, 0
v_permlane32_swap_b32 v112, v114
v_permlane32_swap_b32 v113, v115
v_mfma_f32_32x32x16_bf16 v[26:41], v[204:207], v[78:81], v[26:41]
buffer_load_dwordx4 v1, s[4:7], s63 offen offset:1024 sc1 lds
ds_read_b128 v[46:49], v109 offset:21504
v_add_f32 v112, v112, v114
v_add_f32 v113, v113, v115
v_mul_f32 v114, 0x3b124925, v112
v_mul_f32 v113, 0x3b124925, v113
v_fmamk_f32 v112, v114, 0xc3e00000, v112
s_waitcnt lgkmcnt(2)
v_mfma_f32_32x32x16_bf16 v[26:41], v[208:211], v[168:171], v[26:41]
s_lshr_b32 s62, s89, 2
s_add_u32 m0, s62, 110592
s_add_u32 s63, s62, s77
s_add_u32 s63, s63, 81920
ds_read_b128 v[50:53], v109 offset:22528
v_fmamk_f32 v112, v112, 0x3b124925, v114
v_fma_f32 v113, -v112, v112, v113
v_max_f32 v113, 0, v113
v_cvt_pk_bf16_f32 v114, -v112, v113
v_and_b32 v113, 0xffff0000, v114
v_mfma_f32_32x32x16_bf16 v[26:41], v[212:215], v[172:175], v[26:41]
buffer_load_dwordx4 v1, s[4:7], s63 offen offset:0 sc1 lds
ds_read_b128 v[54:57], v109 offset:23552
v_and_b32 v114, 0xffff, v114
v_add_f32 v113, 0x3727c5ac, v113
v_cndmask_b32 v83, v114, 0, s[56:57]
v_cvt_pk_bf16_f32 v113, v113, v113
v_lshl_or_b32 v82, v83, 16, v83
v_mfma_f32_32x32x16_bf16 v[26:41], v[216:219], v[160:163], v[26:41]
ds_read_b128 v[74:77], v109 offset:24576
v_and_b32 v113, 0xffff0000, v113
v_sqrt_f32 v113, v113
s_nop 0
v_cvt_pk_bf16_f32 v113, v113, v113
v_and_b32 v113, 0xffff0000, v113
v_mfma_f32_32x32x16_bf16 v[26:41], v[220:223], v[164:167], v[26:41]
ds_read_b128 v[78:81], v109 offset:25600
v_rcp_f32 v112, v113
s_nop 0
v_mul_f32 v113, 0x3fb8aa3b, v112
v_mov_b32 v112, v82
ds_write_b64 v111, v[112:113]
s_waitcnt lgkmcnt(3)
v_mfma_f32_32x32x16_bf16 v[26:41], v[224:227], v[42:45], v[26:41]
ds_read_b128 v[168:171], v109 offset:26624
v_mfma_f32_32x32x16_bf16 v[26:41], v[228:231], v[46:49], v[26:41]
s_waitcnt vmcnt(5) lgkmcnt(0)
s_barrier
ds_read_b128 v[172:175], v109 offset:27648
v_mfma_f32_32x32x16_bf16 v[26:41], v[232:235], v[50:53], v[26:41]
ds_read_b128 v[160:163], v110 offset:0
v_mfma_f32_32x32x16_bf16 v[26:41], v[236:239], v[54:57], v[26:41]
ds_read_b128 v[164:167], v110 offset:1024
s_waitcnt lgkmcnt(2)
v_mfma_f32_32x32x16_bf16 v[26:41], v[240:243], v[74:77], v[26:41]
s_waitcnt vmcnt(0)
s_barrier
ds_read_b64 v[86:87], v108 offset:0
ds_read_b128 v[42:45], v110 offset:2048
v_mfma_f32_32x32x16_bf16 v[26:41], v[244:247], v[78:81], v[26:41]
s_add_u32 m0, s66, 114688
s_add_u32 s63, s67, 28672
buffer_load_dwordx4 v1, s[4:7], s63 offen offset:0 sc1 lds
ds_read_b128 v[46:49], v110 offset:3072
v_mfma_f32_32x32x16_bf16 v[26:41], v[248:251], v[168:171], v[26:41]
s_waitcnt lgkmcnt(2)
v_mov_b32 v82, v86
v_and_b32 v83, 0xffff, v86
ds_read_b128 v[50:53], v110 offset:4096
v_mfma_f32_32x32x16_bf16 v[26:41], v[252:255], v[172:175], v[26:41]
buffer_load_dwordx4 v1, s[4:7], s63 offen offset:1024 sc1 lds
s_add_u32 m0, s66, 122880
s_add_u32 s63, s67, 36864
ds_read_b128 v[54:57], v110 offset:5120
v_mfma_f32_32x32x16_bf16 v[26:41], v[14:17], v[82:85], v[26:41]
buffer_load_dwordx4 v1, s[4:7], s63 offen offset:0 sc1 lds
s_waitcnt lgkmcnt(2)
v_mfma_f32_32x32x16_bf16 v[58:73], a[224:227], v[160:163], 0
buffer_load_dwordx4 v1, s[4:7], s63 offen offset:1024 sc1 lds
s_add_u32 m0, s66, 131072
s_add_u32 s63, s67, 45056
ds_read_b128 v[74:77], v110 offset:6144
v_mfma_f32_32x32x16_bf16 v[58:73], a[228:231], v[164:167], v[58:73]
buffer_load_dwordx4 v1, s[4:7], s63 offen offset:0 sc1 lds
ds_read_b128 v[78:81], v110 offset:7168
v_mfma_f32_32x32x16_bf16 v[58:73], a[232:235], v[42:45], v[58:73]
ds_read_b128 v[168:171], v110 offset:8192
v_mul_f32 v26, v26, v87
v_exp_f32 v102, -v26
v_mul_f32 v27, v27, v87
v_fma_f32 v102, v102, v106, v106
v_mfma_f32_32x32x16_bf16 v[58:73], a[236:239], v[46:49], v[58:73]
buffer_load_dwordx4 v1, s[4:7], s63 offen offset:1024 sc1 lds
ds_read_b128 v[172:175], v110 offset:9216
v_exp_f32 v103, -v27
v_mul_f32 v28, v28, v87
v_rcp_f32 v102, v102
s_waitcnt lgkmcnt(2)
v_mfma_f32_32x32x16_bf16 v[58:73], a[240:243], v[50:53], v[58:73]
s_lshr_b32 s62, s89, 2
s_add_u32 m0, s62, 139264
s_add_u32 s63, s62, s77
s_add_u32 s63, s63, 53248
ds_read_b128 v[160:163], v110 offset:10240
v_fma_f32 v103, v103, v106, v106
v_exp_f32 v104, -v28
v_mul_f32 v29, v29, v87
v_mul_f32 v26, v26, v102
v_mfma_f32_32x32x16_bf16 v[58:73], a[244:247], v[54:57], v[58:73]
buffer_load_dwordx4 v1, s[4:7], s63 offen offset:0 sc1 lds
ds_read_b128 v[164:167], v110 offset:11264
v_rcp_f32 v103, v103
v_fma_f32 v104, v104, v106, v106
v_exp_f32 v105, -v29
v_mfma_f32_32x32x16_bf16 v[58:73], a[248:251], v[74:77], v[58:73]
ds_read_b128 v[42:45], v110 offset:12288
v_mul_f32 v30, v30, v87
v_mul_f32 v27, v27, v103
v_rcp_f32 v104, v104
v_fma_f32 v105, v105, v106, v106
v_mfma_f32_32x32x16_bf16 v[58:73], a[252:255], v[78:81], v[58:73]
ds_read_b128 v[46:49], v110 offset:13312
v_exp_f32 v102, -v30
v_mul_f32 v31, v31, v87
v_mul_f32 v28, v28, v104
v_rcp_f32 v105, v105
s_waitcnt lgkmcnt(2)
v_mfma_f32_32x32x16_bf16 v[58:73], v[176:179], v[168:171], v[58:73]
ds_read_b128 v[50:53], v110 offset:14336
v_fma_f32 v102, v102, v106, v106
v_exp_f32 v103, -v31
v_mul_f32 v32, v32, v87
v_cvt_pk_bf16_f32 v94, v26, v27
v_mfma_f32_32x32x16_bf16 v[58:73], v[180:183], v[172:175], v[58:73]
ds_read_b128 v[54:57], v110 offset:15360
v_mul_f32 v29, v29, v105
v_rcp_f32 v102, v102
v_fma_f32 v103, v103, v106, v106
v_exp_f32 v104, -v32
v_mfma_f32_32x32x16_bf16 v[58:73], v[184:187], v[160:163], v[58:73]
ds_read_b128 v[74:77], v110 offset:16384
v_mul_f32 v33, v33, v87
v_mul_f32 v30, v30, v102
v_rcp_f32 v103, v103
v_fma_f32 v104, v104, v106, v106
v_mfma_f32_32x32x16_bf16 v[58:73], v[188:191], v[164:167], v[58:73]
ds_read_b128 v[78:81], v110 offset:17408
v_exp_f32 v105, -v33
v_mul_f32 v34, v34, v87
v_cvt_pk_bf16_f32 v95, v28, v29
v_mul_f32 v31, v31, v103
s_waitcnt lgkmcnt(2)
v_mfma_f32_32x32x16_bf16 v[58:73], v[192:195], v[42:45], v[58:73]
ds_read_b128 v[168:171], v110 offset:18432
v_rcp_f32 v104, v104
v_fma_f32 v105, v105, v106, v106
v_exp_f32 v102, -v34
v_mfma_f32_32x32x16_bf16 v[58:73], v[196:199], v[46:49], v[58:73]
ds_read_b128 v[172:175], v110 offset:19456
v_mul_f32 v35, v35, v87
v_mul_f32 v32, v32, v104
v_rcp_f32 v105, v105
v_fma_f32 v102, v102, v106, v106
v_mfma_f32_32x32x16_bf16 v[58:73], v[200:203], v[50:53], v[58:73]
ds_read_b128 v[160:163], v110 offset:20480
v_exp_f32 v103, -v35
v_mul_f32 v36, v36, v87
v_cvt_pk_bf16_f32 v96, v30, v31
v_mul_f32 v33, v33, v105
v_mfma_f32_32x32x16_bf16 v[58:73], v[204:207], v[54:57], v[58:73]
ds_read_b128 v[164:167], v110 offset:21504
v_rcp_f32 v102, v102
v_fma_f32 v103, v103, v106, v106
v_exp_f32 v104, -v36
s_waitcnt lgkmcnt(2)
v_mfma_f32_32x32x16_bf16 v[58:73], v[208:211], v[74:77], v[58:73]
ds_read_b128 v[42:45], v110 offset:22528
v_mul_f32 v37, v37, v87
v_mul_f32 v34, v34, v102
v_rcp_f32 v103, v103
v_fma_f32 v104, v104, v106, v106
v_mfma_f32_32x32x16_bf16 v[58:73], v[212:215], v[78:81], v[58:73]
ds_read_b128 v[46:49], v110 offset:23552
v_exp_f32 v105, -v37
v_mul_f32 v38, v38, v87
v_cvt_pk_bf16_f32 v97, v32, v33
s_add_u32 s61, s74, 0
v_mfma_f32_32x32x16_bf16 v[58:73], v[216:219], v[168:171], v[58:73]
buffer_store_dwordx4 v[94:97], v1, s[4:7], s61 offen sc1
ds_read_b128 v[50:53], v110 offset:24576
v_mul_f32 v35, v35, v103
v_rcp_f32 v104, v104
v_fma_f32 v105, v105, v106, v106
v_mfma_f32_32x32x16_bf16 v[58:73], v[220:223], v[172:175], v[58:73]
ds_read_b128 v[54:57], v110 offset:25600
v_exp_f32 v102, -v38
v_mul_f32 v39, v39, v87
v_mul_f32 v36, v36, v104
s_waitcnt lgkmcnt(2)
v_mfma_f32_32x32x16_bf16 v[58:73], v[224:227], v[160:163], v[58:73]
ds_read_b128 v[74:77], v110 offset:26624
v_rcp_f32 v105, v105
v_fma_f32 v102, v102, v106, v106
v_exp_f32 v103, -v39
v_mfma_f32_32x32x16_bf16 v[58:73], v[228:231], v[164:167], v[58:73]
s_waitcnt vmcnt(6)
s_barrier
ds_read_b128 v[78:81], v110 offset:27648
v_mul_f32 v40, v40, v87
v_cvt_pk_bf16_f32 v98, v34, v35
v_mul_f32 v37, v37, v105
v_rcp_f32 v102, v102
v_mfma_f32_32x32x16_bf16 v[58:73], v[232:235], v[42:45], v[58:73]
ds_read_b128 v[168:171], v109 offset:0
v_fma_f32 v103, v103, v106, v106
v_exp_f32 v104, -v40
v_mul_f32 v41, v41, v87
v_mul_f32 v38, v38, v102
v_mfma_f32_32x32x16_bf16 v[58:73], v[236:239], v[46:49], v[58:73]
ds_read_b128 v[172:175], v109 offset:1024
v_rcp_f32 v103, v103
v_fma_f32 v104, v104, v106, v106
v_exp_f32 v105, -v41
s_waitcnt lgkmcnt(2)
v_mfma_f32_32x32x16_bf16 v[58:73], v[240:243], v[50:53], v[58:73]
s_waitcnt vmcnt(1)
s_barrier
ds_read_b64 v[92:93], v108 offset:1024
ds_read_b128 v[160:163], v109 offset:2048
v_cvt_pk_bf16_f32 v99, v36, v37
v_mul_f32 v39, v39, v103
v_rcp_f32 v104, v104
v_mfma_f32_32x32x16_bf16 v[58:73], v[244:247], v[54:57], v[58:73]
s_add_u32 m0, s66, 86016
s_add_u32 s63, s67, 86016
buffer_load_dwordx4 v1, s[4:7], s63 offen offset:0 sc1 lds
ds_read_b128 v[164:167], v109 offset:3072
v_fma_f32 v105, v105, v106, v106
v_mul_f32 v40, v40, v104
v_rcp_f32 v105, v105
v_mfma_f32_32x32x16_bf16 v[58:73], v[248:251], v[74:77], v[58:73]
s_waitcnt lgkmcnt(2)
v_mov_b32 v88, v92
v_and_b32 v89, 0xffff, v92
ds_read_b128 v[42:45], v109 offset:4096
v_cvt_pk_bf16_f32 v100, v38, v39
v_mul_f32 v41, v41, v105
v_mfma_f32_32x32x16_bf16 v[58:73], v[252:255], v[78:81], v[58:73]
buffer_load_dwordx4 v1, s[4:7], s63 offen offset:1024 sc1 lds
s_add_u32 m0, s66, 94208
s_add_u32 s63, s67, 94208
ds_read_b128 v[46:49], v109 offset:5120
v_cvt_pk_bf16_f32 v101, v40, v41
v_mfma_f32_32x32x16_bf16 v[58:73], v[14:17], v[88:91], v[58:73]
buffer_store_dwordx4 v[98:101], v1, s[4:7], s61 offen offset:1024 sc1
buffer_load_dwordx4 v1, s[4:7], s63 offen offset:0 sc1 lds
s_waitcnt lgkmcnt(2)
v_mfma_f32_32x32x16_bf16 v[26:41], a[224:227], v[168:171], 0
buffer_load_dwordx4 v1, s[4:7], s63 offen offset:1024 sc1 lds
s_add_u32 m0, s66, 102400
s_add_u32 s63, s67, 102400
ds_read_b128 v[50:53], v109 offset:6144
v_mfma_f32_32x32x16_bf16 v[26:41], a[228:231], v[172:175], v[26:41]
buffer_load_dwordx4 v1, s[4:7], s63 offen offset:0 sc1 lds
ds_read_b128 v[54:57], v109 offset:7168
v_mfma_f32_32x32x16_bf16 v[26:41], a[232:235], v[160:163], v[26:41]
ds_read_b128 v[74:77], v109 offset:8192
v_mul_f32 v58, v58, v93
v_exp_f32 v102, -v58
v_mul_f32 v59, v59, v93
v_fma_f32 v102, v102, v106, v106
v_mfma_f32_32x32x16_bf16 v[26:41], a[236:239], v[164:167], v[26:41]
buffer_load_dwordx4 v1, s[4:7], s63 offen offset:1024 sc1 lds
ds_read_b128 v[78:81], v109 offset:9216
v_exp_f32 v103, -v59
v_mul_f32 v60, v60, v93
v_rcp_f32 v102, v102
s_waitcnt lgkmcnt(2)
v_mfma_f32_32x32x16_bf16 v[26:41], a[240:243], v[42:45], v[26:41]
s_lshr_b32 s62, s89, 2
s_add_u32 m0, s62, 110592
s_add_u32 s63, s62, s77
s_add_u32 s63, s63, 110592
ds_read_b128 v[168:171], v109 offset:10240
v_fma_f32 v103, v103, v106, v106
v_exp_f32 v104, -v60
v_mul_f32 v61, v61, v93
v_mul_f32 v58, v58, v102
v_mfma_f32_32x32x16_bf16 v[26:41], a[244:247], v[46:49], v[26:41]
buffer_load_dwordx4 v1, s[4:7], s63 offen offset:0 sc1 lds
ds_read_b128 v[172:175], v109 offset:11264
v_rcp_f32 v103, v103
v_fma_f32 v104, v104, v106, v106
v_exp_f32 v105, -v61
v_mfma_f32_32x32x16_bf16 v[26:41], a[248:251], v[50:53], v[26:41]
ds_read_b128 v[160:163], v109 offset:12288
v_mul_f32 v62, v62, v93
v_mul_f32 v59, v59, v103
v_rcp_f32 v104, v104
v_fma_f32 v105, v105, v106, v106
v_mfma_f32_32x32x16_bf16 v[26:41], a[252:255], v[54:57], v[26:41]
ds_read_b128 v[164:167], v109 offset:13312
v_exp_f32 v102, -v62
v_mul_f32 v63, v63, v93
v_mul_f32 v60, v60, v104
v_rcp_f32 v105, v105
s_waitcnt lgkmcnt(2)
v_mfma_f32_32x32x16_bf16 v[26:41], v[176:179], v[74:77], v[26:41]
s_add_u32 s60, s35, 4
v_mov_b32 v107, s60
ds_read_b128 v[42:45], v109 offset:14336
v_fma_f32 v102, v102, v106, v106
v_exp_f32 v103, -v63
v_mul_f32 v64, v64, v93
v_cvt_pk_bf16_f32 v94, v58, v59
v_mfma_f32_32x32x16_bf16 v[26:41], v[180:183], v[78:81], v[26:41]
s_waitcnt vmcnt(5)
s_mov_b64 exec, 1
buffer_store_dword v107, off, s[4:7], s41 sc1
s_mov_b64 exec, -1
ds_read_b128 v[46:49], v109 offset:15360
v_mul_f32 v61, v61, v105
v_rcp_f32 v102, v102
v_fma_f32 v103, v103, v106, v106
v_exp_f32 v104, -v64
v_mfma_f32_32x32x16_bf16 v[26:41], v[184:187], v[168:171], v[26:41]
ds_read_b128 v[50:53], v109 offset:16384
v_mul_f32 v65, v65, v93
v_mul_f32 v62, v62, v102
v_rcp_f32 v103, v103
v_fma_f32 v104, v104, v106, v106
v_mfma_f32_32x32x16_bf16 v[26:41], v[188:191], v[172:175], v[26:41]
ds_read_b128 v[54:57], v109 offset:17408
v_exp_f32 v105, -v65
v_mul_f32 v66, v66, v93
v_cvt_pk_bf16_f32 v95, v60, v61
v_mul_f32 v63, v63, v103
s_waitcnt lgkmcnt(2)
v_mfma_f32_32x32x16_bf16 v[26:41], v[192:195], v[160:163], v[26:41]
ds_read_b128 v[74:77], v109 offset:18432
v_rcp_f32 v104, v104
v_fma_f32 v105, v105, v106, v106
v_exp_f32 v102, -v66
v_mfma_f32_32x32x16_bf16 v[26:41], v[196:199], v[164:167], v[26:41]
ds_read_b128 v[78:81], v109 offset:19456
v_mul_f32 v67, v67, v93
v_mul_f32 v64, v64, v104
v_rcp_f32 v105, v105
v_fma_f32 v102, v102, v106, v106
v_mfma_f32_32x32x16_bf16 v[26:41], v[200:203], v[42:45], v[26:41]
ds_read_b128 v[168:171], v109 offset:20480
v_exp_f32 v103, -v67
v_mul_f32 v68, v68, v93
v_cvt_pk_bf16_f32 v96, v62, v63
v_mul_f32 v65, v65, v105
v_mfma_f32_32x32x16_bf16 v[26:41], v[204:207], v[46:49], v[26:41]
ds_read_b128 v[172:175], v109 offset:21504
v_rcp_f32 v102, v102
v_fma_f32 v103, v103, v106, v106
v_exp_f32 v104, -v68
s_waitcnt lgkmcnt(2)
v_mfma_f32_32x32x16_bf16 v[26:41], v[208:211], v[50:53], v[26:41]
ds_read_b128 v[160:163], v109 offset:22528
v_mul_f32 v69, v69, v93
v_mul_f32 v66, v66, v102
v_rcp_f32 v103, v103
v_fma_f32 v104, v104, v106, v106
v_mfma_f32_32x32x16_bf16 v[26:41], v[212:215], v[54:57], v[26:41]
ds_read_b128 v[164:167], v109 offset:23552
v_exp_f32 v105, -v69
v_mul_f32 v70, v70, v93
v_cvt_pk_bf16_f32 v97, v64, v65
s_add_u32 s61, s74, 229376
v_mfma_f32_32x32x16_bf16 v[26:41], v[216:219], v[74:77], v[26:41]
buffer_store_dwordx4 v[94:97], v1, s[4:7], s61 offen sc1
ds_read_b128 v[42:45], v109 offset:24576
v_mul_f32 v67, v67, v103
v_rcp_f32 v104, v104
v_fma_f32 v105, v105, v106, v106
v_mfma_f32_32x32x16_bf16 v[26:41], v[220:223], v[78:81], v[26:41]
ds_read_b128 v[46:49], v109 offset:25600
v_exp_f32 v102, -v70
v_mul_f32 v71, v71, v93
v_mul_f32 v68, v68, v104
s_waitcnt lgkmcnt(2)
v_mfma_f32_32x32x16_bf16 v[26:41], v[224:227], v[168:171], v[26:41]
ds_read_b128 v[50:53], v109 offset:26624
v_rcp_f32 v105, v105
v_fma_f32 v102, v102, v106, v106
v_exp_f32 v103, -v71
v_mfma_f32_32x32x16_bf16 v[26:41], v[228:231], v[172:175], v[26:41]
s_waitcnt vmcnt(8)
s_barrier
ds_read_b128 v[54:57], v109 offset:27648
v_mul_f32 v72, v72, v93
v_cvt_pk_bf16_f32 v98, v66, v67
v_mul_f32 v69, v69, v105
v_rcp_f32 v102, v102
v_mfma_f32_32x32x16_bf16 v[26:41], v[232:235], v[160:163], v[26:41]
ds_read_b128 v[74:77], v110 offset:0
v_fma_f32 v103, v103, v106, v106
v_exp_f32 v104, -v72
v_mul_f32 v73, v73, v93
v_mul_f32 v70, v70, v102
v_mfma_f32_32x32x16_bf16 v[26:41], v[236:239], v[164:167], v[26:41]
ds_read_b128 v[78:81], v110 offset:1024
v_rcp_f32 v103, v103
v_fma_f32 v104, v104, v106, v106
v_exp_f32 v105, -v73
s_waitcnt lgkmcnt(2)
v_mfma_f32_32x32x16_bf16 v[26:41], v[240:243], v[42:45], v[26:41]
s_waitcnt vmcnt(2)
s_barrier
ds_read_b64 v[86:87], v108 offset:512
ds_read_b128 v[168:171], v110 offset:2048
v_cvt_pk_bf16_f32 v99, v68, v69
v_mul_f32 v71, v71, v103
v_rcp_f32 v104, v104
v_mfma_f32_32x32x16_bf16 v[26:41], v[244:247], v[46:49], v[26:41]
ds_read_b128 v[172:175], v110 offset:3072
v_fma_f32 v105, v105, v106, v106
v_mul_f32 v72, v72, v104
v_rcp_f32 v105, v105
v_cvt_pk_bf16_f32 v100, v70, v71
v_mfma_f32_32x32x16_bf16 v[26:41], v[248:251], v[50:53], v[26:41]
s_waitcnt lgkmcnt(2)
v_mov_b32 v82, v86
v_and_b32 v83, 0xffff, v86
ds_read_b128 v[160:163], v110 offset:4096
v_mul_f32 v73, v73, v105
v_cvt_pk_bf16_f32 v101, v72, v73
v_mfma_f32_32x32x16_bf16 v[26:41], v[252:255], v[54:57], v[26:41]
buffer_store_dwordx4 v[98:101], v1, s[4:7], s61 offen offset:1024 sc1
ds_read_b128 v[164:167], v110 offset:5120
v_mfma_f32_32x32x16_bf16 v[26:41], v[14:17], v[82:85], v[26:41]
s_waitcnt lgkmcnt(2)
v_mfma_f32_32x32x16_bf16 v[58:73], a[224:227], v[74:77], 0
ds_read_b128 v[42:45], v110 offset:6144
v_mfma_f32_32x32x16_bf16 v[58:73], a[228:231], v[78:81], v[58:73]
ds_read_b128 v[46:49], v110 offset:7168
v_mfma_f32_32x32x16_bf16 v[58:73], a[232:235], v[168:171], v[58:73]
ds_read_b128 v[50:53], v110 offset:8192
s_nop 4
v_mul_f32 v26, v26, v87
v_exp_f32 v102, -v26
v_mul_f32 v27, v27, v87
v_fma_f32 v102, v102, v106, v106
v_mfma_f32_32x32x16_bf16 v[58:73], a[236:239], v[172:175], v[58:73]
ds_read_b128 v[54:57], v110 offset:9216
v_exp_f32 v103, -v27
v_mul_f32 v28, v28, v87
v_rcp_f32 v102, v102
s_waitcnt lgkmcnt(2)
v_mfma_f32_32x32x16_bf16 v[58:73], a[240:243], v[160:163], v[58:73]
ds_read_b128 v[74:77], v110 offset:10240
v_fma_f32 v103, v103, v106, v106
v_exp_f32 v104, -v28
v_mul_f32 v29, v29, v87
v_mul_f32 v26, v26, v102
v_mfma_f32_32x32x16_bf16 v[58:73], a[244:247], v[164:167], v[58:73]
ds_read_b128 v[78:81], v110 offset:11264
v_rcp_f32 v103, v103
v_fma_f32 v104, v104, v106, v106
v_exp_f32 v105, -v29
v_mfma_f32_32x32x16_bf16 v[58:73], a[248:251], v[42:45], v[58:73]
ds_read_b128 v[168:171], v110 offset:12288
v_mul_f32 v30, v30, v87
v_mul_f32 v27, v27, v103
v_rcp_f32 v104, v104
v_fma_f32 v105, v105, v106, v106
v_mfma_f32_32x32x16_bf16 v[58:73], a[252:255], v[46:49], v[58:73]
ds_read_b128 v[172:175], v110 offset:13312
v_exp_f32 v102, -v30
v_mul_f32 v31, v31, v87
v_mul_f32 v28, v28, v104
v_rcp_f32 v105, v105
s_waitcnt lgkmcnt(2)
v_mfma_f32_32x32x16_bf16 v[58:73], v[176:179], v[50:53], v[58:73]
s_add_u32 s60, s35, 5
v_mov_b32 v107, s60
ds_read_b128 v[160:163], v110 offset:14336
v_fma_f32 v102, v102, v106, v106
v_exp_f32 v103, -v31
v_mul_f32 v32, v32, v87
v_cvt_pk_bf16_f32 v94, v26, v27
v_mfma_f32_32x32x16_bf16 v[58:73], v[180:183], v[54:57], v[58:73]
s_waitcnt vmcnt(0)
s_mov_b64 exec, 1
buffer_store_dword v107, off, s[4:7], s41 sc1
s_mov_b64 exec, -1
ds_read_b128 v[164:167], v110 offset:15360
v_mul_f32 v29, v29, v105
v_rcp_f32 v102, v102
v_fma_f32 v103, v103, v106, v106
v_exp_f32 v104, -v32
v_mfma_f32_32x32x16_bf16 v[58:73], v[184:187], v[74:77], v[58:73]
ds_read_b128 v[42:45], v110 offset:16384
v_mul_f32 v33, v33, v87
v_mul_f32 v30, v30, v102
v_rcp_f32 v103, v103
v_fma_f32 v104, v104, v106, v106
v_mfma_f32_32x32x16_bf16 v[58:73], v[188:191], v[78:81], v[58:73]
ds_read_b128 v[46:49], v110 offset:17408
v_exp_f32 v105, -v33
v_mul_f32 v34, v34, v87
v_cvt_pk_bf16_f32 v95, v28, v29
v_mul_f32 v31, v31, v103
s_waitcnt lgkmcnt(2)
v_mfma_f32_32x32x16_bf16 v[58:73], v[192:195], v[168:171], v[58:73]
ds_read_b128 v[50:53], v110 offset:18432
v_rcp_f32 v104, v104
v_fma_f32 v105, v105, v106, v106
v_exp_f32 v102, -v34
v_mfma_f32_32x32x16_bf16 v[58:73], v[196:199], v[172:175], v[58:73]
ds_read_b128 v[54:57], v110 offset:19456
v_mul_f32 v35, v35, v87
v_mul_f32 v32, v32, v104
v_rcp_f32 v105, v105
v_fma_f32 v102, v102, v106, v106
v_mfma_f32_32x32x16_bf16 v[58:73], v[200:203], v[160:163], v[58:73]
ds_read_b128 v[74:77], v110 offset:20480
v_exp_f32 v103, -v35
v_mul_f32 v36, v36, v87
v_cvt_pk_bf16_f32 v96, v30, v31
v_mul_f32 v33, v33, v105
v_mfma_f32_32x32x16_bf16 v[58:73], v[204:207], v[164:167], v[58:73]
buffer_load_dword v107, v4, s[4:7], s40 offen sc1
ds_read_b128 v[78:81], v110 offset:21504
v_rcp_f32 v102, v102
v_fma_f32 v103, v103, v106, v106
v_exp_f32 v104, -v36
s_waitcnt lgkmcnt(2)
v_mfma_f32_32x32x16_bf16 v[58:73], v[208:211], v[42:45], v[58:73]
ds_read_b128 v[168:171], v110 offset:22528
v_mul_f32 v37, v37, v87
v_mul_f32 v34, v34, v102
v_rcp_f32 v103, v103
v_fma_f32 v104, v104, v106, v106
v_mfma_f32_32x32x16_bf16 v[58:73], v[212:215], v[46:49], v[58:73]
ds_read_b128 v[172:175], v110 offset:23552
v_exp_f32 v105, -v37
v_mul_f32 v38, v38, v87
v_cvt_pk_bf16_f32 v97, v32, v33
s_add_u32 s61, s74, 114688
v_mfma_f32_32x32x16_bf16 v[58:73], v[216:219], v[50:53], v[58:73]
buffer_store_dwordx4 v[94:97], v1, s[4:7], s61 offen sc1
ds_read_b128 v[160:163], v110 offset:24576
v_mul_f32 v35, v35, v103
v_rcp_f32 v104, v104
v_fma_f32 v105, v105, v106, v106
v_mfma_f32_32x32x16_bf16 v[58:73], v[220:223], v[54:57], v[58:73]
ds_read_b128 v[164:167], v110 offset:25600
v_exp_f32 v102, -v38
v_mul_f32 v39, v39, v87
v_mul_f32 v36, v36, v104
s_waitcnt lgkmcnt(2)
v_mfma_f32_32x32x16_bf16 v[58:73], v[224:227], v[74:77], v[58:73]
ds_read_b128 v[42:45], v110 offset:26624
v_rcp_f32 v105, v105
v_fma_f32 v102, v102, v106, v106
v_exp_f32 v103, -v39
v_mfma_f32_32x32x16_bf16 v[58:73], v[228:231], v[78:81], v[58:73]
s_add_u32 s60, s35, s39
s_add_u32 s60, s60, 4
s_waitcnt vmcnt(1)
LC_177:
v_subrev_u32 v107, s60, v107
v_cmp_le_u32 vcc, 64, v107
s_and_b64 vcc, vcc, s[52:53]
s_cbranch_scc1 LS_178
LD_179:
s_add_u32 s65, s75, s90
buffer_load_dwordx4 v[112:115], v1, s[4:7], s65 offen offset:0 sc1
ds_read_b128 v[46:49], v110 offset:27648
v_mul_f32 v40, v40, v87
v_cvt_pk_bf16_f32 v98, v34, v35
v_mul_f32 v37, v37, v105
v_rcp_f32 v102, v102
v_mfma_f32_32x32x16_bf16 v[58:73], v[232:235], v[168:171], v[58:73]
buffer_load_dwordx4 v[116:119], v1, s[4:7], s65 offen offset:1024 sc1
v_fma_f32 v103, v103, v106, v106
v_exp_f32 v104, -v40
v_mul_f32 v41, v41, v87
v_mul_f32 v38, v38, v102
v_mfma_f32_32x32x16_bf16 v[58:73], v[236:239], v[172:175], v[58:73]
buffer_load_dwordx4 v[120:123], v1, s[4:7], s65 offen offset:2048 sc1
v_rcp_f32 v103, v103
v_fma_f32 v104, v104, v106, v106
v_exp_f32 v105, -v41
s_waitcnt lgkmcnt(0)
v_mfma_f32_32x32x16_bf16 v[58:73], v[240:243], v[160:163], v[58:73]
ds_read_b64 v[92:93], v108 offset:1536
buffer_load_dwordx4 v[124:127], v1, s[4:7], s65 offen offset:3072 sc1
v_cvt_pk_bf16_f32 v99, v36, v37
v_mul_f32 v39, v39, v103
v_rcp_f32 v104, v104
v_mfma_f32_32x32x16_bf16 v[58:73], v[244:247], v[164:167], v[58:73]
s_add_u32 s65, s75, s91
buffer_load_dwordx4 v[128:131], v1, s[4:7], s65 offen offset:0 sc1
v_fma_f32 v105, v105, v106, v106
v_mul_f32 v40, v40, v104
v_rcp_f32 v105, v105
v_mfma_f32_32x32x16_bf16 v[58:73], v[248:251], v[42:45], v[58:73]
s_waitcnt lgkmcnt(0)
v_mov_b32 v88, v92
v_and_b32 v89, 0xffff, v92
buffer_load_dwordx4 v[132:135], v1, s[4:7], s65 offen offset:1024 sc1
v_cvt_pk_bf16_f32 v100, v38, v39
v_mul_f32 v41, v41, v105
v_mfma_f32_32x32x16_bf16 v[58:73], v[252:255], v[46:49], v[58:73]
buffer_load_dwordx4 v[136:139], v1, s[4:7], s65 offen offset:2048 sc1
v_cvt_pk_bf16_f32 v101, v40, v41
v_mfma_f32_32x32x16_bf16 v[58:73], v[14:17], v[88:91], v[58:73]
buffer_store_dwordx4 v[98:101], v1, s[4:7], s61 offen offset:1024 sc1
buffer_load_dwordx4 v[140:143], v1, s[4:7], s65 offen offset:3072 sc1
s_waitcnt vmcnt(8)
v_mfma_f32_32x32x16_bf16 v[26:41], a[0:3], v[112:115], 0
v_mfma_f32_32x32x16_bf16 v[42:57], a[4:7], v[112:115], 0
s_nop 6
v_pk_mul_f32 v[58:59], v[58:59], v[92:93] op_sel:[0,1] op_sel_hi:[1,1]
v_pk_mul_f32 v[60:61], v[60:61], v[92:93] op_sel:[0,1] op_sel_hi:[1,1]
v_exp_f32 v102, -v58
v_exp_f32 v103, -v59
v_exp_f32 v104, -v60
v_exp_f32 v105, -v61
v_pk_fma_f32 v[102:103], v[102:103], s[82:83], s[82:83]
v_pk_fma_f32 v[104:105], v[104:105], s[82:83], s[82:83]
v_rcp_f32 v102, v102
v_rcp_f32 v103, v103
v_rcp_f32 v104, v104
v_rcp_f32 v105, v105
v_pk_mul_f32 v[58:59], v[58:59], v[102:103]
v_pk_mul_f32 v[60:61], v[60:61], v[104:105]
v_cvt_pk_bf16_f32 v94, v58, v59
v_cvt_pk_bf16_f32 v95, v60, v61
s_add_u32 s65, s75, s92
buffer_load_dwordx4 v[144:147], v1, s[4:7], s65 offen offset:0 sc1
buffer_load_dwordx4 v[148:151], v1, s[4:7], s65 offen offset:1024 sc1
v_pk_mul_f32 v[62:63], v[62:63], v[92:93] op_sel:[0,1] op_sel_hi:[1,1]
v_pk_mul_f32 v[64:65], v[64:65], v[92:93] op_sel:[0,1] op_sel_hi:[1,1]
v_exp_f32 v102, -v62
v_exp_f32 v103, -v63
v_exp_f32 v104, -v64
v_exp_f32 v105, -v65
v_pk_fma_f32 v[102:103], v[102:103], s[82:83], s[82:83]
v_pk_fma_f32 v[104:105], v[104:105], s[82:83], s[82:83]
v_rcp_f32 v102, v102
v_rcp_f32 v103, v103
v_rcp_f32 v104, v104
v_rcp_f32 v105, v105
v_pk_mul_f32 v[62:63], v[62:63], v[102:103]
v_pk_mul_f32 v[64:65], v[64:65], v[104:105]
v_cvt_pk_bf16_f32 v96, v62, v63
v_cvt_pk_bf16_f32 v97, v64, v65
buffer_load_dwordx4 v[152:155], v1, s[4:7], s65 offen offset:2048 sc1
buffer_load_dwordx4 v[156:159], v1, s[4:7], s65 offen offset:3072 sc1
s_add_u32 s61, s74, 344064
buffer_store_dwordx4 v[94:97], v1, s[4:7], s61 offen sc1
v_pk_mul_f32 v[66:67], v[66:67], v[92:93] op_sel:[0,1] op_sel_hi:[1,1]
v_pk_mul_f32 v[68:69], v[68:69], v[92:93] op_sel:[0,1] op_sel_hi:[1,1]
v_exp_f32 v102, -v66
v_exp_f32 v103, -v67
v_exp_f32 v104, -v68
v_exp_f32 v105, -v69
v_pk_fma_f32 v[102:103], v[102:103], s[82:83], s[82:83]
v_pk_fma_f32 v[104:105], v[104:105], s[82:83], s[82:83]
v_rcp_f32 v102, v102
v_rcp_f32 v103, v103
v_rcp_f32 v104, v104
v_rcp_f32 v105, v105
v_pk_mul_f32 v[66:67], v[66:67], v[102:103]
v_pk_mul_f32 v[68:69], v[68:69], v[104:105]
v_cvt_pk_bf16_f32 v98, v66, v67
v_cvt_pk_bf16_f32 v99, v68, v69
v_pk_mul_f32 v[70:71], v[70:71], v[92:93] op_sel:[0,1] op_sel_hi:[1,1]
v_pk_mul_f32 v[72:73], v[72:73], v[92:93] op_sel:[0,1] op_sel_hi:[1,1]
v_exp_f32 v102, -v70
v_exp_f32 v103, -v71
v_exp_f32 v104, -v72
v_exp_f32 v105, -v73
v_pk_fma_f32 v[102:103], v[102:103], s[82:83], s[82:83]
v_pk_fma_f32 v[104:105], v[104:105], s[82:83], s[82:83]
v_rcp_f32 v102, v102
v_rcp_f32 v103, v103
v_rcp_f32 v104, v104
v_rcp_f32 v105, v105
v_pk_mul_f32 v[70:71], v[70:71], v[102:103]
v_pk_mul_f32 v[72:73], v[72:73], v[104:105]
v_cvt_pk_bf16_f32 v100, v70, v71
v_cvt_pk_bf16_f32 v101, v72, v73
buffer_store_dwordx4 v[98:101], v1, s[4:7], s61 offen offset:1024 sc1
s_waitcnt vmcnt(13)
v_mfma_f32_32x32x16_bf16 v[26:41], a[8:11], v[116:119], v[26:41]
s_add_u32 s60, s35, 6
v_mov_b32 v107, s60
s_add_u32 s65, s75, s93
buffer_load_dwordx4 v[112:115], v1, s[4:7], s65 offen offset:0 sc1
v_mfma_f32_32x32x16_bf16 v[42:57], a[12:15], v[116:119], v[42:57]
s_waitcnt vmcnt(8)
s_mov_b64 exec, 1
buffer_store_dword v107, off, s[4:7], s41 sc1
s_mov_b64 exec, -1
buffer_load_dwordx4 v[116:119], v1, s[4:7], s65 offen offset:1024 sc1
s_waitcnt vmcnt(15)
v_mfma_f32_32x32x16_bf16 v[26:41], a[16:19], v[120:123], v[26:41]
v_mfma_f32_32x32x16_bf16 v[42:57], a[20:23], v[120:123], v[42:57]
buffer_load_dwordx4 v[120:123], v1, s[4:7], s65 offen offset:2048 sc1
s_waitcnt vmcnt(15)
v_mfma_f32_32x32x16_bf16 v[26:41], a[24:27], v[124:127], v[26:41]
v_mfma_f32_32x32x16_bf16 v[42:57], a[28:31], v[124:127], v[42:57]
buffer_load_dwordx4 v[124:127], v1, s[4:7], s65 offen offset:3072 sc1
s_waitcnt vmcnt(15)
v_mfma_f32_32x32x16_bf16 v[26:41], a[32:35], v[128:131], v[26:41]
v_mfma_f32_32x32x16_bf16 v[42:57], a[36:39], v[128:131], v[42:57]
s_add_u32 s65, s75, s94
buffer_load_dwordx4 v[128:131], v1, s[4:7], s65 offen offset:0 sc1
s_waitcnt vmcnt(15)
v_mfma_f32_32x32x16_bf16 v[26:41], a[40:43], v[132:135], v[26:41]
v_mfma_f32_32x32x16_bf16 v[42:57], a[44:47], v[132:135], v[42:57]
buffer_load_dwordx4 v[132:135], v1, s[4:7], s65 offen offset:1024 sc1
s_waitcnt vmcnt(15)
v_mfma_f32_32x32x16_bf16 v[26:41], a[48:51], v[136:139], v[26:41]
s_add_u32 s60, s35, 7
v_mov_b32 v107, s60
v_mfma_f32_32x32x16_bf16 v[42:57], a[52:55], v[136:139], v[42:57]
s_waitcnt vmcnt(7)
s_mov_b64 exec, 1
buffer_store_dword v107, off, s[4:7], s41 sc1
s_mov_b64 exec, -1
buffer_load_dwordx4 v[136:139], v1, s[4:7], s65 offen offset:2048 sc1
s_waitcnt vmcnt(15)
v_mfma_f32_32x32x16_bf16 v[26:41], a[56:59], v[140:143], v[26:41]
v_mfma_f32_32x32x16_bf16 v[42:57], a[60:63], v[140:143], v[42:57]
buffer_load_dwordx4 v[140:143], v1, s[4:7], s65 offen offset:3072 sc1
s_waitcnt vmcnt(15)
v_mfma_f32_32x32x16_bf16 v[26:41], a[64:67], v[144:147], v[26:41]
v_mfma_f32_32x32x16_bf16 v[42:57], a[68:71], v[144:147], v[42:57]
s_add_u32 s65, s75, s95
buffer_load_dwordx4 v[144:147], v1, s[4:7], s65 offen offset:0 sc1
s_waitcnt vmcnt(15)
v_mfma_f32_32x32x16_bf16 v[26:41], a[72:75], v[148:151], v[26:41]
v_mfma_f32_32x32x16_bf16 v[42:57], a[76:79], v[148:151], v[42:57]
buffer_load_dwordx4 v[148:151], v1, s[4:7], s65 offen offset:1024 sc1
s_waitcnt vmcnt(15)
v_mfma_f32_32x32x16_bf16 v[26:41], a[80:83], v[152:155], v[26:41]
v_mfma_f32_32x32x16_bf16 v[42:57], a[84:87], v[152:155], v[42:57]
buffer_load_dwordx4 v[152:155], v1, s[4:7], s65 offen offset:2048 sc1
s_waitcnt vmcnt(15)
v_mfma_f32_32x32x16_bf16 v[26:41], a[88:91], v[156:159], v[26:41]
v_mfma_f32_32x32x16_bf16 v[42:57], a[92:95], v[156:159], v[42:57]
buffer_load_dwordx4 v[156:159], v1, s[4:7], s65 offen offset:3072 sc1
s_waitcnt vmcnt(13)
v_mfma_f32_32x32x16_bf16 v[26:41], a[96:99], v[112:115], v[26:41]
buffer_load_dword v107, v4, s[4:7], s40 offen sc1
v_mfma_f32_32x32x16_bf16 v[42:57], a[100:103], v[112:115], v[42:57]
s_add_u32 s65, s75, s96
buffer_load_dwordx4 v[112:115], v1, s[4:7], s65 offen offset:0 sc1
s_waitcnt vmcnt(13)
v_mfma_f32_32x32x16_bf16 v[26:41], a[104:107], v[116:119], v[26:41]
v_mfma_f32_32x32x16_bf16 v[42:57], a[108:111], v[116:119], v[42:57]
buffer_load_dwordx4 v[116:119], v1, s[4:7], s65 offen offset:1024 sc1
s_waitcnt vmcnt(13)
v_mfma_f32_32x32x16_bf16 v[26:41], a[112:115], v[120:123], v[26:41]
v_mfma_f32_32x32x16_bf16 v[42:57], a[116:119], v[120:123], v[42:57]
buffer_load_dwordx4 v[120:123], v1, s[4:7], s65 offen offset:2048 sc1
s_waitcnt vmcnt(13)
v_mfma_f32_32x32x16_bf16 v[26:41], a[120:123], v[124:127], v[26:41]
v_mfma_f32_32x32x16_bf16 v[42:57], a[124:127], v[124:127], v[42:57]
buffer_load_dwordx4 v[124:127], v1, s[4:7], s65 offen offset:3072 sc1
s_waitcnt vmcnt(13)
v_mfma_f32_32x32x16_bf16 v[26:41], a[128:131], v[128:131], v[26:41]
v_mfma_f32_32x32x16_bf16 v[42:57], a[132:135], v[128:131], v[42:57]
s_waitcnt vmcnt(12)
v_mfma_f32_32x32x16_bf16 v[26:41], a[136:139], v[132:135], v[26:41]
v_mfma_f32_32x32x16_bf16 v[42:57], a[140:143], v[132:135], v[42:57]
s_waitcnt vmcnt(10)
v_mfma_f32_32x32x16_bf16 v[26:41], a[144:147], v[136:139], v[26:41]
s_add_u32 s60, s35, s39
s_add_u32 s60, s60, 6
s_waitcnt vmcnt(4)
LC_180:
v_subrev_u32 v107, s60, v107
v_cmp_le_u32 vcc, 64, v107
s_and_b64 vcc, vcc, s[52:53]
s_cbranch_scc1 LS_181
LD_182:
s_add_u32 s65, s3, s90
buffer_load_dwordx4 v[128:131], v1, s[4:7], s65 offen offset:0 sc1
v_mfma_f32_32x32x16_bf16 v[42:57], a[148:151], v[136:139], v[42:57]
buffer_load_dwordx4 v[132:135], v1, s[4:7], s65 offen offset:1024 sc1
s_waitcnt vmcnt(11)
v_mfma_f32_32x32x16_bf16 v[26:41], a[152:155], v[140:143], v[26:41]
buffer_load_dwordx4 v[136:139], v1, s[4:7], s65 offen offset:2048 sc1
v_mfma_f32_32x32x16_bf16 v[42:57], a[156:159], v[140:143], v[42:57]
buffer_load_dwordx4 v[140:143], v1, s[4:7], s65 offen offset:3072 sc1
s_waitcnt vmcnt(12)
v_mfma_f32_32x32x16_bf16 v[26:41], a[160:163], v[144:147], v[26:41]
s_and_b32 s61, s32, 1
s_mul_i32 s62, s61, 12288
s_add_u32 s62, s62, 86016
v_add_u32 v90, s62, v1
v_mfma_f32_32x32x16_bf16 v[42:57], a[164:167], v[144:147], v[42:57]
s_add_u32 s65, s3, s91
buffer_load_dwordx4 v[144:147], v1, s[4:7], s65 offen offset:0 sc1
s_waitcnt vmcnt(12)
v_mfma_f32_32x32x16_bf16 v[26:41], a[168:171], v[148:151], v[26:41]
s_xor_b32 s61, s61, 1
s_mul_i32 s62, s61, 12288
s_add_u32 s62, s62, 86016
v_add_u32 v91, s62, v1
v_mfma_f32_32x32x16_bf16 v[42:57], a[172:175], v[148:151], v[42:57]
buffer_load_dwordx4 v[148:151], v1, s[4:7], s65 offen offset:1024 sc1
s_waitcnt vmcnt(12)
v_mfma_f32_32x32x16_bf16 v[26:41], a[176:179], v[152:155], v[26:41]
v_mfma_f32_32x32x16_bf16 v[42:57], a[180:183], v[152:155], v[42:57]
buffer_load_dwordx4 v[152:155], v1, s[4:7], s65 offen offset:2048 sc1
s_waitcnt vmcnt(12)
v_mfma_f32_32x32x16_bf16 v[26:41], a[184:187], v[156:159], v[26:41]
v_mfma_f32_32x32x16_bf16 v[42:57], a[188:191], v[156:159], v[42:57]
buffer_load_dwordx4 v[156:159], v1, s[4:7], s65 offen offset:3072 sc1
s_waitcnt vmcnt(11)
v_mfma_f32_32x32x16_bf16 v[26:41], a[192:195], v[112:115], v[26:41]
v_mfma_f32_32x32x16_bf16 v[42:57], a[196:199], v[112:115], v[42:57]
s_add_u32 s65, s3, s92
buffer_load_dwordx4 v[112:115], v1, s[4:7], s65 offen offset:0 sc1
s_waitcnt vmcnt(11)
v_mfma_f32_32x32x16_bf16 v[26:41], a[200:203], v[116:119], v[26:41]
v_mfma_f32_32x32x16_bf16 v[42:57], a[204:207], v[116:119], v[42:57]
buffer_load_dwordx4 v[116:119], v1, s[4:7], s65 offen offset:1024 sc1
s_waitcnt vmcnt(11)
v_mfma_f32_32x32x16_bf16 v[26:41], a[208:211], v[120:123], v[26:41]
v_mfma_f32_32x32x16_bf16 v[42:57], a[212:215], v[120:123], v[42:57]
buffer_load_dwordx4 v[120:123], v1, s[4:7], s65 offen offset:2048 sc1
s_waitcnt vmcnt(11)
v_mfma_f32_32x32x16_bf16 v[26:41], a[216:219], v[124:127], v[26:41]
v_mfma_f32_32x32x16_bf16 v[42:57], a[220:223], v[124:127], v[42:57]
buffer_load_dwordx4 v[124:127], v1, s[4:7], s65 offen offset:3072 sc1
s_cmp_lt_u32 s32, 2
s_cbranch_scc0 LB_183
s_waitcnt vmcnt(11)
v_mfma_f32_32x32x16_bf16 v[58:73], a[0:3], v[128:131], 0
v_mfma_f32_32x32x16_bf16 v[74:89], a[4:7], v[128:131], 0
s_add_u32 s65, s3, s93
buffer_load_dwordx4 v[128:131], v1, s[4:7], s65 offen offset:0 sc1
s_waitcnt vmcnt(11)
v_mfma_f32_32x32x16_bf16 v[58:73], a[8:11], v[132:135], v[58:73]
s_nop 1
ds_write_b128 v91, v[42:45] offset:28672
v_lshlrev_b32 v92, 16, v18
v_and_b32 v93, 0xffff0000, v18
v_add_f32 v26, v26, v92
v_add_f32 v27, v27, v93
v_lshlrev_b32 v92, 16, v19
v_mfma_f32_32x32x16_bf16 v[74:89], a[12:15], v[132:135], v[74:89]
buffer_load_dwordx4 v[132:135], v1, s[4:7], s65 offen offset:1024 sc1
v_and_b32 v93, 0xffff0000, v19
v_add_f32 v28, v28, v92
v_add_f32 v29, v29, v93
v_lshlrev_b32 v92, 16, v20
s_waitcnt vmcnt(11)
v_mfma_f32_32x32x16_bf16 v[58:73], a[16:19], v[136:139], v[58:73]
ds_write_b128 v91, v[46:49] offset:29696
v_and_b32 v93, 0xffff0000, v20
v_add_f32 v30, v30, v92
v_add_f32 v31, v31, v93
v_lshlrev_b32 v92, 16, v21
v_and_b32 v93, 0xffff0000, v21
v_mfma_f32_32x32x16_bf16 v[74:89], a[20:23], v[136:139], v[74:89]
buffer_load_dwordx4 v[136:139], v1, s[4:7], s65 offen offset:2048 sc1
v_add_f32 v32, v32, v92
v_add_f32 v33, v33, v93
v_lshlrev_b32 v92, 16, v22
v_and_b32 v93, 0xffff0000, v22
s_waitcnt vmcnt(11)
v_mfma_f32_32x32x16_bf16 v[58:73], a[24:27], v[140:143], v[58:73]
ds_write_b128 v91, v[50:53] offset:30720
v_add_f32 v34, v34, v92
v_add_f32 v35, v35, v93
v_lshlrev_b32 v92, 16, v23
v_and_b32 v93, 0xffff0000, v23
v_add_f32 v36, v36, v92
v_mfma_f32_32x32x16_bf16 v[74:89], a[28:31], v[140:143], v[74:89]
buffer_load_dwordx4 v[140:143], v1, s[4:7], s65 offen offset:3072 sc1
v_add_f32 v37, v37, v93
v_lshlrev_b32 v92, 16, v24
v_and_b32 v93, 0xffff0000, v24
v_add_f32 v38, v38, v92
s_waitcnt vmcnt(11)
v_mfma_f32_32x32x16_bf16 v[58:73], a[32:35], v[144:147], v[58:73]
ds_write_b128 v91, v[54:57] offset:31744
v_add_f32 v39, v39, v93
v_lshlrev_b32 v92, 16, v25
v_and_b32 v93, 0xffff0000, v25
v_add_f32 v40, v40, v92
v_add_f32 v41, v41, v93
v_mfma_f32_32x32x16_bf16 v[74:89], a[36:39], v[144:147], v[74:89]
s_add_u32 s65, s3, s94
buffer_load_dwordx4 v[144:147], v1, s[4:7], s65 offen offset:0 sc1
s_waitcnt vmcnt(11)
v_mfma_f32_32x32x16_bf16 v[58:73], a[40:43], v[148:151], v[58:73]
v_mfma_f32_32x32x16_bf16 v[74:89], a[44:47], v[148:151], v[74:89]
buffer_load_dwordx4 v[148:151], v1, s[4:7], s65 offen offset:1024 sc1
s_waitcnt vmcnt(11)
v_mfma_f32_32x32x16_bf16 v[58:73], a[48:51], v[152:155], v[58:73]
v_mfma_f32_32x32x16_bf16 v[74:89], a[52:55], v[152:155], v[74:89]
buffer_load_dwordx4 v[152:155], v1, s[4:7], s65 offen offset:2048 sc1
s_waitcnt vmcnt(11)
v_mfma_f32_32x32x16_bf16 v[58:73], a[56:59], v[156:159], v[58:73]
v_mfma_f32_32x32x16_bf16 v[74:89], a[60:63], v[156:159], v[74:89]
buffer_load_dwordx4 v[156:159], v1, s[4:7], s65 offen offset:3072 sc1
s_waitcnt vmcnt(11)
v_mfma_f32_32x32x16_bf16 v[58:73], a[64:67], v[112:115], v[58:73]
v_mfma_f32_32x32x16_bf16 v[74:89], a[68:71], v[112:115], v[74:89]
s_add_u32 s65, s3, s95
buffer_load_dwordx4 v[112:115], v1, s[4:7], s65 offen offset:0 sc1
s_waitcnt vmcnt(11)
v_mfma_f32_32x32x16_bf16 v[58:73], a[72:75], v[116:119], v[58:73]
s_waitcnt lgkmcnt(0)
s_barrier
v_mfma_f32_32x32x16_bf16 v[74:89], a[76:79], v[116:119], v[74:89]
buffer_load_dwordx4 v[116:119], v1, s[4:7], s65 offen offset:1024 sc1
s_waitcnt vmcnt(11)
v_mfma_f32_32x32x16_bf16 v[58:73], a[80:83], v[120:123], v[58:73]
ds_read_b128 v[42:45], v90 offset:28672
ds_read_b128 v[46:49], v90 offset:29696
ds_read_b128 v[50:53], v90 offset:30720
ds_read_b128 v[54:57], v90 offset:31744
v_mfma_f32_32x32x16_bf16 v[74:89], a[84:87], v[120:123], v[74:89]
buffer_load_dwordx4 v[120:123], v1, s[4:7], s65 offen offset:2048 sc1
s_waitcnt vmcnt(11)
v_mfma_f32_32x32x16_bf16 v[58:73], a[88:91], v[124:127], v[58:73]
s_waitcnt lgkmcnt(0)
v_add_f32 v26, v26, v42
v_add_f32 v27, v27, v43
v_add_f32 v28, v28, v44
v_add_f32 v29, v29, v45
v_add_f32 v30, v30, v46
v_mfma_f32_32x32x16_bf16 v[74:89], a[92:95], v[124:127], v[74:89]
buffer_load_dwordx4 v[124:127], v1, s[4:7], s65 offen offset:3072 sc1
v_add_f32 v31, v31, v47
v_add_f32 v32, v32, v48
v_add_f32 v33, v33, v49
v_add_f32 v34, v34, v50
s_waitcnt vmcnt(11)
v_mfma_f32_32x32x16_bf16 v[58:73], a[96:99], v[128:131], v[58:73]
v_add_f32 v35, v35, v51
v_add_f32 v36, v36, v52
v_add_f32 v37, v37, v53
v_add_f32 v38, v38, v54
v_add_f32 v39, v39, v55
v_add_f32 v40, v40, v56
v_mfma_f32_32x32x16_bf16 v[74:89], a[100:103], v[128:131], v[74:89]
s_add_u32 s65, s3, s96
buffer_load_dwordx4 v[128:131], v1, s[4:7], s65 offen offset:0 sc1
v_add_f32 v41, v41, v57
s_waitcnt vmcnt(11)
v_mfma_f32_32x32x16_bf16 v[58:73], a[104:107], v[132:135], v[58:73]
ds_read_b128 v[42:45], v90 offset:32768
ds_read_b128 v[46:49], v90 offset:33792
ds_read_b128 v[50:53], v90 offset:34816
ds_read_b128 v[54:57], v90 offset:35840
v_mfma_f32_32x32x16_bf16 v[74:89], a[108:111], v[132:135], v[74:89]
buffer_load_dwordx4 v[132:135], v1, s[4:7], s65 offen offset:1024 sc1
s_waitcnt vmcnt(11)
v_mfma_f32_32x32x16_bf16 v[58:73], a[112:115], v[136:139], v[58:73]
s_waitcnt lgkmcnt(0)
v_add_f32 v26, v26, v42
v_add_f32 v27, v27, v43
v_add_f32 v28, v28, v44
v_add_f32 v29, v29, v45
v_add_f32 v30, v30, v46
v_mfma_f32_32x32x16_bf16 v[74:89], a[116:119], v[136:139], v[74:89]
buffer_load_dwordx4 v[136:139], v1, s[4:7], s65 offen offset:2048 sc1
v_add_f32 v31, v31, v47
v_add_f32 v32, v32, v48
v_add_f32 v33, v33, v49
v_add_f32 v34, v34, v50
s_waitcnt vmcnt(11)
v_mfma_f32_32x32x16_bf16 v[58:73], a[120:123], v[140:143], v[58:73]
v_add_f32 v35, v35, v51
v_add_f32 v36, v36, v52
v_add_f32 v37, v37, v53
v_add_f32 v38, v38, v54
v_add_f32 v39, v39, v55
v_add_f32 v40, v40, v56
v_mfma_f32_32x32x16_bf16 v[74:89], a[124:127], v[140:143], v[74:89]
buffer_load_dwordx4 v[140:143], v1, s[4:7], s65 offen offset:3072 sc1
v_add_f32 v41, v41, v57
s_waitcnt vmcnt(11)
v_mfma_f32_32x32x16_bf16 v[74:89], a[132:135], v[144:147], v[74:89]
ds_read_b128 v[42:45], v90 offset:36864
ds_read_b128 v[46:49], v90 offset:37888
ds_read_b128 v[50:53], v90 offset:38912
ds_read_b128 v[54:57], v90 offset:39936
s_waitcnt vmcnt(10)
v_mfma_f32_32x32x16_bf16 v[74:89], a[140:143], v[148:151], v[74:89]
s_waitcnt lgkmcnt(0)
s_waitcnt vmcnt(9)
v_mfma_f32_32x32x16_bf16 v[74:89], a[148:151], v[152:155], v[74:89]
v_add_f32 v26, v26, v42
v_add_f32 v27, v27, v43
v_add_f32 v28, v28, v44
v_add_f32 v29, v29, v45
v_add_f32 v30, v30, v46
s_waitcnt vmcnt(8)
v_mfma_f32_32x32x16_bf16 v[74:89], a[156:159], v[156:159], v[74:89]
v_add_f32 v31, v31, v47
v_add_f32 v32, v32, v48
v_add_f32 v33, v33, v49
v_add_f32 v34, v34, v50
v_add_f32 v35, v35, v51
s_waitcnt vmcnt(7)
v_mfma_f32_32x32x16_bf16 v[74:89], a[164:167], v[112:115], v[74:89]
v_add_f32 v36, v36, v52
v_add_f32 v37, v37, v53
v_add_f32 v38, v38, v54
v_add_f32 v39, v39, v55
v_add_f32 v40, v40, v56
s_waitcnt vmcnt(6)
v_mfma_f32_32x32x16_bf16 v[74:89], a[172:175], v[116:119], v[74:89]
v_add_f32 v41, v41, v57
v_cvt_pk_bf16_f32 v18, v26, v27
v_cvt_pk_bf16_f32 v19, v28, v29
v_cvt_pk_bf16_f32 v20, v30, v31
v_cvt_pk_bf16_f32 v21, v32, v33
s_waitcnt vmcnt(5)
v_mfma_f32_32x32x16_bf16 v[74:89], a[180:183], v[120:123], v[74:89]
v_cvt_pk_bf16_f32 v22, v34, v35
v_cvt_pk_bf16_f32 v23, v36, v37
v_cvt_pk_bf16_f32 v24, v38, v39
v_cvt_pk_bf16_f32 v25, v40, v41
s_waitcnt vmcnt(4)
v_mfma_f32_32x32x16_bf16 v[74:89], a[188:191], v[124:127], v[74:89]
buffer_store_dwordx4 v[18:21], v1, s[4:7], s44 offen sc1
buffer_store_dwordx4 v[22:25], v1, s[4:7], s44 offen offset:1024 sc1
v_dot2_f32_bf16 v92, s88, v18, 0
v_dot2_f32_bf16 v93, v18, v18, 0
v_dot2_f32_bf16 v92, s88, v19, v92
v_dot2_f32_bf16 v93, v19, v19, v93
v_dot2_f32_bf16 v92, s88, v20, v92
v_dot2_f32_bf16 v93, v20, v20, v93
v_dot2_f32_bf16 v92, s88, v21, v92
v_dot2_f32_bf16 v93, v21, v21, v93
v_dot2_f32_bf16 v92, s88, v22, v92
v_dot2_f32_bf16 v93, v22, v22, v93
v_dot2_f32_bf16 v92, s88, v23, v92
v_dot2_f32_bf16 v93, v23, v23, v93
v_dot2_f32_bf16 v92, s88, v24, v92
v_dot2_f32_bf16 v93, v24, v24, v93
v_dot2_f32_bf16 v92, s88, v25, v92
v_dot2_f32_bf16 v93, v25, v25, v93
s_nop 1
v_mov_b32 v94, v92
v_mov_b32 v95, v93
s_nop 0
v_permlane32_swap_b32 v92, v94
v_permlane32_swap_b32 v93, v95
s_mov_b32 exec_hi, 0
v_pk_add_f32 v[92:93], v[92:93], v[94:95]
buffer_store_dwordx2 v[92:93], v1, s[4:7], s45 offen sc1
s_mov_b64 exec, -1
s_waitcnt vmcnt(6)
v_mfma_f32_32x32x16_bf16 v[74:89], a[196:199], v[128:131], v[74:89]
s_waitcnt vmcnt(5)
v_mfma_f32_32x32x16_bf16 v[74:89], a[204:207], v[132:135], v[74:89]
s_waitcnt vmcnt(4)
v_mfma_f32_32x32x16_bf16 v[74:89], a[212:215], v[136:139], v[74:89]
s_waitcnt vmcnt(3)
v_mfma_f32_32x32x16_bf16 v[74:89], a[220:223], v[140:143], v[74:89]
v_mfma_f32_32x32x16_bf16 v[58:73], a[128:131], v[144:147], v[58:73]
v_mfma_f32_32x32x16_bf16 v[58:73], a[136:139], v[148:151], v[58:73]
s_nop 9
ds_write_b128 v91, v[74:77] offset:4096
v_mfma_f32_32x32x16_bf16 v[58:73], a[144:147], v[152:155], v[58:73]
ds_write_b128 v91, v[78:81] offset:5120
v_mfma_f32_32x32x16_bf16 v[58:73], a[152:155], v[156:159], v[58:73]
ds_write_b128 v91, v[82:85] offset:6144
v_mfma_f32_32x32x16_bf16 v[58:73], a[160:163], v[112:115], v[58:73]
ds_write_b128 v91, v[86:89] offset:7168
v_mfma_f32_32x32x16_bf16 v[58:73], a[168:171], v[116:119], v[58:73]
s_waitcnt lgkmcnt(0)
s_barrier
v_mfma_f32_32x32x16_bf16 v[58:73], a[176:179], v[120:123], v[58:73]
v_mfma_f32_32x32x16_bf16 v[58:73], a[184:187], v[124:127], v[58:73]
v_mfma_f32_32x32x16_bf16 v[58:73], a[192:195], v[128:131], v[58:73]
v_mfma_f32_32x32x16_bf16 v[58:73], a[200:203], v[132:135], v[58:73]
s_waitcnt vmcnt(0)
s_add_u32 s60, s35, 9
s_mov_b64 exec, 1
v_mov_b32 v92, s60
buffer_store_dword v92, off, s[4:7], s41 sc1
s_mov_b64 exec, -1
v_mfma_f32_32x32x16_bf16 v[58:73], a[208:211], v[136:139], v[58:73]
v_mfma_f32_32x32x16_bf16 v[58:73], a[216:219], v[140:143], v[58:73]
s_nop 11
ds_write_b128 v90, v[58:61] offset:8192
ds_write_b128 v90, v[62:65] offset:9216
ds_write_b128 v90, v[66:69] offset:10240
ds_write_b128 v90, v[70:73] offset:11264
s_waitcnt lgkmcnt(0)
s_barrier
s_branch LJ_184
LB_183:
L_vhop10a:
s_nop 0
s_waitcnt vmcnt(11)
v_mfma_f32_32x32x16_bf16 v[58:73], a[0:3], v[128:131], 0
v_mfma_f32_32x32x16_bf16 v[74:89], a[4:7], v[128:131], 0
s_add_u32 s65, s3, s93
buffer_load_dwordx4 v[128:131], v1, s[4:7], s65 offen offset:0 sc1
s_waitcnt vmcnt(11)
v_mfma_f32_32x32x16_bf16 v[58:73], a[8:11], v[132:135], v[58:73]
s_nop 0
ds_write_b128 v91, v[42:45] offset:32768
v_mfma_f32_32x32x16_bf16 v[74:89], a[12:15], v[132:135], v[74:89]
buffer_load_dwordx4 v[132:135], v1, s[4:7], s65 offen offset:1024 sc1
s_waitcnt vmcnt(11)
v_mfma_f32_32x32x16_bf16 v[58:73], a[16:19], v[136:139], v[58:73]
ds_write_b128 v91, v[46:49] offset:33792
v_mfma_f32_32x32x16_bf16 v[74:89], a[20:23], v[136:139], v[74:89]
buffer_load_dwordx4 v[136:139], v1, s[4:7], s65 offen offset:2048 sc1
s_waitcnt vmcnt(11)
v_mfma_f32_32x32x16_bf16 v[58:73], a[24:27], v[140:143], v[58:73]
ds_write_b128 v91, v[50:53] offset:34816
v_mfma_f32_32x32x16_bf16 v[74:89], a[28:31], v[140:143], v[74:89]
buffer_load_dwordx4 v[140:143], v1, s[4:7], s65 offen offset:3072 sc1
s_waitcnt vmcnt(11)
v_mfma_f32_32x32x16_bf16 v[58:73], a[32:35], v[144:147], v[58:73]
ds_write_b128 v91, v[54:57] offset:35840
v_mfma_f32_32x32x16_bf16 v[74:89], a[36:39], v[144:147], v[74:89]
s_add_u32 s65, s3, s94
buffer_load_dwordx4 v[144:147], v1, s[4:7], s65 offen offset:0 sc1
s_waitcnt vmcnt(11)
v_mfma_f32_32x32x16_bf16 v[58:73], a[40:43], v[148:151], v[58:73]
ds_write_b128 v90, v[26:29] offset:36864
v_mfma_f32_32x32x16_bf16 v[74:89], a[44:47], v[148:151], v[74:89]
buffer_load_dwordx4 v[148:151], v1, s[4:7], s65 offen offset:1024 sc1
s_waitcnt vmcnt(11)
v_mfma_f32_32x32x16_bf16 v[58:73], a[48:51], v[152:155], v[58:73]
ds_write_b128 v90, v[30:33] offset:37888
v_mfma_f32_32x32x16_bf16 v[74:89], a[52:55], v[152:155], v[74:89]
buffer_load_dwordx4 v[152:155], v1, s[4:7], s65 offen offset:2048 sc1
s_waitcnt vmcnt(11)
v_mfma_f32_32x32x16_bf16 v[58:73], a[56:59], v[156:159], v[58:73]
ds_write_b128 v90, v[34:37] offset:38912
v_mfma_f32_32x32x16_bf16 v[74:89], a[60:63], v[156:159], v[74:89]
buffer_load_dwordx4 v[156:159], v1, s[4:7], s65 offen offset:3072 sc1
s_waitcnt vmcnt(11)
v_mfma_f32_32x32x16_bf16 v[58:73], a[64:67], v[112:115], v[58:73]
ds_write_b128 v90, v[38:41] offset:39936
v_mfma_f32_32x32x16_bf16 v[74:89], a[68:71], v[112:115], v[74:89]
s_add_u32 s65, s3, s95
buffer_load_dwordx4 v[112:115], v1, s[4:7], s65 offen offset:0 sc1
s_waitcnt vmcnt(11)
v_mfma_f32_32x32x16_bf16 v[58:73], a[72:75], v[116:119], v[58:73]
s_waitcnt lgkmcnt(0)
s_barrier
v_mfma_f32_32x32x16_bf16 v[74:89], a[76:79], v[116:119], v[74:89]
buffer_load_dwordx4 v[116:119], v1, s[4:7], s65 offen offset:1024 sc1
v_lshlrev_b32 v26, 16, v18
v_and_b32 v27, 0xffff0000, v18
v_lshlrev_b32 v28, 16, v19
v_and_b32 v29, 0xffff0000, v19
s_waitcnt vmcnt(11)
v_mfma_f32_32x32x16_bf16 v[58:73], a[80:83], v[120:123], v[58:73]
v_lshlrev_b32 v30, 16, v20
v_and_b32 v31, 0xffff0000, v20
v_lshlrev_b32 v32, 16, v21
v_and_b32 v33, 0xffff0000, v21
v_lshlrev_b32 v34, 16, v22
v_and_b32 v35, 0xffff0000, v22
v_mfma_f32_32x32x16_bf16 v[74:89], a[84:87], v[120:123], v[74:89]
buffer_load_dwordx4 v[120:123], v1, s[4:7], s65 offen offset:2048 sc1
v_lshlrev_b32 v36, 16, v23
v_and_b32 v37, 0xffff0000, v23
v_lshlrev_b32 v38, 16, v24
v_and_b32 v39, 0xffff0000, v24
s_waitcnt vmcnt(11)
v_mfma_f32_32x32x16_bf16 v[58:73], a[88:91], v[124:127], v[58:73]
v_lshlrev_b32 v40, 16, v25
v_and_b32 v41, 0xffff0000, v25
v_mfma_f32_32x32x16_bf16 v[74:89], a[92:95], v[124:127], v[74:89]
buffer_load_dwordx4 v[124:127], v1, s[4:7], s65 offen offset:3072 sc1
s_waitcnt vmcnt(11)
v_mfma_f32_32x32x16_bf16 v[58:73], a[96:99], v[128:131], v[58:73]
v_mfma_f32_32x32x16_bf16 v[74:89], a[100:103], v[128:131], v[74:89]
s_add_u32 s65, s3, s96
buffer_load_dwordx4 v[128:131], v1, s[4:7], s65 offen offset:0 sc1
s_waitcnt vmcnt(11)
v_mfma_f32_32x32x16_bf16 v[58:73], a[104:107], v[132:135], v[58:73]
v_mfma_f32_32x32x16_bf16 v[74:89], a[108:111], v[132:135], v[74:89]
buffer_load_dwordx4 v[132:135], v1, s[4:7], s65 offen offset:1024 sc1
s_waitcnt vmcnt(11)
v_mfma_f32_32x32x16_bf16 v[58:73], a[112:115], v[136:139], v[58:73]
v_mfma_f32_32x32x16_bf16 v[74:89], a[116:119], v[136:139], v[74:89]
buffer_load_dwordx4 v[136:139], v1, s[4:7], s65 offen offset:2048 sc1
s_waitcnt vmcnt(11)
v_mfma_f32_32x32x16_bf16 v[58:73], a[120:123], v[140:143], v[58:73]
v_mfma_f32_32x32x16_bf16 v[74:89], a[124:127], v[140:143], v[74:89]
buffer_load_dwordx4 v[140:143], v1, s[4:7], s65 offen offset:3072 sc1
s_waitcnt vmcnt(11)
v_mfma_f32_32x32x16_bf16 v[74:89], a[132:135], v[144:147], v[74:89]
s_waitcnt vmcnt(10)
v_mfma_f32_32x32x16_bf16 v[74:89], a[140:143], v[148:151], v[74:89]
s_waitcnt vmcnt(9)
v_mfma_f32_32x32x16_bf16 v[74:89], a[148:151], v[152:155], v[74:89]
s_waitcnt vmcnt(8)
v_mfma_f32_32x32x16_bf16 v[74:89], a[156:159], v[156:159], v[74:89]
s_waitcnt vmcnt(7)
v_mfma_f32_32x32x16_bf16 v[74:89], a[164:167], v[112:115], v[74:89]
s_waitcnt vmcnt(6)
v_mfma_f32_32x32x16_bf16 v[74:89], a[172:175], v[116:119], v[74:89]
s_waitcnt vmcnt(5)
v_mfma_f32_32x32x16_bf16 v[74:89], a[180:183], v[120:123], v[74:89]
s_waitcnt vmcnt(4)
v_mfma_f32_32x32x16_bf16 v[74:89], a[188:191], v[124:127], v[74:89]
s_waitcnt vmcnt(3)
v_mfma_f32_32x32x16_bf16 v[74:89], a[196:199], v[128:131], v[74:89]
s_waitcnt vmcnt(2)
v_mfma_f32_32x32x16_bf16 v[74:89], a[204:207], v[132:135], v[74:89]
s_waitcnt vmcnt(1)
v_mfma_f32_32x32x16_bf16 v[74:89], a[212:215], v[136:139], v[74:89]
s_waitcnt vmcnt(0)
v_mfma_f32_32x32x16_bf16 v[74:89], a[220:223], v[140:143], v[74:89]
v_mfma_f32_32x32x16_bf16 v[58:73], a[128:131], v[144:147], v[58:73]
v_mfma_f32_32x32x16_bf16 v[58:73], a[136:139], v[148:151], v[58:73]
s_nop 9
ds_write_b128 v91, v[74:77] offset:0
v_mfma_f32_32x32x16_bf16 v[58:73], a[144:147], v[152:155], v[58:73]
ds_write_b128 v91, v[78:81] offset:1024
v_mfma_f32_32x32x16_bf16 v[58:73], a[152:155], v[156:159], v[58:73]
ds_write_b128 v91, v[82:85] offset:2048
v_mfma_f32_32x32x16_bf16 v[58:73], a[160:163], v[112:115], v[58:73]
ds_write_b128 v91, v[86:89] offset:3072
v_mfma_f32_32x32x16_bf16 v[58:73], a[168:171], v[116:119], v[58:73]
s_waitcnt lgkmcnt(0)
s_barrier
v_mfma_f32_32x32x16_bf16 v[58:73], a[176:179], v[120:123], v[58:73]
ds_read_b128 v[42:45], v90 offset:0
ds_read_b128 v[46:49], v90 offset:1024
ds_read_b128 v[50:53], v90 offset:2048
ds_read_b128 v[54:57], v90 offset:3072
v_mfma_f32_32x32x16_bf16 v[58:73], a[184:187], v[124:127], v[58:73]
ds_read_b128 v[74:77], v90 offset:4096
ds_read_b128 v[78:81], v90 offset:5120
ds_read_b128 v[82:85], v90 offset:6144
ds_read_b128 v[86:89], v90 offset:7168
v_mfma_f32_32x32x16_bf16 v[58:73], a[192:195], v[128:131], v[58:73]
v_mfma_f32_32x32x16_bf16 v[58:73], a[200:203], v[132:135], v[58:73]
s_waitcnt lgkmcnt(0)
v_add_f32 v26, v26, v42
v_add_f32 v27, v27, v43
v_add_f32 v28, v28, v44
v_add_f32 v29, v29, v45
v_add_f32 v30, v30, v46
v_mfma_f32_32x32x16_bf16 v[58:73], a[208:211], v[136:139], v[58:73]
v_add_f32 v31, v31, v47
v_add_f32 v32, v32, v48
v_add_f32 v33, v33, v49
v_add_f32 v34, v34, v50
v_add_f32 v35, v35, v51
v_add_f32 v36, v36, v52
v_mfma_f32_32x32x16_bf16 v[58:73], a[216:219], v[140:143], v[58:73]
v_add_f32 v37, v37, v53
v_add_f32 v38, v38, v54
v_add_f32 v39, v39, v55
v_add_f32 v40, v40, v56
v_add_f32 v41, v41, v57
v_pk_add_f32 v[26:27], v[26:27], v[74:75]
v_pk_add_f32 v[28:29], v[28:29], v[76:77]
v_pk_add_f32 v[30:31], v[30:31], v[78:79]
v_pk_add_f32 v[32:33], v[32:33], v[80:81]
v_pk_add_f32 v[34:35], v[34:35], v[82:83]
v_pk_add_f32 v[36:37], v[36:37], v[84:85]
v_pk_add_f32 v[38:39], v[38:39], v[86:87]
v_pk_add_f32 v[40:41], v[40:41], v[88:89]
v_pk_add_f32 v[26:27], v[26:27], v[58:59]
v_pk_add_f32 v[28:29], v[28:29], v[60:61]
v_pk_add_f32 v[30:31], v[30:31], v[62:63]
v_pk_add_f32 v[32:33], v[32:33], v[64:65]
v_pk_add_f32 v[34:35], v[34:35], v[66:67]
v_pk_add_f32 v[36:37], v[36:37], v[68:69]
v_pk_add_f32 v[38:39], v[38:39], v[70:71]
v_pk_add_f32 v[40:41], v[40:41], v[72:73]
s_barrier
ds_read_b128 v[42:45], v90 offset:8192
ds_read_b128 v[46:49], v90 offset:9216
ds_read_b128 v[50:53], v90 offset:10240
ds_read_b128 v[54:57], v90 offset:11264
s_waitcnt lgkmcnt(3)
v_pk_add_f32 v[26:27], v[26:27], v[42:43]
v_pk_add_f32 v[28:29], v[28:29], v[44:45]
v_cvt_pk_bf16_f32 v18, v26, v27
v_cvt_pk_bf16_f32 v19, v28, v29
s_waitcnt lgkmcnt(2)
v_pk_add_f32 v[30:31], v[30:31], v[46:47]
v_pk_add_f32 v[32:33], v[32:33], v[48:49]
v_cvt_pk_bf16_f32 v20, v30, v31
v_cvt_pk_bf16_f32 v21, v32, v33
s_waitcnt lgkmcnt(1)
v_pk_add_f32 v[34:35], v[34:35], v[50:51]
v_pk_add_f32 v[36:37], v[36:37], v[52:53]
v_cvt_pk_bf16_f32 v22, v34, v35
v_cvt_pk_bf16_f32 v23, v36, v37
s_waitcnt lgkmcnt(0)
v_pk_add_f32 v[38:39], v[38:39], v[54:55]
v_pk_add_f32 v[40:41], v[40:41], v[56:57]
v_cvt_pk_bf16_f32 v24, v38, v39
v_cvt_pk_bf16_f32 v25, v40, v41
buffer_store_dwordx4 v[18:21], v1, s[4:7], s44 offen sc1
buffer_store_dwordx4 v[22:25], v1, s[4:7], s44 offen offset:1024 sc1
v_dot2_f32_bf16 v92, s88, v18, 0
v_dot2_f32_bf16 v93, v18, v18, 0
v_dot2_f32_bf16 v92, s88, v19, v92
v_dot2_f32_bf16 v93, v19, v19, v93
v_dot2_f32_bf16 v92, s88, v20, v92
v_dot2_f32_bf16 v93, v20, v20, v93
v_dot2_f32_bf16 v92, s88, v21, v92
v_dot2_f32_bf16 v93, v21, v21, v93
v_dot2_f32_bf16 v92, s88, v22, v92
v_dot2_f32_bf16 v93, v22, v22, v93
v_dot2_f32_bf16 v92, s88, v23, v92
v_dot2_f32_bf16 v93, v23, v23, v93
v_dot2_f32_bf16 v92, s88, v24, v92
v_dot2_f32_bf16 v93, v24, v24, v93
v_dot2_f32_bf16 v92, s88, v25, v92
v_dot2_f32_bf16 v93, v25, v25, v93
s_nop 1
v_mov_b32 v94, v92
v_mov_b32 v95, v93
s_nop 0
v_permlane32_swap_b32 v92, v94
v_permlane32_swap_b32 v93, v95
s_mov_b32 exec_hi, 0
v_pk_add_f32 v[92:93], v[92:93], v[94:95]
buffer_store_dwordx2 v[92:93], v1, s[4:7], s45 offen sc1
s_mov_b64 exec, -1
s_add_u32 s60, s35, 9
v_mov_b32 v96, s60
s_mov_b64 exec, 1
s_waitcnt vmcnt(0)
buffer_store_dword v96, off, s[4:7], s41 sc1
s_mov_b64 exec, -1
LJ_184:
L_vhop10b:
s_nop 0
s_branch LQ_171
LR_170:
s_waitcnt vmcnt(0)
s_add_u32 s60, s35, 2
s_mov_b64 exec, 1
v_mov_b32 v28, s60
buffer_store_dword v28, off, s[4:7], s41 sc1
s_mov_b64 exec, -1
v_lshlrev_b32 v26, 7, v0
s_and_b32 s61, s33, 1
s_lshl2_add_u32 s61, s61, s32
s_lshl_b32 s61, s61, 14
s_add_u32 s61, s61, s40
buffer_load_dword v27, v26, s[4:7], s61 offen
s_add_u32 s61, s61, 8192
buffer_load_dword v27, v26, s[4:7], s61 offen
s_add_u32 s40, s40, 256
s_add_u32 s60, s35, 0
LP_185:
s_sleep 8
buffer_load_dword v28, v4, s[4:7], s40 offen sc1
s_sub_u32 s37, s37, 1
s_cmp_lt_i32 s37, 0
s_cbranch_scc1 LD_186
s_waitcnt vmcnt(0)
v_subrev_u32 v28, s60, v28
v_cmp_le_u32 vcc, 64, v28
s_and_b64 vcc, vcc, 1
s_cbranch_scc1 LP_185
LD_186:
s_sub_u32 s40, s40, 256
s_and_b32 s61, s33, 1
s_lshl2_add_u32 s61, s61, s32
s_mul_i32 s61, s61, 10240
s_add_u32 s61, s61, s40
s_add_u32 s61, s61, 163840
s_add_u32 s62, s61, 0
buffer_load_dword v27, v26, s[4:7], s62 offen
s_add_u32 s62, s62, 8192
s_mov_b64 exec, 0xffff
buffer_load_dword v27, v26, s[4:7], s62 offen
s_mov_b64 exec, -1
s_add_u32 s62, s61, 229376
buffer_load_dword v27, v26, s[4:7], s62 offen
s_add_u32 s62, s62, 8192
s_mov_b64 exec, 0xffff
buffer_load_dword v27, v26, s[4:7], s62 offen
s_mov_b64 exec, -1
s_add_u32 s62, s61, 114688
buffer_load_dword v27, v26, s[4:7], s62 offen
s_add_u32 s62, s62, 8192
s_mov_b64 exec, 0xffff
buffer_load_dword v27, v26, s[4:7], s62 offen
s_mov_b64 exec, -1
s_add_u32 s62, s61, 344064
buffer_load_dword v27, v26, s[4:7], s62 offen
s_add_u32 s62, s62, 8192
s_mov_b64 exec, 0xffff
buffer_load_dword v27, v26, s[4:7], s62 offen
s_mov_b64 exec, -1
s_mov_b32 s62, 0x33333333
s_mov_b32 s63, 0x333333
s_add_u32 s60, s35, 9
LP_187:
s_sleep 8
buffer_load_dword v28, v4, s[4:7], s40 offen sc1
s_sub_u32 s37, s37, 1
s_cmp_lt_i32 s37, 0
s_cbranch_scc1 LD_188
s_waitcnt vmcnt(0)
v_subrev_u32 v28, s60, v28
v_cmp_le_u32 vcc, 64, v28
s_and_b64 vcc, vcc, s[62:63]
s_cbranch_scc1 LP_187
LD_188:
LQ_171:
v_lshrrev_b32 v172, 5, v0
v_mul_u32_u24 v172, 1536, v172
v_add_u32 v172, v1, v172
s_add_u32 s60, s35, 9
LP_189:
buffer_load_dword v142, v4, s[4:7], s40 offen sc1
s_sub_u32 s37, s37, 1
s_cmp_lt_i32 s37, 0
s_cbranch_scc1 LD_190
s_waitcnt vmcnt(0)
v_subrev_u32 v142, s60, v142
v_cmp_le_u32 vcc, 64, v142
s_and_b64 vcc, vcc, s[46:47]
s_cbranch_scc1 LP_189
LD_190:
s_add_u32 s65, s70, 0
buffer_load_dwordx4 v[94:97], v1, s[4:7], s65 offen offset:0 sc1
buffer_load_dwordx4 v[98:101], v1, s[4:7], s65 offen offset:1024 sc1
buffer_load_dwordx4 v[102:105], v1, s[4:7], s65 offen offset:2048 sc1
buffer_load_dwordx4 v[106:109], v1, s[4:7], s65 offen offset:3072 sc1
s_add_u32 s65, s70, 4096
buffer_load_dwordx4 v[110:113], v1, s[4:7], s65 offen offset:0 sc1
buffer_load_dwordx4 v[114:117], v1, s[4:7], s65 offen offset:1024 sc1
buffer_load_dwordx4 v[118:121], v1, s[4:7], s65 offen offset:2048 sc1
buffer_load_dwordx4 v[122:125], v1, s[4:7], s65 offen offset:3072 sc1
ds_read_b64_tr_b16 v[74:75], v2 offset:0
ds_read_b64_tr_b16 v[76:77], v2 offset:256
ds_read_b64_tr_b16 v[78:79], v2 offset:28672
ds_read_b64_tr_b16 v[80:81], v2 offset:28928
ds_read_b64_tr_b16 v[82:83], v3 offset:0
ds_read_b64_tr_b16 v[84:85], v3 offset:256
ds_read_b64_tr_b16 v[86:87], v2 offset:1024
ds_read_b64_tr_b16 v[88:89], v2 offset:1280
s_waitcnt vmcnt(7) lgkmcnt(6)
v_mfma_f32_32x32x16_bf16 v[26:41], v[94:97], v[74:77], 0
s_add_u32 s65, s70, 8192
buffer_load_dwordx4 v[126:129], v1, s[4:7], s65 offen offset:0 sc1
ds_read_b64_tr_b16 v[90:91], v2 offset:29696
ds_read_b64_tr_b16 v[92:93], v2 offset:29952
s_waitcnt lgkmcnt(6)
v_mfma_f32_32x32x16_bf16 v[42:57], v[94:97], v[78:81], 0
ds_read_b64_tr_b16 v[74:75], v3 offset:1024
ds_read_b64_tr_b16 v[76:77], v3 offset:1280
s_waitcnt lgkmcnt(6)
v_mfma_f32_32x32x16_bf16 v[58:73], v[82:85], v[94:97], 0
buffer_load_dwordx4 v[130:133], v1, s[4:7], s65 offen offset:1024 sc1
ds_read_b64_tr_b16 v[78:79], v2 offset:2048
ds_read_b64_tr_b16 v[80:81], v2 offset:2304
s_waitcnt vmcnt(8) lgkmcnt(6)
v_mfma_f32_32x32x16_bf16 v[26:41], v[98:101], v[86:89], v[26:41]
ds_read_b64_tr_b16 v[82:83], v2 offset:30720
ds_read_b64_tr_b16 v[84:85], v2 offset:30976
s_waitcnt lgkmcnt(6)
v_mfma_f32_32x32x16_bf16 v[42:57], v[98:101], v[90:93], v[42:57]
buffer_load_dwordx4 v[134:137], v1, s[4:7], s65 offen offset:2048 sc1
ds_read_b64_tr_b16 v[86:87], v3 offset:2048
ds_read_b64_tr_b16 v[88:89], v3 offset:2304
s_waitcnt lgkmcnt(6)
v_mfma_f32_32x32x16_bf16 v[58:73], v[74:77], v[98:101], v[58:73]
ds_read_b64_tr_b16 v[90:91], v2 offset:3072
ds_read_b64_tr_b16 v[92:93], v2 offset:3328
s_waitcnt vmcnt(8) lgkmcnt(6)
v_mfma_f32_32x32x16_bf16 v[26:41], v[102:105], v[78:81], v[26:41]
buffer_load_dwordx4 v[138:141], v1, s[4:7], s65 offen offset:3072 sc1
ds_read_b64_tr_b16 v[74:75], v2 offset:31744
ds_read_b64_tr_b16 v[76:77], v2 offset:32000
s_waitcnt lgkmcnt(6)
v_mfma_f32_32x32x16_bf16 v[42:57], v[102:105], v[82:85], v[42:57]
buffer_load_dwordx4 v[158:161], v172, s[4:7], s71 offen offset:0 sc1
ds_read_b64_tr_b16 v[78:79], v3 offset:3072
ds_read_b64_tr_b16 v[80:81], v3 offset:3328
s_waitcnt lgkmcnt(6)
v_mfma_f32_32x32x16_bf16 v[58:73], v[86:89], v[102:105], v[58:73]
s_add_u32 s65, s70, 12288
buffer_load_dwordx4 v[94:97], v1, s[4:7], s65 offen offset:0 sc1
ds_read_b64_tr_b16 v[82:83], v2 offset:4096
ds_read_b64_tr_b16 v[84:85], v2 offset:4352
s_waitcnt vmcnt(10) lgkmcnt(6)
v_mfma_f32_32x32x16_bf16 v[26:41], v[106:109], v[90:93], v[26:41]
buffer_load_dwordx4 v[162:165], v172, s[4:7], s71 offen offset:512 sc1
ds_read_b64_tr_b16 v[86:87], v2 offset:32768
ds_read_b64_tr_b16 v[88:89], v2 offset:33024
s_waitcnt lgkmcnt(6)
v_mfma_f32_32x32x16_bf16 v[42:57], v[106:109], v[74:77], v[42:57]
buffer_load_dwordx4 v[98:101], v1, s[4:7], s65 offen offset:1024 sc1
ds_read_b64_tr_b16 v[90:91], v3 offset:4096
ds_read_b64_tr_b16 v[92:93], v3 offset:4352
s_waitcnt lgkmcnt(6)
v_mfma_f32_32x32x16_bf16 v[58:73], v[78:81], v[106:109], v[58:73]
buffer_load_dwordx4 v[166:169], v172, s[4:7], s71 offen offset:1024 sc1
ds_read_b64_tr_b16 v[74:75], v2 offset:5120
ds_read_b64_tr_b16 v[76:77], v2 offset:5376
s_waitcnt vmcnt(12) lgkmcnt(6)
v_mfma_f32_32x32x16_bf16 v[26:41], v[110:113], v[82:85], v[26:41]
buffer_load_dwordx4 v[102:105], v1, s[4:7], s65 offen offset:2048 sc1
ds_read_b64_tr_b16 v[78:79], v2 offset:33792
ds_read_b64_tr_b16 v[80:81], v2 offset:34048
s_waitcnt lgkmcnt(6)
v_mfma_f32_32x32x16_bf16 v[42:57], v[110:113], v[86:89], v[42:57]
buffer_load_dwordx4 v[170:173], v172, s[4:7], s71 offen offset:1536 sc1
ds_read_b64_tr_b16 v[82:83], v3 offset:5120
ds_read_b64_tr_b16 v[84:85], v3 offset:5376
s_waitcnt lgkmcnt(6)
v_mfma_f32_32x32x16_bf16 v[58:73], v[90:93], v[110:113], v[58:73]
buffer_load_dwordx4 v[106:109], v1, s[4:7], s65 offen offset:3072 sc1
ds_read_b64_tr_b16 v[86:87], v2 offset:6144
ds_read_b64_tr_b16 v[88:89], v2 offset:6400
s_waitcnt vmcnt(14) lgkmcnt(6)
v_mfma_f32_32x32x16_bf16 v[26:41], v[114:117], v[74:77], v[26:41]
ds_read_b64_tr_b16 v[90:91], v2 offset:34816
ds_read_b64_tr_b16 v[92:93], v2 offset:35072
s_waitcnt lgkmcnt(6)
v_mfma_f32_32x32x16_bf16 v[42:57], v[114:117], v[78:81], v[42:57]
s_add_u32 s65, s70, 16384
buffer_load_dwordx4 v[110:113], v1, s[4:7], s65 offen offset:0 sc1
ds_read_b64_tr_b16 v[74:75], v3 offset:6144
ds_read_b64_tr_b16 v[76:77], v3 offset:6400
s_waitcnt lgkmcnt(6)
v_mfma_f32_32x32x16_bf16 v[58:73], v[82:85], v[114:117], v[58:73]
ds_read_b64_tr_b16 v[78:79], v2 offset:7168
ds_read_b64_tr_b16 v[80:81], v2 offset:7424
s_waitcnt vmcnt(14) lgkmcnt(6)
v_mfma_f32_32x32x16_bf16 v[26:41], v[118:121], v[86:89], v[26:41]
buffer_load_dwordx4 v[114:117], v1, s[4:7], s65 offen offset:1024 sc1
ds_read_b64_tr_b16 v[82:83], v2 offset:35840
ds_read_b64_tr_b16 v[84:85], v2 offset:36096
s_waitcnt lgkmcnt(6)
v_mfma_f32_32x32x16_bf16 v[42:57], v[118:121], v[90:93], v[42:57]
ds_read_b64_tr_b16 v[86:87], v3 offset:7168
ds_read_b64_tr_b16 v[88:89], v3 offset:7424
s_waitcnt lgkmcnt(6)
v_mfma_f32_32x32x16_bf16 v[58:73], v[74:77], v[118:121], v[58:73]
buffer_load_dwordx4 v[118:121], v1, s[4:7], s65 offen offset:2048 sc1
ds_read_b64_tr_b16 v[90:91], v2 offset:8192
ds_read_b64_tr_b16 v[92:93], v2 offset:8448
s_waitcnt vmcnt(15) lgkmcnt(6)
v_mfma_f32_32x32x16_bf16 v[26:41], v[122:125], v[78:81], v[26:41]
ds_read_b64_tr_b16 v[74:75], v2 offset:36864
ds_read_b64_tr_b16 v[76:77], v2 offset:37120
s_waitcnt lgkmcnt(6)
v_mfma_f32_32x32x16_bf16 v[42:57], v[122:125], v[82:85], v[42:57]
ds_read_b64_tr_b16 v[78:79], v2 offset:9216
ds_read_b64_tr_b16 v[80:81], v2 offset:9472
s_waitcnt vmcnt(4)
v_add_f32 v158, v158, v160
v_add_f32 v159, v159, v161
s_waitcnt lgkmcnt(6)
v_mfma_f32_32x32x16_bf16 v[58:73], v[86:89], v[122:125], v[58:73]
buffer_load_dwordx4 v[122:125], v1, s[4:7], s65 offen offset:3072 sc1
ds_read_b64_tr_b16 v[82:83], v2 offset:37888
ds_read_b64_tr_b16 v[84:85], v2 offset:38144
v_add_f32 v162, v162, v164
v_add_f32 v163, v163, v165
s_waitcnt vmcnt(15) lgkmcnt(6)
v_mfma_f32_32x32x16_bf16 v[26:41], v[126:129], v[90:93], v[26:41]
ds_read_b64_tr_b16 v[86:87], v2 offset:10240
ds_read_b64_tr_b16 v[88:89], v2 offset:10496
v_add_f32 v166, v166, v168
v_add_f32 v167, v167, v169
v_add_f32 v170, v170, v172
s_waitcnt lgkmcnt(6)
v_mfma_f32_32x32x16_bf16 v[42:57], v[126:129], v[74:77], v[42:57]
s_add_u32 s65, s70, 20480
buffer_load_dwordx4 v[126:129], v1, s[4:7], s65 offen offset:0 sc1
ds_read_b64_tr_b16 v[90:91], v2 offset:38912
ds_read_b64_tr_b16 v[92:93], v2 offset:39168
v_add_f32 v171, v171, v173
v_cndmask_b32 v170, v170, 0, s[56:57]
s_waitcnt vmcnt(15) lgkmcnt(6)
v_mfma_f32_32x32x16_bf16 v[26:41], v[130:133], v[78:81], v[26:41]
ds_read_b64_tr_b16 v[74:75], v2 offset:11264
ds_read_b64_tr_b16 v[76:77], v2 offset:11520
v_cndmask_b32 v171, v171, 0, s[56:57]
v_add_f32 v158, v158, v162
v_add_f32 v159, v159, v163
s_waitcnt lgkmcnt(6)
v_mfma_f32_32x32x16_bf16 v[42:57], v[130:133], v[82:85], v[42:57]
buffer_load_dwordx4 v[130:133], v1, s[4:7], s65 offen offset:1024 sc1
ds_read_b64_tr_b16 v[78:79], v2 offset:39936
ds_read_b64_tr_b16 v[80:81], v2 offset:40192
v_add_f32 v166, v166, v170
v_add_f32 v167, v167, v171
s_waitcnt vmcnt(15) lgkmcnt(6)
v_mfma_f32_32x32x16_bf16 v[26:41], v[134:137], v[86:89], v[26:41]
ds_read_b64_tr_b16 v[82:83], v2 offset:12288
ds_read_b64_tr_b16 v[84:85], v2 offset:12544
v_add_f32 v158, v158, v166
v_add_f32 v159, v159, v167
v_mov_b32 v160, v158
s_waitcnt lgkmcnt(6)
v_mfma_f32_32x32x16_bf16 v[42:57], v[134:137], v[90:93], v[42:57]
buffer_load_dwordx4 v[134:137], v1, s[4:7], s65 offen offset:2048 sc1
ds_read_b64_tr_b16 v[86:87], v2 offset:40960
ds_read_b64_tr_b16 v[88:89], v2 offset:41216
v_mov_b32 v161, v159
v_mov_b32 v174, 0
s_waitcnt vmcnt(15) lgkmcnt(6)
v_mfma_f32_32x32x16_bf16 v[26:41], v[138:141], v[74:77], v[26:41]
ds_read_b64_tr_b16 v[90:91], v2 offset:13312
ds_read_b64_tr_b16 v[92:93], v2 offset:13568
v_mov_b32 v175, 0
v_permlane32_swap_b32 v158, v160
v_permlane32_swap_b32 v159, v161
s_waitcnt lgkmcnt(6)
v_mfma_f32_32x32x16_bf16 v[42:57], v[138:141], v[78:81], v[42:57]
buffer_load_dwordx4 v[138:141], v1, s[4:7], s65 offen offset:3072 sc1
ds_read_b64_tr_b16 v[74:75], v2 offset:41984
ds_read_b64_tr_b16 v[76:77], v2 offset:42240
v_add_f32 v158, v158, v160
v_add_f32 v159, v159, v161
s_waitcnt vmcnt(14) lgkmcnt(6)
v_mfma_f32_32x32x16_bf16 v[26:41], v[94:97], v[82:85], v[26:41]
ds_read_b64_tr_b16 v[78:79], v2 offset:14336
ds_read_b64_tr_b16 v[80:81], v2 offset:14592
v_mul_f32 v160, 0x3b124925, v158
v_mul_f32 v159, 0x3b124925, v159
v_fmamk_f32 v158, v160, 0xc3e00000, v158
s_waitcnt lgkmcnt(6)
v_mfma_f32_32x32x16_bf16 v[42:57], v[94:97], v[86:89], v[42:57]
s_add_u32 s65, s70, 24576
buffer_load_dwordx4 v[94:97], v1, s[4:7], s65 offen offset:0 sc1
ds_read_b64_tr_b16 v[82:83], v2 offset:43008
ds_read_b64_tr_b16 v[84:85], v2 offset:43264
v_fmamk_f32 v158, v158, 0x3b124925, v160
v_fma_f32 v159, -v158, v158, v159
s_waitcnt vmcnt(13) lgkmcnt(6)
v_mfma_f32_32x32x16_bf16 v[26:41], v[98:101], v[90:93], v[26:41]
ds_read_b64_tr_b16 v[86:87], v2 offset:15360
ds_read_b64_tr_b16 v[88:89], v2 offset:15616
v_max_f32 v159, 0, v159
v_cvt_pk_bf16_f32 v160, -v158, v159
v_and_b32 v159, 0xffff0000, v160
s_waitcnt lgkmcnt(6)
v_mfma_f32_32x32x16_bf16 v[42:57], v[98:101], v[74:77], v[42:57]
buffer_load_dwordx4 v[98:101], v1, s[4:7], s65 offen offset:1024 sc1
ds_read_b64_tr_b16 v[90:91], v2 offset:44032
ds_read_b64_tr_b16 v[92:93], v2 offset:44288
v_and_b32 v160, 0xffff, v160
v_add_f32 v159, 0x3727c5ac, v159
s_waitcnt vmcnt(12) lgkmcnt(6)
v_mfma_f32_32x32x16_bf16 v[26:41], v[102:105], v[78:81], v[26:41]
ds_read_b64_tr_b16 v[74:75], v2 offset:16384
ds_read_b64_tr_b16 v[76:77], v2 offset:16640
v_cndmask_b32 v173, v160, 0, s[56:57]
v_cvt_pk_bf16_f32 v159, v159, v159
v_lshl_or_b32 v172, v173, 16, v173
s_waitcnt lgkmcnt(6)
v_mfma_f32_32x32x16_bf16 v[42:57], v[102:105], v[82:85], v[42:57]
buffer_load_dwordx4 v[102:105], v1, s[4:7], s65 offen offset:2048 sc1
ds_read_b64_tr_b16 v[78:79], v2 offset:45056
ds_read_b64_tr_b16 v[80:81], v2 offset:45312
v_and_b32 v159, 0xffff0000, v159
v_sqrt_f32 v159, v159
s_waitcnt vmcnt(11) lgkmcnt(6)
v_mfma_f32_32x32x16_bf16 v[26:41], v[106:109], v[86:89], v[26:41]
ds_read_b64_tr_b16 v[82:83], v2 offset:17408
ds_read_b64_tr_b16 v[84:85], v2 offset:17664
v_cvt_pk_bf16_f32 v159, v159, v159
v_and_b32 v159, 0xffff0000, v159
v_rcp_f32 v158, v159
s_waitcnt lgkmcnt(6)
v_mfma_f32_32x32x16_bf16 v[42:57], v[106:109], v[90:93], v[42:57]
buffer_load_dwordx4 v[106:109], v1, s[4:7], s65 offen offset:3072 sc1
ds_read_b64_tr_b16 v[86:87], v2 offset:46080
ds_read_b64_tr_b16 v[88:89], v2 offset:46336
v_mul_f32 v159, 0x3fb8aa3b, v158
s_lshl_b32 s64, s32, 7
s_waitcnt vmcnt(11) lgkmcnt(6)
v_mfma_f32_32x32x16_bf16 v[26:41], v[110:113], v[74:77], v[26:41]
ds_read_b64_tr_b16 v[90:91], v2 offset:18432
ds_read_b64_tr_b16 v[92:93], v2 offset:18688
s_add_u32 s64, s64, 161792
v_and_b32 v168, 31, v0
v_lshl_add_u32 v168, v168, 2, s64
s_waitcnt lgkmcnt(6)
v_mfma_f32_32x32x16_bf16 v[42:57], v[110:113], v[78:81], v[42:57]
ds_read_b64_tr_b16 v[74:75], v2 offset:47104
ds_read_b64_tr_b16 v[76:77], v2 offset:47360
v_lshrrev_b32 v169, 5, v0
v_lshl_add_u32 v169, v169, 4, s64
ds_write_b32 v168, v158
s_waitcnt vmcnt(10) lgkmcnt(7)
v_mfma_f32_32x32x16_bf16 v[26:41], v[114:117], v[82:85], v[26:41]
ds_read_b64_tr_b16 v[78:79], v2 offset:19456
ds_read_b64_tr_b16 v[80:81], v2 offset:19712
ds_read_b128 v[142:145], v169 offset:0
ds_read_b128 v[146:149], v169 offset:32
ds_read_b128 v[150:153], v169 offset:64
s_waitcnt lgkmcnt(10)
v_mfma_f32_32x32x16_bf16 v[42:57], v[114:117], v[86:89], v[42:57]
ds_read_b64_tr_b16 v[82:83], v2 offset:48128
ds_read_b64_tr_b16 v[84:85], v2 offset:48384
ds_read_b128 v[154:157], v169 offset:96
v_mov_b32 v160, 0x3f803f80
v_mov_b32 v161, 0x3f803f80
s_waitcnt vmcnt(9) lgkmcnt(11)
v_mfma_f32_32x32x16_bf16 v[26:41], v[118:121], v[90:93], v[26:41]
ds_read_b64_tr_b16 v[86:87], v2 offset:20480
ds_read_b64_tr_b16 v[88:89], v2 offset:20736
v_mov_b32 v162, 0x3f803f80
v_mov_b32 v163, 0x3f803f80
v_mov_b32 v164, 0x3f803f80
s_waitcnt lgkmcnt(11)
v_mfma_f32_32x32x16_bf16 v[42:57], v[118:121], v[74:77], v[42:57]
ds_read_b64_tr_b16 v[90:91], v2 offset:21504
ds_read_b64_tr_b16 v[92:93], v2 offset:21760
v_mov_b32 v165, 0x3f803f80
v_mov_b32 v166, 0x3f803f80
v_mov_b32 v167, 0x3f803f80
s_waitcnt vmcnt(8) lgkmcnt(10)
v_mfma_f32_32x32x16_bf16 v[26:41], v[122:125], v[78:81], v[26:41]
ds_read_b64_tr_b16 v[74:75], v2 offset:22528
ds_read_b64_tr_b16 v[76:77], v2 offset:22784
s_waitcnt lgkmcnt(7)
v_mfma_f32_32x32x16_bf16 v[42:57], v[122:125], v[82:85], v[42:57]
ds_read_b64_tr_b16 v[78:79], v2 offset:23552
ds_read_b64_tr_b16 v[80:81], v2 offset:23808
s_waitcnt vmcnt(7) lgkmcnt(6)
v_mfma_f32_32x32x16_bf16 v[26:41], v[126:129], v[86:89], v[26:41]
ds_read_b64_tr_b16 v[82:83], v2 offset:24576
ds_read_b64_tr_b16 v[84:85], v2 offset:24832
s_waitcnt vmcnt(6) lgkmcnt(6)
v_mfma_f32_32x32x16_bf16 v[26:41], v[130:133], v[90:93], v[26:41]
ds_read_b64_tr_b16 v[86:87], v2 offset:25600
ds_read_b64_tr_b16 v[88:89], v2 offset:25856
s_waitcnt vmcnt(5) lgkmcnt(6)
v_mfma_f32_32x32x16_bf16 v[26:41], v[134:137], v[74:77], v[26:41]
ds_read_b64_tr_b16 v[90:91], v2 offset:26624
ds_read_b64_tr_b16 v[92:93], v2 offset:26880
s_waitcnt vmcnt(4) lgkmcnt(6)
v_mfma_f32_32x32x16_bf16 v[26:41], v[138:141], v[78:81], v[26:41]
ds_read_b64_tr_b16 v[74:75], v2 offset:27648
ds_read_b64_tr_b16 v[76:77], v2 offset:27904
s_waitcnt vmcnt(3) lgkmcnt(6)
v_mfma_f32_32x32x16_bf16 v[26:41], v[94:97], v[82:85], v[26:41]
ds_read_b64_tr_b16 v[78:79], v2 offset:49152
ds_read_b64_tr_b16 v[80:81], v2 offset:49408
s_waitcnt vmcnt(2) lgkmcnt(6)
v_mfma_f32_32x32x16_bf16 v[26:41], v[98:101], v[86:89], v[26:41]
ds_read_b64_tr_b16 v[82:83], v2 offset:50176
ds_read_b64_tr_b16 v[84:85], v2 offset:50432
s_waitcnt vmcnt(1) lgkmcnt(6)
v_mfma_f32_32x32x16_bf16 v[26:41], v[102:105], v[90:93], v[26:41]
ds_read_b64_tr_b16 v[86:87], v2 offset:51200
ds_read_b64_tr_b16 v[88:89], v2 offset:51456
s_waitcnt vmcnt(0) lgkmcnt(6)
v_mfma_f32_32x32x16_bf16 v[26:41], v[106:109], v[74:77], v[26:41]
ds_read_b64_tr_b16 v[90:91], v2 offset:52224
ds_read_b64_tr_b16 v[92:93], v2 offset:52480
v_mfma_f32_32x32x16_bf16 v[26:41], v[172:175], v[8:11], v[26:41]
s_waitcnt lgkmcnt(6)
v_mfma_f32_32x32x16_bf16 v[42:57], v[126:129], v[78:81], v[42:57]
ds_read_b64_tr_b16 v[74:75], v2 offset:53248
ds_read_b64_tr_b16 v[76:77], v2 offset:53504
s_waitcnt lgkmcnt(6)
v_mfma_f32_32x32x16_bf16 v[42:57], v[130:133], v[82:85], v[42:57]
ds_read_b64_tr_b16 v[78:79], v2 offset:54272
ds_read_b64_tr_b16 v[80:81], v2 offset:54528
s_waitcnt lgkmcnt(15)
s_nop 2
v_mul_f32 v26, v26, v142
v_mul_f32 v27, v27, v143
s_waitcnt lgkmcnt(6)
v_mfma_f32_32x32x16_bf16 v[42:57], v[134:137], v[86:89], v[42:57]
ds_read_b64_tr_b16 v[82:83], v2 offset:55296
ds_read_b64_tr_b16 v[84:85], v2 offset:55552
v_mul_f32 v168, s82, v26
v_mul_f32 v169, s82, v27
v_exp_f32 v168, v168 clamp
s_waitcnt lgkmcnt(6)
v_mfma_f32_32x32x16_bf16 v[42:57], v[138:141], v[90:93], v[42:57]
ds_read_b64_tr_b16 v[86:87], v2 offset:56320
ds_read_b64_tr_b16 v[88:89], v2 offset:56576
v_exp_f32 v169, v169 clamp
v_add_f32 v26, s84, v26
s_waitcnt lgkmcnt(6)
v_mfma_f32_32x32x16_bf16 v[42:57], v[94:97], v[74:77], v[42:57]
v_add_f32 v27, s84, v27
v_add_f32 v168, s86, v168
v_add_f32 v169, s86, v169
v_max_f32 v168, v168, v26
v_max_f32 v169, v169, v27
s_waitcnt lgkmcnt(4)
v_mfma_f32_32x32x16_bf16 v[42:57], v[98:101], v[78:81], v[42:57]
v_cvt_pk_bf16_f32 v26, v168, v169
v_mul_f32 v28, v28, v144
v_mul_f32 v29, v29, v145
v_mul_f32 v170, s82, v28
v_mul_f32 v171, s82, v29
s_waitcnt lgkmcnt(2)
v_mfma_f32_32x32x16_bf16 v[42:57], v[102:105], v[82:85], v[42:57]
v_exp_f32 v170, v170 clamp
v_exp_f32 v171, v171 clamp
v_add_f32 v28, s84, v28
s_waitcnt lgkmcnt(0)
v_mfma_f32_32x32x16_bf16 v[42:57], v[106:109], v[86:89], v[42:57]
v_add_f32 v29, s84, v29
v_add_f32 v170, s86, v170
v_add_f32 v171, s86, v171
v_max_f32 v170, v170, v28
v_max_f32 v171, v171, v29
v_cvt_pk_bf16_f32 v27, v170, v171
v_mfma_f32_32x32x16_bf16 v[42:57], v[172:175], v[10:13], v[42:57]
v_pk_mul_f32 v[30:31], v[30:31], v[146:147]
v_pk_mul_f32 v[168:169], v[30:31], s[82:83]
v_exp_f32 v168, v168 clamp
v_exp_f32 v169, v169 clamp
v_pk_add_f32 v[30:31], v[30:31], s[84:85]
v_pk_add_f32 v[168:169], v[168:169], s[86:87]
v_max_f32 v168, v168, v30
v_max_f32 v169, v169, v31
v_cvt_pk_bf16_f32 v28, v168, v169
v_pk_mul_f32 v[32:33], v[32:33], v[148:149]
v_pk_mul_f32 v[170:171], v[32:33], s[82:83]
v_exp_f32 v170, v170 clamp
v_exp_f32 v171, v171 clamp
v_pk_add_f32 v[32:33], v[32:33], s[84:85]
v_pk_add_f32 v[170:171], v[170:171], s[86:87]
v_max_f32 v170, v170, v32
v_max_f32 v171, v171, v33
v_cvt_pk_bf16_f32 v29, v170, v171
v_pk_mul_f32 v[34:35], v[34:35], v[150:151]
v_pk_mul_f32 v[168:169], v[34:35], s[82:83]
v_exp_f32 v168, v168 clamp
v_exp_f32 v169, v169 clamp
v_pk_add_f32 v[34:35], v[34:35], s[84:85]
v_pk_add_f32 v[168:169], v[168:169], s[86:87]
v_max_f32 v168, v168, v34
v_max_f32 v169, v169, v35
v_cvt_pk_bf16_f32 v30, v168, v169
v_pk_mul_f32 v[36:37], v[36:37], v[152:153]
v_pk_mul_f32 v[170:171], v[36:37], s[82:83]
v_exp_f32 v170, v170 clamp
v_exp_f32 v171, v171 clamp
v_pk_add_f32 v[36:37], v[36:37], s[84:85]
v_pk_add_f32 v[170:171], v[170:171], s[86:87]
v_max_f32 v170, v170, v36
v_max_f32 v171, v171, v37
v_cvt_pk_bf16_f32 v31, v170, v171
v_pk_mul_f32 v[38:39], v[38:39], v[154:155]
v_pk_mul_f32 v[168:169], v[38:39], s[82:83]
v_exp_f32 v168, v168 clamp
v_exp_f32 v169, v169 clamp
v_pk_add_f32 v[38:39], v[38:39], s[84:85]
v_pk_add_f32 v[168:169], v[168:169], s[86:87]
v_max_f32 v168, v168, v38
v_max_f32 v169, v169, v39
v_cvt_pk_bf16_f32 v32, v168, v169
v_pk_mul_f32 v[40:41], v[40:41], v[156:157]
v_pk_mul_f32 v[170:171], v[40:41], s[82:83]
v_exp_f32 v170, v170 clamp
v_exp_f32 v171, v171 clamp
v_pk_add_f32 v[40:41], v[40:41], s[84:85]
v_pk_add_f32 v[170:171], v[170:171], s[86:87]
v_max_f32 v170, v170, v40
v_max_f32 v171, v171, v41
v_cvt_pk_bf16_f32 v33, v170, v171
v_pk_mul_f32 v[42:43], v[42:43], v[142:143]
v_pk_mul_f32 v[44:45], v[44:45], v[144:145]
v_pk_mul_f32 v[46:47], v[46:47], v[146:147]
v_pk_mul_f32 v[48:49], v[48:49], v[148:149]
v_pk_mul_f32 v[50:51], v[50:51], v[150:151]
v_pk_mul_f32 v[52:53], v[52:53], v[152:153]
v_pk_mul_f32 v[54:55], v[54:55], v[154:155]
v_pk_mul_f32 v[56:57], v[56:57], v[156:157]
s_mov_b64 exec, s[54:55]
v_cvt_pk_bf16_f32 v160, v42, v43
v_cvt_pk_bf16_f32 v161, v44, v45
v_cvt_pk_bf16_f32 v162, v46, v47
v_cvt_pk_bf16_f32 v163, v48, v49
v_cvt_pk_bf16_f32 v164, v50, v51
v_cvt_pk_bf16_f32 v165, v52, v53
v_cvt_pk_bf16_f32 v166, v54, v55
v_cvt_pk_bf16_f32 v167, v56, v57
s_mov_b64 exec, -1
s_add_u32 s61, s89, 143360
v_add_u32 v168, s61, v1
v_mfma_f32_32x32x16_bf16 v[42:57], v[26:29], v[160:163], 0
v_mfma_f32_32x32x16_bf16 v[42:57], v[30:33], v[164:167], v[42:57]
s_lshr_b32 s61, s89, 2
s_add_u32 s61, s61, 143360
v_add_u32 v169, s61, v1
s_add_u32 s42, s42, 1048576
s_add_u32 s43, s43, 1048576
s_nop 6
ds_write_b128 v168, v[42:45] offset:0
ds_write_b128 v168, v[46:49] offset:1024
ds_write_b128 v168, v[50:53] offset:2048
ds_write_b128 v168, v[54:57] offset:3072
s_waitcnt lgkmcnt(0)
s_barrier
ds_read_b128 v[26:29], v169 offset:0
ds_read_b128 v[30:33], v169 offset:4096
ds_read_b128 v[34:37], v169 offset:8192
ds_read_b128 v[38:41], v169 offset:12288
v_lshlrev_b32 v160, 3, v0
v_mov_b32 v161, s81
v_cndmask_b32 v161, -2, v161, s[56:57]
s_waitcnt lgkmcnt(2)
v_pk_add_f32 v[26:27], v[26:27], v[30:31]
v_pk_add_f32 v[28:29], v[28:29], v[32:33]
s_waitcnt lgkmcnt(0)
v_pk_add_f32 v[34:35], v[34:35], v[38:39]
v_pk_add_f32 v[36:37], v[36:37], v[40:41]
v_pk_add_f32 v[26:27], v[26:27], v[34:35]
v_pk_add_f32 v[28:29], v[28:29], v[36:37]
v_cvt_pk_bf16_f32 v26, v26, v27
v_cvt_pk_bf16_f32 v27, v28, v29
v_min_u32 v26, v161, v26
v_min_u32 v27, v161, v27
buffer_store_dwordx2 v[26:27], v160, s[4:7], s42 offen sc1
ds_read_b64_tr_b16 v[74:75], v3 offset:16384
ds_read_b64_tr_b16 v[76:77], v3 offset:16640
ds_read_b64_tr_b16 v[78:79], v3 offset:17408
ds_read_b64_tr_b16 v[80:81], v3 offset:17664
ds_read_b64_tr_b16 v[82:83], v3 offset:18432
ds_read_b64_tr_b16 v[84:85], v3 offset:18688
ds_read_b64_tr_b16 v[86:87], v3 offset:19456
ds_read_b64_tr_b16 v[88:89], v3 offset:19712
s_waitcnt lgkmcnt(6)
v_mfma_f32_32x32x16_bf16 v[58:73], v[74:77], v[110:113], v[58:73]
s_add_u32 s65, s70, 8192
buffer_load_dwordx4 v[110:113], v1, s[4:7], s65 offen sc1
ds_read_b64_tr_b16 v[90:91], v3 offset:20480
ds_read_b64_tr_b16 v[92:93], v3 offset:20736
s_waitcnt lgkmcnt(6)
v_mfma_f32_32x32x16_bf16 v[58:73], v[78:81], v[114:117], v[58:73]
s_add_u32 s65, s70, 9216
buffer_load_dwordx4 v[114:117], v1, s[4:7], s65 offen sc1
ds_read_b64_tr_b16 v[74:75], v3 offset:21504
ds_read_b64_tr_b16 v[76:77], v3 offset:21760
s_waitcnt lgkmcnt(6)
v_mfma_f32_32x32x16_bf16 v[58:73], v[82:85], v[118:121], v[58:73]
s_add_u32 s65, s70, 10240
buffer_load_dwordx4 v[118:121], v1, s[4:7], s65 offen sc1
ds_read_b64_tr_b16 v[78:79], v3 offset:22528
ds_read_b64_tr_b16 v[80:81], v3 offset:22784
s_waitcnt lgkmcnt(6)
v_mfma_f32_32x32x16_bf16 v[58:73], v[86:89], v[122:125], v[58:73]
s_add_u32 s65, s70, 11264
buffer_load_dwordx4 v[122:125], v1, s[4:7], s65 offen sc1
ds_read_b64_tr_b16 v[82:83], v3 offset:23552
ds_read_b64_tr_b16 v[84:85], v3 offset:23808
s_waitcnt lgkmcnt(6)
v_mfma_f32_32x32x16_bf16 v[58:73], v[90:93], v[126:129], v[58:73]
s_add_u32 s65, s70, 12288
buffer_load_dwordx4 v[126:129], v1, s[4:7], s65 offen sc1
ds_read_b64_tr_b16 v[86:87], v3 offset:24576
ds_read_b64_tr_b16 v[88:89], v3 offset:24832
s_waitcnt lgkmcnt(6)
v_mfma_f32_32x32x16_bf16 v[58:73], v[74:77], v[130:133], v[58:73]
s_add_u32 s65, s70, 13312
buffer_load_dwordx4 v[130:133], v1, s[4:7], s65 offen sc1
ds_read_b64_tr_b16 v[90:91], v3 offset:25600
ds_read_b64_tr_b16 v[92:93], v3 offset:25856
s_waitcnt lgkmcnt(6)
v_mfma_f32_32x32x16_bf16 v[58:73], v[78:81], v[134:137], v[58:73]
s_add_u32 s65, s70, 14336
buffer_load_dwordx4 v[134:137], v1, s[4:7], s65 offen sc1
ds_read_b64_tr_b16 v[74:75], v3 offset:26624
ds_read_b64_tr_b16 v[76:77], v3 offset:26880
s_waitcnt lgkmcnt(6)
v_mfma_f32_32x32x16_bf16 v[58:73], v[82:85], v[138:141], v[58:73]
s_add_u32 s65, s70, 15360
buffer_load_dwordx4 v[138:141], v1, s[4:7], s65 offen sc1
ds_read_b64_tr_b16 v[78:79], v3 offset:27648
ds_read_b64_tr_b16 v[80:81], v3 offset:27904
s_waitcnt lgkmcnt(6)
v_mfma_f32_32x32x16_bf16 v[58:73], v[86:89], v[94:97], v[58:73]
s_add_u32 m0, s80, 0
s_add_u32 s63, s79, 0
buffer_load_dwordx4 v6, s[12:15], s63 offen offset:0 lds
ds_read_b64_tr_b16 v[82:83], v3 offset:8192
ds_read_b64_tr_b16 v[84:85], v3 offset:8448
s_waitcnt lgkmcnt(6)
v_mfma_f32_32x32x16_bf16 v[58:73], v[90:93], v[98:101], v[58:73]
s_add_u32 s63, s79, 6144
buffer_load_dwordx4 v6, s[12:15], s63 offen offset:1024 lds
ds_read_b64_tr_b16 v[86:87], v3 offset:9216
ds_read_b64_tr_b16 v[88:89], v3 offset:9472
s_waitcnt lgkmcnt(6)
v_mfma_f32_32x32x16_bf16 v[58:73], v[74:77], v[102:105], v[58:73]
s_add_u32 s63, s79, 12288
buffer_load_dwordx4 v6, s[12:15], s63 offen offset:2048 lds
ds_read_b64_tr_b16 v[90:91], v3 offset:10240
ds_read_b64_tr_b16 v[92:93], v3 offset:10496
s_waitcnt lgkmcnt(6)
v_mfma_f32_32x32x16_bf16 v[58:73], v[78:81], v[106:109], v[58:73]
s_add_u32 s63, s79, 18432
buffer_load_dwordx4 v6, s[12:15], s63 offen offset:3072 lds
ds_read_b64_tr_b16 v[74:75], v3 offset:11264
ds_read_b64_tr_b16 v[76:77], v3 offset:11520
s_waitcnt vmcnt(11) lgkmcnt(6)
v_mfma_f32_32x32x16_bf16 v[58:73], v[82:85], v[110:113], v[58:73]
s_add_u32 m0, s80, 4096
s_add_u32 s63, s79, 28672
buffer_load_dwordx4 v6, s[12:15], s63 offen offset:0 lds
ds_read_b64_tr_b16 v[78:79], v3 offset:12288
ds_read_b64_tr_b16 v[80:81], v3 offset:12544
s_waitcnt vmcnt(11) lgkmcnt(6)
v_mfma_f32_32x32x16_bf16 v[58:73], v[86:89], v[114:117], v[58:73]
s_add_u32 s63, s79, 34816
buffer_load_dwordx4 v6, s[12:15], s63 offen offset:1024 lds
ds_read_b64_tr_b16 v[82:83], v3 offset:13312
ds_read_b64_tr_b16 v[84:85], v3 offset:13568
s_waitcnt vmcnt(11) lgkmcnt(6)
v_mfma_f32_32x32x16_bf16 v[58:73], v[90:93], v[118:121], v[58:73]
s_add_u32 s63, s79, 40960
buffer_load_dwordx4 v6, s[12:15], s63 offen offset:2048 lds
ds_read_b64_tr_b16 v[86:87], v3 offset:14336
ds_read_b64_tr_b16 v[88:89], v3 offset:14592
s_waitcnt vmcnt(11) lgkmcnt(6)
v_mfma_f32_32x32x16_bf16 v[58:73], v[74:77], v[122:125], v[58:73]
s_add_u32 s63, s79, 47104
buffer_load_dwordx4 v6, s[12:15], s63 offen offset:3072 lds
ds_read_b64_tr_b16 v[90:91], v3 offset:15360
ds_read_b64_tr_b16 v[92:93], v3 offset:15616
s_waitcnt vmcnt(11) lgkmcnt(6)
v_mfma_f32_32x32x16_bf16 v[58:73], v[78:81], v[126:129], v[58:73]
s_add_u32 m0, s80, 8192
s_add_u32 s63, s79, 57344
buffer_load_dwordx4 v6, s[12:15], s63 offen offset:0 lds
s_waitcnt vmcnt(11) lgkmcnt(4)
v_mfma_f32_32x32x16_bf16 v[58:73], v[82:85], v[130:133], v[58:73]
s_add_u32 s63, s79, 63488
buffer_load_dwordx4 v6, s[12:15], s63 offen offset:1024 lds
s_waitcnt vmcnt(11) lgkmcnt(2)
v_mfma_f32_32x32x16_bf16 v[58:73], v[86:89], v[134:137], v[58:73]
s_add_u32 s63, s79, 69632
buffer_load_dwordx4 v6, s[12:15], s63 offen offset:2048 lds
s_waitcnt vmcnt(11) lgkmcnt(0)
v_mfma_f32_32x32x16_bf16 v[58:73], v[90:93], v[138:141], v[58:73]
s_add_u32 s63, s79, 75776
buffer_load_dwordx4 v6, s[12:15], s63 offen offset:3072 lds
v_mfma_f32_32x32x16_bf16 v[58:73], v[12:15], v[172:175], v[58:73]
s_add_u32 m0, s80, 12288
s_add_u32 s63, s79, 86016
buffer_load_dwordx4 v6, s[12:15], s63 offen offset:0 lds
s_add_u32 s63, s79, 92160
buffer_load_dwordx4 v6, s[12:15], s63 offen offset:1024 lds
s_nop 6
v_pk_mul_f32 v[168:169], v[58:59], v[158:159] op_sel:[0,1] op_sel_hi:[1,1]
v_exp_f32 v168, v168 clamp
v_exp_f32 v169, v169 clamp
v_pk_fma_f32 v[58:59], v[58:59], v[158:159], s[84:85] op_sel_hi:[1,0,1]
v_pk_add_f32 v[168:169], v[168:169], s[86:87]
v_max_f32 v168, v168, v58
v_max_f32 v169, v169, v59
v_cvt_pk_bf16_f32 v142, v168, v169
v_pk_mul_f32 v[170:171], v[60:61], v[158:159] op_sel:[0,1] op_sel_hi:[1,1]
v_exp_f32 v170, v170 clamp
v_exp_f32 v171, v171 clamp
v_pk_fma_f32 v[60:61], v[60:61], v[158:159], s[84:85] op_sel_hi:[1,0,1]
v_pk_add_f32 v[170:171], v[170:171], s[86:87]
v_max_f32 v170, v170, v60
v_max_f32 v171, v171, v61
v_cvt_pk_bf16_f32 v143, v170, v171
v_pk_mul_f32 v[168:169], v[62:63], v[158:159] op_sel:[0,1] op_sel_hi:[1,1]
v_exp_f32 v168, v168 clamp
v_exp_f32 v169, v169 clamp
v_pk_fma_f32 v[62:63], v[62:63], v[158:159], s[84:85] op_sel_hi:[1,0,1]
v_pk_add_f32 v[168:169], v[168:169], s[86:87]
v_max_f32 v168, v168, v62
v_max_f32 v169, v169, v63
v_cvt_pk_bf16_f32 v144, v168, v169
v_pk_mul_f32 v[170:171], v[64:65], v[158:159] op_sel:[0,1] op_sel_hi:[1,1]
v_exp_f32 v170, v170 clamp
v_exp_f32 v171, v171 clamp
v_pk_fma_f32 v[64:65], v[64:65], v[158:159], s[84:85] op_sel_hi:[1,0,1]
v_pk_add_f32 v[170:171], v[170:171], s[86:87]
v_max_f32 v170, v170, v64
v_max_f32 v171, v171, v65
v_cvt_pk_bf16_f32 v145, v170, v171
v_pk_mul_f32 v[168:169], v[66:67], v[158:159] op_sel:[0,1] op_sel_hi:[1,1]
v_exp_f32 v168, v168 clamp
v_exp_f32 v169, v169 clamp
v_pk_fma_f32 v[66:67], v[66:67], v[158:159], s[84:85] op_sel_hi:[1,0,1]
v_pk_add_f32 v[168:169], v[168:169], s[86:87]
v_max_f32 v168, v168, v66
v_max_f32 v169, v169, v67
v_cvt_pk_bf16_f32 v146, v168, v169
v_pk_mul_f32 v[170:171], v[68:69], v[158:159] op_sel:[0,1] op_sel_hi:[1,1]
v_exp_f32 v170, v170 clamp
v_exp_f32 v171, v171 clamp
v_pk_fma_f32 v[68:69], v[68:69], v[158:159], s[84:85] op_sel_hi:[1,0,1]
v_pk_add_f32 v[170:171], v[170:171], s[86:87]
v_max_f32 v170, v170, v68
v_max_f32 v171, v171, v69
v_cvt_pk_bf16_f32 v147, v170, v171
v_pk_mul_f32 v[168:169], v[70:71], v[158:159] op_sel:[0,1] op_sel_hi:[1,1]
v_exp_f32 v168, v168 clamp
v_exp_f32 v169, v169 clamp
v_pk_fma_f32 v[70:71], v[70:71], v[158:159], s[84:85] op_sel_hi:[1,0,1]
v_pk_add_f32 v[168:169], v[168:169], s[86:87]
v_max_f32 v168, v168, v70
v_max_f32 v169, v169, v71
v_cvt_pk_bf16_f32 v148, v168, v169
v_pk_mul_f32 v[170:171], v[72:73], v[158:159] op_sel:[0,1] op_sel_hi:[1,1]
v_exp_f32 v170, v170 clamp
v_exp_f32 v171, v171 clamp
v_pk_fma_f32 v[72:73], v[72:73], v[158:159], s[84:85] op_sel_hi:[1,0,1]
v_pk_add_f32 v[170:171], v[170:171], s[86:87]
v_max_f32 v170, v170, v72
v_max_f32 v171, v171, v73
v_cvt_pk_bf16_f32 v149, v170, v171
s_add_u32 s65, s43, 0
buffer_load_dwordx2 v[28:29], v160, s[4:7], s65 offen offset:0 sc1
buffer_load_dwordx2 v[30:31], v160, s[4:7], s65 offen offset:512 sc1
buffer_load_dwordx2 v[32:33], v160, s[4:7], s65 offen offset:1024 sc1
buffer_load_dwordx2 v[34:35], v160, s[4:7], s65 offen offset:1536 sc1
buffer_load_dwordx2 v[36:37], v160, s[4:7], s65 offen offset:2048 sc1
buffer_load_dwordx2 v[38:39], v160, s[4:7], s65 offen offset:2560 sc1
buffer_load_dwordx2 v[40:41], v160, s[4:7], s65 offen offset:3072 sc1
buffer_load_dwordx2 v[42:43], v160, s[4:7], s65 offen offset:3584 sc1
s_add_u32 s65, s43, 4096
buffer_load_dwordx2 v[44:45], v160, s[4:7], s65 offen offset:0 sc1
buffer_load_dwordx2 v[46:47], v160, s[4:7], s65 offen offset:512 sc1
buffer_load_dwordx2 v[48:49], v160, s[4:7], s65 offen offset:1024 sc1
buffer_load_dwordx2 v[50:51], v160, s[4:7], s65 offen offset:1536 sc1
buffer_load_dwordx2 v[52:53], v160, s[4:7], s65 offen offset:2048 sc1
buffer_load_dwordx2 v[54:55], v160, s[4:7], s65 offen offset:2560 sc1
buffer_load_dwordx2 v[56:57], v160, s[4:7], s65 offen offset:3072 sc1
buffer_load_dwordx2 v[26:27], v160, s[4:7], s65 offen offset:3584 sc1
s_waitcnt vmcnt(15)
LC_210:
v_max_u32 v94, v28, v29
v_cmp_eq_u32 vcc, -1, v94
v_lshlrev_b32 v96, 16, v28
v_and_b32 v97, 0xffff0000, v28
v_lshlrev_b32 v98, 16, v29
v_and_b32 v99, 0xffff0000, v29
s_cbranch_vccnz LS_211
LO_212:
v_pk_add_f32 v[90:91], v[96:97], 0
v_pk_add_f32 v[92:93], v[98:99], 0
s_waitcnt vmcnt(14)
LC_213:
v_max_u32 v94, v30, v31
v_cmp_eq_u32 vcc, -1, v94
v_lshlrev_b32 v96, 16, v30
v_and_b32 v97, 0xffff0000, v30
v_lshlrev_b32 v98, 16, v31
v_and_b32 v99, 0xffff0000, v31
s_cbranch_vccnz LS_214
LO_215:
v_pk_add_f32 v[90:91], v[90:91], v[96:97]
v_pk_add_f32 v[92:93], v[92:93], v[98:99]
s_waitcnt vmcnt(13)
LC_216:
v_max_u32 v94, v32, v33
v_cmp_eq_u32 vcc, -1, v94
v_lshlrev_b32 v96, 16, v32
v_and_b32 v97, 0xffff0000, v32
v_lshlrev_b32 v98, 16, v33
v_and_b32 v99, 0xffff0000, v33
s_cbranch_vccnz LS_217
LO_218:
v_pk_add_f32 v[90:91], v[90:91], v[96:97]
v_pk_add_f32 v[92:93], v[92:93], v[98:99]
s_lshr_b32 s61, s89, 3
s_add_u32 s61, s61, 159744
v_add_u32 v163, s61, v160
v_add_u32 v162, 159744, v160
s_waitcnt vmcnt(12)
LC_219:
v_max_u32 v94, v34, v35
v_cmp_eq_u32 vcc, -1, v94
v_lshlrev_b32 v96, 16, v34
v_and_b32 v97, 0xffff0000, v34
v_lshlrev_b32 v98, 16, v35
v_and_b32 v99, 0xffff0000, v35
s_cbranch_vccnz LS_220
LO_221:
v_pk_add_f32 v[90:91], v[90:91], v[96:97]
v_pk_add_f32 v[92:93], v[92:93], v[98:99]
s_waitcnt vmcnt(11)
LC_222:
v_max_u32 v94, v36, v37
v_cmp_eq_u32 vcc, -1, v94
v_lshlrev_b32 v96, 16, v36
v_and_b32 v97, 0xffff0000, v36
v_lshlrev_b32 v98, 16, v37
v_and_b32 v99, 0xffff0000, v37
s_cbranch_vccnz LS_223
LO_224:
v_pk_add_f32 v[90:91], v[90:91], v[96:97]
v_pk_add_f32 v[92:93], v[92:93], v[98:99]
s_waitcnt vmcnt(10)
LC_225:
v_max_u32 v94, v38, v39
v_cmp_eq_u32 vcc, -1, v94
v_lshlrev_b32 v96, 16, v38
v_and_b32 v97, 0xffff0000, v38
v_lshlrev_b32 v98, 16, v39
v_and_b32 v99, 0xffff0000, v39
s_cbranch_vccnz LS_226
LO_227:
v_pk_add_f32 v[90:91], v[90:91], v[96:97]
v_pk_add_f32 v[92:93], v[92:93], v[98:99]
s_waitcnt vmcnt(9)
LC_228:
v_max_u32 v94, v40, v41
v_cmp_eq_u32 vcc, -1, v94
v_lshlrev_b32 v96, 16, v40
v_and_b32 v97, 0xffff0000, v40
v_lshlrev_b32 v98, 16, v41
v_and_b32 v99, 0xffff0000, v41
s_cbranch_vccnz LS_229
LO_230:
v_pk_add_f32 v[90:91], v[90:91], v[96:97]
v_pk_add_f32 v[92:93], v[92:93], v[98:99]
s_waitcnt vmcnt(8)
LC_231:
v_max_u32 v94, v42, v43
v_cmp_eq_u32 vcc, -1, v94
v_lshlrev_b32 v96, 16, v42
v_and_b32 v97, 0xffff0000, v42
v_lshlrev_b32 v98, 16, v43
v_and_b32 v99, 0xffff0000, v43
s_cbranch_vccnz LS_232
LO_233:
v_pk_add_f32 v[90:91], v[90:91], v[96:97]
v_pk_add_f32 v[92:93], v[92:93], v[98:99]
s_waitcnt vmcnt(7)
LC_234:
v_max_u32 v94, v44, v45
v_cmp_eq_u32 vcc, -1, v94
v_lshlrev_b32 v96, 16, v44
v_and_b32 v97, 0xffff0000, v44
v_lshlrev_b32 v98, 16, v45
v_and_b32 v99, 0xffff0000, v45
s_cbranch_vccnz LS_235
LO_236:
v_pk_add_f32 v[90:91], v[90:91], v[96:97]
v_pk_add_f32 v[92:93], v[92:93], v[98:99]
s_waitcnt vmcnt(6)
LC_237:
v_max_u32 v94, v46, v47
v_cmp_eq_u32 vcc, -1, v94
v_lshlrev_b32 v96, 16, v46
v_and_b32 v97, 0xffff0000, v46
v_lshlrev_b32 v98, 16, v47
v_and_b32 v99, 0xffff0000, v47
s_cbranch_vccnz LS_238
LO_239:
v_pk_add_f32 v[90:91], v[90:91], v[96:97]
v_pk_add_f32 v[92:93], v[92:93], v[98:99]
s_waitcnt vmcnt(5)
LC_240:
v_max_u32 v94, v48, v49
v_cmp_eq_u32 vcc, -1, v94
v_lshlrev_b32 v96, 16, v48
v_and_b32 v97, 0xffff0000, v48
v_lshlrev_b32 v98, 16, v49
v_and_b32 v99, 0xffff0000, v49
s_cbranch_vccnz LS_241
LO_242:
v_pk_add_f32 v[90:91], v[90:91], v[96:97]
v_pk_add_f32 v[92:93], v[92:93], v[98:99]
s_waitcnt vmcnt(4)
LC_243:
v_max_u32 v94, v50, v51
v_cmp_eq_u32 vcc, -1, v94
v_lshlrev_b32 v96, 16, v50
v_and_b32 v97, 0xffff0000, v50
v_lshlrev_b32 v98, 16, v51
v_and_b32 v99, 0xffff0000, v51
s_cbranch_vccnz LS_244
LO_245:
v_pk_add_f32 v[90:91], v[90:91], v[96:97]
v_pk_add_f32 v[92:93], v[92:93], v[98:99]
s_waitcnt vmcnt(3)
LC_246:
v_max_u32 v94, v52, v53
v_cmp_eq_u32 vcc, -1, v94
v_lshlrev_b32 v96, 16, v52
v_and_b32 v97, 0xffff0000, v52
v_lshlrev_b32 v98, 16, v53
v_and_b32 v99, 0xffff0000, v53
s_cbranch_vccnz LS_247
LO_248:
v_pk_add_f32 v[90:91], v[90:91], v[96:97]
v_pk_add_f32 v[92:93], v[92:93], v[98:99]
s_waitcnt vmcnt(2)
LC_249:
v_max_u32 v94, v54, v55
v_cmp_eq_u32 vcc, -1, v94
v_lshlrev_b32 v96, 16, v54
v_and_b32 v97, 0xffff0000, v54
v_lshlrev_b32 v98, 16, v55
v_and_b32 v99, 0xffff0000, v55
s_cbranch_vccnz LS_250
LO_251:
v_pk_add_f32 v[90:91], v[90:91], v[96:97]
v_pk_add_f32 v[92:93], v[92:93], v[98:99]
s_waitcnt vmcnt(1)
LC_252:
v_max_u32 v94, v56, v57
v_cmp_eq_u32 vcc, -1, v94
v_lshlrev_b32 v96, 16, v56
v_and_b32 v97, 0xffff0000, v56
v_lshlrev_b32 v98, 16, v57
v_and_b32 v99, 0xffff0000, v57
s_cbranch_vccnz LS_253
LO_254:
v_pk_add_f32 v[90:91], v[90:91], v[96:97]
v_pk_add_f32 v[92:93], v[92:93], v[98:99]
s_waitcnt vmcnt(0)
LC_255:
v_max_u32 v94, v26, v27
v_cmp_eq_u32 vcc, -1, v94
v_lshlrev_b32 v96, 16, v26
v_and_b32 v97, 0xffff0000, v26
v_lshlrev_b32 v98, 16, v27
v_and_b32 v99, 0xffff0000, v27
s_cbranch_vccnz LS_256
LO_257:
v_pk_add_f32 v[90:91], v[90:91], v[96:97]
v_pk_add_f32 v[92:93], v[92:93], v[98:99]
v_cvt_pk_bf16_f32 v90, v90, v91
v_cvt_pk_bf16_f32 v91, v92, v93
ds_write_b64 v163, v[90:91]
s_waitcnt lgkmcnt(0)
s_barrier
ds_read_b64 v[26:27], v162 offset:0
ds_read_b64 v[28:29], v162 offset:512
ds_read_b64 v[30:31], v162 offset:1024
ds_read_b64 v[32:33], v162 offset:1536
s_waitcnt lgkmcnt(2)
v_mfma_f32_32x32x16_bf16 v[42:57], v[26:29], v[142:145], 0
s_waitcnt lgkmcnt(0)
v_mfma_f32_32x32x16_bf16 v[42:57], v[30:33], v[146:149], v[42:57]
s_nop 11
v_add_f32 v94, s86, v54
v_rcp_f32 v94, v94
s_nop 0
v_mov_b32 v95, v94
s_nop 1
v_permlane32_swap_b32 v94, v95
v_pk_mul_f32 v[42:43], v[42:43], v[94:95] op_sel:[0,1] op_sel_hi:[1,1]
v_pk_mul_f32 v[44:45], v[44:45], v[94:95] op_sel:[0,1] op_sel_hi:[1,1]
v_pk_mul_f32 v[46:47], v[46:47], v[94:95] op_sel:[0,1] op_sel_hi:[1,1]
v_pk_mul_f32 v[48:49], v[48:49], v[94:95] op_sel:[0,1] op_sel_hi:[1,1]
v_cvt_pk_bf16_f32 v58, v42, v43
v_cvt_pk_bf16_f32 v59, v44, v45
v_cvt_pk_bf16_f32 v60, v46, v47
v_cvt_pk_bf16_f32 v61, v48, v49
buffer_store_dwordx4 v[58:61], v1, s[4:7], s72 offen sc1
v_pk_mul_f32 v[50:51], v[50:51], v[94:95] op_sel:[0,1] op_sel_hi:[1,1]
v_pk_mul_f32 v[52:53], v[52:53], v[94:95] op_sel:[0,1] op_sel_hi:[1,1]
v_pk_mul_f32 v[54:55], v[54:55], v[94:95] op_sel:[0,1] op_sel_hi:[1,1]
v_pk_mul_f32 v[56:57], v[56:57], v[94:95] op_sel:[0,1] op_sel_hi:[1,1]
v_cvt_pk_bf16_f32 v62, v50, v51
v_cvt_pk_bf16_f32 v63, v52, v53
v_cvt_pk_bf16_f32 v64, v54, v55
v_cvt_pk_bf16_f32 v65, v56, v57
v_cndmask_b32 v64, v64, 0, s[56:57]
v_cndmask_b32 v65, v65, 0, s[56:57]
buffer_store_dwordx4 v[62:65], v1, s[4:7], s72 offen offset:1024 sc1
s_add_u32 s60, s35, 10
v_mov_b32 v96, s60
s_mov_b64 exec, 1
s_waitcnt vmcnt(0)
buffer_store_dword v96, off, s[4:7], s41 sc1
s_mov_b64 exec, -1
s_cmp_ge_u32 s33, 14
s_cbranch_scc1 LR_258
s_and_b32 s61, s32, 1
s_lshl_b32 s62, s61, 6
s_mul_i32 s61, s61, 28672
s_add_u32 s61, s61, 86016
v_xor_b32 v142, s62, v5
v_xor_b32 v143, 64, v142
v_add_u32 v142, s61, v142
v_add_u32 v143, s61, v143
v_lshrrev_b32 v147, 5, v0
v_lshlrev_b32 v147, 9, v147
v_sub_u32 v144, v142, v147
v_sub_u32 v145, v143, v147
v_lshlrev_b32 v26, 16, v18
v_and_b32 v27, 0xffff0000, v18
v_lshlrev_b32 v28, 16, v19
v_and_b32 v29, 0xffff0000, v19
v_lshlrev_b32 v30, 16, v20
v_and_b32 v31, 0xffff0000, v20
v_lshlrev_b32 v32, 16, v21
v_and_b32 v33, 0xffff0000, v21
v_lshlrev_b32 v34, 16, v22
v_and_b32 v35, 0xffff0000, v22
v_lshlrev_b32 v36, 16, v23
v_and_b32 v37, 0xffff0000, v23
v_lshlrev_b32 v38, 16, v24
v_and_b32 v39, 0xffff0000, v24
v_lshlrev_b32 v40, 16, v25
v_and_b32 v41, 0xffff0000, v25
s_add_u32 s61, s89, 143360
v_add_u32 v148, s61, v1
s_xor_b32 s61, s89, 4096
s_add_u32 s61, s61, 143360
v_add_u32 v149, s61, v1
s_add_u32 s60, s35, 10
LP_260:
buffer_load_dword v152, v4, s[4:7], s40 offen sc1
s_sub_u32 s37, s37, 1
s_cmp_lt_i32 s37, 0
s_cbranch_scc1 LD_261
s_waitcnt vmcnt(0)
v_subrev_u32 v152, s60, v152
v_cmp_le_u32 vcc, 64, v152
s_and_b64 vcc, vcc, s[50:51]
s_cbranch_scc1 LP_260
LD_261:
s_add_u32 s65, s73, 0
buffer_load_dwordx4 v[58:61], v1, s[4:7], s65 offen offset:0 sc1
buffer_load_dwordx4 v[62:65], v1, s[4:7], s65 offen offset:1024 sc1
buffer_load_dwordx4 v[66:69], v1, s[4:7], s65 offen offset:2048 sc1
buffer_load_dwordx4 v[70:73], v1, s[4:7], s65 offen offset:3072 sc1
s_add_u32 s65, s73, 4096
buffer_load_dwordx4 v[74:77], v1, s[4:7], s65 offen offset:0 sc1
buffer_load_dwordx4 v[78:81], v1, s[4:7], s65 offen offset:1024 sc1
buffer_load_dwordx4 v[82:85], v1, s[4:7], s65 offen offset:2048 sc1
buffer_load_dwordx4 v[86:89], v1, s[4:7], s65 offen offset:3072 sc1
s_add_u32 s65, s73, 8192
buffer_load_dwordx4 v[90:93], v1, s[4:7], s65 offen offset:0 sc1
buffer_load_dwordx4 v[94:97], v1, s[4:7], s65 offen offset:1024 sc1
ds_read_b64_tr_b16 v[122:123], v143 offset:0
ds_read_b64_tr_b16 v[124:125], v143 offset:512
ds_read_b64_tr_b16 v[126:127], v142 offset:0
ds_read_b64_tr_b16 v[128:129], v142 offset:512
ds_read_b64_tr_b16 v[130:131], v143 offset:2048
ds_read_b64_tr_b16 v[132:133], v145 offset:2560
ds_read_b64_tr_b16 v[134:135], v142 offset:2048
ds_read_b64_tr_b16 v[136:137], v144 offset:2560
s_waitcnt vmcnt(9) lgkmcnt(6)
v_mfma_f32_32x32x16_bf16 v[42:57], v[122:125], v[58:61], 0
buffer_load_dwordx4 v[98:101], v1, s[4:7], s65 offen offset:2048 sc1
ds_read_b64_tr_b16 v[138:139], v143 offset:3584
ds_read_b64_tr_b16 v[140:141], v143 offset:4096
s_waitcnt lgkmcnt(6)
v_mfma_f32_32x32x16_bf16 v[26:41], v[126:129], v[58:61], v[26:41]
ds_read_b64_tr_b16 v[122:123], v142 offset:3584
ds_read_b64_tr_b16 v[124:125], v142 offset:4096
s_waitcnt vmcnt(9) lgkmcnt(6)
v_mfma_f32_32x32x16_bf16 v[42:57], v[130:133], v[62:65], v[42:57]
buffer_load_dwordx4 v[102:105], v1, s[4:7], s65 offen offset:3072 sc1
ds_read_b64_tr_b16 v[126:127], v143 offset:5632
ds_read_b64_tr_b16 v[128:129], v145 offset:6144
s_waitcnt lgkmcnt(6)
v_mfma_f32_32x32x16_bf16 v[26:41], v[134:137], v[62:65], v[26:41]
ds_read_b64_tr_b16 v[130:131], v142 offset:5632
ds_read_b64_tr_b16 v[132:133], v144 offset:6144
s_waitcnt vmcnt(9) lgkmcnt(6)
v_mfma_f32_32x32x16_bf16 v[42:57], v[138:141], v[66:69], v[42:57]
s_add_u32 s65, s73, 12288
buffer_load_dwordx4 v[106:109], v1, s[4:7], s65 offen offset:0 sc1
ds_read_b64_tr_b16 v[134:135], v143 offset:7168
ds_read_b64_tr_b16 v[136:137], v143 offset:7680
s_waitcnt lgkmcnt(6)
v_mfma_f32_32x32x16_bf16 v[26:41], v[122:125], v[66:69], v[26:41]
ds_read_b64_tr_b16 v[138:139], v142 offset:7168
ds_read_b64_tr_b16 v[140:141], v142 offset:7680
s_waitcnt vmcnt(9) lgkmcnt(6)
v_mfma_f32_32x32x16_bf16 v[42:57], v[126:129], v[70:73], v[42:57]
buffer_load_dwordx4 v[110:113], v1, s[4:7], s65 offen offset:1024 sc1
ds_read_b64_tr_b16 v[122:123], v143 offset:9216
ds_read_b64_tr_b16 v[124:125], v145 offset:9728
s_waitcnt lgkmcnt(6)
v_mfma_f32_32x32x16_bf16 v[26:41], v[130:133], v[70:73], v[26:41]
ds_read_b64_tr_b16 v[126:127], v142 offset:9216
ds_read_b64_tr_b16 v[128:129], v144 offset:9728
s_waitcnt vmcnt(9) lgkmcnt(6)
v_mfma_f32_32x32x16_bf16 v[42:57], v[134:137], v[74:77], v[42:57]
buffer_load_dwordx4 v[114:117], v1, s[4:7], s65 offen offset:2048 sc1
ds_read_b64_tr_b16 v[130:131], v143 offset:10752
ds_read_b64_tr_b16 v[132:133], v143 offset:11264
s_waitcnt lgkmcnt(6)
v_mfma_f32_32x32x16_bf16 v[26:41], v[138:141], v[74:77], v[26:41]
ds_read_b64_tr_b16 v[134:135], v142 offset:10752
ds_read_b64_tr_b16 v[136:137], v142 offset:11264
s_waitcnt vmcnt(9) lgkmcnt(6)
v_mfma_f32_32x32x16_bf16 v[42:57], v[122:125], v[78:81], v[42:57]
buffer_load_dwordx4 v[118:121], v1, s[4:7], s65 offen offset:3072 sc1
ds_read_b64_tr_b16 v[138:139], v143 offset:12800
ds_read_b64_tr_b16 v[140:141], v145 offset:13312
s_waitcnt lgkmcnt(6)
v_mfma_f32_32x32x16_bf16 v[26:41], v[126:129], v[78:81], v[26:41]
ds_read_b64_tr_b16 v[122:123], v142 offset:12800
ds_read_b64_tr_b16 v[124:125], v144 offset:13312
s_waitcnt vmcnt(9) lgkmcnt(6)
v_mfma_f32_32x32x16_bf16 v[42:57], v[130:133], v[82:85], v[42:57]
ds_read_b64_tr_b16 v[126:127], v143 offset:14336
ds_read_b64_tr_b16 v[128:129], v143 offset:14848
s_waitcnt lgkmcnt(6)
v_mfma_f32_32x32x16_bf16 v[26:41], v[134:137], v[82:85], v[26:41]
ds_read_b64_tr_b16 v[130:131], v142 offset:14336
ds_read_b64_tr_b16 v[132:133], v142 offset:14848
s_waitcnt vmcnt(8) lgkmcnt(6)
v_mfma_f32_32x32x16_bf16 v[42:57], v[138:141], v[86:89], v[42:57]
ds_read_b64_tr_b16 v[134:135], v143 offset:16384
ds_read_b64_tr_b16 v[136:137], v145 offset:16896
s_waitcnt lgkmcnt(6)
v_mfma_f32_32x32x16_bf16 v[26:41], v[122:125], v[86:89], v[26:41]
ds_read_b64_tr_b16 v[138:139], v142 offset:16384
ds_read_b64_tr_b16 v[140:141], v144 offset:16896
s_waitcnt vmcnt(7) lgkmcnt(6)
v_mfma_f32_32x32x16_bf16 v[42:57], v[126:129], v[90:93], v[42:57]
ds_read_b64_tr_b16 v[122:123], v143 offset:17920
ds_read_b64_tr_b16 v[124:125], v143 offset:18432
s_waitcnt lgkmcnt(6)
v_mfma_f32_32x32x16_bf16 v[26:41], v[130:133], v[90:93], v[26:41]
ds_read_b64_tr_b16 v[126:127], v143 offset:19968
ds_read_b64_tr_b16 v[128:129], v145 offset:20480
s_waitcnt vmcnt(6) lgkmcnt(6)
v_mfma_f32_32x32x16_bf16 v[42:57], v[134:137], v[94:97], v[42:57]
ds_read_b64_tr_b16 v[130:131], v143 offset:21504
ds_read_b64_tr_b16 v[132:133], v143 offset:22016
s_waitcnt lgkmcnt(6)
v_mfma_f32_32x32x16_bf16 v[26:41], v[138:141], v[94:97], v[26:41]
ds_read_b64_tr_b16 v[134:135], v143 offset:23552
ds_read_b64_tr_b16 v[136:137], v145 offset:24064
s_waitcnt vmcnt(5) lgkmcnt(6)
v_mfma_f32_32x32x16_bf16 v[42:57], v[122:125], v[98:101], v[42:57]
ds_read_b64_tr_b16 v[138:139], v143 offset:25088
ds_read_b64_tr_b16 v[140:141], v143 offset:25600
s_waitcnt vmcnt(4) lgkmcnt(6)
v_mfma_f32_32x32x16_bf16 v[42:57], v[126:129], v[102:105], v[42:57]
ds_read_b64_tr_b16 v[122:123], v143 offset:27136
ds_read_b64_tr_b16 v[124:125], v145 offset:27648
s_waitcnt vmcnt(3) lgkmcnt(6)
v_mfma_f32_32x32x16_bf16 v[42:57], v[130:133], v[106:109], v[42:57]
ds_read_b64_tr_b16 v[126:127], v142 offset:17920
ds_read_b64_tr_b16 v[128:129], v142 offset:18432
s_waitcnt vmcnt(2) lgkmcnt(6)
v_mfma_f32_32x32x16_bf16 v[42:57], v[134:137], v[110:113], v[42:57]
ds_read_b64_tr_b16 v[130:131], v142 offset:19968
ds_read_b64_tr_b16 v[132:133], v144 offset:20480
s_waitcnt vmcnt(1) lgkmcnt(6)
v_mfma_f32_32x32x16_bf16 v[42:57], v[138:141], v[114:117], v[42:57]
ds_read_b64_tr_b16 v[134:135], v142 offset:21504
ds_read_b64_tr_b16 v[136:137], v142 offset:22016
s_waitcnt vmcnt(0) lgkmcnt(6)
v_mfma_f32_32x32x16_bf16 v[42:57], v[122:125], v[118:121], v[42:57]
ds_read_b64_tr_b16 v[138:139], v142 offset:23552
ds_read_b64_tr_b16 v[140:141], v144 offset:24064
s_waitcnt lgkmcnt(6)
v_mfma_f32_32x32x16_bf16 v[26:41], v[126:129], v[98:101], v[26:41]
ds_read_b64_tr_b16 v[122:123], v142 offset:25088
ds_read_b64_tr_b16 v[124:125], v142 offset:25600
s_waitcnt lgkmcnt(6)
v_mfma_f32_32x32x16_bf16 v[26:41], v[130:133], v[102:105], v[26:41]
ds_read_b64_tr_b16 v[126:127], v142 offset:27136
ds_read_b64_tr_b16 v[128:129], v144 offset:27648
s_waitcnt lgkmcnt(6)
v_mfma_f32_32x32x16_bf16 v[26:41], v[134:137], v[106:109], v[26:41]
ds_write_b128 v148, v[42:45] offset:0
s_waitcnt lgkmcnt(5)
v_mfma_f32_32x32x16_bf16 v[26:41], v[138:141], v[110:113], v[26:41]
ds_write_b128 v148, v[46:49] offset:1024
s_waitcnt lgkmcnt(4)
v_mfma_f32_32x32x16_bf16 v[26:41], v[122:125], v[114:117], v[26:41]
ds_write_b128 v148, v[50:53] offset:2048
s_waitcnt lgkmcnt(3)
v_mfma_f32_32x32x16_bf16 v[26:41], v[126:129], v[118:121], v[26:41]
ds_write_b128 v148, v[54:57] offset:3072
s_waitcnt lgkmcnt(0)
s_barrier
ds_read_b128 v[58:61], v149 offset:0
ds_read_b128 v[62:65], v149 offset:1024
ds_read_b128 v[66:69], v149 offset:2048
ds_read_b128 v[70:73], v149 offset:3072
s_waitcnt lgkmcnt(3)
s_nop 3
v_pk_add_f32 v[26:27], v[26:27], v[58:59]
v_pk_add_f32 v[28:29], v[28:29], v[60:61]
v_cvt_pk_bf16_f32 v18, v26, v27
v_cvt_pk_bf16_f32 v19, v28, v29
s_waitcnt lgkmcnt(2)
v_pk_add_f32 v[30:31], v[30:31], v[62:63]
v_pk_add_f32 v[32:33], v[32:33], v[64:65]
v_cvt_pk_bf16_f32 v20, v30, v31
v_cvt_pk_bf16_f32 v21, v32, v33
s_waitcnt lgkmcnt(1)
v_pk_add_f32 v[34:35], v[34:35], v[66:67]
v_pk_add_f32 v[36:37], v[36:37], v[68:69]
v_cvt_pk_bf16_f32 v22, v34, v35
v_cvt_pk_bf16_f32 v23, v36, v37
s_waitcnt lgkmcnt(0)
v_pk_add_f32 v[38:39], v[38:39], v[70:71]
v_pk_add_f32 v[40:41], v[40:41], v[72:73]
v_cvt_pk_bf16_f32 v24, v38, v39
v_cvt_pk_bf16_f32 v25, v40, v41
buffer_store_dwordx4 v[18:21], v1, s[4:7], s44 offen sc1
buffer_store_dwordx4 v[22:25], v1, s[4:7], s44 offen offset:1024 sc1
v_dot2_f32_bf16 v146, s88, v18, 0
v_dot2_f32_bf16 v147, v18, v18, 0
v_dot2_f32_bf16 v146, s88, v19, v146
v_dot2_f32_bf16 v147, v19, v19, v147
v_dot2_f32_bf16 v146, s88, v20, v146
v_dot2_f32_bf16 v147, v20, v20, v147
v_dot2_f32_bf16 v146, s88, v21, v146
v_dot2_f32_bf16 v147, v21, v21, v147
v_dot2_f32_bf16 v146, s88, v22, v146
v_dot2_f32_bf16 v147, v22, v22, v147
v_dot2_f32_bf16 v146, s88, v23, v146
v_dot2_f32_bf16 v147, v23, v23, v147
v_dot2_f32_bf16 v146, s88, v24, v146
v_dot2_f32_bf16 v147, v24, v24, v147
v_dot2_f32_bf16 v146, s88, v25, v146
v_dot2_f32_bf16 v147, v25, v25, v147
s_nop 1
v_mov_b32 v148, v146
v_mov_b32 v149, v147
s_nop 0
v_permlane32_swap_b32 v146, v148
v_permlane32_swap_b32 v147, v149
s_mov_b32 exec_hi, 0
v_pk_add_f32 v[146:147], v[146:147], v[148:149]
buffer_store_dwordx2 v[146:147], v1, s[4:7], s45 offen sc1
s_mov_b64 exec, -1
s_add_u32 s60, s35, 11
v_mov_b32 v150, s60
s_mov_b64 exec, 1
s_waitcnt vmcnt(0)
buffer_store_dword v150, off, s[4:7], s41 sc1
s_mov_b64 exec, -1
v_lshrrev_b32 v126, 5, v0
v_mul_u32_u24 v126, 1536, v126
v_add_u32 v126, v1, v126
v_add_u32 v109, 114688, v1
v_add_u32 v110, 86016, v1
v_lshlrev_b32 v108, 3, v0
v_add_u32 v108, 161792, v108
s_lshr_b32 s61, s89, 3
v_add_u32 v111, s61, v108
v_mov_b32 v106, s82
v_mov_b32 v90, 0
v_mov_b32 v91, 0
s_lshr_b32 s66, s89, 1
s_add_u32 s67, s66, s77
s_add_u32 s60, s35, 11
LP_262:
buffer_load_dword v94, v4, s[4:7], s40 offen sc1
s_sub_u32 s37, s37, 1
s_cmp_lt_i32 s37, 0
s_cbranch_scc1 LD_263
s_waitcnt vmcnt(0)
v_subrev_u32 v94, s60, v94
v_cmp_le_u32 vcc, 64, v94
s_and_b64 vcc, vcc, s[48:49]
s_cbranch_scc1 LP_262
LD_263:
s_add_u32 m0, s66, 114688
s_add_u32 s63, s67, 0
buffer_load_dwordx4 v1, s[4:7], s63 offen offset:0 sc1 lds
buffer_load_dwordx4 v1, s[4:7], s63 offen offset:1024 sc1 lds
s_add_u32 m0, s66, 122880
s_add_u32 s63, s67, 8192
buffer_load_dwordx4 v1, s[4:7], s63 offen offset:0 sc1 lds
buffer_load_dwordx4 v1, s[4:7], s63 offen offset:1024 sc1 lds
s_add_u32 m0, s66, 131072
s_add_u32 s63, s67, 16384
buffer_load_dwordx4 v1, s[4:7], s63 offen offset:0 sc1 lds
buffer_load_dwordx4 v1, s[4:7], s63 offen offset:1024 sc1 lds
s_lshr_b32 s62, s89, 2
s_add_u32 m0, s62, 139264
s_add_u32 s63, s62, s77
s_add_u32 s63, s63, 24576
buffer_load_dwordx4 v1, s[4:7], s63 offen offset:0 sc1 lds
s_waitcnt vmcnt(5)
s_barrier
ds_read_b128 v[42:45], v109 offset:0
ds_read_b128 v[46:49], v109 offset:1024
ds_read_b128 v[50:53], v109 offset:2048
ds_read_b128 v[54:57], v109 offset:3072
ds_read_b128 v[74:77], v109 offset:4096
ds_read_b128 v[78:81], v109 offset:5120
s_waitcnt lgkmcnt(2)
v_mfma_f32_32x32x16_bf16 v[26:41], a[224:227], v[42:45], 0
buffer_load_dwordx4 v[112:115], v126, s[4:7], s71 offen offset:0 sc1
ds_read_b128 v[168:171], v109 offset:6144
v_mfma_f32_32x32x16_bf16 v[26:41], a[228:231], v[46:49], v[26:41]
buffer_load_dwordx4 v[116:119], v126, s[4:7], s71 offen offset:512 sc1
s_waitcnt vmcnt(5)
s_barrier
ds_read_b128 v[172:175], v109 offset:7168
v_mfma_f32_32x32x16_bf16 v[26:41], a[232:235], v[50:53], v[26:41]
buffer_load_dwordx4 v[120:123], v126, s[4:7], s71 offen offset:1024 sc1
ds_read_b128 v[160:163], v109 offset:8192
v_mfma_f32_32x32x16_bf16 v[26:41], a[236:239], v[54:57], v[26:41]
buffer_load_dwordx4 v[124:127], v126, s[4:7], s71 offen offset:1536 sc1
ds_read_b128 v[164:167], v109 offset:9216
s_waitcnt lgkmcnt(2)
v_mfma_f32_32x32x16_bf16 v[26:41], a[240:243], v[74:77], v[26:41]
s_add_u32 m0, s66, 86016
s_add_u32 s63, s67, 57344
ds_read_b128 v[42:45], v109 offset:10240
v_mfma_f32_32x32x16_bf16 v[26:41], a[244:247], v[78:81], v[26:41]
buffer_load_dwordx4 v1, s[4:7], s63 offen offset:0 sc1 lds
ds_read_b128 v[46:49], v109 offset:11264
v_mfma_f32_32x32x16_bf16 v[26:41], a[248:251], v[168:171], v[26:41]
ds_read_b128 v[50:53], v109 offset:12288
v_mfma_f32_32x32x16_bf16 v[26:41], a[252:255], v[172:175], v[26:41]
buffer_load_dwordx4 v1, s[4:7], s63 offen offset:1024 sc1 lds
ds_read_b128 v[54:57], v109 offset:13312
s_waitcnt lgkmcnt(2)
v_mfma_f32_32x32x16_bf16 v[26:41], v[176:179], v[160:163], v[26:41]
s_add_u32 m0, s66, 94208
s_add_u32 s63, s67, 65536
ds_read_b128 v[74:77], v109 offset:14336
v_mfma_f32_32x32x16_bf16 v[26:41], v[180:183], v[164:167], v[26:41]
s_waitcnt vmcnt(6)
s_barrier
buffer_load_dwordx4 v1, s[4:7], s63 offen offset:0 sc1 lds
ds_read_b128 v[78:81], v109 offset:15360
v_mfma_f32_32x32x16_bf16 v[26:41], v[184:187], v[42:45], v[26:41]
ds_read_b128 v[168:171], v109 offset:16384
v_mfma_f32_32x32x16_bf16 v[26:41], v[188:191], v[46:49], v[26:41]
buffer_load_dwordx4 v1, s[4:7], s63 offen offset:1024 sc1 lds
ds_read_b128 v[172:175], v109 offset:17408
s_waitcnt vmcnt(4)
v_add_f32 v112, v112, v114
v_add_f32 v113, v113, v115
v_add_f32 v116, v116, v118
v_add_f32 v117, v117, v119
v_add_f32 v120, v120, v122
s_waitcnt lgkmcnt(2)
v_mfma_f32_32x32x16_bf16 v[26:41], v[192:195], v[50:53], v[26:41]
s_add_u32 m0, s66, 102400
s_add_u32 s63, s67, 73728
ds_read_b128 v[160:163], v109 offset:18432
v_add_f32 v121, v121, v123
v_add_f32 v124, v124, v126
v_add_f32 v125, v125, v127
v_cndmask_b32 v124, v124, 0, s[56:57]
v_cndmask_b32 v125, v125, 0, s[56:57]
v_add_f32 v112, v112, v116
v_mfma_f32_32x32x16_bf16 v[26:41], v[196:199], v[54:57], v[26:41]
buffer_load_dwordx4 v1, s[4:7], s63 offen offset:0 sc1 lds
ds_read_b128 v[164:167], v109 offset:19456
v_add_f32 v113, v113, v117
v_add_f32 v120, v120, v124
v_add_f32 v121, v121, v125
v_add_f32 v112, v112, v120
v_add_f32 v113, v113, v121
v_mov_b32 v114, v112
v_mfma_f32_32x32x16_bf16 v[26:41], v[200:203], v[74:77], v[26:41]
ds_read_b128 v[42:45], v109 offset:20480
v_mov_b32 v115, v113
v_mov_b32 v84, 0
v_mov_b32 v85, 0
v_permlane32_swap_b32 v112, v114
v_permlane32_swap_b32 v113, v115
v_mfma_f32_32x32x16_bf16 v[26:41], v[204:207], v[78:81], v[26:41]
buffer_load_dwordx4 v1, s[4:7], s63 offen offset:1024 sc1 lds
ds_read_b128 v[46:49], v109 offset:21504
v_add_f32 v112, v112, v114
v_add_f32 v113, v113, v115
v_mul_f32 v114, 0x3b124925, v112
v_mul_f32 v113, 0x3b124925, v113
v_fmamk_f32 v112, v114, 0xc3e00000, v112
s_waitcnt lgkmcnt(2)
v_mfma_f32_32x32x16_bf16 v[26:41], v[208:211], v[168:171], v[26:41]
s_lshr_b32 s62, s89, 2
s_add_u32 m0, s62, 110592
s_add_u32 s63, s62, s77
s_add_u32 s63, s63, 81920
ds_read_b128 v[50:53], v109 offset:22528
v_fmamk_f32 v112, v112, 0x3b124925, v114
v_fma_f32 v113, -v112, v112, v113
v_max_f32 v113, 0, v113
v_cvt_pk_bf16_f32 v114, -v112, v113
v_and_b32 v113, 0xffff0000, v114
v_mfma_f32_32x32x16_bf16 v[26:41], v[212:215], v[172:175], v[26:41]
buffer_load_dwordx4 v1, s[4:7], s63 offen offset:0 sc1 lds
ds_read_b128 v[54:57], v109 offset:23552
v_and_b32 v114, 0xffff, v114
v_add_f32 v113, 0x3727c5ac, v113
v_cndmask_b32 v83, v114, 0, s[56:57]
v_cvt_pk_bf16_f32 v113, v113, v113
v_lshl_or_b32 v82, v83, 16, v83
v_mfma_f32_32x32x16_bf16 v[26:41], v[216:219], v[160:163], v[26:41]
ds_read_b128 v[74:77], v109 offset:24576
v_and_b32 v113, 0xffff0000, v113
v_sqrt_f32 v113, v113
s_nop 0
v_cvt_pk_bf16_f32 v113, v113, v113
v_and_b32 v113, 0xffff0000, v113
v_mfma_f32_32x32x16_bf16 v[26:41], v[220:223], v[164:167], v[26:41]
ds_read_b128 v[78:81], v109 offset:25600
v_rcp_f32 v112, v113
s_nop 0
v_mul_f32 v113, 0x3fb8aa3b, v112
v_mov_b32 v112, v82
ds_write_b64 v111, v[112:113]
s_waitcnt lgkmcnt(3)
v_mfma_f32_32x32x16_bf16 v[26:41], v[224:227], v[42:45], v[26:41]
ds_read_b128 v[168:171], v109 offset:26624
v_mfma_f32_32x32x16_bf16 v[26:41], v[228:231], v[46:49], v[26:41]
s_waitcnt vmcnt(5) lgkmcnt(0)
s_barrier
ds_read_b128 v[172:175], v109 offset:27648
v_mfma_f32_32x32x16_bf16 v[26:41], v[232:235], v[50:53], v[26:41]
ds_read_b128 v[160:163], v110 offset:0
v_mfma_f32_32x32x16_bf16 v[26:41], v[236:239], v[54:57], v[26:41]
ds_read_b128 v[164:167], v110 offset:1024
s_waitcnt lgkmcnt(2)
v_mfma_f32_32x32x16_bf16 v[26:41], v[240:243], v[74:77], v[26:41]
s_waitcnt vmcnt(0)
s_barrier
ds_read_b64 v[86:87], v108 offset:0
ds_read_b128 v[42:45], v110 offset:2048
v_mfma_f32_32x32x16_bf16 v[26:41], v[244:247], v[78:81], v[26:41]
s_add_u32 m0, s66, 114688
s_add_u32 s63, s67, 28672
buffer_load_dwordx4 v1, s[4:7], s63 offen offset:0 sc1 lds
ds_read_b128 v[46:49], v110 offset:3072
v_mfma_f32_32x32x16_bf16 v[26:41], v[248:251], v[168:171], v[26:41]
s_waitcnt lgkmcnt(2)
v_mov_b32 v82, v86
v_and_b32 v83, 0xffff, v86
ds_read_b128 v[50:53], v110 offset:4096
v_mfma_f32_32x32x16_bf16 v[26:41], v[252:255], v[172:175], v[26:41]
buffer_load_dwordx4 v1, s[4:7], s63 offen offset:1024 sc1 lds
s_add_u32 m0, s66, 122880
s_add_u32 s63, s67, 36864
ds_read_b128 v[54:57], v110 offset:5120
v_mfma_f32_32x32x16_bf16 v[26:41], v[14:17], v[82:85], v[26:41]
buffer_load_dwordx4 v1, s[4:7], s63 offen offset:0 sc1 lds
s_waitcnt lgkmcnt(2)
v_mfma_f32_32x32x16_bf16 v[58:73], a[224:227], v[160:163], 0
buffer_load_dwordx4 v1, s[4:7], s63 offen offset:1024 sc1 lds
s_add_u32 m0, s66, 131072
s_add_u32 s63, s67, 45056
ds_read_b128 v[74:77], v110 offset:6144
v_mfma_f32_32x32x16_bf16 v[58:73], a[228:231], v[164:167], v[58:73]
buffer_load_dwordx4 v1, s[4:7], s63 offen offset:0 sc1 lds
ds_read_b128 v[78:81], v110 offset:7168
v_mfma_f32_32x32x16_bf16 v[58:73], a[232:235], v[42:45], v[58:73]
ds_read_b128 v[168:171], v110 offset:8192
v_mul_f32 v26, v26, v87
v_exp_f32 v102, -v26
v_mul_f32 v27, v27, v87
v_fma_f32 v102, v102, v106, v106
v_mfma_f32_32x32x16_bf16 v[58:73], a[236:239], v[46:49], v[58:73]
buffer_load_dwordx4 v1, s[4:7], s63 offen offset:1024 sc1 lds
ds_read_b128 v[172:175], v110 offset:9216
v_exp_f32 v103, -v27
v_mul_f32 v28, v28, v87
v_rcp_f32 v102, v102
s_waitcnt lgkmcnt(2)
v_mfma_f32_32x32x16_bf16 v[58:73], a[240:243], v[50:53], v[58:73]
s_lshr_b32 s62, s89, 2
s_add_u32 m0, s62, 139264
s_add_u32 s63, s62, s77
s_add_u32 s63, s63, 53248
ds_read_b128 v[160:163], v110 offset:10240
v_fma_f32 v103, v103, v106, v106
v_exp_f32 v104, -v28
v_mul_f32 v29, v29, v87
v_mul_f32 v26, v26, v102
v_mfma_f32_32x32x16_bf16 v[58:73], a[244:247], v[54:57], v[58:73]
buffer_load_dwordx4 v1, s[4:7], s63 offen offset:0 sc1 lds
ds_read_b128 v[164:167], v110 offset:11264
v_rcp_f32 v103, v103
v_fma_f32 v104, v104, v106, v106
v_exp_f32 v105, -v29
v_mfma_f32_32x32x16_bf16 v[58:73], a[248:251], v[74:77], v[58:73]
ds_read_b128 v[42:45], v110 offset:12288
v_mul_f32 v30, v30, v87
v_mul_f32 v27, v27, v103
v_rcp_f32 v104, v104
v_fma_f32 v105, v105, v106, v106
v_mfma_f32_32x32x16_bf16 v[58:73], a[252:255], v[78:81], v[58:73]
ds_read_b128 v[46:49], v110 offset:13312
v_exp_f32 v102, -v30
v_mul_f32 v31, v31, v87
v_mul_f32 v28, v28, v104
v_rcp_f32 v105, v105
s_waitcnt lgkmcnt(2)
v_mfma_f32_32x32x16_bf16 v[58:73], v[176:179], v[168:171], v[58:73]
ds_read_b128 v[50:53], v110 offset:14336
v_fma_f32 v102, v102, v106, v106
v_exp_f32 v103, -v31
v_mul_f32 v32, v32, v87
v_cvt_pk_bf16_f32 v94, v26, v27
v_mfma_f32_32x32x16_bf16 v[58:73], v[180:183], v[172:175], v[58:73]
ds_read_b128 v[54:57], v110 offset:15360
v_mul_f32 v29, v29, v105
v_rcp_f32 v102, v102
v_fma_f32 v103, v103, v106, v106
v_exp_f32 v104, -v32
v_mfma_f32_32x32x16_bf16 v[58:73], v[184:187], v[160:163], v[58:73]
ds_read_b128 v[74:77], v110 offset:16384
v_mul_f32 v33, v33, v87
v_mul_f32 v30, v30, v102
v_rcp_f32 v103, v103
v_fma_f32 v104, v104, v106, v106
v_mfma_f32_32x32x16_bf16 v[58:73], v[188:191], v[164:167], v[58:73]
ds_read_b128 v[78:81], v110 offset:17408
v_exp_f32 v105, -v33
v_mul_f32 v34, v34, v87
v_cvt_pk_bf16_f32 v95, v28, v29
v_mul_f32 v31, v31, v103
s_waitcnt lgkmcnt(2)
v_mfma_f32_32x32x16_bf16 v[58:73], v[192:195], v[42:45], v[58:73]
ds_read_b128 v[168:171], v110 offset:18432
v_rcp_f32 v104, v104
v_fma_f32 v105, v105, v106, v106
v_exp_f32 v102, -v34
v_mfma_f32_32x32x16_bf16 v[58:73], v[196:199], v[46:49], v[58:73]
ds_read_b128 v[172:175], v110 offset:19456
v_mul_f32 v35, v35, v87
v_mul_f32 v32, v32, v104
v_rcp_f32 v105, v105
v_fma_f32 v102, v102, v106, v106
v_mfma_f32_32x32x16_bf16 v[58:73], v[200:203], v[50:53], v[58:73]
ds_read_b128 v[160:163], v110 offset:20480
v_exp_f32 v103, -v35
v_mul_f32 v36, v36, v87
v_cvt_pk_bf16_f32 v96, v30, v31
v_mul_f32 v33, v33, v105
v_mfma_f32_32x32x16_bf16 v[58:73], v[204:207], v[54:57], v[58:73]
ds_read_b128 v[164:167], v110 offset:21504
v_rcp_f32 v102, v102
v_fma_f32 v103, v103, v106, v106
v_exp_f32 v104, -v36
s_waitcnt lgkmcnt(2)
v_mfma_f32_32x32x16_bf16 v[58:73], v[208:211], v[74:77], v[58:73]
ds_read_b128 v[42:45], v110 offset:22528
v_mul_f32 v37, v37, v87
v_mul_f32 v34, v34, v102
v_rcp_f32 v103, v103
v_fma_f32 v104, v104, v106, v106
v_mfma_f32_32x32x16_bf16 v[58:73], v[212:215], v[78:81], v[58:73]
ds_read_b128 v[46:49], v110 offset:23552
v_exp_f32 v105, -v37
v_mul_f32 v38, v38, v87
v_cvt_pk_bf16_f32 v97, v32, v33
s_add_u32 s61, s74, 0
v_mfma_f32_32x32x16_bf16 v[58:73], v[216:219], v[168:171], v[58:73]
buffer_store_dwordx4 v[94:97], v1, s[4:7], s61 offen sc1
ds_read_b128 v[50:53], v110 offset:24576
v_mul_f32 v35, v35, v103
v_rcp_f32 v104, v104
v_fma_f32 v105, v105, v106, v106
v_mfma_f32_32x32x16_bf16 v[58:73], v[220:223], v[172:175], v[58:73]
ds_read_b128 v[54:57], v110 offset:25600
v_exp_f32 v102, -v38
v_mul_f32 v39, v39, v87
v_mul_f32 v36, v36, v104
s_waitcnt lgkmcnt(2)
v_mfma_f32_32x32x16_bf16 v[58:73], v[224:227], v[160:163], v[58:73]
ds_read_b128 v[74:77], v110 offset:26624
v_rcp_f32 v105, v105
v_fma_f32 v102, v102, v106, v106
v_exp_f32 v103, -v39
v_mfma_f32_32x32x16_bf16 v[58:73], v[228:231], v[164:167], v[58:73]
s_waitcnt vmcnt(6)
s_barrier
ds_read_b128 v[78:81], v110 offset:27648
v_mul_f32 v40, v40, v87
v_cvt_pk_bf16_f32 v98, v34, v35
v_mul_f32 v37, v37, v105
v_rcp_f32 v102, v102
v_mfma_f32_32x32x16_bf16 v[58:73], v[232:235], v[42:45], v[58:73]
ds_read_b128 v[168:171], v109 offset:0
v_fma_f32 v103, v103, v106, v106
v_exp_f32 v104, -v40
v_mul_f32 v41, v41, v87
v_mul_f32 v38, v38, v102
v_mfma_f32_32x32x16_bf16 v[58:73], v[236:239], v[46:49], v[58:73]
ds_read_b128 v[172:175], v109 offset:1024
v_rcp_f32 v103, v103
v_fma_f32 v104, v104, v106, v106
v_exp_f32 v105, -v41
s_waitcnt lgkmcnt(2)
v_mfma_f32_32x32x16_bf16 v[58:73], v[240:243], v[50:53], v[58:73]
s_waitcnt vmcnt(1)
s_barrier
ds_read_b64 v[92:93], v108 offset:1024
ds_read_b128 v[160:163], v109 offset:2048
v_cvt_pk_bf16_f32 v99, v36, v37
v_mul_f32 v39, v39, v103
v_rcp_f32 v104, v104
v_mfma_f32_32x32x16_bf16 v[58:73], v[244:247], v[54:57], v[58:73]
s_add_u32 m0, s66, 86016
s_add_u32 s63, s67, 86016
buffer_load_dwordx4 v1, s[4:7], s63 offen offset:0 sc1 lds
ds_read_b128 v[164:167], v109 offset:3072
v_fma_f32 v105, v105, v106, v106
v_mul_f32 v40, v40, v104
v_rcp_f32 v105, v105
v_mfma_f32_32x32x16_bf16 v[58:73], v[248:251], v[74:77], v[58:73]
s_waitcnt lgkmcnt(2)
v_mov_b32 v88, v92
v_and_b32 v89, 0xffff, v92
ds_read_b128 v[42:45], v109 offset:4096
v_cvt_pk_bf16_f32 v100, v38, v39
v_mul_f32 v41, v41, v105
v_mfma_f32_32x32x16_bf16 v[58:73], v[252:255], v[78:81], v[58:73]
buffer_load_dwordx4 v1, s[4:7], s63 offen offset:1024 sc1 lds
s_add_u32 m0, s66, 94208
s_add_u32 s63, s67, 94208
ds_read_b128 v[46:49], v109 offset:5120
v_cvt_pk_bf16_f32 v101, v40, v41
v_mfma_f32_32x32x16_bf16 v[58:73], v[14:17], v[88:91], v[58:73]
buffer_store_dwordx4 v[98:101], v1, s[4:7], s61 offen offset:1024 sc1
buffer_load_dwordx4 v1, s[4:7], s63 offen offset:0 sc1 lds
s_waitcnt lgkmcnt(2)
v_mfma_f32_32x32x16_bf16 v[26:41], a[224:227], v[168:171], 0
buffer_load_dwordx4 v1, s[4:7], s63 offen offset:1024 sc1 lds
s_add_u32 m0, s66, 102400
s_add_u32 s63, s67, 102400
ds_read_b128 v[50:53], v109 offset:6144
v_mfma_f32_32x32x16_bf16 v[26:41], a[228:231], v[172:175], v[26:41]
buffer_load_dwordx4 v1, s[4:7], s63 offen offset:0 sc1 lds
ds_read_b128 v[54:57], v109 offset:7168
v_mfma_f32_32x32x16_bf16 v[26:41], a[232:235], v[160:163], v[26:41]
ds_read_b128 v[74:77], v109 offset:8192
v_mul_f32 v58, v58, v93
v_exp_f32 v102, -v58
v_mul_f32 v59, v59, v93
v_fma_f32 v102, v102, v106, v106
v_mfma_f32_32x32x16_bf16 v[26:41], a[236:239], v[164:167], v[26:41]
buffer_load_dwordx4 v1, s[4:7], s63 offen offset:1024 sc1 lds
ds_read_b128 v[78:81], v109 offset:9216
v_exp_f32 v103, -v59
v_mul_f32 v60, v60, v93
v_rcp_f32 v102, v102
s_waitcnt lgkmcnt(2)
v_mfma_f32_32x32x16_bf16 v[26:41], a[240:243], v[42:45], v[26:41]
s_lshr_b32 s62, s89, 2
s_add_u32 m0, s62, 110592
s_add_u32 s63, s62, s77
s_add_u32 s63, s63, 110592
ds_read_b128 v[168:171], v109 offset:10240
v_fma_f32 v103, v103, v106, v106
v_exp_f32 v104, -v60
v_mul_f32 v61, v61, v93
v_mul_f32 v58, v58, v102
v_mfma_f32_32x32x16_bf16 v[26:41], a[244:247], v[46:49], v[26:41]
buffer_load_dwordx4 v1, s[4:7], s63 offen offset:0 sc1 lds
ds_read_b128 v[172:175], v109 offset:11264
v_rcp_f32 v103, v103
v_fma_f32 v104, v104, v106, v106
v_exp_f32 v105, -v61
v_mfma_f32_32x32x16_bf16 v[26:41], a[248:251], v[50:53], v[26:41]
ds_read_b128 v[160:163], v109 offset:12288
v_mul_f32 v62, v62, v93
v_mul_f32 v59, v59, v103
v_rcp_f32 v104, v104
v_fma_f32 v105, v105, v106, v106
v_mfma_f32_32x32x16_bf16 v[26:41], a[252:255], v[54:57], v[26:41]
ds_read_b128 v[164:167], v109 offset:13312
v_exp_f32 v102, -v62
v_mul_f32 v63, v63, v93
v_mul_f32 v60, v60, v104
v_rcp_f32 v105, v105
s_waitcnt lgkmcnt(2)
v_mfma_f32_32x32x16_bf16 v[26:41], v[176:179], v[74:77], v[26:41]
s_add_u32 s60, s35, 12
v_mov_b32 v107, s60
ds_read_b128 v[42:45], v109 offset:14336
v_fma_f32 v102, v102, v106, v106
v_exp_f32 v103, -v63
v_mul_f32 v64, v64, v93
v_cvt_pk_bf16_f32 v94, v58, v59
v_mfma_f32_32x32x16_bf16 v[26:41], v[180:183], v[78:81], v[26:41]
s_waitcnt vmcnt(5)
s_mov_b64 exec, 1
buffer_store_dword v107, off, s[4:7], s41 sc1
s_mov_b64 exec, -1
ds_read_b128 v[46:49], v109 offset:15360
v_mul_f32 v61, v61, v105
v_rcp_f32 v102, v102
v_fma_f32 v103, v103, v106, v106
v_exp_f32 v104, -v64
v_mfma_f32_32x32x16_bf16 v[26:41], v[184:187], v[168:171], v[26:41]
ds_read_b128 v[50:53], v109 offset:16384
v_mul_f32 v65, v65, v93
v_mul_f32 v62, v62, v102
v_rcp_f32 v103, v103
v_fma_f32 v104, v104, v106, v106
v_mfma_f32_32x32x16_bf16 v[26:41], v[188:191], v[172:175], v[26:41]
ds_read_b128 v[54:57], v109 offset:17408
v_exp_f32 v105, -v65
v_mul_f32 v66, v66, v93
v_cvt_pk_bf16_f32 v95, v60, v61
v_mul_f32 v63, v63, v103
s_waitcnt lgkmcnt(2)
v_mfma_f32_32x32x16_bf16 v[26:41], v[192:195], v[160:163], v[26:41]
ds_read_b128 v[74:77], v109 offset:18432
v_rcp_f32 v104, v104
v_fma_f32 v105, v105, v106, v106
v_exp_f32 v102, -v66
v_mfma_f32_32x32x16_bf16 v[26:41], v[196:199], v[164:167], v[26:41]
ds_read_b128 v[78:81], v109 offset:19456
v_mul_f32 v67, v67, v93
v_mul_f32 v64, v64, v104
v_rcp_f32 v105, v105
v_fma_f32 v102, v102, v106, v106
v_mfma_f32_32x32x16_bf16 v[26:41], v[200:203], v[42:45], v[26:41]
ds_read_b128 v[168:171], v109 offset:20480
v_exp_f32 v103, -v67
v_mul_f32 v68, v68, v93
v_cvt_pk_bf16_f32 v96, v62, v63
v_mul_f32 v65, v65, v105
v_mfma_f32_32x32x16_bf16 v[26:41], v[204:207], v[46:49], v[26:41]
ds_read_b128 v[172:175], v109 offset:21504
v_rcp_f32 v102, v102
v_fma_f32 v103, v103, v106, v106
v_exp_f32 v104, -v68
s_waitcnt lgkmcnt(2)
v_mfma_f32_32x32x16_bf16 v[26:41], v[208:211], v[50:53], v[26:41]
ds_read_b128 v[160:163], v109 offset:22528
v_mul_f32 v69, v69, v93
v_mul_f32 v66, v66, v102
v_rcp_f32 v103, v103
v_fma_f32 v104, v104, v106, v106
v_mfma_f32_32x32x16_bf16 v[26:41], v[212:215], v[54:57], v[26:41]
ds_read_b128 v[164:167], v109 offset:23552
v_exp_f32 v105, -v69
v_mul_f32 v70, v70, v93
v_cvt_pk_bf16_f32 v97, v64, v65
s_add_u32 s61, s74, 229376
v_mfma_f32_32x32x16_bf16 v[26:41], v[216:219], v[74:77], v[26:41]
buffer_store_dwordx4 v[94:97], v1, s[4:7], s61 offen sc1
ds_read_b128 v[42:45], v109 offset:24576
v_mul_f32 v67, v67, v103
v_rcp_f32 v104, v104
v_fma_f32 v105, v105, v106, v106
v_mfma_f32_32x32x16_bf16 v[26:41], v[220:223], v[78:81], v[26:41]
ds_read_b128 v[46:49], v109 offset:25600
v_exp_f32 v102, -v70
v_mul_f32 v71, v71, v93
v_mul_f32 v68, v68, v104
s_waitcnt lgkmcnt(2)
v_mfma_f32_32x32x16_bf16 v[26:41], v[224:227], v[168:171], v[26:41]
ds_read_b128 v[50:53], v109 offset:26624
v_rcp_f32 v105, v105
v_fma_f32 v102, v102, v106, v106
v_exp_f32 v103, -v71
v_mfma_f32_32x32x16_bf16 v[26:41], v[228:231], v[172:175], v[26:41]
s_waitcnt vmcnt(8)
s_barrier
ds_read_b128 v[54:57], v109 offset:27648
v_mul_f32 v72, v72, v93
v_cvt_pk_bf16_f32 v98, v66, v67
v_mul_f32 v69, v69, v105
v_rcp_f32 v102, v102
v_mfma_f32_32x32x16_bf16 v[26:41], v[232:235], v[160:163], v[26:41]
ds_read_b128 v[74:77], v110 offset:0
v_fma_f32 v103, v103, v106, v106
v_exp_f32 v104, -v72
v_mul_f32 v73, v73, v93
v_mul_f32 v70, v70, v102
v_mfma_f32_32x32x16_bf16 v[26:41], v[236:239], v[164:167], v[26:41]
ds_read_b128 v[78:81], v110 offset:1024
v_rcp_f32 v103, v103
v_fma_f32 v104, v104, v106, v106
v_exp_f32 v105, -v73
s_waitcnt lgkmcnt(2)
v_mfma_f32_32x32x16_bf16 v[26:41], v[240:243], v[42:45], v[26:41]
s_waitcnt vmcnt(2)
s_barrier
ds_read_b64 v[86:87], v108 offset:512
ds_read_b128 v[168:171], v110 offset:2048
v_cvt_pk_bf16_f32 v99, v68, v69
v_mul_f32 v71, v71, v103
v_rcp_f32 v104, v104
v_mfma_f32_32x32x16_bf16 v[26:41], v[244:247], v[46:49], v[26:41]
ds_read_b128 v[172:175], v110 offset:3072
v_fma_f32 v105, v105, v106, v106
v_mul_f32 v72, v72, v104
v_rcp_f32 v105, v105
v_cvt_pk_bf16_f32 v100, v70, v71
v_mfma_f32_32x32x16_bf16 v[26:41], v[248:251], v[50:53], v[26:41]
s_waitcnt lgkmcnt(2)
v_mov_b32 v82, v86
v_and_b32 v83, 0xffff, v86
ds_read_b128 v[160:163], v110 offset:4096
v_mul_f32 v73, v73, v105
v_cvt_pk_bf16_f32 v101, v72, v73
v_mfma_f32_32x32x16_bf16 v[26:41], v[252:255], v[54:57], v[26:41]
buffer_store_dwordx4 v[98:101], v1, s[4:7], s61 offen offset:1024 sc1
ds_read_b128 v[164:167], v110 offset:5120
v_mfma_f32_32x32x16_bf16 v[26:41], v[14:17], v[82:85], v[26:41]
s_waitcnt lgkmcnt(2)
v_mfma_f32_32x32x16_bf16 v[58:73], a[224:227], v[74:77], 0
ds_read_b128 v[42:45], v110 offset:6144
v_mfma_f32_32x32x16_bf16 v[58:73], a[228:231], v[78:81], v[58:73]
ds_read_b128 v[46:49], v110 offset:7168
v_mfma_f32_32x32x16_bf16 v[58:73], a[232:235], v[168:171], v[58:73]
ds_read_b128 v[50:53], v110 offset:8192
s_nop 4
v_mul_f32 v26, v26, v87
v_exp_f32 v102, -v26
v_mul_f32 v27, v27, v87
v_fma_f32 v102, v102, v106, v106
v_mfma_f32_32x32x16_bf16 v[58:73], a[236:239], v[172:175], v[58:73]
ds_read_b128 v[54:57], v110 offset:9216
v_exp_f32 v103, -v27
v_mul_f32 v28, v28, v87
v_rcp_f32 v102, v102
s_waitcnt lgkmcnt(2)
v_mfma_f32_32x32x16_bf16 v[58:73], a[240:243], v[160:163], v[58:73]
ds_read_b128 v[74:77], v110 offset:10240
v_fma_f32 v103, v103, v106, v106
v_exp_f32 v104, -v28
v_mul_f32 v29, v29, v87
v_mul_f32 v26, v26, v102
v_mfma_f32_32x32x16_bf16 v[58:73], a[244:247], v[164:167], v[58:73]
ds_read_b128 v[78:81], v110 offset:11264
v_rcp_f32 v103, v103
v_fma_f32 v104, v104, v106, v106
v_exp_f32 v105, -v29
v_mfma_f32_32x32x16_bf16 v[58:73], a[248:251], v[42:45], v[58:73]
ds_read_b128 v[168:171], v110 offset:12288
v_mul_f32 v30, v30, v87
v_mul_f32 v27, v27, v103
v_rcp_f32 v104, v104
v_fma_f32 v105, v105, v106, v106
v_mfma_f32_32x32x16_bf16 v[58:73], a[252:255], v[46:49], v[58:73]
ds_read_b128 v[172:175], v110 offset:13312
v_exp_f32 v102, -v30
v_mul_f32 v31, v31, v87
v_mul_f32 v28, v28, v104
v_rcp_f32 v105, v105
s_waitcnt lgkmcnt(2)
v_mfma_f32_32x32x16_bf16 v[58:73], v[176:179], v[50:53], v[58:73]
s_add_u32 s60, s35, 13
v_mov_b32 v107, s60
ds_read_b128 v[160:163], v110 offset:14336
v_fma_f32 v102, v102, v106, v106
v_exp_f32 v103, -v31
v_mul_f32 v32, v32, v87
v_cvt_pk_bf16_f32 v94, v26, v27
v_mfma_f32_32x32x16_bf16 v[58:73], v[180:183], v[54:57], v[58:73]
s_waitcnt vmcnt(0)
s_mov_b64 exec, 1
buffer_store_dword v107, off, s[4:7], s41 sc1
s_mov_b64 exec, -1
ds_read_b128 v[164:167], v110 offset:15360
v_mul_f32 v29, v29, v105
v_rcp_f32 v102, v102
v_fma_f32 v103, v103, v106, v106
v_exp_f32 v104, -v32
v_mfma_f32_32x32x16_bf16 v[58:73], v[184:187], v[74:77], v[58:73]
ds_read_b128 v[42:45], v110 offset:16384
v_mul_f32 v33, v33, v87
v_mul_f32 v30, v30, v102
v_rcp_f32 v103, v103
v_fma_f32 v104, v104, v106, v106
v_mfma_f32_32x32x16_bf16 v[58:73], v[188:191], v[78:81], v[58:73]
ds_read_b128 v[46:49], v110 offset:17408
v_exp_f32 v105, -v33
v_mul_f32 v34, v34, v87
v_cvt_pk_bf16_f32 v95, v28, v29
v_mul_f32 v31, v31, v103
s_waitcnt lgkmcnt(2)
v_mfma_f32_32x32x16_bf16 v[58:73], v[192:195], v[168:171], v[58:73]
ds_read_b128 v[50:53], v110 offset:18432
v_rcp_f32 v104, v104
v_fma_f32 v105, v105, v106, v106
v_exp_f32 v102, -v34
v_mfma_f32_32x32x16_bf16 v[58:73], v[196:199], v[172:175], v[58:73]
ds_read_b128 v[54:57], v110 offset:19456
v_mul_f32 v35, v35, v87
v_mul_f32 v32, v32, v104
v_rcp_f32 v105, v105
v_fma_f32 v102, v102, v106, v106
v_mfma_f32_32x32x16_bf16 v[58:73], v[200:203], v[160:163], v[58:73]
ds_read_b128 v[74:77], v110 offset:20480
v_exp_f32 v103, -v35
v_mul_f32 v36, v36, v87
v_cvt_pk_bf16_f32 v96, v30, v31
v_mul_f32 v33, v33, v105
v_mfma_f32_32x32x16_bf16 v[58:73], v[204:207], v[164:167], v[58:73]
buffer_load_dword v107, v4, s[4:7], s40 offen sc1
ds_read_b128 v[78:81], v110 offset:21504
v_rcp_f32 v102, v102
v_fma_f32 v103, v103, v106, v106
v_exp_f32 v104, -v36
s_waitcnt lgkmcnt(2)
v_mfma_f32_32x32x16_bf16 v[58:73], v[208:211], v[42:45], v[58:73]
ds_read_b128 v[168:171], v110 offset:22528
v_mul_f32 v37, v37, v87
v_mul_f32 v34, v34, v102
v_rcp_f32 v103, v103
v_fma_f32 v104, v104, v106, v106
v_mfma_f32_32x32x16_bf16 v[58:73], v[212:215], v[46:49], v[58:73]
ds_read_b128 v[172:175], v110 offset:23552
v_exp_f32 v105, -v37
v_mul_f32 v38, v38, v87
v_cvt_pk_bf16_f32 v97, v32, v33
s_add_u32 s61, s74, 114688
v_mfma_f32_32x32x16_bf16 v[58:73], v[216:219], v[50:53], v[58:73]
buffer_store_dwordx4 v[94:97], v1, s[4:7], s61 offen sc1
ds_read_b128 v[160:163], v110 offset:24576
v_mul_f32 v35, v35, v103
v_rcp_f32 v104, v104
v_fma_f32 v105, v105, v106, v106
v_mfma_f32_32x32x16_bf16 v[58:73], v[220:223], v[54:57], v[58:73]
ds_read_b128 v[164:167], v110 offset:25600
v_exp_f32 v102, -v38
v_mul_f32 v39, v39, v87
v_mul_f32 v36, v36, v104
s_waitcnt lgkmcnt(2)
v_mfma_f32_32x32x16_bf16 v[58:73], v[224:227], v[74:77], v[58:73]
ds_read_b128 v[42:45], v110 offset:26624
v_rcp_f32 v105, v105
v_fma_f32 v102, v102, v106, v106
v_exp_f32 v103, -v39
v_mfma_f32_32x32x16_bf16 v[58:73], v[228:231], v[78:81], v[58:73]
s_add_u32 s60, s35, s39
s_add_u32 s60, s60, 12
s_waitcnt vmcnt(1)
LC_264:
v_subrev_u32 v107, s60, v107
v_cmp_le_u32 vcc, 64, v107
s_and_b64 vcc, vcc, s[52:53]
s_cbranch_scc1 LS_265
LD_266:
s_add_u32 s65, s75, s90
buffer_load_dwordx4 v[112:115], v1, s[4:7], s65 offen offset:0 sc1
ds_read_b128 v[46:49], v110 offset:27648
v_mul_f32 v40, v40, v87
v_cvt_pk_bf16_f32 v98, v34, v35
v_mul_f32 v37, v37, v105
v_rcp_f32 v102, v102
v_mfma_f32_32x32x16_bf16 v[58:73], v[232:235], v[168:171], v[58:73]
buffer_load_dwordx4 v[116:119], v1, s[4:7], s65 offen offset:1024 sc1
v_fma_f32 v103, v103, v106, v106
v_exp_f32 v104, -v40
v_mul_f32 v41, v41, v87
v_mul_f32 v38, v38, v102
v_mfma_f32_32x32x16_bf16 v[58:73], v[236:239], v[172:175], v[58:73]
buffer_load_dwordx4 v[120:123], v1, s[4:7], s65 offen offset:2048 sc1
v_rcp_f32 v103, v103
v_fma_f32 v104, v104, v106, v106
v_exp_f32 v105, -v41
s_waitcnt lgkmcnt(0)
v_mfma_f32_32x32x16_bf16 v[58:73], v[240:243], v[160:163], v[58:73]
ds_read_b64 v[92:93], v108 offset:1536
buffer_load_dwordx4 v[124:127], v1, s[4:7], s65 offen offset:3072 sc1
v_cvt_pk_bf16_f32 v99, v36, v37
v_mul_f32 v39, v39, v103
v_rcp_f32 v104, v104
v_mfma_f32_32x32x16_bf16 v[58:73], v[244:247], v[164:167], v[58:73]
s_add_u32 s65, s75, s91
buffer_load_dwordx4 v[128:131], v1, s[4:7], s65 offen offset:0 sc1
v_fma_f32 v105, v105, v106, v106
v_mul_f32 v40, v40, v104
v_rcp_f32 v105, v105
v_mfma_f32_32x32x16_bf16 v[58:73], v[248:251], v[42:45], v[58:73]
s_waitcnt lgkmcnt(0)
v_mov_b32 v88, v92
v_and_b32 v89, 0xffff, v92
buffer_load_dwordx4 v[132:135], v1, s[4:7], s65 offen offset:1024 sc1
v_cvt_pk_bf16_f32 v100, v38, v39
v_mul_f32 v41, v41, v105
v_mfma_f32_32x32x16_bf16 v[58:73], v[252:255], v[46:49], v[58:73]
buffer_load_dwordx4 v[136:139], v1, s[4:7], s65 offen offset:2048 sc1
v_cvt_pk_bf16_f32 v101, v40, v41
v_mfma_f32_32x32x16_bf16 v[58:73], v[14:17], v[88:91], v[58:73]
buffer_store_dwordx4 v[98:101], v1, s[4:7], s61 offen offset:1024 sc1
buffer_load_dwordx4 v[140:143], v1, s[4:7], s65 offen offset:3072 sc1
s_waitcnt vmcnt(8)
v_mfma_f32_32x32x16_bf16 v[26:41], a[0:3], v[112:115], 0
v_mfma_f32_32x32x16_bf16 v[42:57], a[4:7], v[112:115], 0
s_nop 6
v_pk_mul_f32 v[58:59], v[58:59], v[92:93] op_sel:[0,1] op_sel_hi:[1,1]
v_pk_mul_f32 v[60:61], v[60:61], v[92:93] op_sel:[0,1] op_sel_hi:[1,1]
v_exp_f32 v102, -v58
v_exp_f32 v103, -v59
v_exp_f32 v104, -v60
v_exp_f32 v105, -v61
v_pk_fma_f32 v[102:103], v[102:103], s[82:83], s[82:83]
v_pk_fma_f32 v[104:105], v[104:105], s[82:83], s[82:83]
v_rcp_f32 v102, v102
v_rcp_f32 v103, v103
v_rcp_f32 v104, v104
v_rcp_f32 v105, v105
v_pk_mul_f32 v[58:59], v[58:59], v[102:103]
v_pk_mul_f32 v[60:61], v[60:61], v[104:105]
v_cvt_pk_bf16_f32 v94, v58, v59
v_cvt_pk_bf16_f32 v95, v60, v61
s_add_u32 s65, s75, s92
buffer_load_dwordx4 v[144:147], v1, s[4:7], s65 offen offset:0 sc1
buffer_load_dwordx4 v[148:151], v1, s[4:7], s65 offen offset:1024 sc1
v_pk_mul_f32 v[62:63], v[62:63], v[92:93] op_sel:[0,1] op_sel_hi:[1,1]
v_pk_mul_f32 v[64:65], v[64:65], v[92:93] op_sel:[0,1] op_sel_hi:[1,1]
v_exp_f32 v102, -v62
v_exp_f32 v103, -v63
v_exp_f32 v104, -v64
v_exp_f32 v105, -v65
v_pk_fma_f32 v[102:103], v[102:103], s[82:83], s[82:83]
v_pk_fma_f32 v[104:105], v[104:105], s[82:83], s[82:83]
v_rcp_f32 v102, v102
v_rcp_f32 v103, v103
v_rcp_f32 v104, v104
v_rcp_f32 v105, v105
v_pk_mul_f32 v[62:63], v[62:63], v[102:103]
v_pk_mul_f32 v[64:65], v[64:65], v[104:105]
v_cvt_pk_bf16_f32 v96, v62, v63
v_cvt_pk_bf16_f32 v97, v64, v65
buffer_load_dwordx4 v[152:155], v1, s[4:7], s65 offen offset:2048 sc1
buffer_load_dwordx4 v[156:159], v1, s[4:7], s65 offen offset:3072 sc1
s_add_u32 s61, s74, 344064
buffer_store_dwordx4 v[94:97], v1, s[4:7], s61 offen sc1
v_pk_mul_f32 v[66:67], v[66:67], v[92:93] op_sel:[0,1] op_sel_hi:[1,1]
v_pk_mul_f32 v[68:69], v[68:69], v[92:93] op_sel:[0,1] op_sel_hi:[1,1]
v_exp_f32 v102, -v66
v_exp_f32 v103, -v67
v_exp_f32 v104, -v68
v_exp_f32 v105, -v69
v_pk_fma_f32 v[102:103], v[102:103], s[82:83], s[82:83]
v_pk_fma_f32 v[104:105], v[104:105], s[82:83], s[82:83]
v_rcp_f32 v102, v102
v_rcp_f32 v103, v103
v_rcp_f32 v104, v104
v_rcp_f32 v105, v105
v_pk_mul_f32 v[66:67], v[66:67], v[102:103]
v_pk_mul_f32 v[68:69], v[68:69], v[104:105]
v_cvt_pk_bf16_f32 v98, v66, v67
v_cvt_pk_bf16_f32 v99, v68, v69
v_pk_mul_f32 v[70:71], v[70:71], v[92:93] op_sel:[0,1] op_sel_hi:[1,1]
v_pk_mul_f32 v[72:73], v[72:73], v[92:93] op_sel:[0,1] op_sel_hi:[1,1]
v_exp_f32 v102, -v70
v_exp_f32 v103, -v71
v_exp_f32 v104, -v72
v_exp_f32 v105, -v73
v_pk_fma_f32 v[102:103], v[102:103], s[82:83], s[82:83]
v_pk_fma_f32 v[104:105], v[104:105], s[82:83], s[82:83]
v_rcp_f32 v102, v102
v_rcp_f32 v103, v103
v_rcp_f32 v104, v104
v_rcp_f32 v105, v105
v_pk_mul_f32 v[70:71], v[70:71], v[102:103]
v_pk_mul_f32 v[72:73], v[72:73], v[104:105]
v_cvt_pk_bf16_f32 v100, v70, v71
v_cvt_pk_bf16_f32 v101, v72, v73
buffer_store_dwordx4 v[98:101], v1, s[4:7], s61 offen offset:1024 sc1
s_waitcnt vmcnt(13)
v_mfma_f32_32x32x16_bf16 v[26:41], a[8:11], v[116:119], v[26:41]
s_add_u32 s60, s35, 14
v_mov_b32 v107, s60
s_add_u32 s65, s75, s93
buffer_load_dwordx4 v[112:115], v1, s[4:7], s65 offen offset:0 sc1
v_mfma_f32_32x32x16_bf16 v[42:57], a[12:15], v[116:119], v[42:57]
s_waitcnt vmcnt(8)
s_mov_b64 exec, 1
buffer_store_dword v107, off, s[4:7], s41 sc1
s_mov_b64 exec, -1
buffer_load_dwordx4 v[116:119], v1, s[4:7], s65 offen offset:1024 sc1
s_waitcnt vmcnt(15)
v_mfma_f32_32x32x16_bf16 v[26:41], a[16:19], v[120:123], v[26:41]
v_mfma_f32_32x32x16_bf16 v[42:57], a[20:23], v[120:123], v[42:57]
buffer_load_dwordx4 v[120:123], v1, s[4:7], s65 offen offset:2048 sc1
s_waitcnt vmcnt(15)
v_mfma_f32_32x32x16_bf16 v[26:41], a[24:27], v[124:127], v[26:41]
v_mfma_f32_32x32x16_bf16 v[42:57], a[28:31], v[124:127], v[42:57]
buffer_load_dwordx4 v[124:127], v1, s[4:7], s65 offen offset:3072 sc1
s_waitcnt vmcnt(15)
v_mfma_f32_32x32x16_bf16 v[26:41], a[32:35], v[128:131], v[26:41]
v_mfma_f32_32x32x16_bf16 v[42:57], a[36:39], v[128:131], v[42:57]
s_add_u32 s65, s75, s94
buffer_load_dwordx4 v[128:131], v1, s[4:7], s65 offen offset:0 sc1
s_waitcnt vmcnt(15)
v_mfma_f32_32x32x16_bf16 v[26:41], a[40:43], v[132:135], v[26:41]
v_mfma_f32_32x32x16_bf16 v[42:57], a[44:47], v[132:135], v[42:57]
buffer_load_dwordx4 v[132:135], v1, s[4:7], s65 offen offset:1024 sc1
s_waitcnt vmcnt(15)
v_mfma_f32_32x32x16_bf16 v[26:41], a[48:51], v[136:139], v[26:41]
s_add_u32 s60, s35, 15
v_mov_b32 v107, s60
v_mfma_f32_32x32x16_bf16 v[42:57], a[52:55], v[136:139], v[42:57]
s_waitcnt vmcnt(7)
s_mov_b64 exec, 1
buffer_store_dword v107, off, s[4:7], s41 sc1
s_mov_b64 exec, -1
buffer_load_dwordx4 v[136:139], v1, s[4:7], s65 offen offset:2048 sc1
s_waitcnt vmcnt(15)
v_mfma_f32_32x32x16_bf16 v[26:41], a[56:59], v[140:143], v[26:41]
v_mfma_f32_32x32x16_bf16 v[42:57], a[60:63], v[140:143], v[42:57]
buffer_load_dwordx4 v[140:143], v1, s[4:7], s65 offen offset:3072 sc1
s_waitcnt vmcnt(15)
v_mfma_f32_32x32x16_bf16 v[26:41], a[64:67], v[144:147], v[26:41]
v_mfma_f32_32x32x16_bf16 v[42:57], a[68:71], v[144:147], v[42:57]
s_add_u32 s65, s75, s95
buffer_load_dwordx4 v[144:147], v1, s[4:7], s65 offen offset:0 sc1
s_waitcnt vmcnt(15)
v_mfma_f32_32x32x16_bf16 v[26:41], a[72:75], v[148:151], v[26:41]
v_mfma_f32_32x32x16_bf16 v[42:57], a[76:79], v[148:151], v[42:57]
buffer_load_dwordx4 v[148:151], v1, s[4:7], s65 offen offset:1024 sc1
s_waitcnt vmcnt(15)
v_mfma_f32_32x32x16_bf16 v[26:41], a[80:83], v[152:155], v[26:41]
v_mfma_f32_32x32x16_bf16 v[42:57], a[84:87], v[152:155], v[42:57]
buffer_load_dwordx4 v[152:155], v1, s[4:7], s65 offen offset:2048 sc1
s_waitcnt vmcnt(15)
v_mfma_f32_32x32x16_bf16 v[26:41], a[88:91], v[156:159], v[26:41]
v_mfma_f32_32x32x16_bf16 v[42:57], a[92:95], v[156:159], v[42:57]
buffer_load_dwordx4 v[156:159], v1, s[4:7], s65 offen offset:3072 sc1
s_waitcnt vmcnt(13)
v_mfma_f32_32x32x16_bf16 v[26:41], a[96:99], v[112:115], v[26:41]
buffer_load_dword v107, v4, s[4:7], s40 offen sc1
v_mfma_f32_32x32x16_bf16 v[42:57], a[100:103], v[112:115], v[42:57]
s_add_u32 s65, s75, s96
buffer_load_dwordx4 v[112:115], v1, s[4:7], s65 offen offset:0 sc1
s_waitcnt vmcnt(13)
v_mfma_f32_32x32x16_bf16 v[26:41], a[104:107], v[116:119], v[26:41]
v_mfma_f32_32x32x16_bf16 v[42:57], a[108:111], v[116:119], v[42:57]
buffer_load_dwordx4 v[116:119], v1, s[4:7], s65 offen offset:1024 sc1
s_waitcnt vmcnt(13)
v_mfma_f32_32x32x16_bf16 v[26:41], a[112:115], v[120:123], v[26:41]
v_mfma_f32_32x32x16_bf16 v[42:57], a[116:119], v[120:123], v[42:57]
buffer_load_dwordx4 v[120:123], v1, s[4:7], s65 offen offset:2048 sc1
s_waitcnt vmcnt(13)
v_mfma_f32_32x32x16_bf16 v[26:41], a[120:123], v[124:127], v[26:41]
v_mfma_f32_32x32x16_bf16 v[42:57], a[124:127], v[124:127], v[42:57]
buffer_load_dwordx4 v[124:127], v1, s[4:7], s65 offen offset:3072 sc1
s_waitcnt vmcnt(13)
v_mfma_f32_32x32x16_bf16 v[26:41], a[128:131], v[128:131], v[26:41]
v_mfma_f32_32x32x16_bf16 v[42:57], a[132:135], v[128:131], v[42:57]
s_waitcnt vmcnt(12)
v_mfma_f32_32x32x16_bf16 v[26:41], a[136:139], v[132:135], v[26:41]
v_mfma_f32_32x32x16_bf16 v[42:57], a[140:143], v[132:135], v[42:57]
s_waitcnt vmcnt(10)
v_mfma_f32_32x32x16_bf16 v[26:41], a[144:147], v[136:139], v[26:41]
s_add_u32 s60, s35, s39
s_add_u32 s60, s60, 14
s_waitcnt vmcnt(4)
LC_267:
v_subrev_u32 v107, s60, v107
v_cmp_le_u32 vcc, 64, v107
s_and_b64 vcc, vcc, s[52:53]
s_cbranch_scc1 LS_268
LD_269:
s_add_u32 s65, s3, s90
buffer_load_dwordx4 v[128:131], v1, s[4:7], s65 offen offset:0 sc1
v_mfma_f32_32x32x16_bf16 v[42:57], a[148:151], v[136:139], v[42:57]
buffer_load_dwordx4 v[132:135], v1, s[4:7], s65 offen offset:1024 sc1
s_waitcnt vmcnt(11)
v_mfma_f32_32x32x16_bf16 v[26:41], a[152:155], v[140:143], v[26:41]
buffer_load_dwordx4 v[136:139], v1, s[4:7], s65 offen offset:2048 sc1
v_mfma_f32_32x32x16_bf16 v[42:57], a[156:159], v[140:143], v[42:57]
buffer_load_dwordx4 v[140:143], v1, s[4:7], s65 offen offset:3072 sc1
s_waitcnt vmcnt(12)
v_mfma_f32_32x32x16_bf16 v[26:41], a[160:163], v[144:147], v[26:41]
s_and_b32 s61, s32, 1
s_mul_i32 s62, s61, 12288
s_add_u32 s62, s62, 86016
v_add_u32 v90, s62, v1
v_mfma_f32_32x32x16_bf16 v[42:57], a[164:167], v[144:147], v[42:57]
s_add_u32 s65, s3, s91
buffer_load_dwordx4 v[144:147], v1, s[4:7], s65 offen offset:0 sc1
s_waitcnt vmcnt(12)
v_mfma_f32_32x32x16_bf16 v[26:41], a[168:171], v[148:151], v[26:41]
s_xor_b32 s61, s61, 1
s_mul_i32 s62, s61, 12288
s_add_u32 s62, s62, 86016
v_add_u32 v91, s62, v1
v_mfma_f32_32x32x16_bf16 v[42:57], a[172:175], v[148:151], v[42:57]
buffer_load_dwordx4 v[148:151], v1, s[4:7], s65 offen offset:1024 sc1
s_waitcnt vmcnt(12)
v_mfma_f32_32x32x16_bf16 v[26:41], a[176:179], v[152:155], v[26:41]
v_mfma_f32_32x32x16_bf16 v[42:57], a[180:183], v[152:155], v[42:57]
buffer_load_dwordx4 v[152:155], v1, s[4:7], s65 offen offset:2048 sc1
s_waitcnt vmcnt(12)
v_mfma_f32_32x32x16_bf16 v[26:41], a[184:187], v[156:159], v[26:41]
v_mfma_f32_32x32x16_bf16 v[42:57], a[188:191], v[156:159], v[42:57]
buffer_load_dwordx4 v[156:159], v1, s[4:7], s65 offen offset:3072 sc1
s_waitcnt vmcnt(11)
v_mfma_f32_32x32x16_bf16 v[26:41], a[192:195], v[112:115], v[26:41]
v_mfma_f32_32x32x16_bf16 v[42:57], a[196:199], v[112:115], v[42:57]
s_add_u32 s65, s3, s92
buffer_load_dwordx4 v[112:115], v1, s[4:7], s65 offen offset:0 sc1
s_waitcnt vmcnt(11)
v_mfma_f32_32x32x16_bf16 v[26:41], a[200:203], v[116:119], v[26:41]
v_mfma_f32_32x32x16_bf16 v[42:57], a[204:207], v[116:119], v[42:57]
buffer_load_dwordx4 v[116:119], v1, s[4:7], s65 offen offset:1024 sc1
s_waitcnt vmcnt(11)
v_mfma_f32_32x32x16_bf16 v[26:41], a[208:211], v[120:123], v[26:41]
v_mfma_f32_32x32x16_bf16 v[42:57], a[212:215], v[120:123], v[42:57]
buffer_load_dwordx4 v[120:123], v1, s[4:7], s65 offen offset:2048 sc1
s_waitcnt vmcnt(11)
v_mfma_f32_32x32x16_bf16 v[26:41], a[216:219], v[124:127], v[26:41]
v_mfma_f32_32x32x16_bf16 v[42:57], a[220:223], v[124:127], v[42:57]
buffer_load_dwordx4 v[124:127], v1, s[4:7], s65 offen offset:3072 sc1
s_cmp_lt_u32 s32, 2
s_cbranch_scc0 LB_270
s_waitcnt vmcnt(11)
v_mfma_f32_32x32x16_bf16 v[58:73], a[0:3], v[128:131], 0
v_mfma_f32_32x32x16_bf16 v[74:89], a[4:7], v[128:131], 0
s_add_u32 s65, s3, s93
buffer_load_dwordx4 v[128:131], v1, s[4:7], s65 offen offset:0 sc1
s_waitcnt vmcnt(11)
v_mfma_f32_32x32x16_bf16 v[58:73], a[8:11], v[132:135], v[58:73]
s_nop 1
ds_write_b128 v91, v[42:45] offset:28672
v_lshlrev_b32 v92, 16, v18
v_and_b32 v93, 0xffff0000, v18
v_add_f32 v26, v26, v92
v_add_f32 v27, v27, v93
v_lshlrev_b32 v92, 16, v19
v_mfma_f32_32x32x16_bf16 v[74:89], a[12:15], v[132:135], v[74:89]
buffer_load_dwordx4 v[132:135], v1, s[4:7], s65 offen offset:1024 sc1
v_and_b32 v93, 0xffff0000, v19
v_add_f32 v28, v28, v92
v_add_f32 v29, v29, v93
v_lshlrev_b32 v92, 16, v20
s_waitcnt vmcnt(11)
v_mfma_f32_32x32x16_bf16 v[58:73], a[16:19], v[136:139], v[58:73]
ds_write_b128 v91, v[46:49] offset:29696
v_and_b32 v93, 0xffff0000, v20
v_add_f32 v30, v30, v92
v_add_f32 v31, v31, v93
v_lshlrev_b32 v92, 16, v21
v_and_b32 v93, 0xffff0000, v21
v_mfma_f32_32x32x16_bf16 v[74:89], a[20:23], v[136:139], v[74:89]
buffer_load_dwordx4 v[136:139], v1, s[4:7], s65 offen offset:2048 sc1
v_add_f32 v32, v32, v92
v_add_f32 v33, v33, v93
v_lshlrev_b32 v92, 16, v22
v_and_b32 v93, 0xffff0000, v22
s_waitcnt vmcnt(11)
v_mfma_f32_32x32x16_bf16 v[58:73], a[24:27], v[140:143], v[58:73]
ds_write_b128 v91, v[50:53] offset:30720
v_add_f32 v34, v34, v92
v_add_f32 v35, v35, v93
v_lshlrev_b32 v92, 16, v23
v_and_b32 v93, 0xffff0000, v23
v_add_f32 v36, v36, v92
v_mfma_f32_32x32x16_bf16 v[74:89], a[28:31], v[140:143], v[74:89]
buffer_load_dwordx4 v[140:143], v1, s[4:7], s65 offen offset:3072 sc1
v_add_f32 v37, v37, v93
v_lshlrev_b32 v92, 16, v24
v_and_b32 v93, 0xffff0000, v24
v_add_f32 v38, v38, v92
s_waitcnt vmcnt(11)
v_mfma_f32_32x32x16_bf16 v[58:73], a[32:35], v[144:147], v[58:73]
ds_write_b128 v91, v[54:57] offset:31744
v_add_f32 v39, v39, v93
v_lshlrev_b32 v92, 16, v25
v_and_b32 v93, 0xffff0000, v25
v_add_f32 v40, v40, v92
v_add_f32 v41, v41, v93
v_mfma_f32_32x32x16_bf16 v[74:89], a[36:39], v[144:147], v[74:89]
s_add_u32 s65, s3, s94
buffer_load_dwordx4 v[144:147], v1, s[4:7], s65 offen offset:0 sc1
s_waitcnt vmcnt(11)
v_mfma_f32_32x32x16_bf16 v[58:73], a[40:43], v[148:151], v[58:73]
v_mfma_f32_32x32x16_bf16 v[74:89], a[44:47], v[148:151], v[74:89]
buffer_load_dwordx4 v[148:151], v1, s[4:7], s65 offen offset:1024 sc1
s_waitcnt vmcnt(11)
v_mfma_f32_32x32x16_bf16 v[58:73], a[48:51], v[152:155], v[58:73]
v_mfma_f32_32x32x16_bf16 v[74:89], a[52:55], v[152:155], v[74:89]
buffer_load_dwordx4 v[152:155], v1, s[4:7], s65 offen offset:2048 sc1
s_waitcnt vmcnt(11)
v_mfma_f32_32x32x16_bf16 v[58:73], a[56:59], v[156:159], v[58:73]
v_mfma_f32_32x32x16_bf16 v[74:89], a[60:63], v[156:159], v[74:89]
buffer_load_dwordx4 v[156:159], v1, s[4:7], s65 offen offset:3072 sc1
s_waitcnt vmcnt(11)
v_mfma_f32_32x32x16_bf16 v[58:73], a[64:67], v[112:115], v[58:73]
v_mfma_f32_32x32x16_bf16 v[74:89], a[68:71], v[112:115], v[74:89]
s_add_u32 s65, s3, s95
buffer_load_dwordx4 v[112:115], v1, s[4:7], s65 offen offset:0 sc1
s_waitcnt vmcnt(11)
v_mfma_f32_32x32x16_bf16 v[58:73], a[72:75], v[116:119], v[58:73]
s_waitcnt lgkmcnt(0)
s_barrier
v_mfma_f32_32x32x16_bf16 v[74:89], a[76:79], v[116:119], v[74:89]
buffer_load_dwordx4 v[116:119], v1, s[4:7], s65 offen offset:1024 sc1
s_waitcnt vmcnt(11)
v_mfma_f32_32x32x16_bf16 v[58:73], a[80:83], v[120:123], v[58:73]
ds_read_b128 v[42:45], v90 offset:28672
ds_read_b128 v[46:49], v90 offset:29696
ds_read_b128 v[50:53], v90 offset:30720
ds_read_b128 v[54:57], v90 offset:31744
v_mfma_f32_32x32x16_bf16 v[74:89], a[84:87], v[120:123], v[74:89]
buffer_load_dwordx4 v[120:123], v1, s[4:7], s65 offen offset:2048 sc1
s_waitcnt vmcnt(11)
v_mfma_f32_32x32x16_bf16 v[58:73], a[88:91], v[124:127], v[58:73]
s_waitcnt lgkmcnt(0)
v_add_f32 v26, v26, v42
v_add_f32 v27, v27, v43
v_add_f32 v28, v28, v44
v_add_f32 v29, v29, v45
v_add_f32 v30, v30, v46
v_mfma_f32_32x32x16_bf16 v[74:89], a[92:95], v[124:127], v[74:89]
buffer_load_dwordx4 v[124:127], v1, s[4:7], s65 offen offset:3072 sc1
v_add_f32 v31, v31, v47
v_add_f32 v32, v32, v48
v_add_f32 v33, v33, v49
v_add_f32 v34, v34, v50
s_waitcnt vmcnt(11)
v_mfma_f32_32x32x16_bf16 v[58:73], a[96:99], v[128:131], v[58:73]
v_add_f32 v35, v35, v51
v_add_f32 v36, v36, v52
v_add_f32 v37, v37, v53
v_add_f32 v38, v38, v54
v_add_f32 v39, v39, v55
v_add_f32 v40, v40, v56
v_mfma_f32_32x32x16_bf16 v[74:89], a[100:103], v[128:131], v[74:89]
s_add_u32 s65, s3, s96
buffer_load_dwordx4 v[128:131], v1, s[4:7], s65 offen offset:0 sc1
v_add_f32 v41, v41, v57
s_waitcnt vmcnt(11)
v_mfma_f32_32x32x16_bf16 v[58:73], a[104:107], v[132:135], v[58:73]
ds_read_b128 v[42:45], v90 offset:32768
ds_read_b128 v[46:49], v90 offset:33792
ds_read_b128 v[50:53], v90 offset:34816
ds_read_b128 v[54:57], v90 offset:35840
v_mfma_f32_32x32x16_bf16 v[74:89], a[108:111], v[132:135], v[74:89]
buffer_load_dwordx4 v[132:135], v1, s[4:7], s65 offen offset:1024 sc1
s_waitcnt vmcnt(11)
v_mfma_f32_32x32x16_bf16 v[58:73], a[112:115], v[136:139], v[58:73]
s_waitcnt lgkmcnt(0)
v_add_f32 v26, v26, v42
v_add_f32 v27, v27, v43
v_add_f32 v28, v28, v44
v_add_f32 v29, v29, v45
v_add_f32 v30, v30, v46
v_mfma_f32_32x32x16_bf16 v[74:89], a[116:119], v[136:139], v[74:89]
buffer_load_dwordx4 v[136:139], v1, s[4:7], s65 offen offset:2048 sc1
v_add_f32 v31, v31, v47
v_add_f32 v32, v32, v48
v_add_f32 v33, v33, v49
v_add_f32 v34, v34, v50
s_waitcnt vmcnt(11)
v_mfma_f32_32x32x16_bf16 v[58:73], a[120:123], v[140:143], v[58:73]
v_add_f32 v35, v35, v51
v_add_f32 v36, v36, v52
v_add_f32 v37, v37, v53
v_add_f32 v38, v38, v54
v_add_f32 v39, v39, v55
v_add_f32 v40, v40, v56
v_mfma_f32_32x32x16_bf16 v[74:89], a[124:127], v[140:143], v[74:89]
buffer_load_dwordx4 v[140:143], v1, s[4:7], s65 offen offset:3072 sc1
v_add_f32 v41, v41, v57
s_waitcnt vmcnt(11)
v_mfma_f32_32x32x16_bf16 v[74:89], a[132:135], v[144:147], v[74:89]
ds_read_b128 v[42:45], v90 offset:36864
ds_read_b128 v[46:49], v90 offset:37888
ds_read_b128 v[50:53], v90 offset:38912
ds_read_b128 v[54:57], v90 offset:39936
s_waitcnt vmcnt(10)
v_mfma_f32_32x32x16_bf16 v[74:89], a[140:143], v[148:151], v[74:89]
s_waitcnt lgkmcnt(0)
s_waitcnt vmcnt(9)
v_mfma_f32_32x32x16_bf16 v[74:89], a[148:151], v[152:155], v[74:89]
v_add_f32 v26, v26, v42
v_add_f32 v27, v27, v43
v_add_f32 v28, v28, v44
v_add_f32 v29, v29, v45
v_add_f32 v30, v30, v46
s_waitcnt vmcnt(8)
v_mfma_f32_32x32x16_bf16 v[74:89], a[156:159], v[156:159], v[74:89]
v_add_f32 v31, v31, v47
v_add_f32 v32, v32, v48
v_add_f32 v33, v33, v49
v_add_f32 v34, v34, v50
v_add_f32 v35, v35, v51
s_waitcnt vmcnt(7)
v_mfma_f32_32x32x16_bf16 v[74:89], a[164:167], v[112:115], v[74:89]
v_add_f32 v36, v36, v52
v_add_f32 v37, v37, v53
v_add_f32 v38, v38, v54
v_add_f32 v39, v39, v55
v_add_f32 v40, v40, v56
s_waitcnt vmcnt(6)
v_mfma_f32_32x32x16_bf16 v[74:89], a[172:175], v[116:119], v[74:89]
v_add_f32 v41, v41, v57
v_cvt_pk_bf16_f32 v18, v26, v27
v_cvt_pk_bf16_f32 v19, v28, v29
v_cvt_pk_bf16_f32 v20, v30, v31
v_cvt_pk_bf16_f32 v21, v32, v33
s_waitcnt vmcnt(5)
v_mfma_f32_32x32x16_bf16 v[74:89], a[180:183], v[120:123], v[74:89]
v_cvt_pk_bf16_f32 v22, v34, v35
v_cvt_pk_bf16_f32 v23, v36, v37
v_cvt_pk_bf16_f32 v24, v38, v39
v_cvt_pk_bf16_f32 v25, v40, v41
s_waitcnt vmcnt(4)
v_mfma_f32_32x32x16_bf16 v[74:89], a[188:191], v[124:127], v[74:89]
v_and_b32 v92, 31, v0
v_mul_u32_u24 v92, 896, v92
v_lshrrev_b32 v93, 5, v0
v_lshl_add_u32 v92, v93, 4, v92
buffer_store_dwordx4 v[18:21], v92, s[28:31], s76 offen
buffer_store_dwordx4 v[22:25], v92, s[28:31], s76 offen offset:32
s_waitcnt vmcnt(5)
v_mfma_f32_32x32x16_bf16 v[74:89], a[196:199], v[128:131], v[74:89]
s_waitcnt vmcnt(4)
v_mfma_f32_32x32x16_bf16 v[74:89], a[204:207], v[132:135], v[74:89]
s_waitcnt vmcnt(3)
v_mfma_f32_32x32x16_bf16 v[74:89], a[212:215], v[136:139], v[74:89]
s_waitcnt vmcnt(2)
v_mfma_f32_32x32x16_bf16 v[74:89], a[220:223], v[140:143], v[74:89]
v_mfma_f32_32x32x16_bf16 v[58:73], a[128:131], v[144:147], v[58:73]
v_mfma_f32_32x32x16_bf16 v[58:73], a[136:139], v[148:151], v[58:73]
s_nop 9
ds_write_b128 v91, v[74:77] offset:4096
v_mfma_f32_32x32x16_bf16 v[58:73], a[144:147], v[152:155], v[58:73]
ds_write_b128 v91, v[78:81] offset:5120
v_mfma_f32_32x32x16_bf16 v[58:73], a[152:155], v[156:159], v[58:73]
ds_write_b128 v91, v[82:85] offset:6144
v_mfma_f32_32x32x16_bf16 v[58:73], a[160:163], v[112:115], v[58:73]
ds_write_b128 v91, v[86:89] offset:7168
v_mfma_f32_32x32x16_bf16 v[58:73], a[168:171], v[116:119], v[58:73]
s_waitcnt lgkmcnt(0)
s_barrier
v_mfma_f32_32x32x16_bf16 v[58:73], a[176:179], v[120:123], v[58:73]
v_mfma_f32_32x32x16_bf16 v[58:73], a[184:187], v[124:127], v[58:73]
v_mfma_f32_32x32x16_bf16 v[58:73], a[192:195], v[128:131], v[58:73]
v_mfma_f32_32x32x16_bf16 v[58:73], a[200:203], v[132:135], v[58:73]
v_mfma_f32_32x32x16_bf16 v[58:73], a[208:211], v[136:139], v[58:73]
v_mfma_f32_32x32x16_bf16 v[58:73], a[216:219], v[140:143], v[58:73]
s_nop 11
ds_write_b128 v90, v[58:61] offset:8192
ds_write_b128 v90, v[62:65] offset:9216
ds_write_b128 v90, v[66:69] offset:10240
ds_write_b128 v90, v[70:73] offset:11264
s_waitcnt lgkmcnt(0)
s_barrier
s_branch LJ_271
LB_270:
L_vhop11a:
s_nop 0
s_waitcnt vmcnt(11)
v_mfma_f32_32x32x16_bf16 v[58:73], a[0:3], v[128:131], 0
v_mfma_f32_32x32x16_bf16 v[74:89], a[4:7], v[128:131], 0
s_add_u32 s65, s3, s93
buffer_load_dwordx4 v[128:131], v1, s[4:7], s65 offen offset:0 sc1
s_waitcnt vmcnt(11)
v_mfma_f32_32x32x16_bf16 v[58:73], a[8:11], v[132:135], v[58:73]
s_nop 0
ds_write_b128 v91, v[42:45] offset:32768
v_mfma_f32_32x32x16_bf16 v[74:89], a[12:15], v[132:135], v[74:89]
buffer_load_dwordx4 v[132:135], v1, s[4:7], s65 offen offset:1024 sc1
s_waitcnt vmcnt(11)
v_mfma_f32_32x32x16_bf16 v[58:73], a[16:19], v[136:139], v[58:73]
ds_write_b128 v91, v[46:49] offset:33792
v_mfma_f32_32x32x16_bf16 v[74:89], a[20:23], v[136:139], v[74:89]
buffer_load_dwordx4 v[136:139], v1, s[4:7], s65 offen offset:2048 sc1
s_waitcnt vmcnt(11)
v_mfma_f32_32x32x16_bf16 v[58:73], a[24:27], v[140:143], v[58:73]
ds_write_b128 v91, v[50:53] offset:34816
v_mfma_f32_32x32x16_bf16 v[74:89], a[28:31], v[140:143], v[74:89]
buffer_load_dwordx4 v[140:143], v1, s[4:7], s65 offen offset:3072 sc1
s_waitcnt vmcnt(11)
v_mfma_f32_32x32x16_bf16 v[58:73], a[32:35], v[144:147], v[58:73]
ds_write_b128 v91, v[54:57] offset:35840
v_mfma_f32_32x32x16_bf16 v[74:89], a[36:39], v[144:147], v[74:89]
s_add_u32 s65, s3, s94
buffer_load_dwordx4 v[144:147], v1, s[4:7], s65 offen offset:0 sc1
s_waitcnt vmcnt(11)
v_mfma_f32_32x32x16_bf16 v[58:73], a[40:43], v[148:151], v[58:73]
ds_write_b128 v90, v[26:29] offset:36864
v_mfma_f32_32x32x16_bf16 v[74:89], a[44:47], v[148:151], v[74:89]
buffer_load_dwordx4 v[148:151], v1, s[4:7], s65 offen offset:1024 sc1
s_waitcnt vmcnt(11)
v_mfma_f32_32x32x16_bf16 v[58:73], a[48:51], v[152:155], v[58:73]
ds_write_b128 v90, v[30:33] offset:37888
v_mfma_f32_32x32x16_bf16 v[74:89], a[52:55], v[152:155], v[74:89]
buffer_load_dwordx4 v[152:155], v1, s[4:7], s65 offen offset:2048 sc1
s_waitcnt vmcnt(11)
v_mfma_f32_32x32x16_bf16 v[58:73], a[56:59], v[156:159], v[58:73]
ds_write_b128 v90, v[34:37] offset:38912
v_mfma_f32_32x32x16_bf16 v[74:89], a[60:63], v[156:159], v[74:89]
buffer_load_dwordx4 v[156:159], v1, s[4:7], s65 offen offset:3072 sc1
s_waitcnt vmcnt(11)
v_mfma_f32_32x32x16_bf16 v[58:73], a[64:67], v[112:115], v[58:73]
ds_write_b128 v90, v[38:41] offset:39936
v_mfma_f32_32x32x16_bf16 v[74:89], a[68:71], v[112:115], v[74:89]
s_add_u32 s65, s3, s95
buffer_load_dwordx4 v[112:115], v1, s[4:7], s65 offen offset:0 sc1
s_waitcnt vmcnt(11)
v_mfma_f32_32x32x16_bf16 v[58:73], a[72:75], v[116:119], v[58:73]
s_waitcnt lgkmcnt(0)
s_barrier
v_mfma_f32_32x32x16_bf16 v[74:89], a[76:79], v[116:119], v[74:89]
buffer_load_dwordx4 v[116:119], v1, s[4:7], s65 offen offset:1024 sc1
v_lshlrev_b32 v26, 16, v18
v_and_b32 v27, 0xffff0000, v18
v_lshlrev_b32 v28, 16, v19
v_and_b32 v29, 0xffff0000, v19
s_waitcnt vmcnt(11)
v_mfma_f32_32x32x16_bf16 v[58:73], a[80:83], v[120:123], v[58:73]
v_lshlrev_b32 v30, 16, v20
v_and_b32 v31, 0xffff0000, v20
v_lshlrev_b32 v32, 16, v21
v_and_b32 v33, 0xffff0000, v21
v_lshlrev_b32 v34, 16, v22
v_and_b32 v35, 0xffff0000, v22
v_mfma_f32_32x32x16_bf16 v[74:89], a[84:87], v[120:123], v[74:89]
buffer_load_dwordx4 v[120:123], v1, s[4:7], s65 offen offset:2048 sc1
v_lshlrev_b32 v36, 16, v23
v_and_b32 v37, 0xffff0000, v23
v_lshlrev_b32 v38, 16, v24
v_and_b32 v39, 0xffff0000, v24
s_waitcnt vmcnt(11)
v_mfma_f32_32x32x16_bf16 v[58:73], a[88:91], v[124:127], v[58:73]
v_lshlrev_b32 v40, 16, v25
v_and_b32 v41, 0xffff0000, v25
v_mfma_f32_32x32x16_bf16 v[74:89], a[92:95], v[124:127], v[74:89]
buffer_load_dwordx4 v[124:127], v1, s[4:7], s65 offen offset:3072 sc1
s_waitcnt vmcnt(11)
v_mfma_f32_32x32x16_bf16 v[58:73], a[96:99], v[128:131], v[58:73]
v_mfma_f32_32x32x16_bf16 v[74:89], a[100:103], v[128:131], v[74:89]
s_add_u32 s65, s3, s96
buffer_load_dwordx4 v[128:131], v1, s[4:7], s65 offen offset:0 sc1
s_waitcnt vmcnt(11)
v_mfma_f32_32x32x16_bf16 v[58:73], a[104:107], v[132:135], v[58:73]
v_mfma_f32_32x32x16_bf16 v[74:89], a[108:111], v[132:135], v[74:89]
buffer_load_dwordx4 v[132:135], v1, s[4:7], s65 offen offset:1024 sc1
s_waitcnt vmcnt(11)
v_mfma_f32_32x32x16_bf16 v[58:73], a[112:115], v[136:139], v[58:73]
v_mfma_f32_32x32x16_bf16 v[74:89], a[116:119], v[136:139], v[74:89]
buffer_load_dwordx4 v[136:139], v1, s[4:7], s65 offen offset:2048 sc1
s_waitcnt vmcnt(11)
v_mfma_f32_32x32x16_bf16 v[58:73], a[120:123], v[140:143], v[58:73]
v_mfma_f32_32x32x16_bf16 v[74:89], a[124:127], v[140:143], v[74:89]
buffer_load_dwordx4 v[140:143], v1, s[4:7], s65 offen offset:3072 sc1
s_waitcnt vmcnt(11)
v_mfma_f32_32x32x16_bf16 v[74:89], a[132:135], v[144:147], v[74:89]
s_waitcnt vmcnt(10)
v_mfma_f32_32x32x16_bf16 v[74:89], a[140:143], v[148:151], v[74:89]
s_waitcnt vmcnt(9)
v_mfma_f32_32x32x16_bf16 v[74:89], a[148:151], v[152:155], v[74:89]
s_waitcnt vmcnt(8)
v_mfma_f32_32x32x16_bf16 v[74:89], a[156:159], v[156:159], v[74:89]
s_waitcnt vmcnt(7)
v_mfma_f32_32x32x16_bf16 v[74:89], a[164:167], v[112:115], v[74:89]
s_waitcnt vmcnt(6)
v_mfma_f32_32x32x16_bf16 v[74:89], a[172:175], v[116:119], v[74:89]
s_waitcnt vmcnt(5)
v_mfma_f32_32x32x16_bf16 v[74:89], a[180:183], v[120:123], v[74:89]
s_waitcnt vmcnt(4)
v_mfma_f32_32x32x16_bf16 v[74:89], a[188:191], v[124:127], v[74:89]
s_waitcnt vmcnt(3)
v_mfma_f32_32x32x16_bf16 v[74:89], a[196:199], v[128:131], v[74:89]
s_waitcnt vmcnt(2)
v_mfma_f32_32x32x16_bf16 v[74:89], a[204:207], v[132:135], v[74:89]
s_waitcnt vmcnt(1)
v_mfma_f32_32x32x16_bf16 v[74:89], a[212:215], v[136:139], v[74:89]
s_waitcnt vmcnt(0)
v_mfma_f32_32x32x16_bf16 v[74:89], a[220:223], v[140:143], v[74:89]
v_mfma_f32_32x32x16_bf16 v[58:73], a[128:131], v[144:147], v[58:73]
v_mfma_f32_32x32x16_bf16 v[58:73], a[136:139], v[148:151], v[58:73]
s_nop 9
ds_write_b128 v91, v[74:77] offset:0
v_mfma_f32_32x32x16_bf16 v[58:73], a[144:147], v[152:155], v[58:73]
ds_write_b128 v91, v[78:81] offset:1024
v_mfma_f32_32x32x16_bf16 v[58:73], a[152:155], v[156:159], v[58:73]
ds_write_b128 v91, v[82:85] offset:2048
v_mfma_f32_32x32x16_bf16 v[58:73], a[160:163], v[112:115], v[58:73]
ds_write_b128 v91, v[86:89] offset:3072
v_mfma_f32_32x32x16_bf16 v[58:73], a[168:171], v[116:119], v[58:73]
s_waitcnt lgkmcnt(0)
s_barrier
v_mfma_f32_32x32x16_bf16 v[58:73], a[176:179], v[120:123], v[58:73]
ds_read_b128 v[42:45], v90 offset:0
ds_read_b128 v[46:49], v90 offset:1024
ds_read_b128 v[50:53], v90 offset:2048
ds_read_b128 v[54:57], v90 offset:3072
v_mfma_f32_32x32x16_bf16 v[58:73], a[184:187], v[124:127], v[58:73]
ds_read_b128 v[74:77], v90 offset:4096
ds_read_b128 v[78:81], v90 offset:5120
ds_read_b128 v[82:85], v90 offset:6144
ds_read_b128 v[86:89], v90 offset:7168
v_mfma_f32_32x32x16_bf16 v[58:73], a[192:195], v[128:131], v[58:73]
v_mfma_f32_32x32x16_bf16 v[58:73], a[200:203], v[132:135], v[58:73]
s_waitcnt lgkmcnt(0)
v_add_f32 v26, v26, v42
v_add_f32 v27, v27, v43
v_add_f32 v28, v28, v44
v_add_f32 v29, v29, v45
v_add_f32 v30, v30, v46
v_mfma_f32_32x32x16_bf16 v[58:73], a[208:211], v[136:139], v[58:73]
v_add_f32 v31, v31, v47
v_add_f32 v32, v32, v48
v_add_f32 v33, v33, v49
v_add_f32 v34, v34, v50
v_add_f32 v35, v35, v51
v_add_f32 v36, v36, v52
v_mfma_f32_32x32x16_bf16 v[58:73], a[216:219], v[140:143], v[58:73]
v_add_f32 v37, v37, v53
v_add_f32 v38, v38, v54
v_add_f32 v39, v39, v55
v_add_f32 v40, v40, v56
v_add_f32 v41, v41, v57
v_pk_add_f32 v[26:27], v[26:27], v[74:75]
v_pk_add_f32 v[28:29], v[28:29], v[76:77]
v_pk_add_f32 v[30:31], v[30:31], v[78:79]
v_pk_add_f32 v[32:33], v[32:33], v[80:81]
v_pk_add_f32 v[34:35], v[34:35], v[82:83]
v_pk_add_f32 v[36:37], v[36:37], v[84:85]
v_pk_add_f32 v[38:39], v[38:39], v[86:87]
v_pk_add_f32 v[40:41], v[40:41], v[88:89]
v_pk_add_f32 v[26:27], v[26:27], v[58:59]
v_pk_add_f32 v[28:29], v[28:29], v[60:61]
v_pk_add_f32 v[30:31], v[30:31], v[62:63]
v_pk_add_f32 v[32:33], v[32:33], v[64:65]
v_pk_add_f32 v[34:35], v[34:35], v[66:67]
v_pk_add_f32 v[36:37], v[36:37], v[68:69]
v_pk_add_f32 v[38:39], v[38:39], v[70:71]
v_pk_add_f32 v[40:41], v[40:41], v[72:73]
s_barrier
ds_read_b128 v[42:45], v90 offset:8192
ds_read_b128 v[46:49], v90 offset:9216
ds_read_b128 v[50:53], v90 offset:10240
ds_read_b128 v[54:57], v90 offset:11264
s_waitcnt lgkmcnt(3)
v_pk_add_f32 v[26:27], v[26:27], v[42:43]
v_pk_add_f32 v[28:29], v[28:29], v[44:45]
v_cvt_pk_bf16_f32 v18, v26, v27
v_cvt_pk_bf16_f32 v19, v28, v29
s_waitcnt lgkmcnt(2)
v_pk_add_f32 v[30:31], v[30:31], v[46:47]
v_pk_add_f32 v[32:33], v[32:33], v[48:49]
v_cvt_pk_bf16_f32 v20, v30, v31
v_cvt_pk_bf16_f32 v21, v32, v33
s_waitcnt lgkmcnt(1)
v_pk_add_f32 v[34:35], v[34:35], v[50:51]
v_pk_add_f32 v[36:37], v[36:37], v[52:53]
v_cvt_pk_bf16_f32 v22, v34, v35
v_cvt_pk_bf16_f32 v23, v36, v37
s_waitcnt lgkmcnt(0)
v_pk_add_f32 v[38:39], v[38:39], v[54:55]
v_pk_add_f32 v[40:41], v[40:41], v[56:57]
v_cvt_pk_bf16_f32 v24, v38, v39
v_cvt_pk_bf16_f32 v25, v40, v41
v_and_b32 v92, 31, v0
v_mul_u32_u24 v92, 896, v92
v_lshrrev_b32 v93, 5, v0
v_lshl_add_u32 v92, v93, 4, v92
buffer_store_dwordx4 v[18:21], v92, s[28:31], s76 offen
buffer_store_dwordx4 v[22:25], v92, s[28:31], s76 offen offset:32
LJ_271:
LR_258:
s_endpgm
LS_178:
s_sub_u32 s37, s37, 1
s_cmp_lt_i32 s37, 0
s_cbranch_scc1 LD_179
buffer_load_dword v107, v4, s[4:7], s40 offen sc1
s_waitcnt vmcnt(0)
s_branch LC_177
LS_181:
s_sub_u32 s37, s37, 1
s_cmp_lt_i32 s37, 0
s_cbranch_scc1 LD_182
buffer_load_dword v107, v4, s[4:7], s40 offen sc1
s_waitcnt vmcnt(0)
s_branch LC_180
LS_265:
s_sub_u32 s37, s37, 1
s_cmp_lt_i32 s37, 0
s_cbranch_scc1 LD_266
buffer_load_dword v107, v4, s[4:7], s40 offen sc1
s_waitcnt vmcnt(0)
s_branch LC_264
LS_268:
s_sub_u32 s37, s37, 1
s_cmp_lt_i32 s37, 0
s_cbranch_scc1 LD_269
buffer_load_dword v107, v4, s[4:7], s40 offen sc1
s_waitcnt vmcnt(0)
s_branch LC_267
LS_211:
s_cmp_lt_i32 s37, 0
s_cbranch_scc1 LO_212
s_call_b64 s[98:99], LK_191
s_branch LC_210
LS_214:
s_cmp_lt_i32 s37, 0
s_cbranch_scc1 LO_215
s_call_b64 s[98:99], LK_191
s_branch LC_213
LS_217:
s_cmp_lt_i32 s37, 0
s_cbranch_scc1 LO_218
s_call_b64 s[98:99], LK_191
s_branch LC_216
LS_220:
s_cmp_lt_i32 s37, 0
s_cbranch_scc1 LO_221
s_call_b64 s[98:99], LK_191
s_branch LC_219
LS_223:
s_cmp_lt_i32 s37, 0
s_cbranch_scc1 LO_224
s_call_b64 s[98:99], LK_191
s_branch LC_222
LS_226:
s_cmp_lt_i32 s37, 0
s_cbranch_scc1 LO_227
s_call_b64 s[98:99], LK_191
s_branch LC_225
LS_229:
s_cmp_lt_i32 s37, 0
s_cbranch_scc1 LO_230
s_call_b64 s[98:99], LK_191
s_branch LC_228
LS_232:
s_cmp_lt_i32 s37, 0
s_cbranch_scc1 LO_233
s_call_b64 s[98:99], LK_191
s_branch LC_231
LS_235:
s_cmp_lt_i32 s37, 0
s_cbranch_scc1 LO_236
s_call_b64 s[98:99], LK_191
s_branch LC_234
LS_238:
s_cmp_lt_i32 s37, 0
s_cbranch_scc1 LO_239
s_call_b64 s[98:99], LK_191
s_branch LC_237
LS_241:
s_cmp_lt_i32 s37, 0
s_cbranch_scc1 LO_242
s_call_b64 s[98:99], LK_191
s_branch LC_240
LS_244:
s_cmp_lt_i32 s37, 0
s_cbranch_scc1 LO_245
s_call_b64 s[98:99], LK_191
s_branch LC_243
LS_247:
s_cmp_lt_i32 s37, 0
s_cbranch_scc1 LO_248
s_call_b64 s[98:99], LK_191
s_branch LC_246
LS_250:
s_cmp_lt_i32 s37, 0
s_cbranch_scc1 LO_251
s_call_b64 s[98:99], LK_191
s_branch LC_249
LS_253:
s_cmp_lt_i32 s37, 0
s_cbranch_scc1 LO_254
s_call_b64 s[98:99], LK_191
s_branch LC_252
LS_256:
s_cmp_lt_i32 s37, 0
s_cbranch_scc1 LO_257
s_call_b64 s[98:99], LK_191
s_branch LC_255
LK_191:
s_waitcnt vmcnt(0)
LL_192:
s_mov_b32 s68, 0
v_max_u32 v94, v28, v29
v_cmp_eq_u32 vcc, -1, v94
s_cbranch_vccz LN_194
s_add_u32 s63, s43, 0
buffer_load_dwordx2 v[28:29], v160, s[4:7], s63 offen sc1
s_mov_b32 s68, 1
LN_194:
v_max_u32 v94, v30, v31
v_cmp_eq_u32 vcc, -1, v94
s_cbranch_vccz LN_195
s_add_u32 s63, s43, 512
buffer_load_dwordx2 v[30:31], v160, s[4:7], s63 offen sc1
s_mov_b32 s68, 1
LN_195:
v_max_u32 v94, v32, v33
v_cmp_eq_u32 vcc, -1, v94
s_cbranch_vccz LN_196
s_add_u32 s63, s43, 1024
buffer_load_dwordx2 v[32:33], v160, s[4:7], s63 offen sc1
s_mov_b32 s68, 1
LN_196:
v_max_u32 v94, v34, v35
v_cmp_eq_u32 vcc, -1, v94
s_cbranch_vccz LN_197
s_add_u32 s63, s43, 1536
buffer_load_dwordx2 v[34:35], v160, s[4:7], s63 offen sc1
s_mov_b32 s68, 1
LN_197:
v_max_u32 v94, v36, v37
v_cmp_eq_u32 vcc, -1, v94
s_cbranch_vccz LN_198
s_add_u32 s63, s43, 2048
buffer_load_dwordx2 v[36:37], v160, s[4:7], s63 offen sc1
s_mov_b32 s68, 1
LN_198:
v_max_u32 v94, v38, v39
v_cmp_eq_u32 vcc, -1, v94
s_cbranch_vccz LN_199
s_add_u32 s63, s43, 2560
buffer_load_dwordx2 v[38:39], v160, s[4:7], s63 offen sc1
s_mov_b32 s68, 1
LN_199:
v_max_u32 v94, v40, v41
v_cmp_eq_u32 vcc, -1, v94
s_cbranch_vccz LN_200
s_add_u32 s63, s43, 3072
buffer_load_dwordx2 v[40:41], v160, s[4:7], s63 offen sc1
s_mov_b32 s68, 1
LN_200:
v_max_u32 v94, v42, v43
v_cmp_eq_u32 vcc, -1, v94
s_cbranch_vccz LN_201
s_add_u32 s63, s43, 3584
buffer_load_dwordx2 v[42:43], v160, s[4:7], s63 offen sc1
s_mov_b32 s68, 1
LN_201:
v_max_u32 v94, v44, v45
v_cmp_eq_u32 vcc, -1, v94
s_cbranch_vccz LN_202
s_add_u32 s63, s43, 4096
buffer_load_dwordx2 v[44:45], v160, s[4:7], s63 offen sc1
s_mov_b32 s68, 1
LN_202:
v_max_u32 v94, v46, v47
v_cmp_eq_u32 vcc, -1, v94
s_cbranch_vccz LN_203
s_add_u32 s63, s43, 4608
buffer_load_dwordx2 v[46:47], v160, s[4:7], s63 offen sc1
s_mov_b32 s68, 1
LN_203:
v_max_u32 v94, v48, v49
v_cmp_eq_u32 vcc, -1, v94
s_cbranch_vccz LN_204
s_add_u32 s63, s43, 5120
buffer_load_dwordx2 v[48:49], v160, s[4:7], s63 offen sc1
s_mov_b32 s68, 1
LN_204:
v_max_u32 v94, v50, v51
v_cmp_eq_u32 vcc, -1, v94
s_cbranch_vccz LN_205
s_add_u32 s63, s43, 5632
buffer_load_dwordx2 v[50:51], v160, s[4:7], s63 offen sc1
s_mov_b32 s68, 1
LN_205:
v_max_u32 v94, v52, v53
v_cmp_eq_u32 vcc, -1, v94
s_cbranch_vccz LN_206
s_add_u32 s63, s43, 6144
buffer_load_dwordx2 v[52:53], v160, s[4:7], s63 offen sc1
s_mov_b32 s68, 1
LN_206:
v_max_u32 v94, v54, v55
v_cmp_eq_u32 vcc, -1, v94
s_cbranch_vccz LN_207
s_add_u32 s63, s43, 6656
buffer_load_dwordx2 v[54:55], v160, s[4:7], s63 offen sc1
s_mov_b32 s68, 1
LN_207:
v_max_u32 v94, v56, v57
v_cmp_eq_u32 vcc, -1, v94
s_cbranch_vccz LN_208
s_add_u32 s63, s43, 7168
buffer_load_dwordx2 v[56:57], v160, s[4:7], s63 offen sc1
s_mov_b32 s68, 1
LN_208:
v_max_u32 v94, v26, v27
v_cmp_eq_u32 vcc, -1, v94
s_cbranch_vccz LN_209
s_add_u32 s63, s43, 7680
buffer_load_dwordx2 v[26:27], v160, s[4:7], s63 offen sc1
s_mov_b32 s68, 1
LN_209:
s_cmp_eq_u32 s68, 0
s_cbranch_scc1 LT_193
s_sub_u32 s37, s37, 1
s_waitcnt vmcnt(0)
s_cmp_ge_i32 s37, 0
s_cbranch_scc1 LL_192
LT_193:
s_setpc_b64 s[98:99]
L_end:
s_endpgm
.section .rodata,"a"
.p2align 6
.amdhsa_kernel interleave_layers__linear_attn_block__dense_activation_silu__prompt_kernel
  .amdhsa_next_free_vgpr 512
  .amdhsa_next_free_sgpr 102
  .amdhsa_accum_offset 256
  .amdhsa_group_segment_fixed_size 0
  .amdhsa_kernarg_size 72
  .amdhsa_user_sgpr_count 2
  .amdhsa_user_sgpr_kernarg_segment_ptr 1
  .amdhsa_system_sgpr_workgroup_id_x 1
  .amdhsa_float_denorm_mode_32 3
.end_amdhsa_kernel
```
